```python
import torch

def _softmax(x, axis=-1):
    return torch.softmax(x, dim=axis)

def _gelu(x):
    return torch.nn.functional.gelu(x, approximate='tanh')

def _silu(x):
    return torch.nn.functional.silu(x)

def _sigmoid(x):
    return torch.sigmoid(x)

def _layernorm(x, axis=-1, eps=1e-05):
    m = x.mean(dim=axis, keepdim=True)
    v = x.var(dim=axis, keepdim=True, unbiased=False)
    return (x - m) / torch.sqrt(v + eps)

def _scatter_add(tgt, idx, src, axis=0):
    return tgt.clone().index_add_(axis, idx, src)

def _segment_sum(src, seg, n):
    out = torch.zeros((n,) + src.shape[1:], dtype=src.dtype)
    return out.index_add_(0, seg, src)

def _pad(x, pw):
    flat = tuple((v for pair in reversed(pw) for v in pair))
    return torch.nn.functional.pad(x, flat)
kernel_name = 'sequential_preLN__memory_aug_recurrent_mem_tr__glu_gated_swiglu__prompt'

def setup_inputs():

    _w = lambda a: (lambda t: t.to(torch.bfloat16) if t.is_floating_point() else t)(torch.as_tensor(a))

    def _A_setup():
        B, S, Dm = (1, 2048, 1024)
        H, Dh = (32, 128)
        M, seg = (8, 32)
        seg = min(seg, S)
        S = S // seg * seg
        return {'x': _w((lambda *s: torch.randn(*s, dtype=torch.bfloat16) * 0.05)(B, S, Dm)), 'mem0': _w((lambda *s: torch.randn(*s, dtype=torch.bfloat16) * 0.2)(B, M, Dm)), 'Wq': _w((lambda *s: torch.randn(*s, dtype=torch.bfloat16) * 1.6)(Dm, H, Dh) * Dm ** (-0.5)), 'Wk': _w((lambda *s: torch.randn(*s, dtype=torch.bfloat16) * 1.6)(Dm, H, Dh) * Dm ** (-0.5)), 'Wv': _w((lambda *s: torch.randn(*s, dtype=torch.bfloat16) * 0.2)(Dm, H, Dh) * Dm ** (-0.5)), 'Wo': _w((lambda *s: torch.randn(*s, dtype=torch.bfloat16) * 0.2)(H, Dh, Dm) * (H * Dh) ** (-0.5)), 'seg_len': seg}
    _A_in = _A_setup()

    def _B_setup():
        B, S, D, F = (1, 2048, 1024, 3584)
        return {'x': _w((lambda *s: torch.randn(*s, dtype=torch.bfloat16) * 0.05)(B, S, D)), 'w1': _w((lambda *s: torch.randn(*s, dtype=torch.bfloat16) * 0.2)(D, F) * (2.0 / D) ** 0.5), 'w3': _w((lambda *s: torch.randn(*s, dtype=torch.bfloat16) * 0.2)(D, F) * (2.0 / D) ** 0.5), 'w2': _w((lambda *s: torch.randn(*s, dtype=torch.bfloat16) * 0.2)(F, D) * (2.0 / F) ** 0.5)}
    _B_in = _B_setup()
    return {'A_x': _A_in['x'], 'A_mem0': _A_in['mem0'], 'A_Wq': _A_in['Wq'], 'A_Wk': _A_in['Wk'], 'A_Wv': _A_in['Wv'], 'A_Wo': _A_in['Wo'], 'A_seg_len': _A_in['seg_len'], 'B_x': _B_in['x'], 'B_w1': _B_in['w1'], 'B_w3': _B_in['w3'], 'B_w2': _B_in['w2']}

def reference(A_x, A_mem0, A_Wq, A_Wk, A_Wv, A_Wo, A_seg_len, B_x, B_w1, B_w3, B_w2):

    def _A_ref(x, mem0, Wq, Wk, Wv, Wo, seg_len):
        B, S, Dm = x.shape
        H, Dh = (Wq.shape[1], Wq.shape[2])
        M = mem0.shape[1]
        scale = Dh ** (-0.5)
        n_seg = S // seg_len
        L = M + seg_len
        idx = torch.arange(L)
        mask = (idx[:, None] < M) | (idx[:, None] >= idx[None, :])
        mem = mem0
        outs = []
        for s in range(n_seg):
            xs = x[:, s * seg_len:(s + 1) * seg_len, :].clone()
            h = torch.concatenate([mem, xs], axis=1)
            q = torch.einsum('btd,dhe->bhte', h, Wq)
            k = torch.einsum('btd,dhe->bhte', h, Wk)
            v = torch.einsum('btd,dhe->bhte', h, Wv)
            scores = torch.einsum('bhqe,bhke->bhqk', q, k) * scale
            scores = torch.where(mask[None, None], scores, -1000000000.0)
            p = _softmax(scores, axis=-1)
            o = torch.einsum('bhqk,bhke->bhqe', p, v)
            o = torch.einsum('bhte,hed->btd', o, Wo)
            mem = o[:, :M, :].clone()
            outs.append(o[:, M:, :])
        return torch.concatenate(outs, axis=1)

    def _B_ref(x, w1, w3, w2):
        gate = torch.einsum('bsd,df->bsf', x, w1)
        up = torch.einsum('bsd,df->bsf', x, w3)
        h = _silu(gate) * up
        out = torch.einsum('bsf,fd->bsd', h, w2)
        return out
    x = A_x
    h = x + _A_ref(_layernorm(x, axis=-1), A_mem0, A_Wq, A_Wk, A_Wv, A_Wo, A_seg_len)
    h2 = h + _B_ref(_layernorm(h, axis=-1), B_w1, B_w3, B_w2)
    return h2
```

```asm
; @launch grid=(256,1,1) block=(256,1,1) lds=163840
.amdgcn_target "amdgcn-amd-amdhsa--gfx950"
.text
.globl sequential_preLN__memory_aug_recurrent_mem_tr__glu_gated_swiglu__prompt_kernel
.p2align 8
.type sequential_preLN__memory_aug_recurrent_mem_tr__glu_gated_swiglu__prompt_kernel,@function
sequential_preLN__memory_aug_recurrent_mem_tr__glu_gated_swiglu__prompt_kernel:
  s_cmp_ge_u32 s2, 256
  s_cbranch_scc1 k_exit_1
  s_load_dwordx2 s[4:5], s[0:1], 104
  s_load_dwordx2 s[60:61], s[0:1], 96
  s_load_dwordx2 s[44:45], s[0:1], 16
  v_lshrrev_b32 v1, 6, v0
  s_nop 0
  v_readfirstlane_b32 s14, v1
  s_waitcnt lgkmcnt(0)
  s_mov_b32 s6, 268435456
  s_mov_b32 s7, 0x00020000
  s_mov_b32 s62, 256
  s_mov_b32 s63, 0x00020000
  s_cmp_lg_u32 s14, 0
  s_cbranch_scc1 role_w_3
  s_getreg_b32 s40, hwreg(HW_REG_XCC_ID, 0, 4)
  s_and_b32 s40, s40, 7
  s_lshl_b32 s23, s40, 5
  v_mov_b32 v2, s23
  v_mov_b32 v3, 1
  s_mov_b64 exec, 1
  buffer_atomic_add v3, v2, s[60:63], 0 offen offset:0 sc0 sc1
  s_waitcnt vmcnt(0)
  v_readfirstlane_b32 s41, v3
  s_mov_b64 exec, -1
  s_mov_b32 s42, 0x40000
  v_and_b32 v4, 7, v0
  v_lshlrev_b32 v4, 5, v4
  s_cmp_ge_u32 s41, 32
  s_cbranch_scc1 role_ov_5
  s_lshl_b32 s31, s40, 5
  s_add_u32 s31, s31, s41
  s_mov_b32 s30, 0
  s_cmp_ge_u32 s40, 2
  s_cbranch_scc1 role_pub_7
  s_branch role_pub_7
role_p_8:
  buffer_load_dword v5, v4, s[60:63], 0 offen offset:0 sc1
  s_waitcnt vmcnt(0)
  v_readlane_b32 s44, v5, 0
  v_readlane_b32 s45, v5, 1
  v_readlane_b32 s46, v5, 2
  v_readlane_b32 s47, v5, 3
  v_readlane_b32 s48, v5, 4
  v_readlane_b32 s49, v5, 5
  v_readlane_b32 s50, v5, 6
  v_readlane_b32 s51, v5, 7
  s_add_u32 s23, s44, s45
  s_add_u32 s23, s23, s46
  s_add_u32 s23, s23, s47
  s_add_u32 s23, s23, s48
  s_add_u32 s23, s23, s49
  s_add_u32 s23, s23, s50
  s_add_u32 s23, s23, s51
  s_min_u32 s24, s44, s45
  s_cmp_ge_u32 s24, 32
  s_cbranch_scc1 role_l_9
  s_cmp_ge_u32 s23, 256
  s_cbranch_scc1 role_pub_7
  s_cmp_eq_u32 s42, 0
  s_cbranch_scc1 role_pub_7
  s_sub_u32 s42, s42, 1
  s_branch role_p_8
role_l_9:
  s_mov_b32 s30, 1
  s_branch role_pub_7
role_ov_5:
  v_mov_b32 v2, 16
  v_mov_b32 v3, 1
  s_mov_b64 exec, 1
  buffer_atomic_add v3, v2, s[60:63], 0 offen offset:0 sc0 sc1
  s_waitcnt vmcnt(0)
  v_readfirstlane_b32 s41, v3
  s_mov_b64 exec, -1
role_p2_10:
  buffer_load_dword v5, v4, s[60:63], 0 offen offset:0 sc1
  s_waitcnt vmcnt(0)
  v_readlane_b32 s44, v5, 0
  v_readlane_b32 s45, v5, 1
  v_readlane_b32 s46, v5, 2
  v_readlane_b32 s47, v5, 3
  v_readlane_b32 s48, v5, 4
  v_readlane_b32 s49, v5, 5
  v_readlane_b32 s50, v5, 6
  v_readlane_b32 s51, v5, 7
  s_add_u32 s23, s44, s45
  s_add_u32 s23, s23, s46
  s_add_u32 s23, s23, s47
  s_add_u32 s23, s23, s48
  s_add_u32 s23, s23, s49
  s_add_u32 s23, s23, s50
  s_add_u32 s23, s23, s51
  s_cmp_ge_u32 s23, 256
  s_cbranch_scc1 role_h_11
  s_cmp_eq_u32 s42, 0
  s_cbranch_scc1 role_h_11
  s_sub_u32 s42, s42, 1
  s_branch role_p2_10
role_h_11:
  s_mov_b32 s30, 0
  s_mov_b32 s31, 255
  s_min_u32 s24, s44, 32
  s_sub_u32 s25, 32, s24
  s_cmp_ge_u32 s41, s25
  s_cbranch_scc1 role_n_12
  s_add_u32 s31, s24, s41
  s_add_u32 s31, s31, 0
  s_branch role_pub_7
role_n_12:
  s_sub_u32 s41, s41, s25
  s_min_u32 s24, s45, 32
  s_sub_u32 s25, 32, s24
  s_cmp_ge_u32 s41, s25
  s_cbranch_scc1 role_n_13
  s_add_u32 s31, s24, s41
  s_add_u32 s31, s31, 32
  s_branch role_pub_7
role_n_13:
  s_sub_u32 s41, s41, s25
  s_min_u32 s24, s46, 32
  s_sub_u32 s25, 32, s24
  s_cmp_ge_u32 s41, s25
  s_cbranch_scc1 role_n_14
  s_add_u32 s31, s24, s41
  s_add_u32 s31, s31, 64
  s_branch role_pub_7
role_n_14:
  s_sub_u32 s41, s41, s25
  s_min_u32 s24, s47, 32
  s_sub_u32 s25, 32, s24
  s_cmp_ge_u32 s41, s25
  s_cbranch_scc1 role_n_15
  s_add_u32 s31, s24, s41
  s_add_u32 s31, s31, 96
  s_branch role_pub_7
role_n_15:
  s_sub_u32 s41, s41, s25
  s_min_u32 s24, s48, 32
  s_sub_u32 s25, 32, s24
  s_cmp_ge_u32 s41, s25
  s_cbranch_scc1 role_n_16
  s_add_u32 s31, s24, s41
  s_add_u32 s31, s31, 128
  s_branch role_pub_7
role_n_16:
  s_sub_u32 s41, s41, s25
  s_min_u32 s24, s49, 32
  s_sub_u32 s25, 32, s24
  s_cmp_ge_u32 s41, s25
  s_cbranch_scc1 role_n_17
  s_add_u32 s31, s24, s41
  s_add_u32 s31, s31, 160
  s_branch role_pub_7
role_n_17:
  s_sub_u32 s41, s41, s25
  s_min_u32 s24, s50, 32
  s_sub_u32 s25, 32, s24
  s_cmp_ge_u32 s41, s25
  s_cbranch_scc1 role_n_18
  s_add_u32 s31, s24, s41
  s_add_u32 s31, s31, 192
  s_branch role_pub_7
role_n_18:
  s_sub_u32 s41, s41, s25
  s_min_u32 s24, s51, 32
  s_sub_u32 s25, 32, s24
  s_cmp_ge_u32 s41, s25
  s_cbranch_scc1 role_n_19
  s_add_u32 s31, s24, s41
  s_add_u32 s31, s31, 224
  s_branch role_pub_7
role_n_19:
  s_sub_u32 s41, s41, s25
role_pub_7:
  v_mov_b32 v2, s31
  v_mov_b32 v3, s30
  v_mov_b32 v4, 16384
  ds_write_b64 v4, v[2:3]
  s_waitcnt lgkmcnt(0)
  s_branch role_x_20
role_w_3:
  s_cmp_lg_u32 s14, 1
  s_cbranch_scc1 prb_21
  s_getreg_b32 s41, hwreg(HW_REG_XCC_ID, 0, 4)
  s_and_b32 s41, s41, 7
  s_cmp_lg_u32 s41, 2
  s_cbranch_scc1 prb_21
  s_and_b32 s41, s2, 31
  s_lshl_b32 s41, s41, 14
  s_lshr_b32 s42, s2, 5
  s_and_b32 s42, s42, 7
  s_lshl_b32 s42, s42, 10
  s_add_u32 s41, s41, s42
  s_add_u32 s41, s41, 152567808
  s_mov_b64 exec, 1
  s_waitcnt vmcnt(0)
  s_mov_b32 s48, -1
  s_mov_b32 s49, -1
  s_mov_b32 s43, 0
prbl_22:
  s_memtime s[44:45]
  s_waitcnt lgkmcnt(0)
  buffer_store_dword v4, off, s[4:7], s41 sc1
  s_waitcnt vmcnt(0)
  s_memtime s[46:47]
  s_waitcnt lgkmcnt(0)
  s_sub_u32 s46, s46, s44
  s_min_u32 s48, s48, s46
  s_add_u32 s42, s41, 8192
  s_memtime s[44:45]
  s_waitcnt lgkmcnt(0)
  buffer_store_dword v4, off, s[4:7], s42 sc1
  s_waitcnt vmcnt(0)
  s_memtime s[46:47]
  s_waitcnt lgkmcnt(0)
  s_sub_u32 s46, s46, s44
  s_min_u32 s49, s49, s46
  s_add_u32 s41, s41, 128
  s_add_u32 s43, s43, 1
  s_cmp_lt_u32 s43, 3
  s_cbranch_scc1 prbl_22
  v_mov_b32 v4, 16392
  v_mov_b32 v6, s48
  v_mov_b32 v7, s49
  ds_write_b64 v4, v[6:7]
  s_waitcnt lgkmcnt(0)
  s_mov_b64 exec, -1
prb_21:
role_x_20:
  s_barrier
  v_mov_b32 v4, 16384
  ds_read_b64 v[2:3], v4
  ds_read_b64 v[6:7], v4 offset:8
  s_waitcnt lgkmcnt(0)
  v_readfirstlane_b32 s31, v2
  v_readfirstlane_b32 s30, v3
  s_mov_b32 s56, 0
  s_cmp_lg_u32 s31, 64
  s_cbranch_scc1 role_s_23
  s_getreg_b32 s23, hwreg(HW_REG_XCC_ID, 0, 4)
  s_and_b32 s23, s23, 7
  s_cmp_lg_u32 s23, 2
  s_cbranch_scc1 role_s_23
  v_readfirstlane_b32 s23, v6
  v_readfirstlane_b32 s24, v7
  s_cmp_lt_u32 s24, s23
  s_cselect_b32 s56, 1, 0
role_s_23:
  s_barrier
  s_cmp_ge_u32 s31, 64
  s_cbranch_scc1 gemm_24
  s_lshr_b32 s12, s31, 5
  s_and_b32 s13, s31, 31
  s_mov_b32 s16, s31
  s_mov_b32 s29, 0x40000
  s_mov_b32 s32, 0x00ff00ff
  s_mov_b32 s33, 0x00ff00ff
  s_mov_b32 s36, 0xff00ff00
  s_mov_b32 s37, 0xff00ff00
  s_mov_b32 s38, 0x3e0293ee
  s_mov_b32 s39, 0x3e0293ee
  s_lshl_b32 s23, s12, 14
  s_add_u32 s40, s23, 196608
  s_lshl_b32 s24, s13, 8
  s_add_u32 s42, s40, s24
  s_xor_b32 s41, s42, 0x2000
  s_lshl_b32 s24, s14, 10
  s_add_u32 s40, s40, s24
  s_mov_b32 s34, 0x3f80
  s_mov_b32 s35, 0x3f800000
  s_lshr_b32 s23, s16, 1
  s_lshl_b32 s23, s23, 14
  s_and_b32 s24, s16, 1
  s_lshl_b32 s24, s24, 12
  s_add_u32 s23, s23, s24
  s_lshl_b32 s24, s14, 10
  s_add_u32 s23, s23, s24
  s_add_u32 s28, s23, 150994944
  s_lshr_b32 s23, s16, 2
  s_lshl_b32 s23, s23, 14
  s_and_b32 s24, s16, 3
  s_lshl_b32 s24, s24, 11
  s_add_u32 s23, s23, s24
  s_lshl_b32 s24, s14, 9
  s_add_u32 s23, s23, s24
  s_add_u32 s17, s23, 152043520
  s_mov_b32 s43, s28
  s_xor_b32 s44, s28, 262144
  s_mov_b32 s45, s17
  s_xor_b32 s46, s17, 131072
  s_lshl_b32 s23, s12, 19
  s_add_u32 s23, s23, 1048576
  s_lshl_b32 s24, s13, 13
  s_add_u32 s48, s23, s24
  s_and_b32 s24, s14, 1
  s_lshl_b32 s24, s24, 7
  s_add_u32 s48, s48, s24
  s_add_u32 s41, s41, s24
  s_add_u32 s42, s42, s24
  s_lshl_b32 s24, s14, 16
  s_add_u32 s23, s23, s24
  s_lshl_b32 s24, s13, 8
  s_add_u32 s47, s23, s24
  s_mov_b32 s49, 0
  s_add_u32 s67, s40, 4096
  s_xor_b32 s48, s48, 262144
  s_xor_b32 s41, s41, 0x2000
  s_xor_b32 s42, s42, 0x2000
  s_add_u32 s69, s48, 4096
  s_cmp_eq_u32 s14, 0
  s_cselect_b32 s96, 1, 0
  s_mov_b32 s97, 0
  s_cmp_eq_u32 s12, 0
  s_cselect_b32 s98, s36, 0
  s_cselect_b32 s100, 0, -1
  s_cselect_b32 s58, -1, 0
  s_cselect_b32 s99, s37, 0
  s_cselect_b32 s101, 0, -1
  s_cselect_b32 s59, -1, 0
  s_cmp_eq_u32 s12, 0
  s_mov_b32 s23, 8388608
  s_cselect_b32 s23, 4194304, s23
  s_lshl_b32 s24, s13, 11
  s_add_u32 s23, s23, s24
  s_lshl_b32 s24, s14, 9
  s_add_u32 s51, s23, s24
  s_lshl_b32 s23, s13, 4
  s_add_u32 s50, s23, 130560
  s_lshl_b32 s23, s12, 2
  s_add_u32 s50, s50, s23
  s_cmp_ge_u32 s14, 2
  s_mov_b32 s24, 67108864
  s_cselect_b32 s66, s24, 50331648
  s_lshl_b32 s23, s13, 13
  s_add_u32 s66, s66, s23
  s_and_b32 s23, s14, 1
  s_lshl_b32 s23, s23, 12
  s_add_u32 s66, s66, s23
  s_lshl_b32 s23, s13, 4
  s_cmp_ge_u32 s14, 2
  s_cselect_b32 s24, 8, 4
  s_add_u32 s23, s23, s24
  s_add_u32 s54, s23, 65536
  s_add_u32 s55, s54, 512
  s_mov_b32 s53, 0
  s_mov_b32 s52, 1
  v_and_b32 v1, 63, v0
  v_and_b32 v2, 15, v1
  v_lshrrev_b32 v3, 4, v1
  v_lshlrev_b32 v112, 4, v1
  v_mov_b32 v113, 0x44444444
  v_mov_b32 v4, 0xeeeeeeee
  v_cmp_lt_u32 vcc, 7, v2
  s_nop 1
  v_cndmask_b32 v113, v113, v4, vcc
  v_lshrrev_b32 v4, 2, v1
  v_and_b32 v4, 3, v4
  v_lshl_add_u32 v4, v3, 3, v4
  v_lshlrev_b32 v4, 5, v4
  v_and_b32 v5, 3, v1
  v_lshl_add_u32 v4, v5, 3, v4
  v_add_u32 v114, 16384, v4
  s_lshl_b32 s23, s14, 10
  s_add_u32 s23, s23, 16384
  v_lshlrev_b32 v4, 5, v2
  v_lshl_add_u32 v4, v3, 3, v4
  v_add_u32 v115, s23, v4
  v_lshlrev_b32 v4, 4, v2
  v_lshl_add_u32 v4, v3, 9, v4
  v_add_u32 v116, 0, v4
  s_lshl_b32 s23, s14, 11
  s_add_u32 s23, s23, 8192
  v_add_u32 v117, s23, v4
  s_lshl_b32 s23, s14, 14
  s_add_u32 s23, s23, 24576
  v_add_u32 v118, s23, v112
  v_add_u32 v119, 0x10000, v118
  v_and_b32 v4, 7, v2
  v_lshrrev_b32 v5, 1, v3
  v_lshl_add_u32 v4, v5, 3, v4
  v_lshlrev_b32 v4, 4, v4
  v_and_b32 v6, 1, v3
  v_lshl_add_u32 v122, v6, 3, v4
  s_lshl_b32 s23, s14, 9
  s_add_u32 s23, s23, 20480
  v_add_u32 v120, s23, v122
  s_lshl_b32 s23, s14, 10
  v_add_u32 v122, s23, v114
  v_lshlrev_b32 v4, 13, v5
  v_lshl_add_u32 v4, v2, 4, v4
  v_lshl_add_u32 v121, v6, 14, v4
  v_and_b32 v4, 7, v2
  v_lshlrev_b32 v4, 4, v4
  v_lshl_add_u32 v123, v3, 7, v4
  v_lshl_add_u32 v4, v5, 4, v2
  v_lshlrev_b32 v4, 4, v4
  v_lshl_add_u32 v124, v6, 3, v4
  v_mov_b32 v126, 1
  v_add_u32 v127, 155648, v112
  v_mov_b32 v4, 0xff800000
  v_mov_b32 v111, 0
  v_cmp_gt_u32 vcc, 32, v1
  s_nop 1
  v_cndmask_b32 v111, v111, v4, vcc
  v_mov_b32 v96, 0
  v_mov_b32 v4, 0x3f80
  v_cmp_eq_u32 vcc, 0, v2
  s_nop 1
  v_cndmask_b32 v96, v96, v4, vcc
  v_mov_b32 v4, 0x3f800000
  v_cmp_eq_u32 vcc, 1, v2
  s_nop 1
  v_cndmask_b32 v96, v96, v4, vcc
  v_mov_b32 v97, 0
  v_mov_b32 v4, 0x3f80
  v_cmp_eq_u32 vcc, 2, v2
  s_nop 1
  v_cndmask_b32 v97, v97, v4, vcc
  v_mov_b32 v4, 0x3f800000
  v_cmp_eq_u32 vcc, 3, v2
  s_nop 1
  v_cndmask_b32 v97, v97, v4, vcc
  v_mov_b32 v98, 0
  v_mov_b32 v4, 0x3f80
  v_cmp_eq_u32 vcc, 4, v2
  s_nop 1
  v_cndmask_b32 v98, v98, v4, vcc
  v_mov_b32 v4, 0x3f800000
  v_cmp_eq_u32 vcc, 5, v2
  s_nop 1
  v_cndmask_b32 v98, v98, v4, vcc
  v_mov_b32 v99, 0
  v_mov_b32 v4, 0x3f80
  v_cmp_eq_u32 vcc, 6, v2
  s_nop 1
  v_cndmask_b32 v99, v99, v4, vcc
  v_mov_b32 v4, 0x3f800000
  v_cmp_eq_u32 vcc, 7, v2
  s_nop 1
  v_cndmask_b32 v99, v99, v4, vcc
  v_and_b32 v1, 63, v0
  v_lshrrev_b32 v4, 5, v1
  v_lshlrev_b32 v6, 4, v4
  v_lshrrev_b32 v4, 4, v1
  v_and_b32 v4, 1, v4
  v_lshl_add_u32 v6, v4, 2, v6
  v_lshlrev_b32 v7, 2, v4
  v_lshrrev_b32 v4, 2, v1
  v_and_b32 v4, 1, v4
  v_add_u32 v6, v6, v4
  v_lshl_add_u32 v7, v4, 1, v7
  v_lshrrev_b32 v4, 3, v1
  v_and_b32 v4, 1, v4
  v_lshl_add_u32 v6, v4, 3, v6
  v_lshl_add_u32 v7, v4, 3, v7
  v_lshrrev_b32 v4, 1, v1
  v_and_b32 v4, 1, v4
  v_xor_b32 v4, v4, v7
  v_lshlrev_b32 v4, 4, v4
  v_and_b32 v5, 1, v1
  v_lshl_add_u32 v4, v5, 3, v4
  v_lshl_add_u32 v14, v6, 8, v4
  s_load_dwordx2 s[8:9], s[0:1], 16
  s_waitcnt lgkmcnt(0)
  s_mov_b32 s10, 8388608
  s_mov_b32 s11, 0x00020000
  s_mov_b32 s23, 8192
  v_lshrrev_b32 v4, 4, v1
  v_mul_lo_u32 v5, v4, s23
  v_and_b32 v4, 1, v4
  v_lshlrev_b32 v4, 1, v4
  v_and_b32 v15, 15, v1
  v_xor_b32 v4, v4, v15
  v_xor_b32 v15, 0, v4
  v_lshl_add_u32 v8, v15, 4, v5
  v_xor_b32 v15, 4, v4
  v_lshl_add_u32 v9, v15, 4, v5
  v_xor_b32 v15, 8, v4
  v_lshl_add_u32 v10, v15, 4, v5
  v_xor_b32 v15, 12, v4
  v_lshl_add_u32 v11, v15, 4, v5
  s_lshl_b32 s23, s12, 22
  s_lshl_b32 s24, s14, 19
  s_add_u32 s23, s23, s24
  s_lshl_b32 s24, s13, 8
  s_add_u32 s23, s23, s24
  s_add_u32 s23, s23, 0
  s_lshl_b32 s24, s14, 14
  s_add_u32 s24, s24, 24576
  s_mov_b32 m0, s24
  s_nop 0
  buffer_load_dwordx4 v8, s[8:11], s23 offen lds
  s_add_u32 s23, s23, 32768
  s_add_u32 s24, s24, 1024
  s_mov_b32 m0, s24
  s_nop 0
  buffer_load_dwordx4 v9, s[8:11], s23 offen lds
  s_add_u32 s23, s23, 32768
  s_add_u32 s24, s24, 1024
  s_mov_b32 m0, s24
  s_nop 0
  buffer_load_dwordx4 v10, s[8:11], s23 offen lds
  s_add_u32 s23, s23, 32768
  s_add_u32 s24, s24, 1024
  s_mov_b32 m0, s24
  s_nop 0
  buffer_load_dwordx4 v11, s[8:11], s23 offen lds
  s_add_u32 s23, s23, 32768
  s_add_u32 s24, s24, 1024
  s_mov_b32 m0, s24
  s_nop 0
  buffer_load_dwordx4 v8, s[8:11], s23 offen lds
  s_add_u32 s23, s23, 32768
  s_add_u32 s24, s24, 1024
  s_mov_b32 m0, s24
  s_nop 0
  buffer_load_dwordx4 v9, s[8:11], s23 offen lds
  s_add_u32 s23, s23, 32768
  s_add_u32 s24, s24, 1024
  s_mov_b32 m0, s24
  s_nop 0
  buffer_load_dwordx4 v10, s[8:11], s23 offen lds
  s_add_u32 s23, s23, 32768
  s_add_u32 s24, s24, 1024
  s_mov_b32 m0, s24
  s_nop 0
  buffer_load_dwordx4 v11, s[8:11], s23 offen lds
  s_add_u32 s23, s23, 32768
  s_add_u32 s24, s24, 1024
  s_mov_b32 m0, s24
  s_nop 0
  buffer_load_dwordx4 v8, s[8:11], s23 offen lds
  s_add_u32 s23, s23, 32768
  s_add_u32 s24, s24, 1024
  s_mov_b32 m0, s24
  s_nop 0
  buffer_load_dwordx4 v9, s[8:11], s23 offen lds
  s_add_u32 s23, s23, 32768
  s_add_u32 s24, s24, 1024
  s_mov_b32 m0, s24
  s_nop 0
  buffer_load_dwordx4 v10, s[8:11], s23 offen lds
  s_add_u32 s23, s23, 32768
  s_add_u32 s24, s24, 1024
  s_mov_b32 m0, s24
  s_nop 0
  buffer_load_dwordx4 v11, s[8:11], s23 offen lds
  s_add_u32 s23, s23, 32768
  s_add_u32 s24, s24, 1024
  s_mov_b32 m0, s24
  s_nop 0
  buffer_load_dwordx4 v8, s[8:11], s23 offen lds
  s_add_u32 s23, s23, 32768
  s_add_u32 s24, s24, 1024
  s_mov_b32 m0, s24
  s_nop 0
  buffer_load_dwordx4 v9, s[8:11], s23 offen lds
  s_add_u32 s23, s23, 32768
  s_add_u32 s24, s24, 1024
  s_mov_b32 m0, s24
  s_nop 0
  buffer_load_dwordx4 v10, s[8:11], s23 offen lds
  s_add_u32 s23, s23, 32768
  s_add_u32 s24, s24, 1024
  s_mov_b32 m0, s24
  s_nop 0
  buffer_load_dwordx4 v11, s[8:11], s23 offen lds
  s_lshl_b32 s23, s12, 22
  s_lshl_b32 s24, s14, 19
  s_add_u32 s23, s23, s24
  s_lshl_b32 s24, s13, 8
  s_add_u32 s23, s23, s24
  s_add_u32 s23, s23, 2097152
  s_lshl_b32 s24, s14, 14
  s_add_u32 s24, s24, 90112
  s_mov_b32 m0, s24
  s_nop 0
  buffer_load_dwordx4 v8, s[8:11], s23 offen lds
  s_add_u32 s23, s23, 32768
  s_add_u32 s24, s24, 1024
  s_mov_b32 m0, s24
  s_nop 0
  buffer_load_dwordx4 v9, s[8:11], s23 offen lds
  s_add_u32 s23, s23, 32768
  s_add_u32 s24, s24, 1024
  s_mov_b32 m0, s24
  s_nop 0
  buffer_load_dwordx4 v10, s[8:11], s23 offen lds
  s_add_u32 s23, s23, 32768
  s_add_u32 s24, s24, 1024
  s_mov_b32 m0, s24
  s_nop 0
  buffer_load_dwordx4 v11, s[8:11], s23 offen lds
  s_add_u32 s23, s23, 32768
  s_add_u32 s24, s24, 1024
  s_mov_b32 m0, s24
  s_nop 0
  buffer_load_dwordx4 v8, s[8:11], s23 offen lds
  s_add_u32 s23, s23, 32768
  s_add_u32 s24, s24, 1024
  s_mov_b32 m0, s24
  s_nop 0
  buffer_load_dwordx4 v9, s[8:11], s23 offen lds
  s_add_u32 s23, s23, 32768
  s_add_u32 s24, s24, 1024
  s_mov_b32 m0, s24
  s_nop 0
  buffer_load_dwordx4 v10, s[8:11], s23 offen lds
  s_add_u32 s23, s23, 32768
  s_add_u32 s24, s24, 1024
  s_mov_b32 m0, s24
  s_nop 0
  buffer_load_dwordx4 v11, s[8:11], s23 offen lds
  s_add_u32 s23, s23, 32768
  s_add_u32 s24, s24, 1024
  s_mov_b32 m0, s24
  s_nop 0
  buffer_load_dwordx4 v8, s[8:11], s23 offen lds
  s_add_u32 s23, s23, 32768
  s_add_u32 s24, s24, 1024
  s_mov_b32 m0, s24
  s_nop 0
  buffer_load_dwordx4 v9, s[8:11], s23 offen lds
  s_add_u32 s23, s23, 32768
  s_add_u32 s24, s24, 1024
  s_mov_b32 m0, s24
  s_nop 0
  buffer_load_dwordx4 v10, s[8:11], s23 offen lds
  s_add_u32 s23, s23, 32768
  s_add_u32 s24, s24, 1024
  s_mov_b32 m0, s24
  s_nop 0
  buffer_load_dwordx4 v11, s[8:11], s23 offen lds
  s_add_u32 s23, s23, 32768
  s_add_u32 s24, s24, 1024
  s_mov_b32 m0, s24
  s_nop 0
  buffer_load_dwordx4 v8, s[8:11], s23 offen lds
  s_add_u32 s23, s23, 32768
  s_add_u32 s24, s24, 1024
  s_mov_b32 m0, s24
  s_nop 0
  buffer_load_dwordx4 v9, s[8:11], s23 offen lds
  s_add_u32 s23, s23, 32768
  s_add_u32 s24, s24, 1024
  s_mov_b32 m0, s24
  s_nop 0
  buffer_load_dwordx4 v10, s[8:11], s23 offen lds
  s_add_u32 s23, s23, 32768
  s_add_u32 s24, s24, 1024
  s_mov_b32 m0, s24
  s_nop 0
  buffer_load_dwordx4 v11, s[8:11], s23 offen lds
  s_waitcnt vmcnt(16)
  s_barrier
  s_lshl_b32 s25, s14, 6
  v_xor_b32 v12, s25, v14
  v_add_u32 v12, 24576, v12
  v_xor_b32 v13, 32, v12
  s_waitcnt lgkmcnt(0)
  s_xor_b32 s26, s14, 0
  s_lshl_b32 s26, s26, 14
  v_add_u32 v2, s26, v12
  v_xor_b32 v3, 32, v2
  ds_read_b64_tr_b16 a[0:1], v2 offset:0
  ds_read_b64_tr_b16 a[2:3], v2 offset:512
  ds_read_b64_tr_b16 a[4:5], v2 offset:8192
  ds_read_b64_tr_b16 a[6:7], v2 offset:8704
  ds_read_b64_tr_b16 a[8:9], v3 offset:0
  ds_read_b64_tr_b16 a[10:11], v3 offset:512
  ds_read_b64_tr_b16 a[12:13], v3 offset:8192
  ds_read_b64_tr_b16 a[14:15], v3 offset:8704
  s_waitcnt lgkmcnt(0)
  s_xor_b32 s26, s14, 1
  s_lshl_b32 s26, s26, 14
  v_add_u32 v2, s26, v12
  v_xor_b32 v3, 32, v2
  ds_read_b64_tr_b16 a[16:17], v2 offset:0
  ds_read_b64_tr_b16 a[18:19], v2 offset:512
  ds_read_b64_tr_b16 a[20:21], v2 offset:8192
  ds_read_b64_tr_b16 a[22:23], v2 offset:8704
  s_waitcnt lgkmcnt(4)
  ds_read_b64_tr_b16 a[24:25], v3 offset:0
  ds_read_b64_tr_b16 a[26:27], v3 offset:512
  ds_read_b64_tr_b16 a[28:29], v3 offset:8192
  ds_read_b64_tr_b16 a[30:31], v3 offset:8704
  s_waitcnt lgkmcnt(0)
  s_xor_b32 s26, s14, 2
  s_lshl_b32 s26, s26, 14
  v_add_u32 v2, s26, v12
  v_xor_b32 v3, 32, v2
  ds_read_b64_tr_b16 a[32:33], v2 offset:0
  ds_read_b64_tr_b16 a[34:35], v2 offset:512
  ds_read_b64_tr_b16 a[36:37], v2 offset:8192
  ds_read_b64_tr_b16 a[38:39], v2 offset:8704
  ds_read_b64_tr_b16 a[40:41], v3 offset:0
  ds_read_b64_tr_b16 a[42:43], v3 offset:512
  ds_read_b64_tr_b16 a[44:45], v3 offset:8192
  ds_read_b64_tr_b16 a[46:47], v3 offset:8704
  s_waitcnt lgkmcnt(4)
  s_waitcnt lgkmcnt(0)
  s_xor_b32 s26, s14, 3
  s_lshl_b32 s26, s26, 14
  v_add_u32 v2, s26, v12
  v_xor_b32 v3, 32, v2
  ds_read_b64_tr_b16 a[48:49], v2 offset:0
  ds_read_b64_tr_b16 a[50:51], v2 offset:512
  ds_read_b64_tr_b16 a[52:53], v2 offset:8192
  ds_read_b64_tr_b16 a[54:55], v2 offset:8704
  ds_read_b64_tr_b16 a[56:57], v3 offset:0
  ds_read_b64_tr_b16 a[58:59], v3 offset:512
  ds_read_b64_tr_b16 a[60:61], v3 offset:8192
  ds_read_b64_tr_b16 a[62:63], v3 offset:8704
  s_waitcnt lgkmcnt(0)
  s_barrier
  s_load_dwordx2 s[8:9], s[0:1], 24
  s_waitcnt lgkmcnt(0)
  s_mov_b32 s10, 8388608
  s_mov_b32 s11, 0x00020000
  s_mov_b32 s23, 8192
  v_lshrrev_b32 v4, 4, v1
  v_mul_lo_u32 v5, v4, s23
  v_and_b32 v4, 1, v4
  v_lshlrev_b32 v4, 1, v4
  v_and_b32 v15, 15, v1
  v_xor_b32 v4, v4, v15
  v_xor_b32 v15, 0, v4
  v_lshl_add_u32 v8, v15, 4, v5
  v_xor_b32 v15, 4, v4
  v_lshl_add_u32 v9, v15, 4, v5
  v_xor_b32 v15, 8, v4
  v_lshl_add_u32 v10, v15, 4, v5
  v_xor_b32 v15, 12, v4
  v_lshl_add_u32 v11, v15, 4, v5
  s_lshl_b32 s23, s12, 22
  s_lshl_b32 s24, s14, 19
  s_add_u32 s23, s23, s24
  s_lshl_b32 s24, s13, 8
  s_add_u32 s23, s23, s24
  s_add_u32 s23, s23, 0
  s_lshl_b32 s24, s14, 14
  s_add_u32 s24, s24, 24576
  s_mov_b32 m0, s24
  s_nop 0
  buffer_load_dwordx4 v8, s[8:11], s23 offen lds
  s_add_u32 s23, s23, 32768
  s_add_u32 s24, s24, 1024
  s_mov_b32 m0, s24
  s_nop 0
  buffer_load_dwordx4 v9, s[8:11], s23 offen lds
  s_add_u32 s23, s23, 32768
  s_add_u32 s24, s24, 1024
  s_mov_b32 m0, s24
  s_nop 0
  buffer_load_dwordx4 v10, s[8:11], s23 offen lds
  s_add_u32 s23, s23, 32768
  s_add_u32 s24, s24, 1024
  s_mov_b32 m0, s24
  s_nop 0
  buffer_load_dwordx4 v11, s[8:11], s23 offen lds
  s_add_u32 s23, s23, 32768
  s_add_u32 s24, s24, 1024
  s_mov_b32 m0, s24
  s_nop 0
  buffer_load_dwordx4 v8, s[8:11], s23 offen lds
  s_add_u32 s23, s23, 32768
  s_add_u32 s24, s24, 1024
  s_mov_b32 m0, s24
  s_nop 0
  buffer_load_dwordx4 v9, s[8:11], s23 offen lds
  s_add_u32 s23, s23, 32768
  s_add_u32 s24, s24, 1024
  s_mov_b32 m0, s24
  s_nop 0
  buffer_load_dwordx4 v10, s[8:11], s23 offen lds
  s_add_u32 s23, s23, 32768
  s_add_u32 s24, s24, 1024
  s_mov_b32 m0, s24
  s_nop 0
  buffer_load_dwordx4 v11, s[8:11], s23 offen lds
  s_add_u32 s23, s23, 32768
  s_add_u32 s24, s24, 1024
  s_mov_b32 m0, s24
  s_nop 0
  buffer_load_dwordx4 v8, s[8:11], s23 offen lds
  s_add_u32 s23, s23, 32768
  s_add_u32 s24, s24, 1024
  s_mov_b32 m0, s24
  s_nop 0
  buffer_load_dwordx4 v9, s[8:11], s23 offen lds
  s_add_u32 s23, s23, 32768
  s_add_u32 s24, s24, 1024
  s_mov_b32 m0, s24
  s_nop 0
  buffer_load_dwordx4 v10, s[8:11], s23 offen lds
  s_add_u32 s23, s23, 32768
  s_add_u32 s24, s24, 1024
  s_mov_b32 m0, s24
  s_nop 0
  buffer_load_dwordx4 v11, s[8:11], s23 offen lds
  s_add_u32 s23, s23, 32768
  s_add_u32 s24, s24, 1024
  s_mov_b32 m0, s24
  s_nop 0
  buffer_load_dwordx4 v8, s[8:11], s23 offen lds
  s_add_u32 s23, s23, 32768
  s_add_u32 s24, s24, 1024
  s_mov_b32 m0, s24
  s_nop 0
  buffer_load_dwordx4 v9, s[8:11], s23 offen lds
  s_add_u32 s23, s23, 32768
  s_add_u32 s24, s24, 1024
  s_mov_b32 m0, s24
  s_nop 0
  buffer_load_dwordx4 v10, s[8:11], s23 offen lds
  s_add_u32 s23, s23, 32768
  s_add_u32 s24, s24, 1024
  s_mov_b32 m0, s24
  s_nop 0
  buffer_load_dwordx4 v11, s[8:11], s23 offen lds
  s_waitcnt vmcnt(16)
  s_barrier
  s_lshl_b32 s25, s14, 6
  v_xor_b32 v12, s25, v14
  v_add_u32 v12, 90112, v12
  v_xor_b32 v13, 32, v12
  s_waitcnt lgkmcnt(0)
  s_xor_b32 s26, s14, 0
  s_lshl_b32 s26, s26, 14
  v_add_u32 v2, s26, v12
  v_xor_b32 v3, 32, v2
  ds_read_b64_tr_b16 a[64:65], v2 offset:0
  ds_read_b64_tr_b16 a[66:67], v2 offset:512
  ds_read_b64_tr_b16 a[68:69], v2 offset:8192
  ds_read_b64_tr_b16 a[70:71], v2 offset:8704
  ds_read_b64_tr_b16 a[72:73], v3 offset:0
  ds_read_b64_tr_b16 a[74:75], v3 offset:512
  ds_read_b64_tr_b16 a[76:77], v3 offset:8192
  ds_read_b64_tr_b16 a[78:79], v3 offset:8704
  s_waitcnt lgkmcnt(0)
  s_xor_b32 s26, s14, 1
  s_lshl_b32 s26, s26, 14
  v_add_u32 v2, s26, v12
  v_xor_b32 v3, 32, v2
  ds_read_b64_tr_b16 a[80:81], v2 offset:0
  ds_read_b64_tr_b16 a[82:83], v2 offset:512
  ds_read_b64_tr_b16 a[84:85], v2 offset:8192
  ds_read_b64_tr_b16 a[86:87], v2 offset:8704
  s_waitcnt lgkmcnt(4)
  ds_read_b64_tr_b16 a[88:89], v3 offset:0
  ds_read_b64_tr_b16 a[90:91], v3 offset:512
  ds_read_b64_tr_b16 a[92:93], v3 offset:8192
  ds_read_b64_tr_b16 a[94:95], v3 offset:8704
  s_waitcnt lgkmcnt(0)
  s_xor_b32 s26, s14, 2
  s_lshl_b32 s26, s26, 14
  v_add_u32 v2, s26, v12
  v_xor_b32 v3, 32, v2
  ds_read_b64_tr_b16 a[96:97], v2 offset:0
  ds_read_b64_tr_b16 a[98:99], v2 offset:512
  ds_read_b64_tr_b16 a[100:101], v2 offset:8192
  ds_read_b64_tr_b16 a[102:103], v2 offset:8704
  ds_read_b64_tr_b16 a[104:105], v3 offset:0
  ds_read_b64_tr_b16 a[106:107], v3 offset:512
  ds_read_b64_tr_b16 a[108:109], v3 offset:8192
  ds_read_b64_tr_b16 a[110:111], v3 offset:8704
  s_waitcnt lgkmcnt(4)
  s_waitcnt lgkmcnt(0)
  s_xor_b32 s26, s14, 3
  s_lshl_b32 s26, s26, 14
  v_add_u32 v2, s26, v12
  v_xor_b32 v3, 32, v2
  ds_read_b64_tr_b16 a[112:113], v2 offset:0
  ds_read_b64_tr_b16 a[114:115], v2 offset:512
  ds_read_b64_tr_b16 a[116:117], v2 offset:8192
  ds_read_b64_tr_b16 a[118:119], v2 offset:8704
  ds_read_b64_tr_b16 a[120:121], v3 offset:0
  ds_read_b64_tr_b16 a[122:123], v3 offset:512
  ds_read_b64_tr_b16 a[124:125], v3 offset:8192
  ds_read_b64_tr_b16 a[126:127], v3 offset:8704
  s_waitcnt lgkmcnt(0)
  s_barrier
  s_lshl_b32 s23, s12, 22
  s_lshl_b32 s24, s14, 19
  s_add_u32 s23, s23, s24
  s_lshl_b32 s24, s13, 8
  s_add_u32 s23, s23, s24
  s_add_u32 s23, s23, 2097152
  s_lshl_b32 s24, s14, 14
  s_add_u32 s24, s24, 90112
  s_mov_b32 m0, s24
  s_nop 0
  buffer_load_dwordx4 v8, s[8:11], s23 offen lds
  s_add_u32 s23, s23, 32768
  s_add_u32 s24, s24, 1024
  s_mov_b32 m0, s24
  s_nop 0
  buffer_load_dwordx4 v9, s[8:11], s23 offen lds
  s_add_u32 s23, s23, 32768
  s_add_u32 s24, s24, 1024
  s_mov_b32 m0, s24
  s_nop 0
  buffer_load_dwordx4 v10, s[8:11], s23 offen lds
  s_add_u32 s23, s23, 32768
  s_add_u32 s24, s24, 1024
  s_mov_b32 m0, s24
  s_nop 0
  buffer_load_dwordx4 v11, s[8:11], s23 offen lds
  s_add_u32 s23, s23, 32768
  s_add_u32 s24, s24, 1024
  s_mov_b32 m0, s24
  s_nop 0
  buffer_load_dwordx4 v8, s[8:11], s23 offen lds
  s_add_u32 s23, s23, 32768
  s_add_u32 s24, s24, 1024
  s_mov_b32 m0, s24
  s_nop 0
  buffer_load_dwordx4 v9, s[8:11], s23 offen lds
  s_add_u32 s23, s23, 32768
  s_add_u32 s24, s24, 1024
  s_mov_b32 m0, s24
  s_nop 0
  buffer_load_dwordx4 v10, s[8:11], s23 offen lds
  s_add_u32 s23, s23, 32768
  s_add_u32 s24, s24, 1024
  s_mov_b32 m0, s24
  s_nop 0
  buffer_load_dwordx4 v11, s[8:11], s23 offen lds
  s_add_u32 s23, s23, 32768
  s_add_u32 s24, s24, 1024
  s_mov_b32 m0, s24
  s_nop 0
  buffer_load_dwordx4 v8, s[8:11], s23 offen lds
  s_add_u32 s23, s23, 32768
  s_add_u32 s24, s24, 1024
  s_mov_b32 m0, s24
  s_nop 0
  buffer_load_dwordx4 v9, s[8:11], s23 offen lds
  s_add_u32 s23, s23, 32768
  s_add_u32 s24, s24, 1024
  s_mov_b32 m0, s24
  s_nop 0
  buffer_load_dwordx4 v10, s[8:11], s23 offen lds
  s_add_u32 s23, s23, 32768
  s_add_u32 s24, s24, 1024
  s_mov_b32 m0, s24
  s_nop 0
  buffer_load_dwordx4 v11, s[8:11], s23 offen lds
  s_add_u32 s23, s23, 32768
  s_add_u32 s24, s24, 1024
  s_mov_b32 m0, s24
  s_nop 0
  buffer_load_dwordx4 v8, s[8:11], s23 offen lds
  s_add_u32 s23, s23, 32768
  s_add_u32 s24, s24, 1024
  s_mov_b32 m0, s24
  s_nop 0
  buffer_load_dwordx4 v9, s[8:11], s23 offen lds
  s_add_u32 s23, s23, 32768
  s_add_u32 s24, s24, 1024
  s_mov_b32 m0, s24
  s_nop 0
  buffer_load_dwordx4 v10, s[8:11], s23 offen lds
  s_add_u32 s23, s23, 32768
  s_add_u32 s24, s24, 1024
  s_mov_b32 m0, s24
  s_nop 0
  buffer_load_dwordx4 v11, s[8:11], s23 offen lds
  s_waitcnt vmcnt(16)
  s_barrier
  s_lshl_b32 s25, s14, 6
  v_xor_b32 v12, s25, v14
  v_add_u32 v12, 24576, v12
  v_xor_b32 v13, 32, v12
  s_waitcnt lgkmcnt(0)
  s_xor_b32 s26, s14, 0
  s_lshl_b32 s26, s26, 14
  v_add_u32 v2, s26, v12
  v_xor_b32 v3, 32, v2
  ds_read_b64_tr_b16 a[128:129], v2 offset:0
  ds_read_b64_tr_b16 a[130:131], v2 offset:512
  ds_read_b64_tr_b16 a[132:133], v2 offset:8192
  ds_read_b64_tr_b16 a[134:135], v2 offset:8704
  ds_read_b64_tr_b16 a[136:137], v3 offset:0
  ds_read_b64_tr_b16 a[138:139], v3 offset:512
  ds_read_b64_tr_b16 a[140:141], v3 offset:8192
  ds_read_b64_tr_b16 a[142:143], v3 offset:8704
  s_waitcnt lgkmcnt(0)
  s_xor_b32 s26, s14, 1
  s_lshl_b32 s26, s26, 14
  v_add_u32 v2, s26, v12
  v_xor_b32 v3, 32, v2
  ds_read_b64_tr_b16 a[144:145], v2 offset:0
  ds_read_b64_tr_b16 a[146:147], v2 offset:512
  ds_read_b64_tr_b16 a[148:149], v2 offset:8192
  ds_read_b64_tr_b16 a[150:151], v2 offset:8704
  s_waitcnt lgkmcnt(4)
  ds_read_b64_tr_b16 a[152:153], v3 offset:0
  ds_read_b64_tr_b16 a[154:155], v3 offset:512
  ds_read_b64_tr_b16 a[156:157], v3 offset:8192
  ds_read_b64_tr_b16 a[158:159], v3 offset:8704
  s_waitcnt lgkmcnt(0)
  s_xor_b32 s26, s14, 2
  s_lshl_b32 s26, s26, 14
  v_add_u32 v2, s26, v12
  v_xor_b32 v3, 32, v2
  ds_read_b64_tr_b16 a[160:161], v2 offset:0
  ds_read_b64_tr_b16 a[162:163], v2 offset:512
  ds_read_b64_tr_b16 a[164:165], v2 offset:8192
  ds_read_b64_tr_b16 a[166:167], v2 offset:8704
  ds_read_b64_tr_b16 a[168:169], v3 offset:0
  ds_read_b64_tr_b16 a[170:171], v3 offset:512
  ds_read_b64_tr_b16 a[172:173], v3 offset:8192
  ds_read_b64_tr_b16 a[174:175], v3 offset:8704
  s_waitcnt lgkmcnt(4)
  s_waitcnt lgkmcnt(0)
  s_xor_b32 s26, s14, 3
  s_lshl_b32 s26, s26, 14
  v_add_u32 v2, s26, v12
  v_xor_b32 v3, 32, v2
  ds_read_b64_tr_b16 a[176:177], v2 offset:0
  ds_read_b64_tr_b16 a[178:179], v2 offset:512
  ds_read_b64_tr_b16 a[180:181], v2 offset:8192
  ds_read_b64_tr_b16 a[182:183], v2 offset:8704
  ds_read_b64_tr_b16 a[184:185], v3 offset:0
  ds_read_b64_tr_b16 a[186:187], v3 offset:512
  ds_read_b64_tr_b16 a[188:189], v3 offset:8192
  ds_read_b64_tr_b16 a[190:191], v3 offset:8704
  s_waitcnt lgkmcnt(0)
  s_barrier
  s_load_dwordx2 s[8:9], s[0:1], 40
  s_waitcnt lgkmcnt(0)
  s_mov_b32 s10, 8388608
  s_mov_b32 s11, 0x00020000
  s_mov_b32 s23, 2048
  v_lshrrev_b32 v4, 4, v1
  v_mul_lo_u32 v5, v4, s23
  v_and_b32 v4, 1, v4
  v_lshlrev_b32 v4, 1, v4
  v_and_b32 v15, 15, v1
  v_xor_b32 v4, v4, v15
  v_xor_b32 v15, 0, v4
  v_lshl_add_u32 v8, v15, 4, v5
  v_xor_b32 v15, 4, v4
  v_lshl_add_u32 v9, v15, 4, v5
  v_xor_b32 v15, 8, v4
  v_lshl_add_u32 v10, v15, 4, v5
  v_xor_b32 v15, 12, v4
  v_lshl_add_u32 v11, v15, 4, v5
  s_lshl_b32 s23, s13, 18
  s_lshl_b32 s24, s12, 10
  s_add_u32 s23, s23, s24
  s_lshl_b32 s24, s14, 8
  s_add_u32 s23, s23, s24
  s_add_u32 s23, s23, 0
  s_lshl_b32 s24, s14, 14
  s_add_u32 s24, s24, 24576
  s_mov_b32 m0, s24
  s_nop 0
  buffer_load_dwordx4 v8, s[8:11], s23 offen sc0 sc1 lds
  s_add_u32 s23, s23, 8192
  s_add_u32 s24, s24, 1024
  s_mov_b32 m0, s24
  s_nop 0
  buffer_load_dwordx4 v9, s[8:11], s23 offen sc0 sc1 lds
  s_add_u32 s23, s23, 8192
  s_add_u32 s24, s24, 1024
  s_mov_b32 m0, s24
  s_nop 0
  buffer_load_dwordx4 v10, s[8:11], s23 offen sc0 sc1 lds
  s_add_u32 s23, s23, 8192
  s_add_u32 s24, s24, 1024
  s_mov_b32 m0, s24
  s_nop 0
  buffer_load_dwordx4 v11, s[8:11], s23 offen sc0 sc1 lds
  s_add_u32 s23, s23, 8192
  s_add_u32 s24, s24, 1024
  s_mov_b32 m0, s24
  s_nop 0
  buffer_load_dwordx4 v8, s[8:11], s23 offen sc0 sc1 lds
  s_add_u32 s23, s23, 8192
  s_add_u32 s24, s24, 1024
  s_mov_b32 m0, s24
  s_nop 0
  buffer_load_dwordx4 v9, s[8:11], s23 offen sc0 sc1 lds
  s_add_u32 s23, s23, 8192
  s_add_u32 s24, s24, 1024
  s_mov_b32 m0, s24
  s_nop 0
  buffer_load_dwordx4 v10, s[8:11], s23 offen sc0 sc1 lds
  s_add_u32 s23, s23, 8192
  s_add_u32 s24, s24, 1024
  s_mov_b32 m0, s24
  s_nop 0
  buffer_load_dwordx4 v11, s[8:11], s23 offen sc0 sc1 lds
  s_add_u32 s23, s23, 8192
  s_add_u32 s24, s24, 1024
  s_mov_b32 m0, s24
  s_nop 0
  buffer_load_dwordx4 v8, s[8:11], s23 offen sc0 sc1 lds
  s_add_u32 s23, s23, 8192
  s_add_u32 s24, s24, 1024
  s_mov_b32 m0, s24
  s_nop 0
  buffer_load_dwordx4 v9, s[8:11], s23 offen sc0 sc1 lds
  s_add_u32 s23, s23, 8192
  s_add_u32 s24, s24, 1024
  s_mov_b32 m0, s24
  s_nop 0
  buffer_load_dwordx4 v10, s[8:11], s23 offen sc0 sc1 lds
  s_add_u32 s23, s23, 8192
  s_add_u32 s24, s24, 1024
  s_mov_b32 m0, s24
  s_nop 0
  buffer_load_dwordx4 v11, s[8:11], s23 offen sc0 sc1 lds
  s_add_u32 s23, s23, 8192
  s_add_u32 s24, s24, 1024
  s_mov_b32 m0, s24
  s_nop 0
  buffer_load_dwordx4 v8, s[8:11], s23 offen sc0 sc1 lds
  s_add_u32 s23, s23, 8192
  s_add_u32 s24, s24, 1024
  s_mov_b32 m0, s24
  s_nop 0
  buffer_load_dwordx4 v9, s[8:11], s23 offen sc0 sc1 lds
  s_add_u32 s23, s23, 8192
  s_add_u32 s24, s24, 1024
  s_mov_b32 m0, s24
  s_nop 0
  buffer_load_dwordx4 v10, s[8:11], s23 offen sc0 sc1 lds
  s_add_u32 s23, s23, 8192
  s_add_u32 s24, s24, 1024
  s_mov_b32 m0, s24
  s_nop 0
  buffer_load_dwordx4 v11, s[8:11], s23 offen sc0 sc1 lds
  s_waitcnt vmcnt(16)
  s_barrier
  s_lshl_b32 s25, s14, 6
  v_xor_b32 v12, s25, v14
  v_add_u32 v12, 90112, v12
  v_xor_b32 v13, 32, v12
  s_waitcnt lgkmcnt(0)
  s_xor_b32 s26, s14, 0
  s_lshl_b32 s26, s26, 14
  v_add_u32 v2, s26, v12
  v_xor_b32 v3, 32, v2
  ds_read_b64_tr_b16 a[192:193], v2 offset:0
  ds_read_b64_tr_b16 a[194:195], v2 offset:512
  ds_read_b64_tr_b16 a[196:197], v2 offset:8192
  ds_read_b64_tr_b16 a[198:199], v2 offset:8704
  ds_read_b64_tr_b16 a[200:201], v3 offset:0
  ds_read_b64_tr_b16 a[202:203], v3 offset:512
  ds_read_b64_tr_b16 a[204:205], v3 offset:8192
  ds_read_b64_tr_b16 a[206:207], v3 offset:8704
  s_waitcnt lgkmcnt(0)
  s_xor_b32 s26, s14, 1
  s_lshl_b32 s26, s26, 14
  v_add_u32 v2, s26, v12
  v_xor_b32 v3, 32, v2
  ds_read_b64_tr_b16 a[208:209], v2 offset:0
  ds_read_b64_tr_b16 a[210:211], v2 offset:512
  ds_read_b64_tr_b16 a[212:213], v2 offset:8192
  ds_read_b64_tr_b16 a[214:215], v2 offset:8704
  s_waitcnt lgkmcnt(4)
  ds_read_b64_tr_b16 a[216:217], v3 offset:0
  ds_read_b64_tr_b16 a[218:219], v3 offset:512
  ds_read_b64_tr_b16 a[220:221], v3 offset:8192
  ds_read_b64_tr_b16 a[222:223], v3 offset:8704
  s_waitcnt lgkmcnt(0)
  s_xor_b32 s26, s14, 2
  s_lshl_b32 s26, s26, 14
  v_add_u32 v2, s26, v12
  v_xor_b32 v3, 32, v2
  ds_read_b64_tr_b16 a[224:225], v2 offset:0
  ds_read_b64_tr_b16 a[226:227], v2 offset:512
  ds_read_b64_tr_b16 a[228:229], v2 offset:8192
  ds_read_b64_tr_b16 a[230:231], v2 offset:8704
  ds_read_b64_tr_b16 a[232:233], v3 offset:0
  ds_read_b64_tr_b16 a[234:235], v3 offset:512
  ds_read_b64_tr_b16 a[236:237], v3 offset:8192
  ds_read_b64_tr_b16 a[238:239], v3 offset:8704
  s_waitcnt lgkmcnt(4)
  s_waitcnt lgkmcnt(0)
  s_xor_b32 s26, s14, 3
  s_lshl_b32 s26, s26, 14
  v_add_u32 v2, s26, v12
  v_xor_b32 v3, 32, v2
  ds_read_b64_tr_b16 a[240:241], v2 offset:0
  ds_read_b64_tr_b16 a[242:243], v2 offset:512
  ds_read_b64_tr_b16 a[244:245], v2 offset:8192
  ds_read_b64_tr_b16 a[246:247], v2 offset:8704
  ds_read_b64_tr_b16 a[248:249], v3 offset:0
  ds_read_b64_tr_b16 a[250:251], v3 offset:512
  ds_read_b64_tr_b16 a[252:253], v3 offset:8192
  ds_read_b64_tr_b16 a[254:255], v3 offset:8704
  s_waitcnt lgkmcnt(0)
  s_barrier
  s_lshl_b32 s23, s13, 18
  s_lshl_b32 s24, s12, 10
  s_add_u32 s23, s23, s24
  s_lshl_b32 s24, s14, 8
  s_add_u32 s23, s23, s24
  s_add_u32 s23, s23, 131072
  s_lshl_b32 s24, s14, 14
  s_add_u32 s24, s24, 90112
  s_mov_b32 m0, s24
  s_nop 0
  buffer_load_dwordx4 v8, s[8:11], s23 offen sc0 sc1 lds
  s_add_u32 s23, s23, 8192
  s_add_u32 s24, s24, 1024
  s_mov_b32 m0, s24
  s_nop 0
  buffer_load_dwordx4 v9, s[8:11], s23 offen sc0 sc1 lds
  s_add_u32 s23, s23, 8192
  s_add_u32 s24, s24, 1024
  s_mov_b32 m0, s24
  s_nop 0
  buffer_load_dwordx4 v10, s[8:11], s23 offen sc0 sc1 lds
  s_add_u32 s23, s23, 8192
  s_add_u32 s24, s24, 1024
  s_mov_b32 m0, s24
  s_nop 0
  buffer_load_dwordx4 v11, s[8:11], s23 offen sc0 sc1 lds
  s_add_u32 s23, s23, 8192
  s_add_u32 s24, s24, 1024
  s_mov_b32 m0, s24
  s_nop 0
  buffer_load_dwordx4 v8, s[8:11], s23 offen sc0 sc1 lds
  s_add_u32 s23, s23, 8192
  s_add_u32 s24, s24, 1024
  s_mov_b32 m0, s24
  s_nop 0
  buffer_load_dwordx4 v9, s[8:11], s23 offen sc0 sc1 lds
  s_add_u32 s23, s23, 8192
  s_add_u32 s24, s24, 1024
  s_mov_b32 m0, s24
  s_nop 0
  buffer_load_dwordx4 v10, s[8:11], s23 offen sc0 sc1 lds
  s_add_u32 s23, s23, 8192
  s_add_u32 s24, s24, 1024
  s_mov_b32 m0, s24
  s_nop 0
  buffer_load_dwordx4 v11, s[8:11], s23 offen sc0 sc1 lds
  s_add_u32 s23, s23, 8192
  s_add_u32 s24, s24, 1024
  s_mov_b32 m0, s24
  s_nop 0
  buffer_load_dwordx4 v8, s[8:11], s23 offen sc0 sc1 lds
  s_add_u32 s23, s23, 8192
  s_add_u32 s24, s24, 1024
  s_mov_b32 m0, s24
  s_nop 0
  buffer_load_dwordx4 v9, s[8:11], s23 offen sc0 sc1 lds
  s_add_u32 s23, s23, 8192
  s_add_u32 s24, s24, 1024
  s_mov_b32 m0, s24
  s_nop 0
  buffer_load_dwordx4 v10, s[8:11], s23 offen sc0 sc1 lds
  s_add_u32 s23, s23, 8192
  s_add_u32 s24, s24, 1024
  s_mov_b32 m0, s24
  s_nop 0
  buffer_load_dwordx4 v11, s[8:11], s23 offen sc0 sc1 lds
  s_add_u32 s23, s23, 8192
  s_add_u32 s24, s24, 1024
  s_mov_b32 m0, s24
  s_nop 0
  buffer_load_dwordx4 v8, s[8:11], s23 offen sc0 sc1 lds
  s_add_u32 s23, s23, 8192
  s_add_u32 s24, s24, 1024
  s_mov_b32 m0, s24
  s_nop 0
  buffer_load_dwordx4 v9, s[8:11], s23 offen sc0 sc1 lds
  s_add_u32 s23, s23, 8192
  s_add_u32 s24, s24, 1024
  s_mov_b32 m0, s24
  s_nop 0
  buffer_load_dwordx4 v10, s[8:11], s23 offen sc0 sc1 lds
  s_add_u32 s23, s23, 8192
  s_add_u32 s24, s24, 1024
  s_mov_b32 m0, s24
  s_nop 0
  buffer_load_dwordx4 v11, s[8:11], s23 offen sc0 sc1 lds
  s_waitcnt vmcnt(16)
  s_barrier
  s_lshl_b32 s25, s14, 14
  s_add_u32 s25, s25, 24576
  v_xor_b32 v12, 0, v14
  v_add_u32 v12, s25, v12
  ds_read_b64_tr_b16 v[128:129], v12 offset:0
  ds_read_b64_tr_b16 v[130:131], v12 offset:512
  ds_read_b64_tr_b16 v[132:133], v12 offset:8192
  ds_read_b64_tr_b16 v[134:135], v12 offset:8704
  s_waitcnt lgkmcnt(0)
  v_xor_b32 v12, 32, v14
  v_add_u32 v12, s25, v12
  ds_read_b64_tr_b16 v[144:145], v12 offset:0
  ds_read_b64_tr_b16 v[146:147], v12 offset:512
  ds_read_b64_tr_b16 v[148:149], v12 offset:8192
  ds_read_b64_tr_b16 v[150:151], v12 offset:8704
  s_waitcnt lgkmcnt(0)
  v_xor_b32 v12, 64, v14
  v_add_u32 v12, s25, v12
  ds_read_b64_tr_b16 v[160:161], v12 offset:0
  ds_read_b64_tr_b16 v[162:163], v12 offset:512
  ds_read_b64_tr_b16 v[164:165], v12 offset:8192
  ds_read_b64_tr_b16 v[166:167], v12 offset:8704
  s_waitcnt lgkmcnt(4)
  s_waitcnt lgkmcnt(0)
  v_xor_b32 v12, 96, v14
  v_add_u32 v12, s25, v12
  ds_read_b64_tr_b16 v[176:177], v12 offset:0
  ds_read_b64_tr_b16 v[178:179], v12 offset:512
  ds_read_b64_tr_b16 v[180:181], v12 offset:8192
  ds_read_b64_tr_b16 v[182:183], v12 offset:8704
  s_waitcnt lgkmcnt(0)
  v_xor_b32 v12, 128, v14
  v_add_u32 v12, s25, v12
  ds_read_b64_tr_b16 v[192:193], v12 offset:0
  ds_read_b64_tr_b16 v[194:195], v12 offset:512
  ds_read_b64_tr_b16 v[196:197], v12 offset:8192
  ds_read_b64_tr_b16 v[198:199], v12 offset:8704
  s_waitcnt lgkmcnt(0)
  v_xor_b32 v12, 160, v14
  v_add_u32 v12, s25, v12
  ds_read_b64_tr_b16 v[208:209], v12 offset:0
  ds_read_b64_tr_b16 v[210:211], v12 offset:512
  ds_read_b64_tr_b16 v[212:213], v12 offset:8192
  ds_read_b64_tr_b16 v[214:215], v12 offset:8704
  s_waitcnt lgkmcnt(4)
  s_waitcnt lgkmcnt(0)
  v_xor_b32 v12, 192, v14
  v_add_u32 v12, s25, v12
  ds_read_b64_tr_b16 v[224:225], v12 offset:0
  ds_read_b64_tr_b16 v[226:227], v12 offset:512
  ds_read_b64_tr_b16 v[228:229], v12 offset:8192
  ds_read_b64_tr_b16 v[230:231], v12 offset:8704
  s_waitcnt lgkmcnt(0)
  v_xor_b32 v12, 224, v14
  v_add_u32 v12, s25, v12
  ds_read_b64_tr_b16 v[240:241], v12 offset:0
  ds_read_b64_tr_b16 v[242:243], v12 offset:512
  ds_read_b64_tr_b16 v[244:245], v12 offset:8192
  ds_read_b64_tr_b16 v[246:247], v12 offset:8704
  s_waitcnt lgkmcnt(0)
  s_waitcnt lgkmcnt(0)
  s_barrier
  s_load_dwordx2 s[8:9], s[0:1], 32
  s_waitcnt lgkmcnt(0)
  s_mov_b32 s10, 8388608
  s_mov_b32 s11, 0x00020000
  s_mov_b32 s23, 8192
  v_lshrrev_b32 v4, 4, v1
  v_mul_lo_u32 v5, v4, s23
  v_and_b32 v4, 1, v4
  v_lshlrev_b32 v4, 1, v4
  v_and_b32 v15, 15, v1
  v_xor_b32 v4, v4, v15
  v_xor_b32 v15, 0, v4
  v_lshl_add_u32 v8, v15, 4, v5
  v_xor_b32 v15, 4, v4
  v_lshl_add_u32 v9, v15, 4, v5
  v_xor_b32 v15, 8, v4
  v_lshl_add_u32 v10, v15, 4, v5
  v_xor_b32 v15, 12, v4
  v_lshl_add_u32 v11, v15, 4, v5
  s_lshl_b32 s23, s12, 22
  s_lshl_b32 s24, s14, 19
  s_add_u32 s23, s23, s24
  s_lshl_b32 s24, s13, 8
  s_add_u32 s23, s23, s24
  s_add_u32 s23, s23, 0
  s_lshl_b32 s24, s14, 14
  s_add_u32 s24, s24, 24576
  s_mov_b32 m0, s24
  s_nop 0
  buffer_load_dwordx4 v8, s[8:11], s23 offen lds
  s_add_u32 s23, s23, 32768
  s_add_u32 s24, s24, 1024
  s_mov_b32 m0, s24
  s_nop 0
  buffer_load_dwordx4 v9, s[8:11], s23 offen lds
  s_add_u32 s23, s23, 32768
  s_add_u32 s24, s24, 1024
  s_mov_b32 m0, s24
  s_nop 0
  buffer_load_dwordx4 v10, s[8:11], s23 offen lds
  s_add_u32 s23, s23, 32768
  s_add_u32 s24, s24, 1024
  s_mov_b32 m0, s24
  s_nop 0
  buffer_load_dwordx4 v11, s[8:11], s23 offen lds
  s_add_u32 s23, s23, 32768
  s_add_u32 s24, s24, 1024
  s_mov_b32 m0, s24
  s_nop 0
  buffer_load_dwordx4 v8, s[8:11], s23 offen lds
  s_add_u32 s23, s23, 32768
  s_add_u32 s24, s24, 1024
  s_mov_b32 m0, s24
  s_nop 0
  buffer_load_dwordx4 v9, s[8:11], s23 offen lds
  s_add_u32 s23, s23, 32768
  s_add_u32 s24, s24, 1024
  s_mov_b32 m0, s24
  s_nop 0
  buffer_load_dwordx4 v10, s[8:11], s23 offen lds
  s_add_u32 s23, s23, 32768
  s_add_u32 s24, s24, 1024
  s_mov_b32 m0, s24
  s_nop 0
  buffer_load_dwordx4 v11, s[8:11], s23 offen lds
  s_add_u32 s23, s23, 32768
  s_add_u32 s24, s24, 1024
  s_mov_b32 m0, s24
  s_nop 0
  buffer_load_dwordx4 v8, s[8:11], s23 offen lds
  s_add_u32 s23, s23, 32768
  s_add_u32 s24, s24, 1024
  s_mov_b32 m0, s24
  s_nop 0
  buffer_load_dwordx4 v9, s[8:11], s23 offen lds
  s_add_u32 s23, s23, 32768
  s_add_u32 s24, s24, 1024
  s_mov_b32 m0, s24
  s_nop 0
  buffer_load_dwordx4 v10, s[8:11], s23 offen lds
  s_add_u32 s23, s23, 32768
  s_add_u32 s24, s24, 1024
  s_mov_b32 m0, s24
  s_nop 0
  buffer_load_dwordx4 v11, s[8:11], s23 offen lds
  s_add_u32 s23, s23, 32768
  s_add_u32 s24, s24, 1024
  s_mov_b32 m0, s24
  s_nop 0
  buffer_load_dwordx4 v8, s[8:11], s23 offen lds
  s_add_u32 s23, s23, 32768
  s_add_u32 s24, s24, 1024
  s_mov_b32 m0, s24
  s_nop 0
  buffer_load_dwordx4 v9, s[8:11], s23 offen lds
  s_add_u32 s23, s23, 32768
  s_add_u32 s24, s24, 1024
  s_mov_b32 m0, s24
  s_nop 0
  buffer_load_dwordx4 v10, s[8:11], s23 offen lds
  s_add_u32 s23, s23, 32768
  s_add_u32 s24, s24, 1024
  s_mov_b32 m0, s24
  s_nop 0
  buffer_load_dwordx4 v11, s[8:11], s23 offen lds
  s_waitcnt vmcnt(16)
  s_barrier
  s_lshl_b32 s25, s14, 14
  s_add_u32 s25, s25, 90112
  v_xor_b32 v12, 0, v14
  v_add_u32 v12, s25, v12
  ds_read_b64_tr_b16 v[136:137], v12 offset:0
  ds_read_b64_tr_b16 v[138:139], v12 offset:512
  ds_read_b64_tr_b16 v[140:141], v12 offset:8192
  ds_read_b64_tr_b16 v[142:143], v12 offset:8704
  s_waitcnt lgkmcnt(0)
  v_xor_b32 v12, 32, v14
  v_add_u32 v12, s25, v12
  ds_read_b64_tr_b16 v[152:153], v12 offset:0
  ds_read_b64_tr_b16 v[154:155], v12 offset:512
  ds_read_b64_tr_b16 v[156:157], v12 offset:8192
  ds_read_b64_tr_b16 v[158:159], v12 offset:8704
  s_waitcnt lgkmcnt(0)
  v_xor_b32 v12, 64, v14
  v_add_u32 v12, s25, v12
  ds_read_b64_tr_b16 v[168:169], v12 offset:0
  ds_read_b64_tr_b16 v[170:171], v12 offset:512
  ds_read_b64_tr_b16 v[172:173], v12 offset:8192
  ds_read_b64_tr_b16 v[174:175], v12 offset:8704
  s_waitcnt lgkmcnt(4)
  s_waitcnt lgkmcnt(0)
  v_xor_b32 v12, 96, v14
  v_add_u32 v12, s25, v12
  ds_read_b64_tr_b16 v[184:185], v12 offset:0
  ds_read_b64_tr_b16 v[186:187], v12 offset:512
  ds_read_b64_tr_b16 v[188:189], v12 offset:8192
  ds_read_b64_tr_b16 v[190:191], v12 offset:8704
  s_waitcnt lgkmcnt(0)
  v_xor_b32 v12, 128, v14
  v_add_u32 v12, s25, v12
  ds_read_b64_tr_b16 v[200:201], v12 offset:0
  ds_read_b64_tr_b16 v[202:203], v12 offset:512
  ds_read_b64_tr_b16 v[204:205], v12 offset:8192
  ds_read_b64_tr_b16 v[206:207], v12 offset:8704
  s_waitcnt lgkmcnt(0)
  v_xor_b32 v12, 160, v14
  v_add_u32 v12, s25, v12
  ds_read_b64_tr_b16 v[216:217], v12 offset:0
  ds_read_b64_tr_b16 v[218:219], v12 offset:512
  ds_read_b64_tr_b16 v[220:221], v12 offset:8192
  ds_read_b64_tr_b16 v[222:223], v12 offset:8704
  s_waitcnt lgkmcnt(4)
  s_waitcnt lgkmcnt(0)
  v_xor_b32 v12, 192, v14
  v_add_u32 v12, s25, v12
  ds_read_b64_tr_b16 v[232:233], v12 offset:0
  ds_read_b64_tr_b16 v[234:235], v12 offset:512
  ds_read_b64_tr_b16 v[236:237], v12 offset:8192
  ds_read_b64_tr_b16 v[238:239], v12 offset:8704
  s_waitcnt lgkmcnt(0)
  v_xor_b32 v12, 224, v14
  v_add_u32 v12, s25, v12
  ds_read_b64_tr_b16 v[248:249], v12 offset:0
  ds_read_b64_tr_b16 v[250:251], v12 offset:512
  ds_read_b64_tr_b16 v[252:253], v12 offset:8192
  ds_read_b64_tr_b16 v[254:255], v12 offset:8704
  s_waitcnt lgkmcnt(0)
  s_waitcnt lgkmcnt(0)
  s_barrier
  s_lshl_b32 s23, s12, 22
  s_lshl_b32 s24, s14, 19
  s_add_u32 s23, s23, s24
  s_lshl_b32 s24, s13, 8
  s_add_u32 s23, s23, s24
  s_add_u32 s23, s23, 2097152
  s_lshl_b32 s24, s14, 14
  s_add_u32 s24, s24, 90112
  s_mov_b32 m0, s24
  s_nop 0
  buffer_load_dwordx4 v8, s[8:11], s23 offen lds
  s_add_u32 s23, s23, 32768
  s_add_u32 s24, s24, 1024
  s_mov_b32 m0, s24
  s_nop 0
  buffer_load_dwordx4 v9, s[8:11], s23 offen lds
  s_add_u32 s23, s23, 32768
  s_add_u32 s24, s24, 1024
  s_mov_b32 m0, s24
  s_nop 0
  buffer_load_dwordx4 v10, s[8:11], s23 offen lds
  s_add_u32 s23, s23, 32768
  s_add_u32 s24, s24, 1024
  s_mov_b32 m0, s24
  s_nop 0
  buffer_load_dwordx4 v11, s[8:11], s23 offen lds
  s_add_u32 s23, s23, 32768
  s_add_u32 s24, s24, 1024
  s_mov_b32 m0, s24
  s_nop 0
  buffer_load_dwordx4 v8, s[8:11], s23 offen lds
  s_add_u32 s23, s23, 32768
  s_add_u32 s24, s24, 1024
  s_mov_b32 m0, s24
  s_nop 0
  buffer_load_dwordx4 v9, s[8:11], s23 offen lds
  s_add_u32 s23, s23, 32768
  s_add_u32 s24, s24, 1024
  s_mov_b32 m0, s24
  s_nop 0
  buffer_load_dwordx4 v10, s[8:11], s23 offen lds
  s_add_u32 s23, s23, 32768
  s_add_u32 s24, s24, 1024
  s_mov_b32 m0, s24
  s_nop 0
  buffer_load_dwordx4 v11, s[8:11], s23 offen lds
  s_add_u32 s23, s23, 32768
  s_add_u32 s24, s24, 1024
  s_mov_b32 m0, s24
  s_nop 0
  buffer_load_dwordx4 v8, s[8:11], s23 offen lds
  s_add_u32 s23, s23, 32768
  s_add_u32 s24, s24, 1024
  s_mov_b32 m0, s24
  s_nop 0
  buffer_load_dwordx4 v9, s[8:11], s23 offen lds
  s_add_u32 s23, s23, 32768
  s_add_u32 s24, s24, 1024
  s_mov_b32 m0, s24
  s_nop 0
  buffer_load_dwordx4 v10, s[8:11], s23 offen lds
  s_add_u32 s23, s23, 32768
  s_add_u32 s24, s24, 1024
  s_mov_b32 m0, s24
  s_nop 0
  buffer_load_dwordx4 v11, s[8:11], s23 offen lds
  s_add_u32 s23, s23, 32768
  s_add_u32 s24, s24, 1024
  s_mov_b32 m0, s24
  s_nop 0
  buffer_load_dwordx4 v8, s[8:11], s23 offen lds
  s_add_u32 s23, s23, 32768
  s_add_u32 s24, s24, 1024
  s_mov_b32 m0, s24
  s_nop 0
  buffer_load_dwordx4 v9, s[8:11], s23 offen lds
  s_add_u32 s23, s23, 32768
  s_add_u32 s24, s24, 1024
  s_mov_b32 m0, s24
  s_nop 0
  buffer_load_dwordx4 v10, s[8:11], s23 offen lds
  s_add_u32 s23, s23, 32768
  s_add_u32 s24, s24, 1024
  s_mov_b32 m0, s24
  s_nop 0
  buffer_load_dwordx4 v11, s[8:11], s23 offen lds
  s_waitcnt vmcnt(16)
  s_barrier
  s_lshl_b32 s25, s14, 6
  v_xor_b32 v12, s25, v14
  v_add_u32 v12, 24576, v12
  v_xor_b32 v13, 32, v12
  s_waitcnt lgkmcnt(0)
  s_xor_b32 s26, s14, 0
  s_lshl_b32 s26, s26, 14
  v_add_u32 v2, s26, v12
  v_xor_b32 v3, 32, v2
  ds_read_b64_tr_b16 v[16:17], v2 offset:0
  ds_read_b64_tr_b16 v[18:19], v2 offset:512
  ds_read_b64_tr_b16 v[20:21], v2 offset:8192
  ds_read_b64_tr_b16 v[22:23], v2 offset:8704
  ds_read_b64_tr_b16 v[24:25], v3 offset:0
  ds_read_b64_tr_b16 v[26:27], v3 offset:512
  ds_read_b64_tr_b16 v[28:29], v3 offset:8192
  ds_read_b64_tr_b16 v[30:31], v3 offset:8704
  s_waitcnt lgkmcnt(0)
  s_xor_b32 s26, s14, 1
  s_lshl_b32 s26, s26, 14
  v_add_u32 v2, s26, v12
  v_xor_b32 v3, 32, v2
  ds_read_b64_tr_b16 v[32:33], v2 offset:0
  ds_read_b64_tr_b16 v[34:35], v2 offset:512
  ds_read_b64_tr_b16 v[36:37], v2 offset:8192
  ds_read_b64_tr_b16 v[38:39], v2 offset:8704
  s_waitcnt lgkmcnt(4)
  ds_read_b64_tr_b16 v[40:41], v3 offset:0
  ds_read_b64_tr_b16 v[42:43], v3 offset:512
  ds_read_b64_tr_b16 v[44:45], v3 offset:8192
  ds_read_b64_tr_b16 v[46:47], v3 offset:8704
  s_waitcnt lgkmcnt(0)
  s_xor_b32 s26, s14, 2
  s_lshl_b32 s26, s26, 14
  v_add_u32 v2, s26, v12
  v_xor_b32 v3, 32, v2
  ds_read_b64_tr_b16 v[48:49], v2 offset:0
  ds_read_b64_tr_b16 v[50:51], v2 offset:512
  ds_read_b64_tr_b16 v[52:53], v2 offset:8192
  ds_read_b64_tr_b16 v[54:55], v2 offset:8704
  ds_read_b64_tr_b16 v[56:57], v3 offset:0
  ds_read_b64_tr_b16 v[58:59], v3 offset:512
  ds_read_b64_tr_b16 v[60:61], v3 offset:8192
  ds_read_b64_tr_b16 v[62:63], v3 offset:8704
  s_waitcnt lgkmcnt(4)
  s_waitcnt lgkmcnt(0)
  s_xor_b32 s26, s14, 3
  s_lshl_b32 s26, s26, 14
  v_add_u32 v2, s26, v12
  v_xor_b32 v3, 32, v2
  ds_read_b64_tr_b16 v[64:65], v2 offset:0
  ds_read_b64_tr_b16 v[66:67], v2 offset:512
  ds_read_b64_tr_b16 v[68:69], v2 offset:8192
  ds_read_b64_tr_b16 v[70:71], v2 offset:8704
  ds_read_b64_tr_b16 v[72:73], v3 offset:0
  ds_read_b64_tr_b16 v[74:75], v3 offset:512
  ds_read_b64_tr_b16 v[76:77], v3 offset:8192
  ds_read_b64_tr_b16 v[78:79], v3 offset:8704
  s_waitcnt lgkmcnt(0)
  s_barrier
  ds_write_b128 v118, v[16:19] offset:0
  ds_write_b128 v118, v[20:23] offset:1024
  ds_write_b128 v118, v[24:27] offset:2048
  ds_write_b128 v118, v[28:31] offset:3072
  ds_write_b128 v118, v[32:35] offset:4096
  ds_write_b128 v118, v[36:39] offset:5120
  ds_write_b128 v118, v[40:43] offset:6144
  ds_write_b128 v118, v[44:47] offset:7168
  ds_write_b128 v118, v[48:51] offset:8192
  ds_write_b128 v118, v[52:55] offset:9216
  ds_write_b128 v118, v[56:59] offset:10240
  ds_write_b128 v118, v[60:63] offset:11264
  ds_write_b128 v118, v[64:67] offset:12288
  ds_write_b128 v118, v[68:71] offset:13312
  ds_write_b128 v118, v[72:75] offset:14336
  ds_write_b128 v118, v[76:79] offset:15360
  s_waitcnt lgkmcnt(0)
  s_waitcnt vmcnt(0)
  s_barrier
  s_lshl_b32 s25, s14, 6
  v_xor_b32 v12, s25, v14
  v_add_u32 v12, 90112, v12
  v_xor_b32 v13, 32, v12
  s_waitcnt lgkmcnt(0)
  s_xor_b32 s26, s14, 0
  s_lshl_b32 s26, s26, 14
  v_add_u32 v2, s26, v12
  v_xor_b32 v3, 32, v2
  ds_read_b64_tr_b16 v[16:17], v2 offset:0
  ds_read_b64_tr_b16 v[18:19], v2 offset:512
  ds_read_b64_tr_b16 v[20:21], v2 offset:8192
  ds_read_b64_tr_b16 v[22:23], v2 offset:8704
  ds_read_b64_tr_b16 v[24:25], v3 offset:0
  ds_read_b64_tr_b16 v[26:27], v3 offset:512
  ds_read_b64_tr_b16 v[28:29], v3 offset:8192
  ds_read_b64_tr_b16 v[30:31], v3 offset:8704
  s_waitcnt lgkmcnt(0)
  s_xor_b32 s26, s14, 1
  s_lshl_b32 s26, s26, 14
  v_add_u32 v2, s26, v12
  v_xor_b32 v3, 32, v2
  ds_read_b64_tr_b16 v[32:33], v2 offset:0
  ds_read_b64_tr_b16 v[34:35], v2 offset:512
  ds_read_b64_tr_b16 v[36:37], v2 offset:8192
  ds_read_b64_tr_b16 v[38:39], v2 offset:8704
  s_waitcnt lgkmcnt(4)
  ds_read_b64_tr_b16 v[40:41], v3 offset:0
  ds_read_b64_tr_b16 v[42:43], v3 offset:512
  ds_read_b64_tr_b16 v[44:45], v3 offset:8192
  ds_read_b64_tr_b16 v[46:47], v3 offset:8704
  s_waitcnt lgkmcnt(0)
  s_xor_b32 s26, s14, 2
  s_lshl_b32 s26, s26, 14
  v_add_u32 v2, s26, v12
  v_xor_b32 v3, 32, v2
  ds_read_b64_tr_b16 v[48:49], v2 offset:0
  ds_read_b64_tr_b16 v[50:51], v2 offset:512
  ds_read_b64_tr_b16 v[52:53], v2 offset:8192
  ds_read_b64_tr_b16 v[54:55], v2 offset:8704
  ds_read_b64_tr_b16 v[56:57], v3 offset:0
  ds_read_b64_tr_b16 v[58:59], v3 offset:512
  ds_read_b64_tr_b16 v[60:61], v3 offset:8192
  ds_read_b64_tr_b16 v[62:63], v3 offset:8704
  s_waitcnt lgkmcnt(4)
  s_waitcnt lgkmcnt(0)
  s_xor_b32 s26, s14, 3
  s_lshl_b32 s26, s26, 14
  v_add_u32 v2, s26, v12
  v_xor_b32 v3, 32, v2
  ds_read_b64_tr_b16 v[64:65], v2 offset:0
  ds_read_b64_tr_b16 v[66:67], v2 offset:512
  ds_read_b64_tr_b16 v[68:69], v2 offset:8192
  ds_read_b64_tr_b16 v[70:71], v2 offset:8704
  ds_read_b64_tr_b16 v[72:73], v3 offset:0
  ds_read_b64_tr_b16 v[74:75], v3 offset:512
  ds_read_b64_tr_b16 v[76:77], v3 offset:8192
  ds_read_b64_tr_b16 v[78:79], v3 offset:8704
  s_waitcnt lgkmcnt(0)
  s_barrier
  ds_write_b128 v119, v[16:19] offset:0
  ds_write_b128 v119, v[20:23] offset:1024
  ds_write_b128 v119, v[24:27] offset:2048
  ds_write_b128 v119, v[28:31] offset:3072
  ds_write_b128 v119, v[32:35] offset:4096
  ds_write_b128 v119, v[36:39] offset:5120
  ds_write_b128 v119, v[40:43] offset:6144
  ds_write_b128 v119, v[44:47] offset:7168
  ds_write_b128 v119, v[48:51] offset:8192
  ds_write_b128 v119, v[52:55] offset:9216
  ds_write_b128 v119, v[56:59] offset:10240
  ds_write_b128 v119, v[60:63] offset:11264
  ds_write_b128 v119, v[64:67] offset:12288
  ds_write_b128 v119, v[68:71] offset:13312
  ds_write_b128 v119, v[72:75] offset:14336
  ds_write_b128 v119, v[76:79] offset:15360
  s_waitcnt lgkmcnt(0)
  s_cmp_lg_u32 s14, 0
  s_cbranch_scc1 iw_26
  s_mov_b32 s24, 0x40000
  v_and_b32 v2, 63, v0
  v_subrev_u32 v4, 4, v2
  v_lshlrev_b32 v4, 5, v4
  v_cmp_gt_u32 vcc, 4, v2
  v_lshlrev_b32 v2, 6, v2
  v_add_u32 v2, 8, v2
  v_cndmask_b32 v2, v4, v2, vcc
iwp_27:
  s_mov_b64 exec, 0xfff
  buffer_load_dword v3, v2, s[60:63], 0 offen sc1
  s_mov_b64 exec, -1
  s_waitcnt vmcnt(0)
  v_readlane_b32 s23, v3, 0
  v_readlane_b32 s25, v3, 1
  s_add_u32 s23, s23, s25
  v_readlane_b32 s25, v3, 2
  s_add_u32 s23, s23, s25
  v_readlane_b32 s25, v3, 3
  s_add_u32 s23, s23, s25
  v_readlane_b32 s26, v3, 4
  v_readlane_b32 s25, v3, 5
  s_min_u32 s27, s26, s25
  s_add_u32 s26, s26, s25
  v_readlane_b32 s25, v3, 6
  s_add_u32 s26, s26, s25
  v_readlane_b32 s25, v3, 7
  s_add_u32 s26, s26, s25
  v_readlane_b32 s25, v3, 8
  s_add_u32 s26, s26, s25
  v_readlane_b32 s25, v3, 9
  s_add_u32 s26, s26, s25
  v_readlane_b32 s25, v3, 10
  s_add_u32 s26, s26, s25
  v_readlane_b32 s25, v3, 11
  s_add_u32 s26, s26, s25
  s_cmp_ge_u32 s27, 32
  s_cselect_b32 s30, 1, 0
  s_cselect_b32 s26, 256, s26
  s_and_b32 s25, s23, 0xffff
  s_cmp_ge_u32 s25, 64
  s_cselect_b32 s26, s26, 0
  s_cmp_ge_u32 s26, 256
  s_cbranch_scc1 iwe_28
  s_cmp_eq_u32 s24, 0
  s_cbranch_scc1 iwg_29
  s_sub_u32 s24, s24, 1
  s_branch iwp_27
iwg_29:
  s_mov_b32 s30, 0
iwe_28:
  s_lshr_b32 s23, s23, 16
  s_and_b32 s23, s23, 1
  v_mov_b32 v2, 16384
  v_mov_b32 v3, s23
  v_mov_b32 v4, s30
  ds_write2_b32 v2, v3, v4 offset1:1
  s_waitcnt lgkmcnt(0)
iw_26:
  s_barrier
  v_mov_b32 v2, 16384
  ds_read_b64 v[4:5], v2
  s_waitcnt lgkmcnt(0)
  v_readfirstlane_b32 s30, v5
  v_mov_b32 v3, v4
  s_nop 0
  v_readfirstlane_b32 s23, v3
  s_lshl_b32 s23, s23, 13
  s_xor_b32 s43, s43, s23
  s_xor_b32 s44, s44, s23
  s_xor_b32 s45, s45, s23
  s_xor_b32 s46, s46, s23
  s_mov_b32 s8, 0x01010101
  s_mov_b32 s10, 0x00010001
  s_mov_b32 s9, 0x01010101
  s_mov_b32 s11, 0x00010001
  s_mov_b32 s15, 0
kvc_30:
  s_lshl_b32 s25, s15, 9
  s_add_u32 s25, s25, s54
  buffer_load_dword v125, off, s[4:7], s25 sc1
  s_waitcnt vmcnt(0)
  v_readfirstlane_b32 s26, v125
  s_cmp_lg_u32 s26, 0
  s_cbranch_scc1 kvb_31
  s_cmp_eq_u32 s29, 0
  s_cbranch_scc1 kvb_31
  s_sub_u32 s29, s29, 1
  s_branch kvc_30
kvb_31:
  s_lshl_b32 s27, s15, 18
  s_add_u32 s27, s27, s66
  s_lshl_b32 s24, s14, 12
  s_mov_b32 m0, s24
  s_nop 0
  buffer_load_dwordx4 v112, s[4:7], s27 offen offset:0 sc1 lds
  buffer_load_dwordx4 v112, s[4:7], s27 offen offset:1024 sc1 lds
  buffer_load_dwordx4 v112, s[4:7], s27 offen offset:2048 sc1 lds
  buffer_load_dwordx4 v112, s[4:7], s27 offen offset:3072 sc1 lds
  v_mov_b64 v[32:33], 0
  v_mov_b64 v[34:35], 0
  v_mov_b64 v[36:37], 0
  v_mov_b64 v[38:39], 0
  v_mov_b64 v[40:41], 0
  v_mov_b64 v[42:43], 0
  v_mov_b64 v[44:45], 0
  v_mov_b64 v[46:47], 0
  v_mov_b64 v[48:49], 0
  v_mov_b64 v[50:51], 0
  v_mov_b64 v[52:53], 0
  v_mov_b64 v[54:55], 0
  s_waitcnt vmcnt(0)
  s_barrier
  s_cmp_eq_u32 s30, 0
  s_cbranch_scc1 mode_gl_32
  s_cmp_lg_u32 s12, 0
  s_cbranch_scc1 die1_33
  s_branch step5_34
  .p2alignl 8, 0xbf800000
  s_nop 0
  s_nop 0
  s_nop 0
  s_nop 0
  s_nop 0
  s_nop 0
  s_nop 0
  s_nop 0
  s_nop 0
  s_nop 0
  s_nop 0
  s_nop 0
  s_nop 0
  s_nop 0
  s_nop 0
  s_nop 0
  s_nop 0
  s_nop 0
  s_nop 0
  s_nop 0
  s_nop 0
  s_nop 0
  s_nop 0
  s_nop 0
  s_nop 0
  s_nop 0
  s_nop 0
  s_nop 0
  s_nop 0
  s_nop 0
  s_nop 0
  s_nop 0
  s_nop 0
  s_nop 0
  s_nop 0
  s_nop 0
  s_nop 0
  s_nop 0
  s_nop 0
  s_nop 0
  s_nop 0
  s_nop 0
  s_nop 0
  s_nop 0
  s_nop 0
step5_34:
  ds_read_b128 v[56:59], v118 offset:0
  ds_read_b128 v[60:63], v118 offset:1024
  ds_read_b128 v[64:67], v118 offset:2048
  ds_read_b128 v[68:71], v118 offset:3072
  ds_read_b128 v[72:75], v118 offset:4096
  ds_read_b128 v[76:79], v118 offset:5120
  buffer_load_dwordx4 v[80:83], v112, s[4:7], s40 offen sc1
  buffer_load_dwordx4 v[84:87], v112, s[4:7], s67 offen sc1
  s_lshl_b32 s23, s14, 10
  v_add_u32 v125, s23, v127
  v_xor_b32 v100, 1024, v125
  v_xor_b32 v101, 2048, v125
  v_xor_b32 v102, 3072, v125
  s_xor_b32 s48, s48, 262144
  s_xor_b32 s69, s69, 262144
  s_xor_b32 s41, s41, 0x2000
  s_xor_b32 s42, s42, 0x2000
  s_lshr_b32 s49, s15, 1
  s_and_b32 s49, s49, 1
  buffer_load_dwordx4 v[88:91], v112, s[4:7], s40 offen sc1
  buffer_load_dwordx4 v[92:95], v112, s[4:7], s67 offen sc1
  s_waitcnt vmcnt(2)
  v_max3_u32 v106, v80, v81, v82
  v_max3_u32 v107, v83, v84, v85
  v_max3_u32 v106, v106, v86, v87
  v_max_u32 v106, v106, v107
  v_cmp_eq_u32 vcc, -1, v106
  s_cbranch_vccnz dpra_36
dpoka_39:
  ds_write_b128 v125, v[80:83]
  ds_write_b128 v125, v[84:87] offset:4096
  v_smfmac_f32_16x16x64_bf16 v[32:35], v[80:83], a[0:7], v113
  v_smfmac_f32_16x16x64_bf16 v[40:43], v[80:83], a[128:135], v113
  v_smfmac_f32_16x16x64_bf16 v[36:39], v[80:83], a[8:15], v113
  v_smfmac_f32_16x16x64_bf16 v[44:47], v[80:83], a[136:143], v113
  s_waitcnt lgkmcnt(0)
  s_barrier
  ds_read_b128 v[4:7], v100 offset:0
  ds_read_b128 v[8:11], v101 offset:0
  ds_read_b128 v[12:15], v102 offset:0
  ds_read_b128 v[20:23], v100 offset:4096
  ds_read_b128 v[24:27], v101 offset:4096
  ds_read_b128 v[28:31], v102 offset:4096
  ds_read_b128 v[0:3], v125 offset:0
  ds_read_b128 v[16:19], v125 offset:4096
  v_smfmac_f32_16x16x64_bf16 v[32:35], v[84:87], a[64:71], v113
  s_mov_b64 exec, s[96:97]
  buffer_store_dword v126, off, s[4:7], s50 sc1
  s_mov_b64 exec, -1
  v_smfmac_f32_16x16x64_bf16 v[40:43], v[84:87], a[192:199], v113
  v_smfmac_f32_16x16x64_bf16 v[36:39], v[84:87], a[72:79], v113
  v_smfmac_f32_16x16x64_bf16 v[44:47], v[84:87], a[200:207], v113
dpj_38:
  buffer_load_dword v110, off, s[4:7], s55 sc1
  s_waitcnt lgkmcnt(7)
  v_smfmac_f32_16x16x64_bf16 v[32:35], v[4:7], a[16:23], v113
  v_smfmac_f32_16x16x64_bf16 v[40:43], v[4:7], a[144:151], v113
  v_smfmac_f32_16x16x64_bf16 v[36:39], v[4:7], a[24:31], v113
  v_smfmac_f32_16x16x64_bf16 v[44:47], v[4:7], a[152:159], v113
  s_waitcnt lgkmcnt(6)
  v_smfmac_f32_16x16x64_bf16 v[32:35], v[8:11], a[32:39], v113
  v_smfmac_f32_16x16x64_bf16 v[40:43], v[8:11], a[160:167], v113
  s_waitcnt lgkmcnt(5)
  v_smfmac_f32_16x16x64_bf16 v[32:35], v[12:15], a[48:55], v113
  v_smfmac_f32_16x16x64_bf16 v[40:43], v[12:15], a[176:183], v113
  s_waitcnt lgkmcnt(4)
  v_smfmac_f32_16x16x64_bf16 v[32:35], v[20:23], a[80:87], v113
  v_smfmac_f32_16x16x64_bf16 v[40:43], v[20:23], a[208:215], v113
  s_waitcnt lgkmcnt(3)
  v_smfmac_f32_16x16x64_bf16 v[32:35], v[24:27], a[96:103], v113
  v_smfmac_f32_16x16x64_bf16 v[40:43], v[24:27], a[224:231], v113
  s_waitcnt lgkmcnt(2)
  v_smfmac_f32_16x16x64_bf16 v[32:35], v[28:31], a[112:119], v113
  v_smfmac_f32_16x16x64_bf16 v[40:43], v[28:31], a[240:247], v113
  v_smfmac_f32_16x16x64_bf16 v[36:39], v[8:11], a[40:47], v113
  v_smfmac_f32_16x16x64_bf16 v[44:47], v[8:11], a[168:175], v113
  v_smfmac_f32_16x16x64_bf16 v[36:39], v[12:15], a[56:63], v113
  v_permlane32_swap_b32 v32, v40
  v_smfmac_f32_16x16x64_bf16 v[44:47], v[12:15], a[184:191], v113
  v_permlane32_swap_b32 v33, v41
  v_smfmac_f32_16x16x64_bf16 v[36:39], v[20:23], a[88:95], v113
  v_permlane32_swap_b32 v34, v42
  v_smfmac_f32_16x16x64_bf16 v[44:47], v[20:23], a[216:223], v113
  v_permlane32_swap_b32 v35, v43
  v_smfmac_f32_16x16x64_bf16 v[36:39], v[24:27], a[104:111], v113
  v_add_f32 v32, v32, v40
  v_smfmac_f32_16x16x64_bf16 v[44:47], v[24:27], a[232:239], v113
  v_add_f32 v33, v33, v41
  v_smfmac_f32_16x16x64_bf16 v[36:39], v[28:31], a[120:127], v113
  v_add_f32 v34, v34, v42
  v_smfmac_f32_16x16x64_bf16 v[44:47], v[28:31], a[248:255], v113
  v_add_f32 v35, v35, v43
  v_cvt_pk_bf16_f32 v40, v32, v33
  v_cvt_pk_bf16_f32 v41, v34, v35
  v_and_or_b32 v40, v40, -2, s49
  s_nop 3
  v_permlane32_swap_b32 v36, v44
  v_permlane32_swap_b32 v37, v45
  v_permlane32_swap_b32 v38, v46
  v_permlane32_swap_b32 v39, v47
  v_add_f32 v36, v36, v44
  v_add_f32 v37, v37, v45
  v_add_f32 v38, v38, v46
  v_add_f32 v39, v39, v47
  v_cvt_pk_bf16_f32 v42, v36, v37
  v_cvt_pk_bf16_f32 v43, v38, v39
  buffer_store_dwordx4 v[40:43], v112, s[4:7], s43 offen sc1
  s_waitcnt lgkmcnt(0)
  v_smfmac_f32_16x16x64_bf16 v[48:51], v[0:3], v[56:63], v113
  ds_read_b128 v[56:59], v118 offset:6144
  ds_read_b128 v[60:63], v118 offset:7168
  v_smfmac_f32_16x16x64_bf16 v[52:55], v[0:3], v[64:71], v113
  ds_read_b128 v[64:67], v118 offset:8192
  ds_read_b128 v[68:71], v118 offset:9216
  v_smfmac_f32_16x16x64_bf16 v[48:51], v[4:7], v[72:79], v113
  ds_read_b128 v[72:75], v118 offset:10240
  ds_read_b128 v[76:79], v118 offset:11264
  s_waitcnt lgkmcnt(4)
  v_smfmac_f32_16x16x64_bf16 v[52:55], v[4:7], v[56:63], v113
  ds_read_b128 v[56:59], v118 offset:12288
  ds_read_b128 v[60:63], v118 offset:13312
  s_waitcnt lgkmcnt(4)
  v_smfmac_f32_16x16x64_bf16 v[48:51], v[8:11], v[64:71], v113
  ds_read_b128 v[64:67], v118 offset:14336
  ds_read_b128 v[68:71], v118 offset:15360
  s_waitcnt lgkmcnt(4)
  v_smfmac_f32_16x16x64_bf16 v[52:55], v[8:11], v[72:79], v113
  ds_read_b128 v[72:75], v119 offset:0
  ds_read_b128 v[76:79], v119 offset:1024
  s_waitcnt lgkmcnt(4)
  v_smfmac_f32_16x16x64_bf16 v[48:51], v[12:15], v[56:63], v113
  ds_read_b128 v[56:59], v119 offset:2048
  ds_read_b128 v[60:63], v119 offset:3072
  s_waitcnt lgkmcnt(4)
  v_smfmac_f32_16x16x64_bf16 v[52:55], v[12:15], v[64:71], v113
  ds_read_b128 v[64:67], v119 offset:4096
  ds_read_b128 v[68:71], v119 offset:5120
  s_waitcnt lgkmcnt(4)
  v_smfmac_f32_16x16x64_bf16 v[48:51], v[16:19], v[72:79], v113
  ds_read_b128 v[72:75], v119 offset:6144
  ds_read_b128 v[76:79], v119 offset:7168
  buffer_load_dwordx4 v[100:103], v112, s[4:7], s44 offen offset:0 sc1
  s_waitcnt lgkmcnt(4)
  v_smfmac_f32_16x16x64_bf16 v[52:55], v[16:19], v[56:63], v113
  ds_read_b128 v[56:59], v119 offset:8192
  ds_read_b128 v[60:63], v119 offset:9216
  s_waitcnt lgkmcnt(4)
  v_smfmac_f32_16x16x64_bf16 v[48:51], v[20:23], v[64:71], v113
  ds_read_b128 v[64:67], v119 offset:10240
  ds_read_b128 v[68:71], v119 offset:11264
  s_waitcnt lgkmcnt(4)
  v_smfmac_f32_16x16x64_bf16 v[52:55], v[20:23], v[72:79], v113
  ds_read_b128 v[72:75], v119 offset:12288
  ds_read_b128 v[76:79], v119 offset:13312
  s_waitcnt lgkmcnt(4)
  v_smfmac_f32_16x16x64_bf16 v[48:51], v[24:27], v[56:63], v113
  ds_read_b128 v[56:59], v119 offset:14336
  ds_read_b128 v[60:63], v119 offset:15360
  s_waitcnt lgkmcnt(4)
  v_smfmac_f32_16x16x64_bf16 v[52:55], v[24:27], v[64:71], v113
  s_waitcnt lgkmcnt(2)
  v_smfmac_f32_16x16x64_bf16 v[48:51], v[28:31], v[72:79], v113
  s_waitcnt lgkmcnt(0)
  v_smfmac_f32_16x16x64_bf16 v[52:55], v[28:31], v[56:63], v113
  s_waitcnt vmcnt(3)
  s_nop 6
  v_permlane32_swap_b32 v48, v52
  v_permlane32_swap_b32 v49, v53
  v_permlane32_swap_b32 v50, v54
  v_permlane32_swap_b32 v51, v55
  v_pk_add_f32 v[92:93], v[48:49], v[52:53]
  v_pk_add_f32 v[94:95], v[50:51], v[54:55]
  v_cvt_pk_bf16_f32 v44, v92, v93
  v_cvt_pk_bf16_f32 v45, v94, v95
  v_lshrrev_b32 v86, 1, v112
  v_and_or_b32 v44, v44, -2, s49
  buffer_store_dwordx2 v[44:45], v86, s[4:7], s45 offen offset:0 sc1
  buffer_load_dwordx4 v[88:91], v112, s[4:7], s44 offen offset:0 sc1
  ds_read_b128 v[0:3], v116 offset:0
  ds_read_b128 v[4:7], v116 offset:2048
  ds_read_b128 v[8:11], v116 offset:4096
  ds_read_b128 v[12:15], v116 offset:6144
  ds_read_b128 v[16:19], v116 offset:256
  ds_read_b128 v[20:23], v116 offset:2304
  ds_read_b128 v[24:27], v116 offset:4352
  ds_read_b128 v[28:31], v116 offset:6400
  ds_read_b128 v[68:71], v117 offset:0
  ds_read_b128 v[72:75], v117 offset:256
  v_mov_b32 v64, v111
  v_mov_b32 v65, v111
  v_mov_b32 v66, v111
  v_mov_b32 v67, v111
  s_waitcnt vmcnt(2)
  v_and_b32 v125, 1, v100
  v_cmp_ne_u32 vcc, s49, v125
  s_cbranch_vccnz mcc_40
mcok_41:
  v_dot2_f32_bf16 v32, v100, s34, v32
  v_dot2_f32_bf16 v33, v100, s35, v33
  v_dot2_f32_bf16 v34, v101, s34, v34
  v_dot2_f32_bf16 v35, v101, s35, v35
  v_dot2_f32_bf16 v36, v102, s34, v36
  v_dot2_f32_bf16 v37, v102, s35, v37
  v_dot2_f32_bf16 v38, v103, s34, v38
  v_dot2_f32_bf16 v39, v103, s35, v39
mcj_42:
  v_cvt_pk_bf16_f32 v32, v32, v33
  v_cvt_pk_bf16_f32 v33, v34, v35
  ds_write_b64 v115, v[32:33] offset:0
  v_cvt_pk_bf16_f32 v36, v36, v37
  v_cvt_pk_bf16_f32 v37, v38, v39
  ds_write_b64 v115, v[36:37] offset:512
  s_waitcnt lgkmcnt(0)
  s_barrier
  buffer_load_dwordx2 v[88:89], v86, s[4:7], s46 offen offset:0 sc1
  ds_read_b64_tr_b16 v[32:33], v114 offset:0
  ds_read_b64_tr_b16 v[34:35], v114 offset:128
  ds_read_b64_tr_b16 v[36:37], v114 offset:1024
  ds_read_b64_tr_b16 v[38:39], v114 offset:1152
  ds_read_b64_tr_b16 v[40:41], v114 offset:2048
  ds_read_b64_tr_b16 v[42:43], v114 offset:2176
  ds_read_b64_tr_b16 v[44:45], v114 offset:3072
  ds_read_b64_tr_b16 v[46:47], v114 offset:3200
  v_readfirstlane_b32 s53, v110
  s_cmp_eq_u32 s53, 0
  s_cbranch_scc1 kvc_45
kvb_46:
  s_lshl_b32 s27, s52, 18
  s_add_u32 s27, s27, s66
  s_lshl_b32 s24, s14, 12
  s_mov_b32 m0, s24
  v_mov_b32 v125, s49
  s_mov_b64 exec, s[8:9]
  buffer_store_dword v125, v112, s[4:7], s44 offen sc1
  s_mov_b64 exec, -1
  s_waitcnt lgkmcnt(6)
  v_mfma_f32_16x16x32_bf16 v[56:59], v[0:3], v[32:35], 0
  v_mfma_f32_16x16x32_bf16 v[60:63], v[16:19], v[32:35], 0
  v_mfma_f32_16x16x32_bf16 v[64:67], v[32:35], v[32:35], v[64:67]
  buffer_load_dwordx4 v112, s[4:7], s27 offen offset:0 sc1 lds
  s_waitcnt lgkmcnt(4)
  v_mfma_f32_16x16x32_bf16 v[56:59], v[4:7], v[36:39], v[56:59]
  v_mfma_f32_16x16x32_bf16 v[60:63], v[20:23], v[36:39], v[60:63]
  v_mfma_f32_16x16x32_bf16 v[64:67], v[36:39], v[36:39], v[64:67]
  s_waitcnt lgkmcnt(2)
  v_mfma_f32_16x16x32_bf16 v[56:59], v[8:11], v[40:43], v[56:59]
  v_mfma_f32_16x16x32_bf16 v[60:63], v[24:27], v[40:43], v[60:63]
  v_mfma_f32_16x16x32_bf16 v[64:67], v[40:43], v[40:43], v[64:67]
  buffer_load_dwordx4 v112, s[4:7], s27 offen offset:1024 sc1 lds
  s_waitcnt lgkmcnt(0)
  v_mfma_f32_16x16x32_bf16 v[56:59], v[12:15], v[44:47], v[56:59]
  v_mfma_f32_16x16x32_bf16 v[60:63], v[28:31], v[44:47], v[60:63]
  v_mfma_f32_16x16x32_bf16 v[64:67], v[44:47], v[44:47], v[64:67]
  v_mov_b32 v28, 0x3f803f80
  v_mov_b32 v29, 0x3f803f80
  v_max3_f32 v106, v56, v57, v58
  v_mov_b32 v30, 0x3f803f80
  v_mov_b32 v31, 0x3f803f80
  v_mov_b64 v[0:1], 0
  v_max3_f32 v107, v59, v60, v61
  v_max3_f32 v106, v106, v62, v63
  v_max3_f32 v107, v107, v64, v65
  v_max3_f32 v106, v106, v66, v67
  v_max_f32 v106, v106, v107
  v_mov_b32 v107, v106
  v_mov_b64 v[2:3], 0
  v_mov_b64 v[4:5], 0
  v_permlane16_swap_b32 v106, v107
  v_max_f32 v106, v106, v107
  v_mov_b32 v107, v106
  v_mov_b64 v[6:7], 0
  v_mov_b64 v[8:9], 0
  v_permlane32_swap_b32 v106, v107
  v_max_f32 v106, v106, v107
  v_mul_f32 v106, s38, v106
  buffer_load_dwordx4 v112, s[4:7], s27 offen offset:2048 sc1 lds
  ds_read_b64_tr_b16 v[76:77], v122 offset:0
  ds_read_b64_tr_b16 v[78:79], v122 offset:128
  v_pk_fma_f32 v[56:57], v[56:57], s[38:39], v[106:107] op_sel_hi:[1,1,0] neg_lo:[0,0,1] neg_hi:[0,0,1]
  v_pk_fma_f32 v[58:59], v[58:59], s[38:39], v[106:107] op_sel_hi:[1,1,0] neg_lo:[0,0,1] neg_hi:[0,0,1]
  v_pk_fma_f32 v[60:61], v[60:61], s[38:39], v[106:107] op_sel_hi:[1,1,0] neg_lo:[0,0,1] neg_hi:[0,0,1]
  v_pk_fma_f32 v[62:63], v[62:63], s[38:39], v[106:107] op_sel_hi:[1,1,0] neg_lo:[0,0,1] neg_hi:[0,0,1]
  v_pk_fma_f32 v[64:65], v[64:65], s[38:39], v[106:107] op_sel_hi:[1,1,0] neg_lo:[0,0,1] neg_hi:[0,0,1]
  v_pk_fma_f32 v[66:67], v[66:67], s[38:39], v[106:107] op_sel_hi:[1,1,0] neg_lo:[0,0,1] neg_hi:[0,0,1]
  v_exp_f32 v56, v56
  v_exp_f32 v57, v57
  buffer_load_dwordx4 v112, s[4:7], s27 offen offset:3072 sc1 lds
  v_exp_f32 v58, v58
  v_exp_f32 v59, v59
  v_exp_f32 v60, v60
  v_exp_f32 v61, v61
  v_exp_f32 v62, v62
  v_exp_f32 v63, v63
  v_exp_f32 v64, v64
  v_exp_f32 v65, v65
  v_exp_f32 v66, v66
  v_exp_f32 v67, v67
  v_cvt_pk_bf16_f32 v80, v56, v57
  v_cvt_pk_bf16_f32 v81, v58, v59
  v_cvt_pk_bf16_f32 v82, v60, v61
  v_cvt_pk_bf16_f32 v83, v62, v63
  v_cvt_pk_bf16_f32 v84, v64, v65
  v_cvt_pk_bf16_f32 v85, v66, v67
  v_mfma_f32_16x16x32_bf16 v[106:109], v[28:31], v[80:83], 0
  v_mfma_f32_16x16x32_bf16 v[48:51], v[68:71], v[80:83], 0
  v_mfma_f32_16x16x32_bf16 v[52:55], v[72:75], v[80:83], 0
  v_mfma_f32_16x16x16_bf16 v[106:109], v[28:29], v[84:85], v[106:109]
  v_mov_b64 v[60:61], 0
  s_waitcnt vmcnt(5)
  v_and_b32 v125, 1, v88
  v_cmp_ne_u32 vcc, s49, v125
  s_cbranch_vccnz spr_47
spok_48:
  v_dot2_f32_bf16 v92, v88, s34, v92
  v_dot2_f32_bf16 v93, v88, s35, v93
  v_dot2_f32_bf16 v94, v89, s34, v94
  v_dot2_f32_bf16 v95, v89, s35, v95
  s_nop 0
  v_cvt_pk_bf16_f32 v104, v92, v93
  s_nop 0
  v_cvt_pk_bf16_f32 v105, v94, v95
  v_permlane32_swap_b32 v60, v104
  v_mov_b64 v[10:11], 0
  v_permlane32_swap_b32 v61, v105
  v_rcp_f32 v106, v106
  v_mov_b64 v[12:13], 0
  v_mfma_f32_16x16x16_bf16 v[48:51], v[60:61], v[84:85], v[48:51]
  v_mfma_f32_16x16x16_bf16 v[52:55], v[104:105], v[84:85], v[52:55]
  s_mov_b64 exec, s[10:11]
  buffer_store_dword v88, v86, s[4:7], s46 offen sc1
  s_mov_b64 exec, -1
  v_mov_b64 v[14:15], 0
  v_mov_b64 v[16:17], 0
  v_mov_b64 v[18:19], 0
  v_mov_b64 v[20:21], 0
  v_pk_mul_f32 v[48:49], v[48:49], v[106:107] op_sel_hi:[1,0]
  v_pk_mul_f32 v[50:51], v[50:51], v[106:107] op_sel_hi:[1,0]
  v_cvt_pk_bf16_f32 v48, v48, v49
  v_cvt_pk_bf16_f32 v49, v50, v51
  v_pk_mul_f32 v[52:53], v[52:53], v[106:107] op_sel_hi:[1,0]
  v_pk_mul_f32 v[54:55], v[54:55], v[106:107] op_sel_hi:[1,0]
  v_cvt_pk_bf16_f32 v52, v52, v53
  v_cvt_pk_bf16_f32 v53, v54, v55
  s_mov_b64 exec, s[32:33]
  ds_write_b64 v120, v[48:49] offset:0
  ds_write_b64 v120, v[52:53] offset:256
  s_mov_b64 exec, -1
  v_mov_b64 v[22:23], 0
  v_mov_b64 v[24:25], 0
  v_mov_b64 v[26:27], 0
  v_mov_b64 v[28:29], 0
  v_mov_b64 v[30:31], 0
  s_waitcnt lgkmcnt(2)
  s_mov_b64 exec, s[36:37]
  buffer_store_dwordx4 v[76:79], v123, s[4:7], s51 offen sc1
  s_mov_b64 exec, -1
  s_waitcnt lgkmcnt(0)
  s_barrier
  ds_read_b128 v[56:59], v112 offset:20480
  ds_read_b128 v[60:63], v112 offset:21504
  v_and_b32 v125, 0x380, v112
  v_add_u32 v125, v125, v112
  s_waitcnt lgkmcnt(1)
  s_mov_b32 s27, s47
  v_smfmac_f32_16x16x64_bf16 v[0:3], v[56:59], v[128:135], v113
  v_smfmac_f32_16x16x64_bf16 v[4:7], v[56:59], v[144:151], v113
  s_waitcnt lgkmcnt(0)
  v_smfmac_f32_16x16x64_bf16 v[0:3], v[60:63], v[136:143], v113
  v_smfmac_f32_16x16x64_bf16 v[4:7], v[60:63], v[152:159], v113
  v_smfmac_f32_16x16x64_bf16 v[8:11], v[56:59], v[160:167], v113
  v_smfmac_f32_16x16x64_bf16 v[12:15], v[56:59], v[176:183], v113
  s_nop 1
  v_permlane32_swap_b32 v0, v4
  v_permlane32_swap_b32 v1, v5
  v_permlane32_swap_b32 v2, v6
  v_smfmac_f32_16x16x64_bf16 v[8:11], v[60:63], v[168:175], v113
  v_permlane32_swap_b32 v3, v7
  v_add_f32 v0, v0, v4
  v_add_f32 v1, v1, v5
  v_smfmac_f32_16x16x64_bf16 v[12:15], v[60:63], v[184:191], v113
  v_add_f32 v2, v2, v6
  v_add_f32 v3, v3, v7
  v_cvt_pk_bf16_f32 v64, v0, v1
  v_smfmac_f32_16x16x64_bf16 v[16:19], v[56:59], v[192:199], v113
  v_cvt_pk_bf16_f32 v65, v2, v3
  v_smfmac_f32_16x16x64_bf16 v[20:23], v[56:59], v[208:215], v113
  s_nop 1
  v_permlane32_swap_b32 v8, v12
  v_permlane32_swap_b32 v9, v13
  v_permlane32_swap_b32 v10, v14
  v_smfmac_f32_16x16x64_bf16 v[16:19], v[60:63], v[200:207], v113
  v_permlane32_swap_b32 v11, v15
  v_add_f32 v8, v8, v12
  v_add_f32 v9, v9, v13
  v_smfmac_f32_16x16x64_bf16 v[20:23], v[60:63], v[216:223], v113
  v_add_f32 v10, v10, v14
  v_add_f32 v11, v11, v15
  v_cvt_pk_bf16_f32 v66, v8, v9
  v_smfmac_f32_16x16x64_bf16 v[24:27], v[56:59], v[224:231], v113
  v_cvt_pk_bf16_f32 v67, v10, v11
  v_permlane16_swap_b32 v64, v66
  s_nop 0
  v_permlane16_swap_b32 v65, v67
  v_smfmac_f32_16x16x64_bf16 v[28:31], v[56:59], v[240:247], v113
  v_and_or_b32 v64, v64, -2, s49
  buffer_store_dwordx4 v[64:67], v121, s[4:7], s27 offen
  s_add_u32 s27, s27, 32768
  s_cmp_lt_u32 s14, 2
  v_permlane32_swap_b32 v16, v20
  v_smfmac_f32_16x16x64_bf16 v[24:27], v[60:63], v[232:239], v113
  v_permlane32_swap_b32 v17, v21
  v_permlane32_swap_b32 v18, v22
  v_permlane32_swap_b32 v19, v23
  v_smfmac_f32_16x16x64_bf16 v[28:31], v[60:63], v[248:255], v113
  v_add_f32 v16, v16, v20
  v_add_f32 v17, v17, v21
  v_add_f32 v18, v18, v22
  v_add_f32 v19, v19, v23
  v_cvt_pk_bf16_f32 v68, v16, v17
  v_cvt_pk_bf16_f32 v69, v18, v19
  s_nop 1
  v_permlane32_swap_b32 v24, v28
  v_permlane32_swap_b32 v25, v29
  v_permlane32_swap_b32 v26, v30
  v_permlane32_swap_b32 v27, v31
  v_pk_add_f32 v[24:25], v[24:25], v[28:29]
  v_pk_add_f32 v[26:27], v[26:27], v[30:31]
  v_cvt_pk_bf16_f32 v70, v24, v25
  v_cvt_pk_bf16_f32 v71, v26, v27
  s_nop 0
  v_permlane16_swap_b32 v68, v70
  v_permlane16_swap_b32 v69, v71
  v_and_or_b32 v68, v68, -2, s49
  buffer_store_dwordx4 v[68:71], v121, s[4:7], s27 offen
  s_cbranch_scc1 hk_55
  s_waitcnt vmcnt(0)
  buffer_load_dwordx4 v[0:3], v125, s[4:7], s48 offen offset:0 sc1
  buffer_load_dwordx4 v[4:7], v125, s[4:7], s48 offen offset:2048 sc1
  buffer_load_dwordx4 v[8:11], v125, s[4:7], s69 offen offset:0 sc1
  buffer_load_dwordx4 v[12:15], v125, s[4:7], s69 offen offset:2048 sc1
  s_xor_b32 s43, s43, 524288
  s_xor_b32 s44, s44, 524288
  s_xor_b32 s45, s45, 262144
  s_xor_b32 s46, s46, 262144
  s_xor_b32 s47, s47, 262144
  s_xor_b32 s40, s40, 0x2000
  s_add_u32 s51, s51, 65536
  s_add_u32 s50, s50, 512
  s_add_u32 s55, s55, 512
  s_xor_b32 s67, s67, 0x2000
  s_add_u32 s15, s15, 1
  s_add_u32 s52, s15, 1
  v_lshrrev_b32 v87, 4, v112
  v_and_b32 v106, 15, v87
  v_lshlrev_b32 v106, 4, v106
  v_bfe_u32 v107, v87, 4, 1
  buffer_load_dwordx4 v[16:19], v125, s[4:7], s48 offen offset:0 sc1
  buffer_load_dwordx4 v[20:23], v125, s[4:7], s48 offen offset:2048 sc1
  buffer_load_dwordx4 v[24:27], v125, s[4:7], s69 offen offset:0 sc1
  buffer_load_dwordx4 v[28:31], v125, s[4:7], s69 offen offset:2048 sc1
  v_lshl_add_u32 v106, v107, 3, v106
  v_lshrrev_b32 v107, 5, v87
  v_lshl_add_u32 v87, v107, 2, v106
  v_mov_b32 v108, -1
  v_mov_b64 v[32:33], 0
  v_mov_b64 v[34:35], 0
  v_mov_b64 v[36:37], 0
  v_mov_b64 v[38:39], 0
  v_mov_b64 v[40:41], 0
  v_mov_b64 v[42:43], 0
  v_mov_b64 v[44:45], 0
  v_mov_b64 v[46:47], 0
  v_mov_b64 v[48:49], 0
  v_mov_b64 v[50:51], 0
  v_mov_b64 v[52:53], 0
  v_mov_b64 v[54:55], 0
  s_waitcnt vmcnt(7)
  v_mfma_f32_16x16x32_bf16 v[100:103], v[0:3], v[96:99], 0
  s_waitcnt vmcnt(6)
  v_mfma_f32_16x16x32_bf16 v[100:103], v[4:7], v[96:99], v[100:103]
  v_bitop3_b32 v106, v0, v4, s49 bitop3:0x7e
  s_waitcnt vmcnt(5)
  v_mfma_f32_16x16x32_bf16 v[100:103], v[8:11], v[96:99], v[100:103]
  v_bitop3_b32 v106, v106, v8, s49 bitop3:0xf6
  s_waitcnt vmcnt(4)
  v_mfma_f32_16x16x32_bf16 v[100:103], v[12:15], v[96:99], v[100:103]
  v_bitop3_b32 v106, v106, v12, s49 bitop3:0xf6
  v_and_b32 v106, 1, v106
  v_cmp_ne_u32 vcc, 0, v106
  s_cbranch_vccnz PR_57
Pok_58:
  s_mov_b64 exec, s[32:33]
  buffer_store_dword v108, v87, s[4:7], s42 offen
  s_mov_b64 exec, -1
  s_nop 0
  v_permlane32_swap_b32 v100, v102
  v_permlane32_swap_b32 v101, v103
  v_pk_add_f32 v[100:101], v[100:101], v[102:103]
  v_cvt_pk_bf16_f32 v100, v100, v101
  s_mov_b64 exec, s[32:33]
  buffer_store_dword v100, v87, s[4:7], s41 offen
  s_mov_b64 exec, -1
redd_56:
  s_barrier
  s_cmp_lt_u32 s15, 63
  s_cbranch_scc1 step5_34
  ds_read_b128 v[56:59], v118 offset:0
  ds_read_b128 v[60:63], v118 offset:1024
  ds_read_b128 v[64:67], v118 offset:2048
  ds_read_b128 v[68:71], v118 offset:3072
  ds_read_b128 v[72:75], v118 offset:4096
  ds_read_b128 v[76:79], v118 offset:5120
  buffer_load_dwordx4 v[80:83], v112, s[4:7], s40 offen sc1
  buffer_load_dwordx4 v[84:87], v112, s[4:7], s67 offen sc1
  s_lshl_b32 s23, s14, 10
  v_add_u32 v125, s23, v127
  v_xor_b32 v100, 1024, v125
  v_xor_b32 v101, 2048, v125
  v_xor_b32 v102, 3072, v125
  s_xor_b32 s48, s48, 262144
  s_xor_b32 s69, s69, 262144
  s_xor_b32 s41, s41, 0x2000
  s_xor_b32 s42, s42, 0x2000
  s_lshr_b32 s49, s15, 1
  s_and_b32 s49, s49, 1
  buffer_load_dwordx4 v[88:91], v112, s[4:7], s40 offen sc1
  buffer_load_dwordx4 v[92:95], v112, s[4:7], s67 offen sc1
  s_waitcnt vmcnt(2)
  v_max3_u32 v106, v80, v81, v82
  v_max3_u32 v107, v83, v84, v85
  v_max3_u32 v106, v106, v86, v87
  v_max_u32 v106, v106, v107
  v_cmp_eq_u32 vcc, -1, v106
  s_cbranch_vccnz dpra_60
dpoka_63:
  ds_write_b128 v125, v[80:83]
  ds_write_b128 v125, v[84:87] offset:4096
  v_smfmac_f32_16x16x64_bf16 v[32:35], v[80:83], a[0:7], v113
  v_smfmac_f32_16x16x64_bf16 v[40:43], v[80:83], a[128:135], v113
  v_smfmac_f32_16x16x64_bf16 v[36:39], v[80:83], a[8:15], v113
  v_smfmac_f32_16x16x64_bf16 v[44:47], v[80:83], a[136:143], v113
  s_waitcnt lgkmcnt(0)
  s_barrier
  ds_read_b128 v[4:7], v100 offset:0
  ds_read_b128 v[8:11], v101 offset:0
  ds_read_b128 v[12:15], v102 offset:0
  ds_read_b128 v[20:23], v100 offset:4096
  ds_read_b128 v[24:27], v101 offset:4096
  ds_read_b128 v[28:31], v102 offset:4096
  ds_read_b128 v[0:3], v125 offset:0
  ds_read_b128 v[16:19], v125 offset:4096
  v_smfmac_f32_16x16x64_bf16 v[32:35], v[84:87], a[64:71], v113
  s_mov_b64 exec, s[96:97]
  buffer_store_dword v126, off, s[4:7], s50 sc1
  s_mov_b64 exec, -1
  v_smfmac_f32_16x16x64_bf16 v[40:43], v[84:87], a[192:199], v113
  v_smfmac_f32_16x16x64_bf16 v[36:39], v[84:87], a[72:79], v113
  v_smfmac_f32_16x16x64_bf16 v[44:47], v[84:87], a[200:207], v113
dpj_62:
  buffer_load_dword v110, off, s[4:7], s55 sc1
  s_waitcnt lgkmcnt(7)
  v_smfmac_f32_16x16x64_bf16 v[32:35], v[4:7], a[16:23], v113
  v_smfmac_f32_16x16x64_bf16 v[40:43], v[4:7], a[144:151], v113
  v_smfmac_f32_16x16x64_bf16 v[36:39], v[4:7], a[24:31], v113
  v_smfmac_f32_16x16x64_bf16 v[44:47], v[4:7], a[152:159], v113
  s_waitcnt lgkmcnt(6)
  v_smfmac_f32_16x16x64_bf16 v[32:35], v[8:11], a[32:39], v113
  v_smfmac_f32_16x16x64_bf16 v[40:43], v[8:11], a[160:167], v113
  s_waitcnt lgkmcnt(5)
  v_smfmac_f32_16x16x64_bf16 v[32:35], v[12:15], a[48:55], v113
  v_smfmac_f32_16x16x64_bf16 v[40:43], v[12:15], a[176:183], v113
  s_waitcnt lgkmcnt(4)
  v_smfmac_f32_16x16x64_bf16 v[32:35], v[20:23], a[80:87], v113
  v_smfmac_f32_16x16x64_bf16 v[40:43], v[20:23], a[208:215], v113
  s_waitcnt lgkmcnt(3)
  v_smfmac_f32_16x16x64_bf16 v[32:35], v[24:27], a[96:103], v113
  v_smfmac_f32_16x16x64_bf16 v[40:43], v[24:27], a[224:231], v113
  s_waitcnt lgkmcnt(2)
  v_smfmac_f32_16x16x64_bf16 v[32:35], v[28:31], a[112:119], v113
  v_smfmac_f32_16x16x64_bf16 v[40:43], v[28:31], a[240:247], v113
  v_smfmac_f32_16x16x64_bf16 v[36:39], v[8:11], a[40:47], v113
  v_smfmac_f32_16x16x64_bf16 v[44:47], v[8:11], a[168:175], v113
  v_smfmac_f32_16x16x64_bf16 v[36:39], v[12:15], a[56:63], v113
  v_permlane32_swap_b32 v32, v40
  v_smfmac_f32_16x16x64_bf16 v[44:47], v[12:15], a[184:191], v113
  v_permlane32_swap_b32 v33, v41
  v_smfmac_f32_16x16x64_bf16 v[36:39], v[20:23], a[88:95], v113
  v_permlane32_swap_b32 v34, v42
  v_smfmac_f32_16x16x64_bf16 v[44:47], v[20:23], a[216:223], v113
  v_permlane32_swap_b32 v35, v43
  v_smfmac_f32_16x16x64_bf16 v[36:39], v[24:27], a[104:111], v113
  v_add_f32 v32, v32, v40
  v_smfmac_f32_16x16x64_bf16 v[44:47], v[24:27], a[232:239], v113
  v_add_f32 v33, v33, v41
  v_smfmac_f32_16x16x64_bf16 v[36:39], v[28:31], a[120:127], v113
  v_add_f32 v34, v34, v42
  v_smfmac_f32_16x16x64_bf16 v[44:47], v[28:31], a[248:255], v113
  v_add_f32 v35, v35, v43
  v_cvt_pk_bf16_f32 v40, v32, v33
  v_cvt_pk_bf16_f32 v41, v34, v35
  v_and_or_b32 v40, v40, -2, s49
  s_nop 3
  v_permlane32_swap_b32 v36, v44
  v_permlane32_swap_b32 v37, v45
  v_permlane32_swap_b32 v38, v46
  v_permlane32_swap_b32 v39, v47
  v_add_f32 v36, v36, v44
  v_add_f32 v37, v37, v45
  v_add_f32 v38, v38, v46
  v_add_f32 v39, v39, v47
  v_cvt_pk_bf16_f32 v42, v36, v37
  v_cvt_pk_bf16_f32 v43, v38, v39
  buffer_store_dwordx4 v[40:43], v112, s[4:7], s43 offen sc1
  s_waitcnt lgkmcnt(0)
  v_smfmac_f32_16x16x64_bf16 v[48:51], v[0:3], v[56:63], v113
  ds_read_b128 v[56:59], v118 offset:6144
  ds_read_b128 v[60:63], v118 offset:7168
  v_smfmac_f32_16x16x64_bf16 v[52:55], v[0:3], v[64:71], v113
  ds_read_b128 v[64:67], v118 offset:8192
  ds_read_b128 v[68:71], v118 offset:9216
  v_smfmac_f32_16x16x64_bf16 v[48:51], v[4:7], v[72:79], v113
  ds_read_b128 v[72:75], v118 offset:10240
  ds_read_b128 v[76:79], v118 offset:11264
  s_waitcnt lgkmcnt(4)
  v_smfmac_f32_16x16x64_bf16 v[52:55], v[4:7], v[56:63], v113
  ds_read_b128 v[56:59], v118 offset:12288
  ds_read_b128 v[60:63], v118 offset:13312
  s_waitcnt lgkmcnt(4)
  v_smfmac_f32_16x16x64_bf16 v[48:51], v[8:11], v[64:71], v113
  ds_read_b128 v[64:67], v118 offset:14336
  ds_read_b128 v[68:71], v118 offset:15360
  s_waitcnt lgkmcnt(4)
  v_smfmac_f32_16x16x64_bf16 v[52:55], v[8:11], v[72:79], v113
  ds_read_b128 v[72:75], v119 offset:0
  ds_read_b128 v[76:79], v119 offset:1024
  s_waitcnt lgkmcnt(4)
  v_smfmac_f32_16x16x64_bf16 v[48:51], v[12:15], v[56:63], v113
  ds_read_b128 v[56:59], v119 offset:2048
  ds_read_b128 v[60:63], v119 offset:3072
  s_waitcnt lgkmcnt(4)
  v_smfmac_f32_16x16x64_bf16 v[52:55], v[12:15], v[64:71], v113
  ds_read_b128 v[64:67], v119 offset:4096
  ds_read_b128 v[68:71], v119 offset:5120
  s_waitcnt lgkmcnt(4)
  v_smfmac_f32_16x16x64_bf16 v[48:51], v[16:19], v[72:79], v113
  ds_read_b128 v[72:75], v119 offset:6144
  ds_read_b128 v[76:79], v119 offset:7168
  s_waitcnt lgkmcnt(4)
  v_smfmac_f32_16x16x64_bf16 v[52:55], v[16:19], v[56:63], v113
  ds_read_b128 v[56:59], v119 offset:8192
  ds_read_b128 v[60:63], v119 offset:9216
  s_waitcnt lgkmcnt(4)
  v_smfmac_f32_16x16x64_bf16 v[48:51], v[20:23], v[64:71], v113
  ds_read_b128 v[64:67], v119 offset:10240
  ds_read_b128 v[68:71], v119 offset:11264
  s_waitcnt lgkmcnt(4)
  v_smfmac_f32_16x16x64_bf16 v[52:55], v[20:23], v[72:79], v113
  ds_read_b128 v[72:75], v119 offset:12288
  ds_read_b128 v[76:79], v119 offset:13312
  s_waitcnt lgkmcnt(4)
  v_smfmac_f32_16x16x64_bf16 v[48:51], v[24:27], v[56:63], v113
  ds_read_b128 v[56:59], v119 offset:14336
  ds_read_b128 v[60:63], v119 offset:15360
  buffer_load_dwordx4 v[100:103], v112, s[4:7], s44 offen offset:0 sc1
  s_waitcnt lgkmcnt(4)
  v_smfmac_f32_16x16x64_bf16 v[52:55], v[24:27], v[64:71], v113
  s_waitcnt lgkmcnt(2)
  v_smfmac_f32_16x16x64_bf16 v[48:51], v[28:31], v[72:79], v113
  s_waitcnt lgkmcnt(0)
  v_smfmac_f32_16x16x64_bf16 v[52:55], v[28:31], v[56:63], v113
  s_waitcnt vmcnt(3)
  s_nop 6
  v_permlane32_swap_b32 v48, v52
  v_permlane32_swap_b32 v49, v53
  v_permlane32_swap_b32 v50, v54
  v_permlane32_swap_b32 v51, v55
  v_pk_add_f32 v[92:93], v[48:49], v[52:53]
  v_pk_add_f32 v[94:95], v[50:51], v[54:55]
  v_cvt_pk_bf16_f32 v44, v92, v93
  v_cvt_pk_bf16_f32 v45, v94, v95
  v_lshrrev_b32 v86, 1, v112
  v_and_or_b32 v44, v44, -2, s49
  buffer_store_dwordx2 v[44:45], v86, s[4:7], s45 offen offset:0 sc1
  s_waitcnt vmcnt(1)
  v_and_b32 v125, 1, v100
  v_cmp_ne_u32 vcc, s49, v125
  s_cbranch_vccnz mcc_64
mcok_65:
  v_dot2_f32_bf16 v32, v100, s34, v32
  v_dot2_f32_bf16 v33, v100, s35, v33
  v_dot2_f32_bf16 v34, v101, s34, v34
  v_dot2_f32_bf16 v35, v101, s35, v35
  v_dot2_f32_bf16 v36, v102, s34, v36
  v_dot2_f32_bf16 v37, v102, s35, v37
  v_dot2_f32_bf16 v38, v103, s34, v38
  v_dot2_f32_bf16 v39, v103, s35, v39
mcj_66:
  v_cvt_pk_bf16_f32 v32, v32, v33
  v_cvt_pk_bf16_f32 v33, v34, v35
  ds_write_b64 v115, v[32:33] offset:0
  v_cvt_pk_bf16_f32 v36, v36, v37
  v_cvt_pk_bf16_f32 v37, v38, v39
  ds_write_b64 v115, v[36:37] offset:512
  s_waitcnt lgkmcnt(0)
  s_barrier
  buffer_load_dwordx2 v[88:89], v86, s[4:7], s46 offen offset:0 sc1
  ds_read_b64_tr_b16 v[32:33], v114 offset:0
  ds_read_b64_tr_b16 v[34:35], v114 offset:128
  ds_read_b64_tr_b16 v[36:37], v114 offset:1024
  ds_read_b64_tr_b16 v[38:39], v114 offset:1152
  ds_read_b64_tr_b16 v[40:41], v114 offset:2048
  ds_read_b64_tr_b16 v[42:43], v114 offset:2176
  ds_read_b64_tr_b16 v[44:45], v114 offset:3072
  ds_read_b64_tr_b16 v[46:47], v114 offset:3200
  s_waitcnt lgkmcnt(0)
  s_cmp_lg_u32 s12, 0
  s_cbranch_scc1 tx1_68
  s_mov_b64 exec, s[36:37]
  s_cmp_eq_u32 s14, 1
  s_cbranch_scc1 pk_71
  s_cmp_eq_u32 s14, 2
  s_cbranch_scc1 pk_72
  s_cmp_eq_u32 s14, 3
  s_cbranch_scc1 pk_73
  buffer_store_dwordx4 v[32:35], v123, s[4:7], s51 offen sc1
  s_branch pkd_74
pk_71:
  buffer_store_dwordx4 v[36:39], v123, s[4:7], s51 offen sc1
  s_branch pkd_74
pk_72:
  buffer_store_dwordx4 v[40:43], v123, s[4:7], s51 offen sc1
  s_branch pkd_74
pk_73:
  buffer_store_dwordx4 v[44:47], v123, s[4:7], s51 offen sc1
pkd_74:
  s_mov_b64 exec, -1
  s_branch txd_69
tx1_68:
  s_waitcnt vmcnt(0)
  s_waitcnt vmcnt(0)
  v_and_b32 v125, 1, v88
  v_cmp_ne_u32 vcc, s49, v125
  s_cbranch_vccnz spr_75
spok_76:
  v_dot2_f32_bf16 v92, v88, s34, v92
  v_dot2_f32_bf16 v93, v88, s35, v93
  v_dot2_f32_bf16 v94, v89, s34, v94
  v_dot2_f32_bf16 v95, v89, s35, v95
  s_nop 0
  v_cvt_pk_bf16_f32 v104, v92, v93
  s_nop 0
  v_cvt_pk_bf16_f32 v105, v94, v95
  buffer_store_dwordx2 v[104:105], v124, s[4:7], s51 offen sc1
txd_69:
  s_waitcnt vmcnt(0)
  s_add_u32 s50, s50, 512
  s_barrier
  s_cmp_lg_u32 s14, 0
  s_cbranch_scc1 fs_77
  s_mov_b64 exec, 1
  buffer_store_dword v126, off, s[4:7], s50 sc1
  s_mov_b64 exec, -1
fs_77:
  s_waitcnt vmcnt(0)
  s_branch loop5done_35
hk_55:
  v_mov_b64 v[32:33], 0
  v_mov_b64 v[34:35], 0
  v_mov_b64 v[36:37], 0
  v_mov_b64 v[38:39], 0
  v_mov_b64 v[40:41], 0
  v_mov_b64 v[42:43], 0
  v_mov_b64 v[44:45], 0
  v_mov_b64 v[46:47], 0
  v_mov_b64 v[48:49], 0
  v_mov_b64 v[50:51], 0
  v_mov_b64 v[52:53], 0
  v_mov_b64 v[54:55], 0
  s_xor_b32 s43, s43, 524288
  s_xor_b32 s44, s44, 524288
  s_xor_b32 s45, s45, 262144
  s_xor_b32 s46, s46, 262144
  s_xor_b32 s47, s47, 262144
  s_xor_b32 s40, s40, 0x2000
  s_add_u32 s51, s51, 65536
  s_add_u32 s50, s50, 512
  s_add_u32 s55, s55, 512
  s_xor_b32 s67, s67, 0x2000
  s_add_u32 s15, s15, 1
  s_add_u32 s52, s15, 1
  s_branch redd_56
dpra_36:
  s_cmp_eq_u32 s29, 0
  s_cbranch_scc1 dpoka_39
  s_sub_u32 s29, s29, 1
  buffer_load_dwordx4 v[80:83], v112, s[4:7], s40 offen sc1
  buffer_load_dwordx4 v[84:87], v112, s[4:7], s67 offen sc1
  s_waitcnt vmcnt(2)
  v_max3_u32 v106, v88, v89, v90
  v_max3_u32 v107, v91, v92, v93
  v_max3_u32 v106, v106, v94, v95
  v_max_u32 v106, v106, v107
  v_cmp_eq_u32 vcc, -1, v106
  s_cbranch_vccz dpub_37
dpl_78:
  buffer_load_dwordx4 v[88:91], v112, s[4:7], s40 offen sc1
  buffer_load_dwordx4 v[92:95], v112, s[4:7], s67 offen sc1
  s_waitcnt vmcnt(2)
  v_max3_u32 v106, v80, v81, v82
  v_max3_u32 v107, v83, v84, v85
  v_max3_u32 v106, v106, v86, v87
  v_max_u32 v106, v106, v107
  v_cmp_eq_u32 vcc, -1, v106
  s_cbranch_vccz dpoka_39
  s_cmp_eq_u32 s29, 0
  s_cbranch_scc1 dpoka_39
  s_sub_u32 s29, s29, 1
  buffer_load_dwordx4 v[80:83], v112, s[4:7], s40 offen sc1
  buffer_load_dwordx4 v[84:87], v112, s[4:7], s67 offen sc1
  s_waitcnt vmcnt(2)
  v_max3_u32 v106, v88, v89, v90
  v_max3_u32 v107, v91, v92, v93
  v_max3_u32 v106, v106, v94, v95
  v_max_u32 v106, v106, v107
  v_cmp_eq_u32 vcc, -1, v106
  s_cbranch_vccnz dpl_78
dpub_37:
  ds_write_b128 v125, v[88:91]
  ds_write_b128 v125, v[92:95] offset:4096
  v_smfmac_f32_16x16x64_bf16 v[32:35], v[88:91], a[0:7], v113
  v_smfmac_f32_16x16x64_bf16 v[40:43], v[88:91], a[128:135], v113
  v_smfmac_f32_16x16x64_bf16 v[36:39], v[88:91], a[8:15], v113
  v_smfmac_f32_16x16x64_bf16 v[44:47], v[88:91], a[136:143], v113
  s_waitcnt lgkmcnt(0)
  s_barrier
  ds_read_b128 v[4:7], v100 offset:0
  ds_read_b128 v[8:11], v101 offset:0
  ds_read_b128 v[12:15], v102 offset:0
  ds_read_b128 v[20:23], v100 offset:4096
  ds_read_b128 v[24:27], v101 offset:4096
  ds_read_b128 v[28:31], v102 offset:4096
  ds_read_b128 v[0:3], v125 offset:0
  ds_read_b128 v[16:19], v125 offset:4096
  v_smfmac_f32_16x16x64_bf16 v[32:35], v[92:95], a[64:71], v113
  s_mov_b64 exec, s[96:97]
  buffer_store_dword v126, off, s[4:7], s50 sc1
  s_mov_b64 exec, -1
  v_smfmac_f32_16x16x64_bf16 v[40:43], v[92:95], a[192:199], v113
  v_smfmac_f32_16x16x64_bf16 v[36:39], v[92:95], a[72:79], v113
  v_smfmac_f32_16x16x64_bf16 v[44:47], v[92:95], a[200:207], v113
  s_branch dpj_38
mcc_40:
  s_cmp_eq_u32 s29, 0
  s_cbranch_scc1 mcok_41
  s_sub_u32 s29, s29, 1
  buffer_load_dwordx4 v[100:103], v112, s[4:7], s44 offen offset:0 sc1
  s_waitcnt vmcnt(1)
  v_and_b32 v125, 1, v88
  v_cmp_ne_u32 vcc, s49, v125
  s_cbranch_vccz mcu_44
mcl_43:
  buffer_load_dwordx4 v[88:91], v112, s[4:7], s44 offen offset:0 sc1
  s_waitcnt vmcnt(1)
  v_and_b32 v125, 1, v100
  v_cmp_ne_u32 vcc, s49, v125
  s_cbranch_vccz mcok_41
  s_cmp_eq_u32 s29, 0
  s_cbranch_scc1 mcok_41
  s_sub_u32 s29, s29, 1
  buffer_load_dwordx4 v[100:103], v112, s[4:7], s44 offen offset:0 sc1
  s_waitcnt vmcnt(1)
  v_and_b32 v125, 1, v88
  v_cmp_ne_u32 vcc, s49, v125
  s_cbranch_vccnz mcl_43
mcu_44:
  v_dot2_f32_bf16 v32, v88, s34, v32
  v_dot2_f32_bf16 v33, v88, s35, v33
  v_dot2_f32_bf16 v34, v89, s34, v34
  v_dot2_f32_bf16 v35, v89, s35, v35
  v_dot2_f32_bf16 v36, v90, s34, v36
  v_dot2_f32_bf16 v37, v90, s35, v37
  v_dot2_f32_bf16 v38, v91, s34, v38
  v_dot2_f32_bf16 v39, v91, s35, v39
  s_branch mcj_42
kvc_45:
  s_lshl_b32 s25, s52, 9
  s_add_u32 s25, s25, s54
  buffer_load_dword v125, off, s[4:7], s25 sc1
  s_waitcnt vmcnt(0)
  v_readfirstlane_b32 s26, v125
  s_cmp_lg_u32 s26, 0
  s_cbranch_scc1 kvb_46
  s_cmp_eq_u32 s29, 0
  s_cbranch_scc1 kvb_46
  s_sub_u32 s29, s29, 1
  s_branch kvc_45
spr_47:
  s_cmp_eq_u32 s29, 0
  s_cbranch_scc1 spok_48
  s_sub_u32 s29, s29, 1
  buffer_load_dwordx2 v[88:89], v86, s[4:7], s46 offen offset:0 sc1
  s_waitcnt vmcnt(0)
  v_and_b32 v125, 1, v88
  v_cmp_ne_u32 vcc, s49, v125
  s_cbranch_vccnz spr_47
  s_branch spok_48
PR_57:
  s_cmp_eq_u32 s29, 0
  s_cbranch_scc1 Pok_58
  s_sub_u32 s29, s29, 1
  buffer_load_dwordx4 v[0:3], v125, s[4:7], s48 offen offset:0 sc1
  buffer_load_dwordx4 v[4:7], v125, s[4:7], s48 offen offset:2048 sc1
  buffer_load_dwordx4 v[8:11], v125, s[4:7], s69 offen offset:0 sc1
  buffer_load_dwordx4 v[12:15], v125, s[4:7], s69 offen offset:2048 sc1
  s_waitcnt vmcnt(7)
  v_mfma_f32_16x16x32_bf16 v[100:103], v[16:19], v[96:99], 0
  s_waitcnt vmcnt(6)
  v_mfma_f32_16x16x32_bf16 v[100:103], v[20:23], v[96:99], v[100:103]
  v_bitop3_b32 v106, v16, v20, s49 bitop3:0x7e
  s_waitcnt vmcnt(5)
  v_mfma_f32_16x16x32_bf16 v[100:103], v[24:27], v[96:99], v[100:103]
  v_bitop3_b32 v106, v106, v24, s49 bitop3:0xf6
  s_waitcnt vmcnt(4)
  v_mfma_f32_16x16x32_bf16 v[100:103], v[28:31], v[96:99], v[100:103]
  v_bitop3_b32 v106, v106, v28, s49 bitop3:0xf6
  v_and_b32 v106, 1, v106
  v_cmp_ne_u32 vcc, 0, v106
  s_cbranch_vccz Pok_58
PL_59:
  buffer_load_dwordx4 v[16:19], v125, s[4:7], s48 offen offset:0 sc1
  buffer_load_dwordx4 v[20:23], v125, s[4:7], s48 offen offset:2048 sc1
  buffer_load_dwordx4 v[24:27], v125, s[4:7], s69 offen offset:0 sc1
  buffer_load_dwordx4 v[28:31], v125, s[4:7], s69 offen offset:2048 sc1
  s_waitcnt vmcnt(7)
  v_mfma_f32_16x16x32_bf16 v[100:103], v[0:3], v[96:99], 0
  s_waitcnt vmcnt(6)
  v_mfma_f32_16x16x32_bf16 v[100:103], v[4:7], v[96:99], v[100:103]
  v_bitop3_b32 v106, v0, v4, s49 bitop3:0x7e
  s_waitcnt vmcnt(5)
  v_mfma_f32_16x16x32_bf16 v[100:103], v[8:11], v[96:99], v[100:103]
  v_bitop3_b32 v106, v106, v8, s49 bitop3:0xf6
  s_waitcnt vmcnt(4)
  v_mfma_f32_16x16x32_bf16 v[100:103], v[12:15], v[96:99], v[100:103]
  v_bitop3_b32 v106, v106, v12, s49 bitop3:0xf6
  v_and_b32 v106, 1, v106
  v_cmp_ne_u32 vcc, 0, v106
  s_cbranch_vccz Pok_58
  s_cmp_eq_u32 s29, 0
  s_cbranch_scc1 Pok_58
  s_sub_u32 s29, s29, 1
  buffer_load_dwordx4 v[0:3], v125, s[4:7], s48 offen offset:0 sc1
  buffer_load_dwordx4 v[4:7], v125, s[4:7], s48 offen offset:2048 sc1
  buffer_load_dwordx4 v[8:11], v125, s[4:7], s69 offen offset:0 sc1
  buffer_load_dwordx4 v[12:15], v125, s[4:7], s69 offen offset:2048 sc1
  s_waitcnt vmcnt(7)
  v_mfma_f32_16x16x32_bf16 v[100:103], v[16:19], v[96:99], 0
  s_waitcnt vmcnt(6)
  v_mfma_f32_16x16x32_bf16 v[100:103], v[20:23], v[96:99], v[100:103]
  v_bitop3_b32 v106, v16, v20, s49 bitop3:0x7e
  s_waitcnt vmcnt(5)
  v_mfma_f32_16x16x32_bf16 v[100:103], v[24:27], v[96:99], v[100:103]
  v_bitop3_b32 v106, v106, v24, s49 bitop3:0xf6
  s_waitcnt vmcnt(4)
  v_mfma_f32_16x16x32_bf16 v[100:103], v[28:31], v[96:99], v[100:103]
  v_bitop3_b32 v106, v106, v28, s49 bitop3:0xf6
  v_and_b32 v106, 1, v106
  v_cmp_ne_u32 vcc, 0, v106
  s_cbranch_vccnz PL_59
  s_branch Pok_58
dpra_60:
  s_cmp_eq_u32 s29, 0
  s_cbranch_scc1 dpoka_63
  s_sub_u32 s29, s29, 1
  buffer_load_dwordx4 v[80:83], v112, s[4:7], s40 offen sc1
  buffer_load_dwordx4 v[84:87], v112, s[4:7], s67 offen sc1
  s_waitcnt vmcnt(2)
  v_max3_u32 v106, v88, v89, v90
  v_max3_u32 v107, v91, v92, v93
  v_max3_u32 v106, v106, v94, v95
  v_max_u32 v106, v106, v107
  v_cmp_eq_u32 vcc, -1, v106
  s_cbranch_vccz dpub_61
dpl_79:
  buffer_load_dwordx4 v[88:91], v112, s[4:7], s40 offen sc1
  buffer_load_dwordx4 v[92:95], v112, s[4:7], s67 offen sc1
  s_waitcnt vmcnt(2)
  v_max3_u32 v106, v80, v81, v82
  v_max3_u32 v107, v83, v84, v85
  v_max3_u32 v106, v106, v86, v87
  v_max_u32 v106, v106, v107
  v_cmp_eq_u32 vcc, -1, v106
  s_cbranch_vccz dpoka_63
  s_cmp_eq_u32 s29, 0
  s_cbranch_scc1 dpoka_63
  s_sub_u32 s29, s29, 1
  buffer_load_dwordx4 v[80:83], v112, s[4:7], s40 offen sc1
  buffer_load_dwordx4 v[84:87], v112, s[4:7], s67 offen sc1
  s_waitcnt vmcnt(2)
  v_max3_u32 v106, v88, v89, v90
  v_max3_u32 v107, v91, v92, v93
  v_max3_u32 v106, v106, v94, v95
  v_max_u32 v106, v106, v107
  v_cmp_eq_u32 vcc, -1, v106
  s_cbranch_vccnz dpl_79
dpub_61:
  ds_write_b128 v125, v[88:91]
  ds_write_b128 v125, v[92:95] offset:4096
  v_smfmac_f32_16x16x64_bf16 v[32:35], v[88:91], a[0:7], v113
  v_smfmac_f32_16x16x64_bf16 v[40:43], v[88:91], a[128:135], v113
  v_smfmac_f32_16x16x64_bf16 v[36:39], v[88:91], a[8:15], v113
  v_smfmac_f32_16x16x64_bf16 v[44:47], v[88:91], a[136:143], v113
  s_waitcnt lgkmcnt(0)
  s_barrier
  ds_read_b128 v[4:7], v100 offset:0
  ds_read_b128 v[8:11], v101 offset:0
  ds_read_b128 v[12:15], v102 offset:0
  ds_read_b128 v[20:23], v100 offset:4096
  ds_read_b128 v[24:27], v101 offset:4096
  ds_read_b128 v[28:31], v102 offset:4096
  ds_read_b128 v[0:3], v125 offset:0
  ds_read_b128 v[16:19], v125 offset:4096
  v_smfmac_f32_16x16x64_bf16 v[32:35], v[92:95], a[64:71], v113
  s_mov_b64 exec, s[96:97]
  buffer_store_dword v126, off, s[4:7], s50 sc1
  s_mov_b64 exec, -1
  v_smfmac_f32_16x16x64_bf16 v[40:43], v[92:95], a[192:199], v113
  v_smfmac_f32_16x16x64_bf16 v[36:39], v[92:95], a[72:79], v113
  v_smfmac_f32_16x16x64_bf16 v[44:47], v[92:95], a[200:207], v113
  s_branch dpj_62
mcc_64:
  s_cmp_eq_u32 s29, 0
  s_cbranch_scc1 mcok_65
  s_sub_u32 s29, s29, 1
mcl_67:
  buffer_load_dwordx4 v[100:103], v112, s[4:7], s44 offen offset:0 sc1
  s_waitcnt vmcnt(0)
  v_and_b32 v125, 1, v100
  v_cmp_ne_u32 vcc, s49, v125
  s_cbranch_vccz mcok_65
  s_cmp_eq_u32 s29, 0
  s_cbranch_scc1 mcok_65
  s_sub_u32 s29, s29, 1
  s_branch mcl_67
spr_75:
  s_cmp_eq_u32 s29, 0
  s_cbranch_scc1 spok_76
  s_sub_u32 s29, s29, 1
  buffer_load_dwordx2 v[88:89], v86, s[4:7], s46 offen offset:0 sc1
  s_waitcnt vmcnt(0)
  v_and_b32 v125, 1, v88
  v_cmp_ne_u32 vcc, s49, v125
  s_cbranch_vccnz spr_75
  s_branch spok_76
loop5done_35:
  s_branch chain_end_25
die1_33:
  s_branch step5_80
  .p2alignl 8, 0xbf800000
  s_nop 0
  s_nop 0
  s_nop 0
  s_nop 0
  s_nop 0
  s_nop 0
  s_nop 0
  s_nop 0
  s_nop 0
  s_nop 0
  s_nop 0
  s_nop 0
  s_nop 0
  s_nop 0
  s_nop 0
  s_nop 0
  s_nop 0
  s_nop 0
  s_nop 0
  s_nop 0
  s_nop 0
  s_nop 0
  s_nop 0
  s_nop 0
  s_nop 0
  s_nop 0
  s_nop 0
  s_nop 0
  s_nop 0
  s_nop 0
  s_nop 0
  s_nop 0
  s_nop 0
  s_nop 0
  s_nop 0
  s_nop 0
  s_nop 0
  s_nop 0
  s_nop 0
  s_nop 0
  s_nop 0
  s_nop 0
  s_nop 0
  s_nop 0
  s_nop 0
step5_80:
  ds_read_b128 v[56:59], v118 offset:0
  ds_read_b128 v[60:63], v118 offset:1024
  ds_read_b128 v[64:67], v118 offset:2048
  ds_read_b128 v[68:71], v118 offset:3072
  ds_read_b128 v[72:75], v118 offset:4096
  ds_read_b128 v[76:79], v118 offset:5120
  buffer_load_dwordx4 v[80:83], v112, s[4:7], s40 offen sc1
  buffer_load_dwordx4 v[84:87], v112, s[4:7], s67 offen sc1
  s_lshl_b32 s23, s14, 10
  v_add_u32 v125, s23, v127
  v_xor_b32 v100, 1024, v125
  v_xor_b32 v101, 2048, v125
  v_xor_b32 v102, 3072, v125
  s_xor_b32 s48, s48, 262144
  s_xor_b32 s69, s69, 262144
  s_xor_b32 s41, s41, 0x2000
  s_xor_b32 s42, s42, 0x2000
  s_lshr_b32 s49, s15, 1
  s_and_b32 s49, s49, 1
  buffer_load_dwordx4 v[88:91], v112, s[4:7], s40 offen sc1
  buffer_load_dwordx4 v[92:95], v112, s[4:7], s67 offen sc1
  s_waitcnt vmcnt(2)
  v_max3_u32 v106, v80, v81, v82
  v_max3_u32 v107, v83, v84, v85
  v_max3_u32 v106, v106, v86, v87
  v_max_u32 v106, v106, v107
  v_cmp_eq_u32 vcc, -1, v106
  s_cbranch_vccnz dpra_82
dpoka_85:
  ds_write_b128 v125, v[80:83]
  ds_write_b128 v125, v[84:87] offset:4096
  v_smfmac_f32_16x16x64_bf16 v[32:35], v[80:83], a[0:7], v113
  v_smfmac_f32_16x16x64_bf16 v[40:43], v[80:83], a[128:135], v113
  v_smfmac_f32_16x16x64_bf16 v[36:39], v[80:83], a[8:15], v113
  v_smfmac_f32_16x16x64_bf16 v[44:47], v[80:83], a[136:143], v113
  s_waitcnt lgkmcnt(0)
  s_barrier
  ds_read_b128 v[4:7], v100 offset:0
  ds_read_b128 v[8:11], v101 offset:0
  ds_read_b128 v[12:15], v102 offset:0
  ds_read_b128 v[20:23], v100 offset:4096
  ds_read_b128 v[24:27], v101 offset:4096
  ds_read_b128 v[28:31], v102 offset:4096
  ds_read_b128 v[0:3], v125 offset:0
  ds_read_b128 v[16:19], v125 offset:4096
  v_smfmac_f32_16x16x64_bf16 v[32:35], v[84:87], a[64:71], v113
  s_mov_b64 exec, s[96:97]
  buffer_store_dword v126, off, s[4:7], s50 sc1
  s_mov_b64 exec, -1
  v_smfmac_f32_16x16x64_bf16 v[40:43], v[84:87], a[192:199], v113
  v_smfmac_f32_16x16x64_bf16 v[36:39], v[84:87], a[72:79], v113
  v_smfmac_f32_16x16x64_bf16 v[44:47], v[84:87], a[200:207], v113
dpj_84:
  buffer_load_dword v110, off, s[4:7], s55 sc1
  s_waitcnt lgkmcnt(7)
  v_smfmac_f32_16x16x64_bf16 v[32:35], v[4:7], a[16:23], v113
  v_smfmac_f32_16x16x64_bf16 v[40:43], v[4:7], a[144:151], v113
  v_smfmac_f32_16x16x64_bf16 v[36:39], v[4:7], a[24:31], v113
  v_smfmac_f32_16x16x64_bf16 v[44:47], v[4:7], a[152:159], v113
  s_waitcnt lgkmcnt(6)
  v_smfmac_f32_16x16x64_bf16 v[32:35], v[8:11], a[32:39], v113
  v_smfmac_f32_16x16x64_bf16 v[40:43], v[8:11], a[160:167], v113
  s_waitcnt lgkmcnt(5)
  v_smfmac_f32_16x16x64_bf16 v[32:35], v[12:15], a[48:55], v113
  v_smfmac_f32_16x16x64_bf16 v[40:43], v[12:15], a[176:183], v113
  s_waitcnt lgkmcnt(4)
  v_smfmac_f32_16x16x64_bf16 v[32:35], v[20:23], a[80:87], v113
  v_smfmac_f32_16x16x64_bf16 v[40:43], v[20:23], a[208:215], v113
  s_waitcnt lgkmcnt(3)
  v_smfmac_f32_16x16x64_bf16 v[32:35], v[24:27], a[96:103], v113
  v_smfmac_f32_16x16x64_bf16 v[40:43], v[24:27], a[224:231], v113
  s_waitcnt lgkmcnt(2)
  v_smfmac_f32_16x16x64_bf16 v[32:35], v[28:31], a[112:119], v113
  v_smfmac_f32_16x16x64_bf16 v[40:43], v[28:31], a[240:247], v113
  v_smfmac_f32_16x16x64_bf16 v[36:39], v[8:11], a[40:47], v113
  v_smfmac_f32_16x16x64_bf16 v[44:47], v[8:11], a[168:175], v113
  v_smfmac_f32_16x16x64_bf16 v[36:39], v[12:15], a[56:63], v113
  v_permlane32_swap_b32 v32, v40
  v_smfmac_f32_16x16x64_bf16 v[44:47], v[12:15], a[184:191], v113
  v_permlane32_swap_b32 v33, v41
  v_smfmac_f32_16x16x64_bf16 v[36:39], v[20:23], a[88:95], v113
  v_permlane32_swap_b32 v34, v42
  v_smfmac_f32_16x16x64_bf16 v[44:47], v[20:23], a[216:223], v113
  v_permlane32_swap_b32 v35, v43
  v_smfmac_f32_16x16x64_bf16 v[36:39], v[24:27], a[104:111], v113
  v_add_f32 v32, v32, v40
  v_smfmac_f32_16x16x64_bf16 v[44:47], v[24:27], a[232:239], v113
  v_add_f32 v33, v33, v41
  v_smfmac_f32_16x16x64_bf16 v[36:39], v[28:31], a[120:127], v113
  v_add_f32 v34, v34, v42
  v_smfmac_f32_16x16x64_bf16 v[44:47], v[28:31], a[248:255], v113
  v_add_f32 v35, v35, v43
  v_cvt_pk_bf16_f32 v40, v32, v33
  v_cvt_pk_bf16_f32 v41, v34, v35
  v_and_or_b32 v40, v40, -2, s49
  s_nop 3
  v_permlane32_swap_b32 v36, v44
  v_permlane32_swap_b32 v37, v45
  v_permlane32_swap_b32 v38, v46
  v_permlane32_swap_b32 v39, v47
  v_add_f32 v36, v36, v44
  v_add_f32 v37, v37, v45
  v_add_f32 v38, v38, v46
  v_add_f32 v39, v39, v47
  v_cvt_pk_bf16_f32 v42, v36, v37
  v_cvt_pk_bf16_f32 v43, v38, v39
  buffer_store_dwordx4 v[40:43], v112, s[4:7], s43 offen sc1
  s_waitcnt lgkmcnt(0)
  v_smfmac_f32_16x16x64_bf16 v[48:51], v[0:3], v[56:63], v113
  ds_read_b128 v[56:59], v118 offset:6144
  ds_read_b128 v[60:63], v118 offset:7168
  v_smfmac_f32_16x16x64_bf16 v[52:55], v[0:3], v[64:71], v113
  ds_read_b128 v[64:67], v118 offset:8192
  ds_read_b128 v[68:71], v118 offset:9216
  v_smfmac_f32_16x16x64_bf16 v[48:51], v[4:7], v[72:79], v113
  ds_read_b128 v[72:75], v118 offset:10240
  ds_read_b128 v[76:79], v118 offset:11264
  s_waitcnt lgkmcnt(4)
  v_smfmac_f32_16x16x64_bf16 v[52:55], v[4:7], v[56:63], v113
  ds_read_b128 v[56:59], v118 offset:12288
  ds_read_b128 v[60:63], v118 offset:13312
  s_waitcnt lgkmcnt(4)
  v_smfmac_f32_16x16x64_bf16 v[48:51], v[8:11], v[64:71], v113
  ds_read_b128 v[64:67], v118 offset:14336
  ds_read_b128 v[68:71], v118 offset:15360
  s_waitcnt lgkmcnt(4)
  v_smfmac_f32_16x16x64_bf16 v[52:55], v[8:11], v[72:79], v113
  ds_read_b128 v[72:75], v119 offset:0
  ds_read_b128 v[76:79], v119 offset:1024
  s_waitcnt lgkmcnt(4)
  v_smfmac_f32_16x16x64_bf16 v[48:51], v[12:15], v[56:63], v113
  ds_read_b128 v[56:59], v119 offset:2048
  ds_read_b128 v[60:63], v119 offset:3072
  s_waitcnt lgkmcnt(4)
  v_smfmac_f32_16x16x64_bf16 v[52:55], v[12:15], v[64:71], v113
  ds_read_b128 v[64:67], v119 offset:4096
  ds_read_b128 v[68:71], v119 offset:5120
  s_waitcnt lgkmcnt(4)
  v_smfmac_f32_16x16x64_bf16 v[48:51], v[16:19], v[72:79], v113
  ds_read_b128 v[72:75], v119 offset:6144
  ds_read_b128 v[76:79], v119 offset:7168
  buffer_load_dwordx4 v[100:103], v112, s[4:7], s44 offen offset:0 sc1
  s_waitcnt lgkmcnt(4)
  v_smfmac_f32_16x16x64_bf16 v[52:55], v[16:19], v[56:63], v113
  ds_read_b128 v[56:59], v119 offset:8192
  ds_read_b128 v[60:63], v119 offset:9216
  s_waitcnt lgkmcnt(4)
  v_smfmac_f32_16x16x64_bf16 v[48:51], v[20:23], v[64:71], v113
  ds_read_b128 v[64:67], v119 offset:10240
  ds_read_b128 v[68:71], v119 offset:11264
  s_waitcnt lgkmcnt(4)
  v_smfmac_f32_16x16x64_bf16 v[52:55], v[20:23], v[72:79], v113
  ds_read_b128 v[72:75], v119 offset:12288
  ds_read_b128 v[76:79], v119 offset:13312
  s_waitcnt lgkmcnt(4)
  v_smfmac_f32_16x16x64_bf16 v[48:51], v[24:27], v[56:63], v113
  ds_read_b128 v[56:59], v119 offset:14336
  ds_read_b128 v[60:63], v119 offset:15360
  s_waitcnt lgkmcnt(4)
  v_smfmac_f32_16x16x64_bf16 v[52:55], v[24:27], v[64:71], v113
  s_waitcnt lgkmcnt(2)
  v_smfmac_f32_16x16x64_bf16 v[48:51], v[28:31], v[72:79], v113
  s_waitcnt lgkmcnt(0)
  v_smfmac_f32_16x16x64_bf16 v[52:55], v[28:31], v[56:63], v113
  s_waitcnt vmcnt(3)
  s_nop 6
  v_permlane32_swap_b32 v48, v52
  v_permlane32_swap_b32 v49, v53
  v_permlane32_swap_b32 v50, v54
  v_permlane32_swap_b32 v51, v55
  v_pk_add_f32 v[92:93], v[48:49], v[52:53]
  v_pk_add_f32 v[94:95], v[50:51], v[54:55]
  v_cvt_pk_bf16_f32 v44, v92, v93
  v_cvt_pk_bf16_f32 v45, v94, v95
  v_lshrrev_b32 v86, 1, v112
  v_and_or_b32 v44, v44, -2, s49
  buffer_store_dwordx2 v[44:45], v86, s[4:7], s45 offen offset:0 sc1
  buffer_load_dwordx4 v[88:91], v112, s[4:7], s44 offen offset:0 sc1
  ds_read_b128 v[0:3], v116 offset:0
  ds_read_b128 v[4:7], v116 offset:2048
  ds_read_b128 v[8:11], v116 offset:4096
  ds_read_b128 v[12:15], v116 offset:6144
  ds_read_b128 v[16:19], v116 offset:256
  ds_read_b128 v[20:23], v116 offset:2304
  ds_read_b128 v[24:27], v116 offset:4352
  ds_read_b128 v[28:31], v116 offset:6400
  ds_read_b128 v[68:71], v117 offset:0
  ds_read_b128 v[72:75], v117 offset:256
  v_mov_b32 v64, v111
  v_mov_b32 v65, v111
  v_mov_b32 v66, v111
  v_mov_b32 v67, v111
  s_waitcnt vmcnt(2)
  v_and_b32 v125, 1, v100
  v_cmp_ne_u32 vcc, s49, v125
  s_cbranch_vccnz mcc_86
mcok_87:
  v_dot2_f32_bf16 v32, v100, s34, v32
  v_dot2_f32_bf16 v33, v100, s35, v33
  v_dot2_f32_bf16 v34, v101, s34, v34
  v_dot2_f32_bf16 v35, v101, s35, v35
  v_dot2_f32_bf16 v36, v102, s34, v36
  v_dot2_f32_bf16 v37, v102, s35, v37
  v_dot2_f32_bf16 v38, v103, s34, v38
  v_dot2_f32_bf16 v39, v103, s35, v39
mcj_88:
  v_cvt_pk_bf16_f32 v32, v32, v33
  v_cvt_pk_bf16_f32 v33, v34, v35
  ds_write_b64 v115, v[32:33] offset:0
  v_cvt_pk_bf16_f32 v36, v36, v37
  v_cvt_pk_bf16_f32 v37, v38, v39
  ds_write_b64 v115, v[36:37] offset:512
  s_waitcnt lgkmcnt(0)
  s_barrier
  buffer_load_dwordx2 v[88:89], v86, s[4:7], s46 offen offset:0 sc1
  ds_read_b64_tr_b16 v[32:33], v114 offset:0
  ds_read_b64_tr_b16 v[34:35], v114 offset:128
  ds_read_b64_tr_b16 v[36:37], v114 offset:1024
  ds_read_b64_tr_b16 v[38:39], v114 offset:1152
  ds_read_b64_tr_b16 v[40:41], v114 offset:2048
  ds_read_b64_tr_b16 v[42:43], v114 offset:2176
  ds_read_b64_tr_b16 v[44:45], v114 offset:3072
  ds_read_b64_tr_b16 v[46:47], v114 offset:3200
  v_readfirstlane_b32 s53, v110
  s_cmp_eq_u32 s53, 0
  s_cbranch_scc1 kvc_91
kvb_92:
  s_lshl_b32 s27, s52, 18
  s_add_u32 s27, s27, s66
  s_lshl_b32 s24, s14, 12
  s_mov_b32 m0, s24
  v_mov_b32 v125, s49
  s_mov_b64 exec, s[8:9]
  buffer_store_dword v125, v112, s[4:7], s44 offen sc1
  s_mov_b64 exec, -1
  s_waitcnt lgkmcnt(6)
  v_mfma_f32_16x16x32_bf16 v[56:59], v[0:3], v[32:35], 0
  v_mfma_f32_16x16x32_bf16 v[60:63], v[16:19], v[32:35], 0
  v_mfma_f32_16x16x32_bf16 v[64:67], v[32:35], v[32:35], v[64:67]
  buffer_load_dwordx4 v112, s[4:7], s27 offen offset:0 sc1 lds
  s_waitcnt lgkmcnt(4)
  v_mfma_f32_16x16x32_bf16 v[56:59], v[4:7], v[36:39], v[56:59]
  v_mfma_f32_16x16x32_bf16 v[60:63], v[20:23], v[36:39], v[60:63]
  v_mfma_f32_16x16x32_bf16 v[64:67], v[36:39], v[36:39], v[64:67]
  s_waitcnt lgkmcnt(2)
  v_mfma_f32_16x16x32_bf16 v[56:59], v[8:11], v[40:43], v[56:59]
  v_mfma_f32_16x16x32_bf16 v[60:63], v[24:27], v[40:43], v[60:63]
  v_mfma_f32_16x16x32_bf16 v[64:67], v[40:43], v[40:43], v[64:67]
  buffer_load_dwordx4 v112, s[4:7], s27 offen offset:1024 sc1 lds
  s_waitcnt lgkmcnt(0)
  v_mfma_f32_16x16x32_bf16 v[56:59], v[12:15], v[44:47], v[56:59]
  v_mfma_f32_16x16x32_bf16 v[60:63], v[28:31], v[44:47], v[60:63]
  v_mfma_f32_16x16x32_bf16 v[64:67], v[44:47], v[44:47], v[64:67]
  v_mov_b32 v28, 0x3f803f80
  v_mov_b32 v29, 0x3f803f80
  v_max3_f32 v106, v56, v57, v58
  v_mov_b32 v30, 0x3f803f80
  v_mov_b32 v31, 0x3f803f80
  v_mov_b64 v[0:1], 0
  v_max3_f32 v107, v59, v60, v61
  v_max3_f32 v106, v106, v62, v63
  v_max3_f32 v107, v107, v64, v65
  v_max3_f32 v106, v106, v66, v67
  v_max_f32 v106, v106, v107
  v_mov_b32 v107, v106
  v_mov_b64 v[2:3], 0
  v_mov_b64 v[4:5], 0
  v_permlane16_swap_b32 v106, v107
  v_max_f32 v106, v106, v107
  v_mov_b32 v107, v106
  v_mov_b64 v[6:7], 0
  v_mov_b64 v[8:9], 0
  v_permlane32_swap_b32 v106, v107
  v_max_f32 v106, v106, v107
  v_mul_f32 v106, s38, v106
  buffer_load_dwordx4 v112, s[4:7], s27 offen offset:2048 sc1 lds
  v_pk_fma_f32 v[56:57], v[56:57], s[38:39], v[106:107] op_sel_hi:[1,1,0] neg_lo:[0,0,1] neg_hi:[0,0,1]
  v_pk_fma_f32 v[58:59], v[58:59], s[38:39], v[106:107] op_sel_hi:[1,1,0] neg_lo:[0,0,1] neg_hi:[0,0,1]
  v_pk_fma_f32 v[60:61], v[60:61], s[38:39], v[106:107] op_sel_hi:[1,1,0] neg_lo:[0,0,1] neg_hi:[0,0,1]
  v_pk_fma_f32 v[62:63], v[62:63], s[38:39], v[106:107] op_sel_hi:[1,1,0] neg_lo:[0,0,1] neg_hi:[0,0,1]
  v_pk_fma_f32 v[64:65], v[64:65], s[38:39], v[106:107] op_sel_hi:[1,1,0] neg_lo:[0,0,1] neg_hi:[0,0,1]
  v_pk_fma_f32 v[66:67], v[66:67], s[38:39], v[106:107] op_sel_hi:[1,1,0] neg_lo:[0,0,1] neg_hi:[0,0,1]
  v_exp_f32 v56, v56
  v_exp_f32 v57, v57
  buffer_load_dwordx4 v112, s[4:7], s27 offen offset:3072 sc1 lds
  v_exp_f32 v58, v58
  v_exp_f32 v59, v59
  v_exp_f32 v60, v60
  v_exp_f32 v61, v61
  v_exp_f32 v62, v62
  v_exp_f32 v63, v63
  v_exp_f32 v64, v64
  v_exp_f32 v65, v65
  v_exp_f32 v66, v66
  v_exp_f32 v67, v67
  v_cvt_pk_bf16_f32 v80, v56, v57
  v_cvt_pk_bf16_f32 v81, v58, v59
  v_cvt_pk_bf16_f32 v82, v60, v61
  v_cvt_pk_bf16_f32 v83, v62, v63
  v_cvt_pk_bf16_f32 v84, v64, v65
  v_cvt_pk_bf16_f32 v85, v66, v67
  v_mfma_f32_16x16x32_bf16 v[106:109], v[28:31], v[80:83], 0
  v_mfma_f32_16x16x32_bf16 v[48:51], v[68:71], v[80:83], 0
  v_mfma_f32_16x16x32_bf16 v[52:55], v[72:75], v[80:83], 0
  v_mfma_f32_16x16x16_bf16 v[106:109], v[28:29], v[84:85], v[106:109]
  v_mov_b64 v[60:61], 0
  s_waitcnt vmcnt(5)
  v_and_b32 v125, 1, v88
  v_cmp_ne_u32 vcc, s49, v125
  s_cbranch_vccnz spr_93
spok_94:
  v_dot2_f32_bf16 v92, v88, s34, v92
  v_dot2_f32_bf16 v93, v88, s35, v93
  v_dot2_f32_bf16 v94, v89, s34, v94
  v_dot2_f32_bf16 v95, v89, s35, v95
  s_nop 0
  v_cvt_pk_bf16_f32 v104, v92, v93
  s_nop 0
  v_cvt_pk_bf16_f32 v105, v94, v95
  v_permlane32_swap_b32 v60, v104
  v_mov_b64 v[10:11], 0
  v_permlane32_swap_b32 v61, v105
  v_rcp_f32 v106, v106
  v_mov_b64 v[12:13], 0
  v_mfma_f32_16x16x16_bf16 v[48:51], v[60:61], v[84:85], v[48:51]
  v_mfma_f32_16x16x16_bf16 v[52:55], v[104:105], v[84:85], v[52:55]
  s_mov_b64 exec, s[10:11]
  buffer_store_dword v88, v86, s[4:7], s46 offen sc1
  s_mov_b64 exec, -1
  v_mov_b64 v[14:15], 0
  v_mov_b64 v[16:17], 0
  v_mov_b64 v[18:19], 0
  v_mov_b64 v[20:21], 0
  v_pk_mul_f32 v[48:49], v[48:49], v[106:107] op_sel_hi:[1,0]
  v_pk_mul_f32 v[50:51], v[50:51], v[106:107] op_sel_hi:[1,0]
  v_cvt_pk_bf16_f32 v48, v48, v49
  v_cvt_pk_bf16_f32 v49, v50, v51
  v_pk_mul_f32 v[52:53], v[52:53], v[106:107] op_sel_hi:[1,0]
  v_pk_mul_f32 v[54:55], v[54:55], v[106:107] op_sel_hi:[1,0]
  v_cvt_pk_bf16_f32 v52, v52, v53
  v_cvt_pk_bf16_f32 v53, v54, v55
  s_mov_b64 exec, s[32:33]
  ds_write_b64 v120, v[48:49] offset:0
  ds_write_b64 v120, v[52:53] offset:256
  s_mov_b64 exec, -1
  v_mov_b64 v[22:23], 0
  v_mov_b64 v[24:25], 0
  v_mov_b64 v[26:27], 0
  v_mov_b64 v[28:29], 0
  v_mov_b64 v[30:31], 0
  v_permlane32_swap_b32 v60, v104
  v_permlane32_swap_b32 v61, v105
  buffer_store_dwordx2 v[104:105], v124, s[4:7], s51 offen sc1
  s_waitcnt lgkmcnt(0)
  s_barrier
  ds_read_b128 v[56:59], v112 offset:20480
  ds_read_b128 v[60:63], v112 offset:21504
  v_and_b32 v125, 0x380, v112
  v_add_u32 v125, v125, v112
  s_waitcnt lgkmcnt(1)
  s_mov_b32 s27, s47
  v_smfmac_f32_16x16x64_bf16 v[0:3], v[56:59], v[128:135], v113
  v_smfmac_f32_16x16x64_bf16 v[4:7], v[56:59], v[144:151], v113
  s_waitcnt lgkmcnt(0)
  v_smfmac_f32_16x16x64_bf16 v[0:3], v[60:63], v[136:143], v113
  v_smfmac_f32_16x16x64_bf16 v[4:7], v[60:63], v[152:159], v113
  v_smfmac_f32_16x16x64_bf16 v[8:11], v[56:59], v[160:167], v113
  v_smfmac_f32_16x16x64_bf16 v[12:15], v[56:59], v[176:183], v113
  s_nop 1
  v_permlane32_swap_b32 v0, v4
  v_permlane32_swap_b32 v1, v5
  v_permlane32_swap_b32 v2, v6
  v_smfmac_f32_16x16x64_bf16 v[8:11], v[60:63], v[168:175], v113
  v_permlane32_swap_b32 v3, v7
  v_add_f32 v0, v0, v4
  v_add_f32 v1, v1, v5
  v_smfmac_f32_16x16x64_bf16 v[12:15], v[60:63], v[184:191], v113
  v_add_f32 v2, v2, v6
  v_add_f32 v3, v3, v7
  v_cvt_pk_bf16_f32 v64, v0, v1
  v_smfmac_f32_16x16x64_bf16 v[16:19], v[56:59], v[192:199], v113
  v_cvt_pk_bf16_f32 v65, v2, v3
  v_smfmac_f32_16x16x64_bf16 v[20:23], v[56:59], v[208:215], v113
  s_nop 1
  v_permlane32_swap_b32 v8, v12
  v_permlane32_swap_b32 v9, v13
  v_permlane32_swap_b32 v10, v14
  v_smfmac_f32_16x16x64_bf16 v[16:19], v[60:63], v[200:207], v113
  v_permlane32_swap_b32 v11, v15
  v_add_f32 v8, v8, v12
  v_add_f32 v9, v9, v13
  v_smfmac_f32_16x16x64_bf16 v[20:23], v[60:63], v[216:223], v113
  v_add_f32 v10, v10, v14
  v_add_f32 v11, v11, v15
  v_cvt_pk_bf16_f32 v66, v8, v9
  v_smfmac_f32_16x16x64_bf16 v[24:27], v[56:59], v[224:231], v113
  v_cvt_pk_bf16_f32 v67, v10, v11
  v_permlane16_swap_b32 v64, v66
  s_nop 0
  v_permlane16_swap_b32 v65, v67
  v_smfmac_f32_16x16x64_bf16 v[28:31], v[56:59], v[240:247], v113
  v_and_or_b32 v64, v64, -2, s49
  buffer_store_dwordx4 v[64:67], v121, s[4:7], s27 offen
  s_add_u32 s27, s27, 32768
  s_cmp_lt_u32 s14, 2
  v_permlane32_swap_b32 v16, v20
  v_smfmac_f32_16x16x64_bf16 v[24:27], v[60:63], v[232:239], v113
  v_permlane32_swap_b32 v17, v21
  v_permlane32_swap_b32 v18, v22
  v_permlane32_swap_b32 v19, v23
  v_smfmac_f32_16x16x64_bf16 v[28:31], v[60:63], v[248:255], v113
  v_add_f32 v16, v16, v20
  v_add_f32 v17, v17, v21
  v_add_f32 v18, v18, v22
  v_add_f32 v19, v19, v23
  v_cvt_pk_bf16_f32 v68, v16, v17
  v_cvt_pk_bf16_f32 v69, v18, v19
  s_nop 1
  v_permlane32_swap_b32 v24, v28
  v_permlane32_swap_b32 v25, v29
  v_permlane32_swap_b32 v26, v30
  v_permlane32_swap_b32 v27, v31
  v_pk_add_f32 v[24:25], v[24:25], v[28:29]
  v_pk_add_f32 v[26:27], v[26:27], v[30:31]
  v_cvt_pk_bf16_f32 v70, v24, v25
  v_cvt_pk_bf16_f32 v71, v26, v27
  s_nop 0
  v_permlane16_swap_b32 v68, v70
  v_permlane16_swap_b32 v69, v71
  v_and_or_b32 v68, v68, -2, s49
  buffer_store_dwordx4 v[68:71], v121, s[4:7], s27 offen
  s_cbranch_scc1 hk_101
  s_waitcnt vmcnt(0)
  buffer_load_dwordx4 v[0:3], v125, s[4:7], s48 offen offset:0 sc1
  buffer_load_dwordx4 v[4:7], v125, s[4:7], s48 offen offset:2048 sc1
  buffer_load_dwordx4 v[8:11], v125, s[4:7], s69 offen offset:0 sc1
  buffer_load_dwordx4 v[12:15], v125, s[4:7], s69 offen offset:2048 sc1
  s_xor_b32 s43, s43, 524288
  s_xor_b32 s44, s44, 524288
  s_xor_b32 s45, s45, 262144
  s_xor_b32 s46, s46, 262144
  s_xor_b32 s47, s47, 262144
  s_xor_b32 s40, s40, 0x2000
  s_add_u32 s51, s51, 65536
  s_add_u32 s50, s50, 512
  s_add_u32 s55, s55, 512
  s_xor_b32 s67, s67, 0x2000
  s_add_u32 s15, s15, 1
  s_add_u32 s52, s15, 1
  v_lshrrev_b32 v87, 4, v112
  v_and_b32 v106, 15, v87
  v_lshlrev_b32 v106, 4, v106
  v_bfe_u32 v107, v87, 4, 1
  buffer_load_dwordx4 v[16:19], v125, s[4:7], s48 offen offset:0 sc1
  buffer_load_dwordx4 v[20:23], v125, s[4:7], s48 offen offset:2048 sc1
  buffer_load_dwordx4 v[24:27], v125, s[4:7], s69 offen offset:0 sc1
  buffer_load_dwordx4 v[28:31], v125, s[4:7], s69 offen offset:2048 sc1
  v_lshl_add_u32 v106, v107, 3, v106
  v_lshrrev_b32 v107, 5, v87
  v_lshl_add_u32 v87, v107, 2, v106
  v_mov_b32 v108, -1
  v_mov_b64 v[32:33], 0
  v_mov_b64 v[34:35], 0
  v_mov_b64 v[36:37], 0
  v_mov_b64 v[38:39], 0
  v_mov_b64 v[40:41], 0
  v_mov_b64 v[42:43], 0
  v_mov_b64 v[44:45], 0
  v_mov_b64 v[46:47], 0
  v_mov_b64 v[48:49], 0
  v_mov_b64 v[50:51], 0
  v_mov_b64 v[52:53], 0
  v_mov_b64 v[54:55], 0
  s_waitcnt vmcnt(7)
  v_mfma_f32_16x16x32_bf16 v[100:103], v[0:3], v[96:99], 0
  s_waitcnt vmcnt(6)
  v_mfma_f32_16x16x32_bf16 v[100:103], v[4:7], v[96:99], v[100:103]
  v_bitop3_b32 v106, v0, v4, s49 bitop3:0x7e
  s_waitcnt vmcnt(5)
  v_mfma_f32_16x16x32_bf16 v[100:103], v[8:11], v[96:99], v[100:103]
  v_bitop3_b32 v106, v106, v8, s49 bitop3:0xf6
  s_waitcnt vmcnt(4)
  v_mfma_f32_16x16x32_bf16 v[100:103], v[12:15], v[96:99], v[100:103]
  v_bitop3_b32 v106, v106, v12, s49 bitop3:0xf6
  v_and_b32 v106, 1, v106
  v_cmp_ne_u32 vcc, 0, v106
  s_cbranch_vccnz PR_103
Pok_104:
  s_mov_b64 exec, s[32:33]
  buffer_store_dword v108, v87, s[4:7], s42 offen
  s_mov_b64 exec, -1
  s_nop 0
  v_permlane32_swap_b32 v100, v102
  v_permlane32_swap_b32 v101, v103
  v_pk_add_f32 v[100:101], v[100:101], v[102:103]
  v_cvt_pk_bf16_f32 v100, v100, v101
  s_mov_b64 exec, s[32:33]
  buffer_store_dword v100, v87, s[4:7], s41 offen
  s_mov_b64 exec, -1
redd_102:
  s_barrier
  s_cmp_lt_u32 s15, 63
  s_cbranch_scc1 step5_80
  ds_read_b128 v[56:59], v118 offset:0
  ds_read_b128 v[60:63], v118 offset:1024
  ds_read_b128 v[64:67], v118 offset:2048
  ds_read_b128 v[68:71], v118 offset:3072
  ds_read_b128 v[72:75], v118 offset:4096
  ds_read_b128 v[76:79], v118 offset:5120
  buffer_load_dwordx4 v[80:83], v112, s[4:7], s40 offen sc1
  buffer_load_dwordx4 v[84:87], v112, s[4:7], s67 offen sc1
  s_lshl_b32 s23, s14, 10
  v_add_u32 v125, s23, v127
  v_xor_b32 v100, 1024, v125
  v_xor_b32 v101, 2048, v125
  v_xor_b32 v102, 3072, v125
  s_xor_b32 s48, s48, 262144
  s_xor_b32 s69, s69, 262144
  s_xor_b32 s41, s41, 0x2000
  s_xor_b32 s42, s42, 0x2000
  s_lshr_b32 s49, s15, 1
  s_and_b32 s49, s49, 1
  buffer_load_dwordx4 v[88:91], v112, s[4:7], s40 offen sc1
  buffer_load_dwordx4 v[92:95], v112, s[4:7], s67 offen sc1
  s_waitcnt vmcnt(2)
  v_max3_u32 v106, v80, v81, v82
  v_max3_u32 v107, v83, v84, v85
  v_max3_u32 v106, v106, v86, v87
  v_max_u32 v106, v106, v107
  v_cmp_eq_u32 vcc, -1, v106
  s_cbranch_vccnz dpra_106
dpoka_109:
  ds_write_b128 v125, v[80:83]
  ds_write_b128 v125, v[84:87] offset:4096
  v_smfmac_f32_16x16x64_bf16 v[32:35], v[80:83], a[0:7], v113
  v_smfmac_f32_16x16x64_bf16 v[40:43], v[80:83], a[128:135], v113
  v_smfmac_f32_16x16x64_bf16 v[36:39], v[80:83], a[8:15], v113
  v_smfmac_f32_16x16x64_bf16 v[44:47], v[80:83], a[136:143], v113
  s_waitcnt lgkmcnt(0)
  s_barrier
  ds_read_b128 v[4:7], v100 offset:0
  ds_read_b128 v[8:11], v101 offset:0
  ds_read_b128 v[12:15], v102 offset:0
  ds_read_b128 v[20:23], v100 offset:4096
  ds_read_b128 v[24:27], v101 offset:4096
  ds_read_b128 v[28:31], v102 offset:4096
  ds_read_b128 v[0:3], v125 offset:0
  ds_read_b128 v[16:19], v125 offset:4096
  v_smfmac_f32_16x16x64_bf16 v[32:35], v[84:87], a[64:71], v113
  s_mov_b64 exec, s[96:97]
  buffer_store_dword v126, off, s[4:7], s50 sc1
  s_mov_b64 exec, -1
  v_smfmac_f32_16x16x64_bf16 v[40:43], v[84:87], a[192:199], v113
  v_smfmac_f32_16x16x64_bf16 v[36:39], v[84:87], a[72:79], v113
  v_smfmac_f32_16x16x64_bf16 v[44:47], v[84:87], a[200:207], v113
dpj_108:
  buffer_load_dword v110, off, s[4:7], s55 sc1
  s_waitcnt lgkmcnt(7)
  v_smfmac_f32_16x16x64_bf16 v[32:35], v[4:7], a[16:23], v113
  v_smfmac_f32_16x16x64_bf16 v[40:43], v[4:7], a[144:151], v113
  v_smfmac_f32_16x16x64_bf16 v[36:39], v[4:7], a[24:31], v113
  v_smfmac_f32_16x16x64_bf16 v[44:47], v[4:7], a[152:159], v113
  s_waitcnt lgkmcnt(6)
  v_smfmac_f32_16x16x64_bf16 v[32:35], v[8:11], a[32:39], v113
  v_smfmac_f32_16x16x64_bf16 v[40:43], v[8:11], a[160:167], v113
  s_waitcnt lgkmcnt(5)
  v_smfmac_f32_16x16x64_bf16 v[32:35], v[12:15], a[48:55], v113
  v_smfmac_f32_16x16x64_bf16 v[40:43], v[12:15], a[176:183], v113
  s_waitcnt lgkmcnt(4)
  v_smfmac_f32_16x16x64_bf16 v[32:35], v[20:23], a[80:87], v113
  v_smfmac_f32_16x16x64_bf16 v[40:43], v[20:23], a[208:215], v113
  s_waitcnt lgkmcnt(3)
  v_smfmac_f32_16x16x64_bf16 v[32:35], v[24:27], a[96:103], v113
  v_smfmac_f32_16x16x64_bf16 v[40:43], v[24:27], a[224:231], v113
  s_waitcnt lgkmcnt(2)
  v_smfmac_f32_16x16x64_bf16 v[32:35], v[28:31], a[112:119], v113
  v_smfmac_f32_16x16x64_bf16 v[40:43], v[28:31], a[240:247], v113
  v_smfmac_f32_16x16x64_bf16 v[36:39], v[8:11], a[40:47], v113
  v_smfmac_f32_16x16x64_bf16 v[44:47], v[8:11], a[168:175], v113
  v_smfmac_f32_16x16x64_bf16 v[36:39], v[12:15], a[56:63], v113
  v_permlane32_swap_b32 v32, v40
  v_smfmac_f32_16x16x64_bf16 v[44:47], v[12:15], a[184:191], v113
  v_permlane32_swap_b32 v33, v41
  v_smfmac_f32_16x16x64_bf16 v[36:39], v[20:23], a[88:95], v113
  v_permlane32_swap_b32 v34, v42
  v_smfmac_f32_16x16x64_bf16 v[44:47], v[20:23], a[216:223], v113
  v_permlane32_swap_b32 v35, v43
  v_smfmac_f32_16x16x64_bf16 v[36:39], v[24:27], a[104:111], v113
  v_add_f32 v32, v32, v40
  v_smfmac_f32_16x16x64_bf16 v[44:47], v[24:27], a[232:239], v113
  v_add_f32 v33, v33, v41
  v_smfmac_f32_16x16x64_bf16 v[36:39], v[28:31], a[120:127], v113
  v_add_f32 v34, v34, v42
  v_smfmac_f32_16x16x64_bf16 v[44:47], v[28:31], a[248:255], v113
  v_add_f32 v35, v35, v43
  v_cvt_pk_bf16_f32 v40, v32, v33
  v_cvt_pk_bf16_f32 v41, v34, v35
  v_and_or_b32 v40, v40, -2, s49
  s_nop 3
  v_permlane32_swap_b32 v36, v44
  v_permlane32_swap_b32 v37, v45
  v_permlane32_swap_b32 v38, v46
  v_permlane32_swap_b32 v39, v47
  v_add_f32 v36, v36, v44
  v_add_f32 v37, v37, v45
  v_add_f32 v38, v38, v46
  v_add_f32 v39, v39, v47
  v_cvt_pk_bf16_f32 v42, v36, v37
  v_cvt_pk_bf16_f32 v43, v38, v39
  buffer_store_dwordx4 v[40:43], v112, s[4:7], s43 offen sc1
  s_waitcnt lgkmcnt(0)
  v_smfmac_f32_16x16x64_bf16 v[48:51], v[0:3], v[56:63], v113
  ds_read_b128 v[56:59], v118 offset:6144
  ds_read_b128 v[60:63], v118 offset:7168
  v_smfmac_f32_16x16x64_bf16 v[52:55], v[0:3], v[64:71], v113
  ds_read_b128 v[64:67], v118 offset:8192
  ds_read_b128 v[68:71], v118 offset:9216
  v_smfmac_f32_16x16x64_bf16 v[48:51], v[4:7], v[72:79], v113
  ds_read_b128 v[72:75], v118 offset:10240
  ds_read_b128 v[76:79], v118 offset:11264
  s_waitcnt lgkmcnt(4)
  v_smfmac_f32_16x16x64_bf16 v[52:55], v[4:7], v[56:63], v113
  ds_read_b128 v[56:59], v118 offset:12288
  ds_read_b128 v[60:63], v118 offset:13312
  s_waitcnt lgkmcnt(4)
  v_smfmac_f32_16x16x64_bf16 v[48:51], v[8:11], v[64:71], v113
  ds_read_b128 v[64:67], v118 offset:14336
  ds_read_b128 v[68:71], v118 offset:15360
  s_waitcnt lgkmcnt(4)
  v_smfmac_f32_16x16x64_bf16 v[52:55], v[8:11], v[72:79], v113
  ds_read_b128 v[72:75], v119 offset:0
  ds_read_b128 v[76:79], v119 offset:1024
  s_waitcnt lgkmcnt(4)
  v_smfmac_f32_16x16x64_bf16 v[48:51], v[12:15], v[56:63], v113
  ds_read_b128 v[56:59], v119 offset:2048
  ds_read_b128 v[60:63], v119 offset:3072
  s_waitcnt lgkmcnt(4)
  v_smfmac_f32_16x16x64_bf16 v[52:55], v[12:15], v[64:71], v113
  ds_read_b128 v[64:67], v119 offset:4096
  ds_read_b128 v[68:71], v119 offset:5120
  s_waitcnt lgkmcnt(4)
  v_smfmac_f32_16x16x64_bf16 v[48:51], v[16:19], v[72:79], v113
  ds_read_b128 v[72:75], v119 offset:6144
  ds_read_b128 v[76:79], v119 offset:7168
  s_waitcnt lgkmcnt(4)
  v_smfmac_f32_16x16x64_bf16 v[52:55], v[16:19], v[56:63], v113
  ds_read_b128 v[56:59], v119 offset:8192
  ds_read_b128 v[60:63], v119 offset:9216
  s_waitcnt lgkmcnt(4)
  v_smfmac_f32_16x16x64_bf16 v[48:51], v[20:23], v[64:71], v113
  ds_read_b128 v[64:67], v119 offset:10240
  ds_read_b128 v[68:71], v119 offset:11264
  s_waitcnt lgkmcnt(4)
  v_smfmac_f32_16x16x64_bf16 v[52:55], v[20:23], v[72:79], v113
  ds_read_b128 v[72:75], v119 offset:12288
  ds_read_b128 v[76:79], v119 offset:13312
  s_waitcnt lgkmcnt(4)
  v_smfmac_f32_16x16x64_bf16 v[48:51], v[24:27], v[56:63], v113
  ds_read_b128 v[56:59], v119 offset:14336
  ds_read_b128 v[60:63], v119 offset:15360
  s_waitcnt lgkmcnt(4)
  v_smfmac_f32_16x16x64_bf16 v[52:55], v[24:27], v[64:71], v113
  s_waitcnt lgkmcnt(2)
  v_smfmac_f32_16x16x64_bf16 v[48:51], v[28:31], v[72:79], v113
  buffer_load_dwordx4 v[100:103], v112, s[4:7], s44 offen offset:0 sc1
  s_waitcnt lgkmcnt(0)
  v_smfmac_f32_16x16x64_bf16 v[52:55], v[28:31], v[56:63], v113
  s_waitcnt vmcnt(3)
  s_nop 6
  v_permlane32_swap_b32 v48, v52
  v_permlane32_swap_b32 v49, v53
  v_permlane32_swap_b32 v50, v54
  v_permlane32_swap_b32 v51, v55
  v_pk_add_f32 v[92:93], v[48:49], v[52:53]
  v_pk_add_f32 v[94:95], v[50:51], v[54:55]
  v_cvt_pk_bf16_f32 v44, v92, v93
  v_cvt_pk_bf16_f32 v45, v94, v95
  v_lshrrev_b32 v86, 1, v112
  v_and_or_b32 v44, v44, -2, s49
  buffer_store_dwordx2 v[44:45], v86, s[4:7], s45 offen offset:0 sc1
  s_waitcnt vmcnt(1)
  v_and_b32 v125, 1, v100
  v_cmp_ne_u32 vcc, s49, v125
  s_cbranch_vccnz mcc_110
mcok_111:
  v_dot2_f32_bf16 v32, v100, s34, v32
  v_dot2_f32_bf16 v33, v100, s35, v33
  v_dot2_f32_bf16 v34, v101, s34, v34
  v_dot2_f32_bf16 v35, v101, s35, v35
  v_dot2_f32_bf16 v36, v102, s34, v36
  v_dot2_f32_bf16 v37, v102, s35, v37
  v_dot2_f32_bf16 v38, v103, s34, v38
  v_dot2_f32_bf16 v39, v103, s35, v39
mcj_112:
  v_cvt_pk_bf16_f32 v32, v32, v33
  v_cvt_pk_bf16_f32 v33, v34, v35
  ds_write_b64 v115, v[32:33] offset:0
  v_cvt_pk_bf16_f32 v36, v36, v37
  v_cvt_pk_bf16_f32 v37, v38, v39
  ds_write_b64 v115, v[36:37] offset:512
  s_waitcnt lgkmcnt(0)
  s_barrier
  buffer_load_dwordx2 v[88:89], v86, s[4:7], s46 offen offset:0 sc1
  ds_read_b64_tr_b16 v[32:33], v114 offset:0
  ds_read_b64_tr_b16 v[34:35], v114 offset:128
  ds_read_b64_tr_b16 v[36:37], v114 offset:1024
  ds_read_b64_tr_b16 v[38:39], v114 offset:1152
  ds_read_b64_tr_b16 v[40:41], v114 offset:2048
  ds_read_b64_tr_b16 v[42:43], v114 offset:2176
  ds_read_b64_tr_b16 v[44:45], v114 offset:3072
  ds_read_b64_tr_b16 v[46:47], v114 offset:3200
  s_waitcnt lgkmcnt(0)
  s_cmp_lg_u32 s12, 0
  s_cbranch_scc1 tx1_114
  s_mov_b64 exec, s[36:37]
  s_cmp_eq_u32 s14, 1
  s_cbranch_scc1 pk_117
  s_cmp_eq_u32 s14, 2
  s_cbranch_scc1 pk_118
  s_cmp_eq_u32 s14, 3
  s_cbranch_scc1 pk_119
  buffer_store_dwordx4 v[32:35], v123, s[4:7], s51 offen sc1
  s_branch pkd_120
pk_117:
  buffer_store_dwordx4 v[36:39], v123, s[4:7], s51 offen sc1
  s_branch pkd_120
pk_118:
  buffer_store_dwordx4 v[40:43], v123, s[4:7], s51 offen sc1
  s_branch pkd_120
pk_119:
  buffer_store_dwordx4 v[44:47], v123, s[4:7], s51 offen sc1
pkd_120:
  s_mov_b64 exec, -1
  s_branch txd_115
tx1_114:
  s_waitcnt vmcnt(0)
  s_waitcnt vmcnt(0)
  v_and_b32 v125, 1, v88
  v_cmp_ne_u32 vcc, s49, v125
  s_cbranch_vccnz spr_121
spok_122:
  v_dot2_f32_bf16 v92, v88, s34, v92
  v_dot2_f32_bf16 v93, v88, s35, v93
  v_dot2_f32_bf16 v94, v89, s34, v94
  v_dot2_f32_bf16 v95, v89, s35, v95
  s_nop 0
  v_cvt_pk_bf16_f32 v104, v92, v93
  s_nop 0
  v_cvt_pk_bf16_f32 v105, v94, v95
  buffer_store_dwordx2 v[104:105], v124, s[4:7], s51 offen sc1
txd_115:
  s_waitcnt vmcnt(0)
  s_add_u32 s50, s50, 512
  s_barrier
  s_cmp_lg_u32 s14, 0
  s_cbranch_scc1 fs_123
  s_mov_b64 exec, 1
  buffer_store_dword v126, off, s[4:7], s50 sc1
  s_mov_b64 exec, -1
fs_123:
  s_waitcnt vmcnt(0)
  s_branch loop5done_81
hk_101:
  v_mov_b64 v[32:33], 0
  v_mov_b64 v[34:35], 0
  v_mov_b64 v[36:37], 0
  v_mov_b64 v[38:39], 0
  v_mov_b64 v[40:41], 0
  v_mov_b64 v[42:43], 0
  v_mov_b64 v[44:45], 0
  v_mov_b64 v[46:47], 0
  v_mov_b64 v[48:49], 0
  v_mov_b64 v[50:51], 0
  v_mov_b64 v[52:53], 0
  v_mov_b64 v[54:55], 0
  s_xor_b32 s43, s43, 524288
  s_xor_b32 s44, s44, 524288
  s_xor_b32 s45, s45, 262144
  s_xor_b32 s46, s46, 262144
  s_xor_b32 s47, s47, 262144
  s_xor_b32 s40, s40, 0x2000
  s_add_u32 s51, s51, 65536
  s_add_u32 s50, s50, 512
  s_add_u32 s55, s55, 512
  s_xor_b32 s67, s67, 0x2000
  s_add_u32 s15, s15, 1
  s_add_u32 s52, s15, 1
  s_branch redd_102
dpra_82:
  s_cmp_eq_u32 s29, 0
  s_cbranch_scc1 dpoka_85
  s_sub_u32 s29, s29, 1
  buffer_load_dwordx4 v[80:83], v112, s[4:7], s40 offen sc1
  buffer_load_dwordx4 v[84:87], v112, s[4:7], s67 offen sc1
  s_waitcnt vmcnt(2)
  v_max3_u32 v106, v88, v89, v90
  v_max3_u32 v107, v91, v92, v93
  v_max3_u32 v106, v106, v94, v95
  v_max_u32 v106, v106, v107
  v_cmp_eq_u32 vcc, -1, v106
  s_cbranch_vccz dpub_83
dpl_124:
  buffer_load_dwordx4 v[88:91], v112, s[4:7], s40 offen sc1
  buffer_load_dwordx4 v[92:95], v112, s[4:7], s67 offen sc1
  s_waitcnt vmcnt(2)
  v_max3_u32 v106, v80, v81, v82
  v_max3_u32 v107, v83, v84, v85
  v_max3_u32 v106, v106, v86, v87
  v_max_u32 v106, v106, v107
  v_cmp_eq_u32 vcc, -1, v106
  s_cbranch_vccz dpoka_85
  s_cmp_eq_u32 s29, 0
  s_cbranch_scc1 dpoka_85
  s_sub_u32 s29, s29, 1
  buffer_load_dwordx4 v[80:83], v112, s[4:7], s40 offen sc1
  buffer_load_dwordx4 v[84:87], v112, s[4:7], s67 offen sc1
  s_waitcnt vmcnt(2)
  v_max3_u32 v106, v88, v89, v90
  v_max3_u32 v107, v91, v92, v93
  v_max3_u32 v106, v106, v94, v95
  v_max_u32 v106, v106, v107
  v_cmp_eq_u32 vcc, -1, v106
  s_cbranch_vccnz dpl_124
dpub_83:
  ds_write_b128 v125, v[88:91]
  ds_write_b128 v125, v[92:95] offset:4096
  v_smfmac_f32_16x16x64_bf16 v[32:35], v[88:91], a[0:7], v113
  v_smfmac_f32_16x16x64_bf16 v[40:43], v[88:91], a[128:135], v113
  v_smfmac_f32_16x16x64_bf16 v[36:39], v[88:91], a[8:15], v113
  v_smfmac_f32_16x16x64_bf16 v[44:47], v[88:91], a[136:143], v113
  s_waitcnt lgkmcnt(0)
  s_barrier
  ds_read_b128 v[4:7], v100 offset:0
  ds_read_b128 v[8:11], v101 offset:0
  ds_read_b128 v[12:15], v102 offset:0
  ds_read_b128 v[20:23], v100 offset:4096
  ds_read_b128 v[24:27], v101 offset:4096
  ds_read_b128 v[28:31], v102 offset:4096
  ds_read_b128 v[0:3], v125 offset:0
  ds_read_b128 v[16:19], v125 offset:4096
  v_smfmac_f32_16x16x64_bf16 v[32:35], v[92:95], a[64:71], v113
  s_mov_b64 exec, s[96:97]
  buffer_store_dword v126, off, s[4:7], s50 sc1
  s_mov_b64 exec, -1
  v_smfmac_f32_16x16x64_bf16 v[40:43], v[92:95], a[192:199], v113
  v_smfmac_f32_16x16x64_bf16 v[36:39], v[92:95], a[72:79], v113
  v_smfmac_f32_16x16x64_bf16 v[44:47], v[92:95], a[200:207], v113
  s_branch dpj_84
mcc_86:
  s_cmp_eq_u32 s29, 0
  s_cbranch_scc1 mcok_87
  s_sub_u32 s29, s29, 1
  buffer_load_dwordx4 v[100:103], v112, s[4:7], s44 offen offset:0 sc1
  s_waitcnt vmcnt(1)
  v_and_b32 v125, 1, v88
  v_cmp_ne_u32 vcc, s49, v125
  s_cbranch_vccz mcu_90
mcl_89:
  buffer_load_dwordx4 v[88:91], v112, s[4:7], s44 offen offset:0 sc1
  s_waitcnt vmcnt(1)
  v_and_b32 v125, 1, v100
  v_cmp_ne_u32 vcc, s49, v125
  s_cbranch_vccz mcok_87
  s_cmp_eq_u32 s29, 0
  s_cbranch_scc1 mcok_87
  s_sub_u32 s29, s29, 1
  buffer_load_dwordx4 v[100:103], v112, s[4:7], s44 offen offset:0 sc1
  s_waitcnt vmcnt(1)
  v_and_b32 v125, 1, v88
  v_cmp_ne_u32 vcc, s49, v125
  s_cbranch_vccnz mcl_89
mcu_90:
  v_dot2_f32_bf16 v32, v88, s34, v32
  v_dot2_f32_bf16 v33, v88, s35, v33
  v_dot2_f32_bf16 v34, v89, s34, v34
  v_dot2_f32_bf16 v35, v89, s35, v35
  v_dot2_f32_bf16 v36, v90, s34, v36
  v_dot2_f32_bf16 v37, v90, s35, v37
  v_dot2_f32_bf16 v38, v91, s34, v38
  v_dot2_f32_bf16 v39, v91, s35, v39
  s_branch mcj_88
kvc_91:
  s_lshl_b32 s25, s52, 9
  s_add_u32 s25, s25, s54
  buffer_load_dword v125, off, s[4:7], s25 sc1
  s_waitcnt vmcnt(0)
  v_readfirstlane_b32 s26, v125
  s_cmp_lg_u32 s26, 0
  s_cbranch_scc1 kvb_92
  s_cmp_eq_u32 s29, 0
  s_cbranch_scc1 kvb_92
  s_sub_u32 s29, s29, 1
  s_branch kvc_91
spr_93:
  s_cmp_eq_u32 s29, 0
  s_cbranch_scc1 spok_94
  s_sub_u32 s29, s29, 1
  buffer_load_dwordx2 v[88:89], v86, s[4:7], s46 offen offset:0 sc1
  s_waitcnt vmcnt(0)
  v_and_b32 v125, 1, v88
  v_cmp_ne_u32 vcc, s49, v125
  s_cbranch_vccnz spr_93
  s_branch spok_94
PR_103:
  s_cmp_eq_u32 s29, 0
  s_cbranch_scc1 Pok_104
  s_sub_u32 s29, s29, 1
  buffer_load_dwordx4 v[0:3], v125, s[4:7], s48 offen offset:0 sc1
  buffer_load_dwordx4 v[4:7], v125, s[4:7], s48 offen offset:2048 sc1
  buffer_load_dwordx4 v[8:11], v125, s[4:7], s69 offen offset:0 sc1
  buffer_load_dwordx4 v[12:15], v125, s[4:7], s69 offen offset:2048 sc1
  s_waitcnt vmcnt(7)
  v_mfma_f32_16x16x32_bf16 v[100:103], v[16:19], v[96:99], 0
  s_waitcnt vmcnt(6)
  v_mfma_f32_16x16x32_bf16 v[100:103], v[20:23], v[96:99], v[100:103]
  v_bitop3_b32 v106, v16, v20, s49 bitop3:0x7e
  s_waitcnt vmcnt(5)
  v_mfma_f32_16x16x32_bf16 v[100:103], v[24:27], v[96:99], v[100:103]
  v_bitop3_b32 v106, v106, v24, s49 bitop3:0xf6
  s_waitcnt vmcnt(4)
  v_mfma_f32_16x16x32_bf16 v[100:103], v[28:31], v[96:99], v[100:103]
  v_bitop3_b32 v106, v106, v28, s49 bitop3:0xf6
  v_and_b32 v106, 1, v106
  v_cmp_ne_u32 vcc, 0, v106
  s_cbranch_vccz Pok_104
PL_105:
  buffer_load_dwordx4 v[16:19], v125, s[4:7], s48 offen offset:0 sc1
  buffer_load_dwordx4 v[20:23], v125, s[4:7], s48 offen offset:2048 sc1
  buffer_load_dwordx4 v[24:27], v125, s[4:7], s69 offen offset:0 sc1
  buffer_load_dwordx4 v[28:31], v125, s[4:7], s69 offen offset:2048 sc1
  s_waitcnt vmcnt(7)
  v_mfma_f32_16x16x32_bf16 v[100:103], v[0:3], v[96:99], 0
  s_waitcnt vmcnt(6)
  v_mfma_f32_16x16x32_bf16 v[100:103], v[4:7], v[96:99], v[100:103]
  v_bitop3_b32 v106, v0, v4, s49 bitop3:0x7e
  s_waitcnt vmcnt(5)
  v_mfma_f32_16x16x32_bf16 v[100:103], v[8:11], v[96:99], v[100:103]
  v_bitop3_b32 v106, v106, v8, s49 bitop3:0xf6
  s_waitcnt vmcnt(4)
  v_mfma_f32_16x16x32_bf16 v[100:103], v[12:15], v[96:99], v[100:103]
  v_bitop3_b32 v106, v106, v12, s49 bitop3:0xf6
  v_and_b32 v106, 1, v106
  v_cmp_ne_u32 vcc, 0, v106
  s_cbranch_vccz Pok_104
  s_cmp_eq_u32 s29, 0
  s_cbranch_scc1 Pok_104
  s_sub_u32 s29, s29, 1
  buffer_load_dwordx4 v[0:3], v125, s[4:7], s48 offen offset:0 sc1
  buffer_load_dwordx4 v[4:7], v125, s[4:7], s48 offen offset:2048 sc1
  buffer_load_dwordx4 v[8:11], v125, s[4:7], s69 offen offset:0 sc1
  buffer_load_dwordx4 v[12:15], v125, s[4:7], s69 offen offset:2048 sc1
  s_waitcnt vmcnt(7)
  v_mfma_f32_16x16x32_bf16 v[100:103], v[16:19], v[96:99], 0
  s_waitcnt vmcnt(6)
  v_mfma_f32_16x16x32_bf16 v[100:103], v[20:23], v[96:99], v[100:103]
  v_bitop3_b32 v106, v16, v20, s49 bitop3:0x7e
  s_waitcnt vmcnt(5)
  v_mfma_f32_16x16x32_bf16 v[100:103], v[24:27], v[96:99], v[100:103]
  v_bitop3_b32 v106, v106, v24, s49 bitop3:0xf6
  s_waitcnt vmcnt(4)
  v_mfma_f32_16x16x32_bf16 v[100:103], v[28:31], v[96:99], v[100:103]
  v_bitop3_b32 v106, v106, v28, s49 bitop3:0xf6
  v_and_b32 v106, 1, v106
  v_cmp_ne_u32 vcc, 0, v106
  s_cbranch_vccnz PL_105
  s_branch Pok_104
dpra_106:
  s_cmp_eq_u32 s29, 0
  s_cbranch_scc1 dpoka_109
  s_sub_u32 s29, s29, 1
  buffer_load_dwordx4 v[80:83], v112, s[4:7], s40 offen sc1
  buffer_load_dwordx4 v[84:87], v112, s[4:7], s67 offen sc1
  s_waitcnt vmcnt(2)
  v_max3_u32 v106, v88, v89, v90
  v_max3_u32 v107, v91, v92, v93
  v_max3_u32 v106, v106, v94, v95
  v_max_u32 v106, v106, v107
  v_cmp_eq_u32 vcc, -1, v106
  s_cbranch_vccz dpub_107
dpl_125:
  buffer_load_dwordx4 v[88:91], v112, s[4:7], s40 offen sc1
  buffer_load_dwordx4 v[92:95], v112, s[4:7], s67 offen sc1
  s_waitcnt vmcnt(2)
  v_max3_u32 v106, v80, v81, v82
  v_max3_u32 v107, v83, v84, v85
  v_max3_u32 v106, v106, v86, v87
  v_max_u32 v106, v106, v107
  v_cmp_eq_u32 vcc, -1, v106
  s_cbranch_vccz dpoka_109
  s_cmp_eq_u32 s29, 0
  s_cbranch_scc1 dpoka_109
  s_sub_u32 s29, s29, 1
  buffer_load_dwordx4 v[80:83], v112, s[4:7], s40 offen sc1
  buffer_load_dwordx4 v[84:87], v112, s[4:7], s67 offen sc1
  s_waitcnt vmcnt(2)
  v_max3_u32 v106, v88, v89, v90
  v_max3_u32 v107, v91, v92, v93
  v_max3_u32 v106, v106, v94, v95
  v_max_u32 v106, v106, v107
  v_cmp_eq_u32 vcc, -1, v106
  s_cbranch_vccnz dpl_125
dpub_107:
  ds_write_b128 v125, v[88:91]
  ds_write_b128 v125, v[92:95] offset:4096
  v_smfmac_f32_16x16x64_bf16 v[32:35], v[88:91], a[0:7], v113
  v_smfmac_f32_16x16x64_bf16 v[40:43], v[88:91], a[128:135], v113
  v_smfmac_f32_16x16x64_bf16 v[36:39], v[88:91], a[8:15], v113
  v_smfmac_f32_16x16x64_bf16 v[44:47], v[88:91], a[136:143], v113
  s_waitcnt lgkmcnt(0)
  s_barrier
  ds_read_b128 v[4:7], v100 offset:0
  ds_read_b128 v[8:11], v101 offset:0
  ds_read_b128 v[12:15], v102 offset:0
  ds_read_b128 v[20:23], v100 offset:4096
  ds_read_b128 v[24:27], v101 offset:4096
  ds_read_b128 v[28:31], v102 offset:4096
  ds_read_b128 v[0:3], v125 offset:0
  ds_read_b128 v[16:19], v125 offset:4096
  v_smfmac_f32_16x16x64_bf16 v[32:35], v[92:95], a[64:71], v113
  s_mov_b64 exec, s[96:97]
  buffer_store_dword v126, off, s[4:7], s50 sc1
  s_mov_b64 exec, -1
  v_smfmac_f32_16x16x64_bf16 v[40:43], v[92:95], a[192:199], v113
  v_smfmac_f32_16x16x64_bf16 v[36:39], v[92:95], a[72:79], v113
  v_smfmac_f32_16x16x64_bf16 v[44:47], v[92:95], a[200:207], v113
  s_branch dpj_108
mcc_110:
  s_cmp_eq_u32 s29, 0
  s_cbranch_scc1 mcok_111
  s_sub_u32 s29, s29, 1
mcl_113:
  buffer_load_dwordx4 v[100:103], v112, s[4:7], s44 offen offset:0 sc1
  s_waitcnt vmcnt(0)
  v_and_b32 v125, 1, v100
  v_cmp_ne_u32 vcc, s49, v125
  s_cbranch_vccz mcok_111
  s_cmp_eq_u32 s29, 0
  s_cbranch_scc1 mcok_111
  s_sub_u32 s29, s29, 1
  s_branch mcl_113
spr_121:
  s_cmp_eq_u32 s29, 0
  s_cbranch_scc1 spok_122
  s_sub_u32 s29, s29, 1
  buffer_load_dwordx2 v[88:89], v86, s[4:7], s46 offen offset:0 sc1
  s_waitcnt vmcnt(0)
  v_and_b32 v125, 1, v88
  v_cmp_ne_u32 vcc, s49, v125
  s_cbranch_vccnz spr_121
  s_branch spok_122
loop5done_81:
  s_branch chain_end_25
mode_gl_32:
  s_branch step5_126
  .p2alignl 8, 0xbf800000
  s_nop 0
  s_nop 0
  s_nop 0
  s_nop 0
  s_nop 0
  s_nop 0
  s_nop 0
  s_nop 0
  s_nop 0
  s_nop 0
  s_nop 0
  s_nop 0
  s_nop 0
  s_nop 0
  s_nop 0
  s_nop 0
  s_nop 0
  s_nop 0
  s_nop 0
  s_nop 0
  s_nop 0
  s_nop 0
  s_nop 0
  s_nop 0
  s_nop 0
  s_nop 0
  s_nop 0
  s_nop 0
  s_nop 0
  s_nop 0
  s_nop 0
  s_nop 0
  s_nop 0
  s_nop 0
  s_nop 0
  s_nop 0
  s_nop 0
  s_nop 0
  s_nop 0
  s_nop 0
  s_nop 0
  s_nop 0
  s_nop 0
  s_nop 0
  s_nop 0
step5_126:
  ds_read_b128 v[56:59], v118 offset:0
  ds_read_b128 v[60:63], v118 offset:1024
  ds_read_b128 v[64:67], v118 offset:2048
  ds_read_b128 v[68:71], v118 offset:3072
  ds_read_b128 v[72:75], v118 offset:4096
  ds_read_b128 v[76:79], v118 offset:5120
  buffer_load_dwordx4 v[80:83], v112, s[4:7], s40 offen sc1
  buffer_load_dwordx4 v[84:87], v112, s[4:7], s67 offen sc1
  s_lshl_b32 s23, s14, 10
  v_add_u32 v125, s23, v127
  v_xor_b32 v100, 1024, v125
  v_xor_b32 v101, 2048, v125
  v_xor_b32 v102, 3072, v125
  s_xor_b32 s48, s48, 262144
  s_xor_b32 s69, s69, 262144
  s_xor_b32 s41, s41, 0x2000
  s_xor_b32 s42, s42, 0x2000
  s_lshr_b32 s49, s15, 1
  s_and_b32 s49, s49, 1
  buffer_load_dwordx4 v[88:91], v112, s[4:7], s40 offen sc1
  buffer_load_dwordx4 v[92:95], v112, s[4:7], s67 offen sc1
  s_waitcnt vmcnt(2)
  v_max3_u32 v106, v80, v81, v82
  v_max3_u32 v107, v83, v84, v85
  v_max3_u32 v106, v106, v86, v87
  v_max_u32 v106, v106, v107
  v_cmp_eq_u32 vcc, -1, v106
  s_cbranch_vccnz dpra_128
dpoka_131:
  ds_write_b128 v125, v[80:83]
  ds_write_b128 v125, v[84:87] offset:4096
  v_smfmac_f32_16x16x64_bf16 v[32:35], v[80:83], a[0:7], v113
  v_smfmac_f32_16x16x64_bf16 v[40:43], v[80:83], a[128:135], v113
  v_smfmac_f32_16x16x64_bf16 v[36:39], v[80:83], a[8:15], v113
  v_smfmac_f32_16x16x64_bf16 v[44:47], v[80:83], a[136:143], v113
  s_waitcnt lgkmcnt(0)
  s_barrier
  ds_read_b128 v[4:7], v100 offset:0
  ds_read_b128 v[8:11], v101 offset:0
  ds_read_b128 v[12:15], v102 offset:0
  ds_read_b128 v[20:23], v100 offset:4096
  ds_read_b128 v[24:27], v101 offset:4096
  ds_read_b128 v[28:31], v102 offset:4096
  ds_read_b128 v[0:3], v125 offset:0
  ds_read_b128 v[16:19], v125 offset:4096
  v_smfmac_f32_16x16x64_bf16 v[32:35], v[84:87], a[64:71], v113
  s_mov_b64 exec, s[96:97]
  buffer_store_dword v126, off, s[4:7], s50 sc1
  s_mov_b64 exec, -1
  v_smfmac_f32_16x16x64_bf16 v[40:43], v[84:87], a[192:199], v113
  v_smfmac_f32_16x16x64_bf16 v[36:39], v[84:87], a[72:79], v113
  v_smfmac_f32_16x16x64_bf16 v[44:47], v[84:87], a[200:207], v113
dpj_130:
  buffer_load_dword v110, off, s[4:7], s55 sc1
  s_waitcnt lgkmcnt(7)
  v_smfmac_f32_16x16x64_bf16 v[32:35], v[4:7], a[16:23], v113
  v_smfmac_f32_16x16x64_bf16 v[40:43], v[4:7], a[144:151], v113
  v_smfmac_f32_16x16x64_bf16 v[36:39], v[4:7], a[24:31], v113
  v_smfmac_f32_16x16x64_bf16 v[44:47], v[4:7], a[152:159], v113
  s_waitcnt lgkmcnt(6)
  v_smfmac_f32_16x16x64_bf16 v[32:35], v[8:11], a[32:39], v113
  v_smfmac_f32_16x16x64_bf16 v[40:43], v[8:11], a[160:167], v113
  s_waitcnt lgkmcnt(5)
  v_smfmac_f32_16x16x64_bf16 v[32:35], v[12:15], a[48:55], v113
  v_smfmac_f32_16x16x64_bf16 v[40:43], v[12:15], a[176:183], v113
  s_waitcnt lgkmcnt(4)
  v_smfmac_f32_16x16x64_bf16 v[32:35], v[20:23], a[80:87], v113
  v_smfmac_f32_16x16x64_bf16 v[40:43], v[20:23], a[208:215], v113
  s_waitcnt lgkmcnt(3)
  v_smfmac_f32_16x16x64_bf16 v[32:35], v[24:27], a[96:103], v113
  v_smfmac_f32_16x16x64_bf16 v[40:43], v[24:27], a[224:231], v113
  s_waitcnt lgkmcnt(2)
  v_smfmac_f32_16x16x64_bf16 v[32:35], v[28:31], a[112:119], v113
  v_smfmac_f32_16x16x64_bf16 v[40:43], v[28:31], a[240:247], v113
  v_smfmac_f32_16x16x64_bf16 v[36:39], v[8:11], a[40:47], v113
  v_smfmac_f32_16x16x64_bf16 v[44:47], v[8:11], a[168:175], v113
  v_smfmac_f32_16x16x64_bf16 v[36:39], v[12:15], a[56:63], v113
  v_permlane32_swap_b32 v32, v40
  v_smfmac_f32_16x16x64_bf16 v[44:47], v[12:15], a[184:191], v113
  v_permlane32_swap_b32 v33, v41
  v_smfmac_f32_16x16x64_bf16 v[36:39], v[20:23], a[88:95], v113
  v_permlane32_swap_b32 v34, v42
  v_smfmac_f32_16x16x64_bf16 v[44:47], v[20:23], a[216:223], v113
  v_permlane32_swap_b32 v35, v43
  v_smfmac_f32_16x16x64_bf16 v[36:39], v[24:27], a[104:111], v113
  v_add_f32 v32, v32, v40
  v_smfmac_f32_16x16x64_bf16 v[44:47], v[24:27], a[232:239], v113
  v_add_f32 v33, v33, v41
  v_smfmac_f32_16x16x64_bf16 v[36:39], v[28:31], a[120:127], v113
  v_add_f32 v34, v34, v42
  v_smfmac_f32_16x16x64_bf16 v[44:47], v[28:31], a[248:255], v113
  v_add_f32 v35, v35, v43
  v_cvt_pk_bf16_f32 v40, v32, v33
  v_cvt_pk_bf16_f32 v41, v34, v35
  v_and_or_b32 v40, v40, -2, s49
  s_nop 3
  v_permlane32_swap_b32 v36, v44
  v_permlane32_swap_b32 v37, v45
  v_permlane32_swap_b32 v38, v46
  v_permlane32_swap_b32 v39, v47
  v_add_f32 v36, v36, v44
  v_add_f32 v37, v37, v45
  v_add_f32 v38, v38, v46
  v_add_f32 v39, v39, v47
  v_cvt_pk_bf16_f32 v42, v36, v37
  v_cvt_pk_bf16_f32 v43, v38, v39
  buffer_store_dwordx4 v[40:43], v112, s[4:7], s43 offen sc1
  s_waitcnt lgkmcnt(0)
  v_smfmac_f32_16x16x64_bf16 v[48:51], v[0:3], v[56:63], v113
  ds_read_b128 v[56:59], v118 offset:6144
  ds_read_b128 v[60:63], v118 offset:7168
  v_smfmac_f32_16x16x64_bf16 v[52:55], v[0:3], v[64:71], v113
  ds_read_b128 v[64:67], v118 offset:8192
  ds_read_b128 v[68:71], v118 offset:9216
  v_smfmac_f32_16x16x64_bf16 v[48:51], v[4:7], v[72:79], v113
  ds_read_b128 v[72:75], v118 offset:10240
  ds_read_b128 v[76:79], v118 offset:11264
  s_waitcnt lgkmcnt(4)
  v_smfmac_f32_16x16x64_bf16 v[52:55], v[4:7], v[56:63], v113
  ds_read_b128 v[56:59], v118 offset:12288
  ds_read_b128 v[60:63], v118 offset:13312
  s_waitcnt lgkmcnt(4)
  v_smfmac_f32_16x16x64_bf16 v[48:51], v[8:11], v[64:71], v113
  ds_read_b128 v[64:67], v118 offset:14336
  ds_read_b128 v[68:71], v118 offset:15360
  s_waitcnt lgkmcnt(4)
  v_smfmac_f32_16x16x64_bf16 v[52:55], v[8:11], v[72:79], v113
  ds_read_b128 v[72:75], v119 offset:0
  ds_read_b128 v[76:79], v119 offset:1024
  s_waitcnt lgkmcnt(4)
  v_smfmac_f32_16x16x64_bf16 v[48:51], v[12:15], v[56:63], v113
  ds_read_b128 v[56:59], v119 offset:2048
  ds_read_b128 v[60:63], v119 offset:3072
  s_waitcnt lgkmcnt(4)
  v_smfmac_f32_16x16x64_bf16 v[52:55], v[12:15], v[64:71], v113
  ds_read_b128 v[64:67], v119 offset:4096
  ds_read_b128 v[68:71], v119 offset:5120
  s_waitcnt lgkmcnt(4)
  v_smfmac_f32_16x16x64_bf16 v[48:51], v[16:19], v[72:79], v113
  ds_read_b128 v[72:75], v119 offset:6144
  ds_read_b128 v[76:79], v119 offset:7168
  s_cmp_lg_u32 s12, 0
  s_cbranch_scc1 xl_132
  buffer_load_dwordx4 v[100:103], v112, s[4:7], s44 offen offset:0 sc1
xl_132:
  s_cmp_lg_u32 s12, 1
  s_cbranch_scc1 xl_133
  buffer_load_dwordx4 v[100:103], v112, s[4:7], s44 offen offset:0 sc1
xl_133:
  s_waitcnt lgkmcnt(4)
  v_smfmac_f32_16x16x64_bf16 v[52:55], v[16:19], v[56:63], v113
  ds_read_b128 v[56:59], v119 offset:8192
  ds_read_b128 v[60:63], v119 offset:9216
  s_waitcnt lgkmcnt(4)
  v_smfmac_f32_16x16x64_bf16 v[48:51], v[20:23], v[64:71], v113
  ds_read_b128 v[64:67], v119 offset:10240
  ds_read_b128 v[68:71], v119 offset:11264
  s_waitcnt lgkmcnt(4)
  v_smfmac_f32_16x16x64_bf16 v[52:55], v[20:23], v[72:79], v113
  ds_read_b128 v[72:75], v119 offset:12288
  ds_read_b128 v[76:79], v119 offset:13312
  s_waitcnt lgkmcnt(4)
  v_smfmac_f32_16x16x64_bf16 v[48:51], v[24:27], v[56:63], v113
  ds_read_b128 v[56:59], v119 offset:14336
  ds_read_b128 v[60:63], v119 offset:15360
  s_waitcnt lgkmcnt(4)
  v_smfmac_f32_16x16x64_bf16 v[52:55], v[24:27], v[64:71], v113
  s_waitcnt lgkmcnt(2)
  v_smfmac_f32_16x16x64_bf16 v[48:51], v[28:31], v[72:79], v113
  s_waitcnt lgkmcnt(0)
  v_smfmac_f32_16x16x64_bf16 v[52:55], v[28:31], v[56:63], v113
  s_waitcnt vmcnt(3)
  s_nop 6
  v_permlane32_swap_b32 v48, v52
  v_permlane32_swap_b32 v49, v53
  v_permlane32_swap_b32 v50, v54
  v_permlane32_swap_b32 v51, v55
  v_pk_add_f32 v[92:93], v[48:49], v[52:53]
  v_pk_add_f32 v[94:95], v[50:51], v[54:55]
  v_cvt_pk_bf16_f32 v44, v92, v93
  v_cvt_pk_bf16_f32 v45, v94, v95
  v_lshrrev_b32 v86, 1, v112
  v_and_or_b32 v44, v44, -2, s49
  buffer_store_dwordx2 v[44:45], v86, s[4:7], s45 offen offset:0 sc1
  buffer_load_dwordx4 v[88:91], v112, s[4:7], s44 offen offset:0 sc1
  ds_read_b128 v[0:3], v116 offset:0
  ds_read_b128 v[4:7], v116 offset:2048
  ds_read_b128 v[8:11], v116 offset:4096
  ds_read_b128 v[12:15], v116 offset:6144
  ds_read_b128 v[16:19], v116 offset:256
  ds_read_b128 v[20:23], v116 offset:2304
  ds_read_b128 v[24:27], v116 offset:4352
  ds_read_b128 v[28:31], v116 offset:6400
  ds_read_b128 v[68:71], v117 offset:0
  ds_read_b128 v[72:75], v117 offset:256
  v_mov_b32 v64, v111
  v_mov_b32 v65, v111
  v_mov_b32 v66, v111
  v_mov_b32 v67, v111
  s_waitcnt vmcnt(2)
  v_and_b32 v125, 1, v100
  v_cmp_ne_u32 vcc, s49, v125
  s_cbranch_vccnz mcc_134
mcok_135:
  v_dot2_f32_bf16 v32, v100, s34, v32
  v_dot2_f32_bf16 v33, v100, s35, v33
  v_dot2_f32_bf16 v34, v101, s34, v34
  v_dot2_f32_bf16 v35, v101, s35, v35
  v_dot2_f32_bf16 v36, v102, s34, v36
  v_dot2_f32_bf16 v37, v102, s35, v37
  v_dot2_f32_bf16 v38, v103, s34, v38
  v_dot2_f32_bf16 v39, v103, s35, v39
mcj_136:
  v_cvt_pk_bf16_f32 v32, v32, v33
  v_cvt_pk_bf16_f32 v33, v34, v35
  ds_write_b64 v115, v[32:33] offset:0
  v_cvt_pk_bf16_f32 v36, v36, v37
  v_cvt_pk_bf16_f32 v37, v38, v39
  ds_write_b64 v115, v[36:37] offset:512
  s_waitcnt lgkmcnt(0)
  s_barrier
  buffer_load_dwordx2 v[88:89], v86, s[4:7], s46 offen offset:0 sc1
  ds_read_b64_tr_b16 v[32:33], v114 offset:0
  ds_read_b64_tr_b16 v[34:35], v114 offset:128
  ds_read_b64_tr_b16 v[36:37], v114 offset:1024
  ds_read_b64_tr_b16 v[38:39], v114 offset:1152
  ds_read_b64_tr_b16 v[40:41], v114 offset:2048
  ds_read_b64_tr_b16 v[42:43], v114 offset:2176
  ds_read_b64_tr_b16 v[44:45], v114 offset:3072
  ds_read_b64_tr_b16 v[46:47], v114 offset:3200
  v_readfirstlane_b32 s53, v110
  s_cmp_eq_u32 s53, 0
  s_cbranch_scc1 kvc_139
kvb_140:
  s_lshl_b32 s27, s52, 18
  s_add_u32 s27, s27, s66
  s_lshl_b32 s24, s14, 12
  s_mov_b32 m0, s24
  v_mov_b32 v125, s49
  s_mov_b64 exec, s[8:9]
  buffer_store_dword v125, v112, s[4:7], s44 offen sc1
  s_mov_b64 exec, -1
  s_waitcnt lgkmcnt(6)
  v_mfma_f32_16x16x32_bf16 v[56:59], v[0:3], v[32:35], 0
  v_mfma_f32_16x16x32_bf16 v[60:63], v[16:19], v[32:35], 0
  v_mfma_f32_16x16x32_bf16 v[64:67], v[32:35], v[32:35], v[64:67]
  buffer_load_dwordx4 v112, s[4:7], s27 offen offset:0 sc1 lds
  s_waitcnt lgkmcnt(4)
  v_mfma_f32_16x16x32_bf16 v[56:59], v[4:7], v[36:39], v[56:59]
  v_mfma_f32_16x16x32_bf16 v[60:63], v[20:23], v[36:39], v[60:63]
  v_mfma_f32_16x16x32_bf16 v[64:67], v[36:39], v[36:39], v[64:67]
  s_waitcnt lgkmcnt(2)
  v_mfma_f32_16x16x32_bf16 v[56:59], v[8:11], v[40:43], v[56:59]
  v_mfma_f32_16x16x32_bf16 v[60:63], v[24:27], v[40:43], v[60:63]
  v_mfma_f32_16x16x32_bf16 v[64:67], v[40:43], v[40:43], v[64:67]
  buffer_load_dwordx4 v112, s[4:7], s27 offen offset:1024 sc1 lds
  s_waitcnt lgkmcnt(0)
  v_mfma_f32_16x16x32_bf16 v[56:59], v[12:15], v[44:47], v[56:59]
  v_mfma_f32_16x16x32_bf16 v[60:63], v[28:31], v[44:47], v[60:63]
  v_mfma_f32_16x16x32_bf16 v[64:67], v[44:47], v[44:47], v[64:67]
  v_mov_b32 v28, 0x3f803f80
  v_mov_b32 v29, 0x3f803f80
  v_max3_f32 v106, v56, v57, v58
  v_mov_b32 v30, 0x3f803f80
  v_mov_b32 v31, 0x3f803f80
  v_mov_b64 v[0:1], 0
  v_max3_f32 v107, v59, v60, v61
  v_max3_f32 v106, v106, v62, v63
  v_max3_f32 v107, v107, v64, v65
  v_max3_f32 v106, v106, v66, v67
  v_max_f32 v106, v106, v107
  v_mov_b32 v107, v106
  v_mov_b64 v[2:3], 0
  v_mov_b64 v[4:5], 0
  v_permlane16_swap_b32 v106, v107
  v_max_f32 v106, v106, v107
  v_mov_b32 v107, v106
  v_mov_b64 v[6:7], 0
  v_mov_b64 v[8:9], 0
  v_permlane32_swap_b32 v106, v107
  v_max_f32 v106, v106, v107
  v_mul_f32 v106, s38, v106
  buffer_load_dwordx4 v112, s[4:7], s27 offen offset:2048 sc1 lds
  ds_read_b64_tr_b16 v[76:77], v122 offset:0
  ds_read_b64_tr_b16 v[78:79], v122 offset:128
  v_pk_fma_f32 v[56:57], v[56:57], s[38:39], v[106:107] op_sel_hi:[1,1,0] neg_lo:[0,0,1] neg_hi:[0,0,1]
  v_pk_fma_f32 v[58:59], v[58:59], s[38:39], v[106:107] op_sel_hi:[1,1,0] neg_lo:[0,0,1] neg_hi:[0,0,1]
  v_pk_fma_f32 v[60:61], v[60:61], s[38:39], v[106:107] op_sel_hi:[1,1,0] neg_lo:[0,0,1] neg_hi:[0,0,1]
  v_pk_fma_f32 v[62:63], v[62:63], s[38:39], v[106:107] op_sel_hi:[1,1,0] neg_lo:[0,0,1] neg_hi:[0,0,1]
  v_pk_fma_f32 v[64:65], v[64:65], s[38:39], v[106:107] op_sel_hi:[1,1,0] neg_lo:[0,0,1] neg_hi:[0,0,1]
  v_pk_fma_f32 v[66:67], v[66:67], s[38:39], v[106:107] op_sel_hi:[1,1,0] neg_lo:[0,0,1] neg_hi:[0,0,1]
  v_exp_f32 v56, v56
  v_exp_f32 v57, v57
  buffer_load_dwordx4 v112, s[4:7], s27 offen offset:3072 sc1 lds
  v_exp_f32 v58, v58
  v_exp_f32 v59, v59
  v_exp_f32 v60, v60
  v_exp_f32 v61, v61
  v_exp_f32 v62, v62
  v_exp_f32 v63, v63
  v_exp_f32 v64, v64
  v_exp_f32 v65, v65
  v_exp_f32 v66, v66
  v_exp_f32 v67, v67
  v_cvt_pk_bf16_f32 v80, v56, v57
  v_cvt_pk_bf16_f32 v81, v58, v59
  v_cvt_pk_bf16_f32 v82, v60, v61
  v_cvt_pk_bf16_f32 v83, v62, v63
  v_cvt_pk_bf16_f32 v84, v64, v65
  v_cvt_pk_bf16_f32 v85, v66, v67
  v_mfma_f32_16x16x32_bf16 v[106:109], v[28:31], v[80:83], 0
  v_mfma_f32_16x16x32_bf16 v[48:51], v[68:71], v[80:83], 0
  v_mfma_f32_16x16x32_bf16 v[52:55], v[72:75], v[80:83], 0
  v_mfma_f32_16x16x16_bf16 v[106:109], v[28:29], v[84:85], v[106:109]
  v_mov_b64 v[60:61], 0
  s_waitcnt vmcnt(5)
  v_and_b32 v125, 1, v88
  v_cmp_ne_u32 vcc, s49, v125
  s_cbranch_vccnz spr_141
spok_142:
  v_dot2_f32_bf16 v92, v88, s34, v92
  v_dot2_f32_bf16 v93, v88, s35, v93
  v_dot2_f32_bf16 v94, v89, s34, v94
  v_dot2_f32_bf16 v95, v89, s35, v95
  s_nop 0
  v_cvt_pk_bf16_f32 v104, v92, v93
  s_nop 0
  v_cvt_pk_bf16_f32 v105, v94, v95
  v_permlane32_swap_b32 v60, v104
  v_mov_b64 v[10:11], 0
  v_permlane32_swap_b32 v61, v105
  v_rcp_f32 v106, v106
  v_mov_b64 v[12:13], 0
  v_mfma_f32_16x16x16_bf16 v[48:51], v[60:61], v[84:85], v[48:51]
  v_mfma_f32_16x16x16_bf16 v[52:55], v[104:105], v[84:85], v[52:55]
  s_mov_b64 exec, s[10:11]
  buffer_store_dword v88, v86, s[4:7], s46 offen sc1
  s_mov_b64 exec, -1
  v_mov_b64 v[14:15], 0
  v_mov_b64 v[16:17], 0
  v_mov_b64 v[18:19], 0
  v_mov_b64 v[20:21], 0
  v_pk_mul_f32 v[48:49], v[48:49], v[106:107] op_sel_hi:[1,0]
  v_pk_mul_f32 v[50:51], v[50:51], v[106:107] op_sel_hi:[1,0]
  v_cvt_pk_bf16_f32 v48, v48, v49
  v_cvt_pk_bf16_f32 v49, v50, v51
  v_pk_mul_f32 v[52:53], v[52:53], v[106:107] op_sel_hi:[1,0]
  v_pk_mul_f32 v[54:55], v[54:55], v[106:107] op_sel_hi:[1,0]
  v_cvt_pk_bf16_f32 v52, v52, v53
  v_cvt_pk_bf16_f32 v53, v54, v55
  s_mov_b64 exec, s[32:33]
  ds_write_b64 v120, v[48:49] offset:0
  ds_write_b64 v120, v[52:53] offset:256
  s_mov_b64 exec, -1
  v_mov_b64 v[22:23], 0
  v_mov_b64 v[24:25], 0
  v_mov_b64 v[26:27], 0
  v_mov_b64 v[28:29], 0
  v_mov_b64 v[30:31], 0
  v_permlane32_swap_b32 v60, v104
  v_permlane32_swap_b32 v61, v105
  s_waitcnt lgkmcnt(2)
  s_mov_b64 exec, s[98:99]
  buffer_store_dwordx4 v[76:79], v123, s[4:7], s51 offen sc1
  s_mov_b64 exec, s[100:101]
  buffer_store_dwordx2 v[104:105], v124, s[4:7], s51 offen sc1
  s_mov_b64 exec, -1
  s_waitcnt lgkmcnt(0)
  s_barrier
  ds_read_b128 v[56:59], v112 offset:20480
  ds_read_b128 v[60:63], v112 offset:21504
  v_and_b32 v125, 0x380, v112
  v_add_u32 v125, v125, v112
  s_waitcnt lgkmcnt(1)
  s_mov_b32 s27, s47
  v_smfmac_f32_16x16x64_bf16 v[0:3], v[56:59], v[128:135], v113
  v_smfmac_f32_16x16x64_bf16 v[4:7], v[56:59], v[144:151], v113
  s_waitcnt lgkmcnt(0)
  v_smfmac_f32_16x16x64_bf16 v[0:3], v[60:63], v[136:143], v113
  v_smfmac_f32_16x16x64_bf16 v[4:7], v[60:63], v[152:159], v113
  v_smfmac_f32_16x16x64_bf16 v[8:11], v[56:59], v[160:167], v113
  v_smfmac_f32_16x16x64_bf16 v[12:15], v[56:59], v[176:183], v113
  s_nop 1
  v_permlane32_swap_b32 v0, v4
  v_permlane32_swap_b32 v1, v5
  v_permlane32_swap_b32 v2, v6
  v_smfmac_f32_16x16x64_bf16 v[8:11], v[60:63], v[168:175], v113
  v_permlane32_swap_b32 v3, v7
  v_add_f32 v0, v0, v4
  v_add_f32 v1, v1, v5
  v_smfmac_f32_16x16x64_bf16 v[12:15], v[60:63], v[184:191], v113
  v_add_f32 v2, v2, v6
  v_add_f32 v3, v3, v7
  v_cvt_pk_bf16_f32 v64, v0, v1
  v_smfmac_f32_16x16x64_bf16 v[16:19], v[56:59], v[192:199], v113
  v_cvt_pk_bf16_f32 v65, v2, v3
  v_smfmac_f32_16x16x64_bf16 v[20:23], v[56:59], v[208:215], v113
  s_nop 1
  v_permlane32_swap_b32 v8, v12
  v_permlane32_swap_b32 v9, v13
  v_permlane32_swap_b32 v10, v14
  v_smfmac_f32_16x16x64_bf16 v[16:19], v[60:63], v[200:207], v113
  v_permlane32_swap_b32 v11, v15
  v_add_f32 v8, v8, v12
  v_add_f32 v9, v9, v13
  v_smfmac_f32_16x16x64_bf16 v[20:23], v[60:63], v[216:223], v113
  v_add_f32 v10, v10, v14
  v_add_f32 v11, v11, v15
  v_cvt_pk_bf16_f32 v66, v8, v9
  v_smfmac_f32_16x16x64_bf16 v[24:27], v[56:59], v[224:231], v113
  v_cvt_pk_bf16_f32 v67, v10, v11
  v_permlane16_swap_b32 v64, v66
  s_nop 0
  v_permlane16_swap_b32 v65, v67
  v_smfmac_f32_16x16x64_bf16 v[28:31], v[56:59], v[240:247], v113
  v_and_or_b32 v64, v64, -2, s49
  buffer_store_dwordx4 v[64:67], v121, s[4:7], s27 offen sc1
  s_add_u32 s27, s27, 32768
  s_cmp_lt_u32 s14, 2
  v_permlane32_swap_b32 v16, v20
  v_smfmac_f32_16x16x64_bf16 v[24:27], v[60:63], v[232:239], v113
  v_permlane32_swap_b32 v17, v21
  v_permlane32_swap_b32 v18, v22
  v_permlane32_swap_b32 v19, v23
  v_smfmac_f32_16x16x64_bf16 v[28:31], v[60:63], v[248:255], v113
  v_add_f32 v16, v16, v20
  v_add_f32 v17, v17, v21
  v_add_f32 v18, v18, v22
  v_add_f32 v19, v19, v23
  v_cvt_pk_bf16_f32 v68, v16, v17
  v_cvt_pk_bf16_f32 v69, v18, v19
  s_nop 1
  v_permlane32_swap_b32 v24, v28
  v_permlane32_swap_b32 v25, v29
  v_permlane32_swap_b32 v26, v30
  v_permlane32_swap_b32 v27, v31
  v_pk_add_f32 v[24:25], v[24:25], v[28:29]
  v_pk_add_f32 v[26:27], v[26:27], v[30:31]
  v_cvt_pk_bf16_f32 v70, v24, v25
  v_cvt_pk_bf16_f32 v71, v26, v27
  s_nop 0
  v_permlane16_swap_b32 v68, v70
  v_permlane16_swap_b32 v69, v71
  v_and_or_b32 v68, v68, -2, s49
  buffer_store_dwordx4 v[68:71], v121, s[4:7], s27 offen sc1
  s_cbranch_scc1 hk_149
  s_waitcnt vmcnt(0)
  buffer_load_dwordx4 v[0:3], v125, s[4:7], s48 offen offset:0 sc1
  buffer_load_dwordx4 v[4:7], v125, s[4:7], s48 offen offset:2048 sc1
  buffer_load_dwordx4 v[8:11], v125, s[4:7], s69 offen offset:0 sc1
  buffer_load_dwordx4 v[12:15], v125, s[4:7], s69 offen offset:2048 sc1
  s_xor_b32 s43, s43, 524288
  s_xor_b32 s44, s44, 524288
  s_xor_b32 s45, s45, 262144
  s_xor_b32 s46, s46, 262144
  s_xor_b32 s47, s47, 262144
  s_xor_b32 s40, s40, 0x2000
  s_add_u32 s51, s51, 65536
  s_add_u32 s50, s50, 512
  s_add_u32 s55, s55, 512
  s_xor_b32 s67, s67, 0x2000
  s_add_u32 s15, s15, 1
  s_add_u32 s52, s15, 1
  v_lshrrev_b32 v87, 4, v112
  v_and_b32 v106, 15, v87
  v_lshlrev_b32 v106, 4, v106
  v_bfe_u32 v107, v87, 4, 1
  buffer_load_dwordx4 v[16:19], v125, s[4:7], s48 offen offset:0 sc1
  buffer_load_dwordx4 v[20:23], v125, s[4:7], s48 offen offset:2048 sc1
  buffer_load_dwordx4 v[24:27], v125, s[4:7], s69 offen offset:0 sc1
  buffer_load_dwordx4 v[28:31], v125, s[4:7], s69 offen offset:2048 sc1
  v_lshl_add_u32 v106, v107, 3, v106
  v_lshrrev_b32 v107, 5, v87
  v_lshl_add_u32 v87, v107, 2, v106
  v_mov_b32 v108, -1
  v_mov_b64 v[32:33], 0
  v_mov_b64 v[34:35], 0
  v_mov_b64 v[36:37], 0
  v_mov_b64 v[38:39], 0
  v_mov_b64 v[40:41], 0
  v_mov_b64 v[42:43], 0
  v_mov_b64 v[44:45], 0
  v_mov_b64 v[46:47], 0
  v_mov_b64 v[48:49], 0
  v_mov_b64 v[50:51], 0
  v_mov_b64 v[52:53], 0
  v_mov_b64 v[54:55], 0
  s_waitcnt vmcnt(7)
  v_mfma_f32_16x16x32_bf16 v[100:103], v[0:3], v[96:99], 0
  s_waitcnt vmcnt(6)
  v_mfma_f32_16x16x32_bf16 v[100:103], v[4:7], v[96:99], v[100:103]
  v_bitop3_b32 v106, v0, v4, s49 bitop3:0x7e
  s_waitcnt vmcnt(5)
  v_mfma_f32_16x16x32_bf16 v[100:103], v[8:11], v[96:99], v[100:103]
  v_bitop3_b32 v106, v106, v8, s49 bitop3:0xf6
  s_waitcnt vmcnt(4)
  v_mfma_f32_16x16x32_bf16 v[100:103], v[12:15], v[96:99], v[100:103]
  v_bitop3_b32 v106, v106, v12, s49 bitop3:0xf6
  v_and_b32 v106, 1, v106
  v_cmp_ne_u32 vcc, 0, v106
  s_cbranch_vccnz PR_151
Pok_152:
  s_mov_b64 exec, s[32:33]
  buffer_store_dword v108, v87, s[4:7], s42 offen sc1
  s_mov_b64 exec, -1
  s_nop 0
  v_permlane32_swap_b32 v100, v102
  v_permlane32_swap_b32 v101, v103
  v_pk_add_f32 v[100:101], v[100:101], v[102:103]
  v_cvt_pk_bf16_f32 v100, v100, v101
  s_mov_b64 exec, s[32:33]
  buffer_store_dword v100, v87, s[4:7], s41 offen sc1
  s_mov_b64 exec, -1
redd_150:
  s_barrier
  s_cmp_lt_u32 s15, 63
  s_cbranch_scc1 step5_126
  ds_read_b128 v[56:59], v118 offset:0
  ds_read_b128 v[60:63], v118 offset:1024
  ds_read_b128 v[64:67], v118 offset:2048
  ds_read_b128 v[68:71], v118 offset:3072
  ds_read_b128 v[72:75], v118 offset:4096
  ds_read_b128 v[76:79], v118 offset:5120
  buffer_load_dwordx4 v[80:83], v112, s[4:7], s40 offen sc1
  buffer_load_dwordx4 v[84:87], v112, s[4:7], s67 offen sc1
  s_lshl_b32 s23, s14, 10
  v_add_u32 v125, s23, v127
  v_xor_b32 v100, 1024, v125
  v_xor_b32 v101, 2048, v125
  v_xor_b32 v102, 3072, v125
  s_xor_b32 s48, s48, 262144
  s_xor_b32 s69, s69, 262144
  s_xor_b32 s41, s41, 0x2000
  s_xor_b32 s42, s42, 0x2000
  s_lshr_b32 s49, s15, 1
  s_and_b32 s49, s49, 1
  buffer_load_dwordx4 v[88:91], v112, s[4:7], s40 offen sc1
  buffer_load_dwordx4 v[92:95], v112, s[4:7], s67 offen sc1
  s_waitcnt vmcnt(2)
  v_max3_u32 v106, v80, v81, v82
  v_max3_u32 v107, v83, v84, v85
  v_max3_u32 v106, v106, v86, v87
  v_max_u32 v106, v106, v107
  v_cmp_eq_u32 vcc, -1, v106
  s_cbranch_vccnz dpra_154
dpoka_157:
  ds_write_b128 v125, v[80:83]
  ds_write_b128 v125, v[84:87] offset:4096
  v_smfmac_f32_16x16x64_bf16 v[32:35], v[80:83], a[0:7], v113
  v_smfmac_f32_16x16x64_bf16 v[40:43], v[80:83], a[128:135], v113
  v_smfmac_f32_16x16x64_bf16 v[36:39], v[80:83], a[8:15], v113
  v_smfmac_f32_16x16x64_bf16 v[44:47], v[80:83], a[136:143], v113
  s_waitcnt lgkmcnt(0)
  s_barrier
  ds_read_b128 v[4:7], v100 offset:0
  ds_read_b128 v[8:11], v101 offset:0
  ds_read_b128 v[12:15], v102 offset:0
  ds_read_b128 v[20:23], v100 offset:4096
  ds_read_b128 v[24:27], v101 offset:4096
  ds_read_b128 v[28:31], v102 offset:4096
  ds_read_b128 v[0:3], v125 offset:0
  ds_read_b128 v[16:19], v125 offset:4096
  v_smfmac_f32_16x16x64_bf16 v[32:35], v[84:87], a[64:71], v113
  s_mov_b64 exec, s[96:97]
  buffer_store_dword v126, off, s[4:7], s50 sc1
  s_mov_b64 exec, -1
  v_smfmac_f32_16x16x64_bf16 v[40:43], v[84:87], a[192:199], v113
  v_smfmac_f32_16x16x64_bf16 v[36:39], v[84:87], a[72:79], v113
  v_smfmac_f32_16x16x64_bf16 v[44:47], v[84:87], a[200:207], v113
dpj_156:
  buffer_load_dword v110, off, s[4:7], s55 sc1
  s_waitcnt lgkmcnt(7)
  v_smfmac_f32_16x16x64_bf16 v[32:35], v[4:7], a[16:23], v113
  v_smfmac_f32_16x16x64_bf16 v[40:43], v[4:7], a[144:151], v113
  v_smfmac_f32_16x16x64_bf16 v[36:39], v[4:7], a[24:31], v113
  v_smfmac_f32_16x16x64_bf16 v[44:47], v[4:7], a[152:159], v113
  s_waitcnt lgkmcnt(6)
  v_smfmac_f32_16x16x64_bf16 v[32:35], v[8:11], a[32:39], v113
  v_smfmac_f32_16x16x64_bf16 v[40:43], v[8:11], a[160:167], v113
  s_waitcnt lgkmcnt(5)
  v_smfmac_f32_16x16x64_bf16 v[32:35], v[12:15], a[48:55], v113
  v_smfmac_f32_16x16x64_bf16 v[40:43], v[12:15], a[176:183], v113
  s_waitcnt lgkmcnt(4)
  v_smfmac_f32_16x16x64_bf16 v[32:35], v[20:23], a[80:87], v113
  v_smfmac_f32_16x16x64_bf16 v[40:43], v[20:23], a[208:215], v113
  s_waitcnt lgkmcnt(3)
  v_smfmac_f32_16x16x64_bf16 v[32:35], v[24:27], a[96:103], v113
  v_smfmac_f32_16x16x64_bf16 v[40:43], v[24:27], a[224:231], v113
  s_waitcnt lgkmcnt(2)
  v_smfmac_f32_16x16x64_bf16 v[32:35], v[28:31], a[112:119], v113
  v_smfmac_f32_16x16x64_bf16 v[40:43], v[28:31], a[240:247], v113
  v_smfmac_f32_16x16x64_bf16 v[36:39], v[8:11], a[40:47], v113
  v_smfmac_f32_16x16x64_bf16 v[44:47], v[8:11], a[168:175], v113
  v_smfmac_f32_16x16x64_bf16 v[36:39], v[12:15], a[56:63], v113
  v_permlane32_swap_b32 v32, v40
  v_smfmac_f32_16x16x64_bf16 v[44:47], v[12:15], a[184:191], v113
  v_permlane32_swap_b32 v33, v41
  v_smfmac_f32_16x16x64_bf16 v[36:39], v[20:23], a[88:95], v113
  v_permlane32_swap_b32 v34, v42
  v_smfmac_f32_16x16x64_bf16 v[44:47], v[20:23], a[216:223], v113
  v_permlane32_swap_b32 v35, v43
  v_smfmac_f32_16x16x64_bf16 v[36:39], v[24:27], a[104:111], v113
  v_add_f32 v32, v32, v40
  v_smfmac_f32_16x16x64_bf16 v[44:47], v[24:27], a[232:239], v113
  v_add_f32 v33, v33, v41
  v_smfmac_f32_16x16x64_bf16 v[36:39], v[28:31], a[120:127], v113
  v_add_f32 v34, v34, v42
  v_smfmac_f32_16x16x64_bf16 v[44:47], v[28:31], a[248:255], v113
  v_add_f32 v35, v35, v43
  v_cvt_pk_bf16_f32 v40, v32, v33
  v_cvt_pk_bf16_f32 v41, v34, v35
  v_and_or_b32 v40, v40, -2, s49
  s_nop 3
  v_permlane32_swap_b32 v36, v44
  v_permlane32_swap_b32 v37, v45
  v_permlane32_swap_b32 v38, v46
  v_permlane32_swap_b32 v39, v47
  v_add_f32 v36, v36, v44
  v_add_f32 v37, v37, v45
  v_add_f32 v38, v38, v46
  v_add_f32 v39, v39, v47
  v_cvt_pk_bf16_f32 v42, v36, v37
  v_cvt_pk_bf16_f32 v43, v38, v39
  buffer_store_dwordx4 v[40:43], v112, s[4:7], s43 offen sc1
  s_waitcnt lgkmcnt(0)
  v_smfmac_f32_16x16x64_bf16 v[48:51], v[0:3], v[56:63], v113
  ds_read_b128 v[56:59], v118 offset:6144
  ds_read_b128 v[60:63], v118 offset:7168
  v_smfmac_f32_16x16x64_bf16 v[52:55], v[0:3], v[64:71], v113
  ds_read_b128 v[64:67], v118 offset:8192
  ds_read_b128 v[68:71], v118 offset:9216
  v_smfmac_f32_16x16x64_bf16 v[48:51], v[4:7], v[72:79], v113
  ds_read_b128 v[72:75], v118 offset:10240
  ds_read_b128 v[76:79], v118 offset:11264
  s_waitcnt lgkmcnt(4)
  v_smfmac_f32_16x16x64_bf16 v[52:55], v[4:7], v[56:63], v113
  ds_read_b128 v[56:59], v118 offset:12288
  ds_read_b128 v[60:63], v118 offset:13312
  s_waitcnt lgkmcnt(4)
  v_smfmac_f32_16x16x64_bf16 v[48:51], v[8:11], v[64:71], v113
  ds_read_b128 v[64:67], v118 offset:14336
  ds_read_b128 v[68:71], v118 offset:15360
  s_waitcnt lgkmcnt(4)
  v_smfmac_f32_16x16x64_bf16 v[52:55], v[8:11], v[72:79], v113
  ds_read_b128 v[72:75], v119 offset:0
  ds_read_b128 v[76:79], v119 offset:1024
  s_waitcnt lgkmcnt(4)
  v_smfmac_f32_16x16x64_bf16 v[48:51], v[12:15], v[56:63], v113
  ds_read_b128 v[56:59], v119 offset:2048
  ds_read_b128 v[60:63], v119 offset:3072
  s_waitcnt lgkmcnt(4)
  v_smfmac_f32_16x16x64_bf16 v[52:55], v[12:15], v[64:71], v113
  ds_read_b128 v[64:67], v119 offset:4096
  ds_read_b128 v[68:71], v119 offset:5120
  s_waitcnt lgkmcnt(4)
  v_smfmac_f32_16x16x64_bf16 v[48:51], v[16:19], v[72:79], v113
  ds_read_b128 v[72:75], v119 offset:6144
  ds_read_b128 v[76:79], v119 offset:7168
  s_waitcnt lgkmcnt(4)
  v_smfmac_f32_16x16x64_bf16 v[52:55], v[16:19], v[56:63], v113
  ds_read_b128 v[56:59], v119 offset:8192
  ds_read_b128 v[60:63], v119 offset:9216
  s_waitcnt lgkmcnt(4)
  v_smfmac_f32_16x16x64_bf16 v[48:51], v[20:23], v[64:71], v113
  ds_read_b128 v[64:67], v119 offset:10240
  ds_read_b128 v[68:71], v119 offset:11264
  s_waitcnt lgkmcnt(4)
  v_smfmac_f32_16x16x64_bf16 v[52:55], v[20:23], v[72:79], v113
  ds_read_b128 v[72:75], v119 offset:12288
  ds_read_b128 v[76:79], v119 offset:13312
  s_waitcnt lgkmcnt(4)
  v_smfmac_f32_16x16x64_bf16 v[48:51], v[24:27], v[56:63], v113
  ds_read_b128 v[56:59], v119 offset:14336
  ds_read_b128 v[60:63], v119 offset:15360
  s_cmp_lg_u32 s12, 0
  s_cbranch_scc1 xl_158
  buffer_load_dwordx4 v[100:103], v112, s[4:7], s44 offen offset:0 sc1
xl_158:
  s_waitcnt lgkmcnt(4)
  v_smfmac_f32_16x16x64_bf16 v[52:55], v[24:27], v[64:71], v113
  s_waitcnt lgkmcnt(2)
  v_smfmac_f32_16x16x64_bf16 v[48:51], v[28:31], v[72:79], v113
  s_cmp_lg_u32 s12, 1
  s_cbranch_scc1 xl_159
  buffer_load_dwordx4 v[100:103], v112, s[4:7], s44 offen offset:0 sc1
xl_159:
  s_waitcnt lgkmcnt(0)
  v_smfmac_f32_16x16x64_bf16 v[52:55], v[28:31], v[56:63], v113
  s_waitcnt vmcnt(3)
  s_nop 6
  v_permlane32_swap_b32 v48, v52
  v_permlane32_swap_b32 v49, v53
  v_permlane32_swap_b32 v50, v54
  v_permlane32_swap_b32 v51, v55
  v_pk_add_f32 v[92:93], v[48:49], v[52:53]
  v_pk_add_f32 v[94:95], v[50:51], v[54:55]
  v_cvt_pk_bf16_f32 v44, v92, v93
  v_cvt_pk_bf16_f32 v45, v94, v95
  v_lshrrev_b32 v86, 1, v112
  v_and_or_b32 v44, v44, -2, s49
  buffer_store_dwordx2 v[44:45], v86, s[4:7], s45 offen offset:0 sc1
  s_waitcnt vmcnt(1)
  v_and_b32 v125, 1, v100
  v_cmp_ne_u32 vcc, s49, v125
  s_cbranch_vccnz mcc_160
mcok_161:
  v_dot2_f32_bf16 v32, v100, s34, v32
  v_dot2_f32_bf16 v33, v100, s35, v33
  v_dot2_f32_bf16 v34, v101, s34, v34
  v_dot2_f32_bf16 v35, v101, s35, v35
  v_dot2_f32_bf16 v36, v102, s34, v36
  v_dot2_f32_bf16 v37, v102, s35, v37
  v_dot2_f32_bf16 v38, v103, s34, v38
  v_dot2_f32_bf16 v39, v103, s35, v39
mcj_162:
  v_cvt_pk_bf16_f32 v32, v32, v33
  v_cvt_pk_bf16_f32 v33, v34, v35
  ds_write_b64 v115, v[32:33] offset:0
  v_cvt_pk_bf16_f32 v36, v36, v37
  v_cvt_pk_bf16_f32 v37, v38, v39
  ds_write_b64 v115, v[36:37] offset:512
  s_waitcnt lgkmcnt(0)
  s_barrier
  buffer_load_dwordx2 v[88:89], v86, s[4:7], s46 offen offset:0 sc1
  ds_read_b64_tr_b16 v[32:33], v114 offset:0
  ds_read_b64_tr_b16 v[34:35], v114 offset:128
  ds_read_b64_tr_b16 v[36:37], v114 offset:1024
  ds_read_b64_tr_b16 v[38:39], v114 offset:1152
  ds_read_b64_tr_b16 v[40:41], v114 offset:2048
  ds_read_b64_tr_b16 v[42:43], v114 offset:2176
  ds_read_b64_tr_b16 v[44:45], v114 offset:3072
  ds_read_b64_tr_b16 v[46:47], v114 offset:3200
  s_waitcnt lgkmcnt(0)
  s_cmp_lg_u32 s12, 0
  s_cbranch_scc1 tx1_164
  s_mov_b64 exec, s[36:37]
  s_cmp_eq_u32 s14, 1
  s_cbranch_scc1 pk_167
  s_cmp_eq_u32 s14, 2
  s_cbranch_scc1 pk_168
  s_cmp_eq_u32 s14, 3
  s_cbranch_scc1 pk_169
  buffer_store_dwordx4 v[32:35], v123, s[4:7], s51 offen sc1
  s_branch pkd_170
pk_167:
  buffer_store_dwordx4 v[36:39], v123, s[4:7], s51 offen sc1
  s_branch pkd_170
pk_168:
  buffer_store_dwordx4 v[40:43], v123, s[4:7], s51 offen sc1
  s_branch pkd_170
pk_169:
  buffer_store_dwordx4 v[44:47], v123, s[4:7], s51 offen sc1
pkd_170:
  s_mov_b64 exec, -1
  s_branch txd_165
tx1_164:
  s_waitcnt vmcnt(0)
  s_waitcnt vmcnt(0)
  v_and_b32 v125, 1, v88
  v_cmp_ne_u32 vcc, s49, v125
  s_cbranch_vccnz spr_171
spok_172:
  v_dot2_f32_bf16 v92, v88, s34, v92
  v_dot2_f32_bf16 v93, v88, s35, v93
  v_dot2_f32_bf16 v94, v89, s34, v94
  v_dot2_f32_bf16 v95, v89, s35, v95
  s_nop 0
  v_cvt_pk_bf16_f32 v104, v92, v93
  s_nop 0
  v_cvt_pk_bf16_f32 v105, v94, v95
  buffer_store_dwordx2 v[104:105], v124, s[4:7], s51 offen sc1
txd_165:
  s_waitcnt vmcnt(0)
  s_add_u32 s50, s50, 512
  s_barrier
  s_cmp_lg_u32 s14, 0
  s_cbranch_scc1 fs_173
  s_mov_b64 exec, 1
  buffer_store_dword v126, off, s[4:7], s50 sc1
  s_mov_b64 exec, -1
fs_173:
  s_waitcnt vmcnt(0)
  s_branch loop5done_127
hk_149:
  v_mov_b64 v[32:33], 0
  v_mov_b64 v[34:35], 0
  v_mov_b64 v[36:37], 0
  v_mov_b64 v[38:39], 0
  v_mov_b64 v[40:41], 0
  v_mov_b64 v[42:43], 0
  v_mov_b64 v[44:45], 0
  v_mov_b64 v[46:47], 0
  v_mov_b64 v[48:49], 0
  v_mov_b64 v[50:51], 0
  v_mov_b64 v[52:53], 0
  v_mov_b64 v[54:55], 0
  s_xor_b32 s43, s43, 524288
  s_xor_b32 s44, s44, 524288
  s_xor_b32 s45, s45, 262144
  s_xor_b32 s46, s46, 262144
  s_xor_b32 s47, s47, 262144
  s_xor_b32 s40, s40, 0x2000
  s_add_u32 s51, s51, 65536
  s_add_u32 s50, s50, 512
  s_add_u32 s55, s55, 512
  s_xor_b32 s67, s67, 0x2000
  s_add_u32 s15, s15, 1
  s_add_u32 s52, s15, 1
  s_branch redd_150
dpra_128:
  s_cmp_eq_u32 s29, 0
  s_cbranch_scc1 dpoka_131
  s_sub_u32 s29, s29, 1
  buffer_load_dwordx4 v[80:83], v112, s[4:7], s40 offen sc1
  buffer_load_dwordx4 v[84:87], v112, s[4:7], s67 offen sc1
  s_waitcnt vmcnt(2)
  v_max3_u32 v106, v88, v89, v90
  v_max3_u32 v107, v91, v92, v93
  v_max3_u32 v106, v106, v94, v95
  v_max_u32 v106, v106, v107
  v_cmp_eq_u32 vcc, -1, v106
  s_cbranch_vccz dpub_129
dpl_174:
  buffer_load_dwordx4 v[88:91], v112, s[4:7], s40 offen sc1
  buffer_load_dwordx4 v[92:95], v112, s[4:7], s67 offen sc1
  s_waitcnt vmcnt(2)
  v_max3_u32 v106, v80, v81, v82
  v_max3_u32 v107, v83, v84, v85
  v_max3_u32 v106, v106, v86, v87
  v_max_u32 v106, v106, v107
  v_cmp_eq_u32 vcc, -1, v106
  s_cbranch_vccz dpoka_131
  s_cmp_eq_u32 s29, 0
  s_cbranch_scc1 dpoka_131
  s_sub_u32 s29, s29, 1
  buffer_load_dwordx4 v[80:83], v112, s[4:7], s40 offen sc1
  buffer_load_dwordx4 v[84:87], v112, s[4:7], s67 offen sc1
  s_waitcnt vmcnt(2)
  v_max3_u32 v106, v88, v89, v90
  v_max3_u32 v107, v91, v92, v93
  v_max3_u32 v106, v106, v94, v95
  v_max_u32 v106, v106, v107
  v_cmp_eq_u32 vcc, -1, v106
  s_cbranch_vccnz dpl_174
dpub_129:
  ds_write_b128 v125, v[88:91]
  ds_write_b128 v125, v[92:95] offset:4096
  v_smfmac_f32_16x16x64_bf16 v[32:35], v[88:91], a[0:7], v113
  v_smfmac_f32_16x16x64_bf16 v[40:43], v[88:91], a[128:135], v113
  v_smfmac_f32_16x16x64_bf16 v[36:39], v[88:91], a[8:15], v113
  v_smfmac_f32_16x16x64_bf16 v[44:47], v[88:91], a[136:143], v113
  s_waitcnt lgkmcnt(0)
  s_barrier
  ds_read_b128 v[4:7], v100 offset:0
  ds_read_b128 v[8:11], v101 offset:0
  ds_read_b128 v[12:15], v102 offset:0
  ds_read_b128 v[20:23], v100 offset:4096
  ds_read_b128 v[24:27], v101 offset:4096
  ds_read_b128 v[28:31], v102 offset:4096
  ds_read_b128 v[0:3], v125 offset:0
  ds_read_b128 v[16:19], v125 offset:4096
  v_smfmac_f32_16x16x64_bf16 v[32:35], v[92:95], a[64:71], v113
  s_mov_b64 exec, s[96:97]
  buffer_store_dword v126, off, s[4:7], s50 sc1
  s_mov_b64 exec, -1
  v_smfmac_f32_16x16x64_bf16 v[40:43], v[92:95], a[192:199], v113
  v_smfmac_f32_16x16x64_bf16 v[36:39], v[92:95], a[72:79], v113
  v_smfmac_f32_16x16x64_bf16 v[44:47], v[92:95], a[200:207], v113
  s_branch dpj_130
mcc_134:
  s_cmp_eq_u32 s29, 0
  s_cbranch_scc1 mcok_135
  s_sub_u32 s29, s29, 1
  buffer_load_dwordx4 v[100:103], v112, s[4:7], s44 offen offset:0 sc1
  s_waitcnt vmcnt(1)
  v_and_b32 v125, 1, v88
  v_cmp_ne_u32 vcc, s49, v125
  s_cbranch_vccz mcu_138
mcl_137:
  buffer_load_dwordx4 v[88:91], v112, s[4:7], s44 offen offset:0 sc1
  s_waitcnt vmcnt(1)
  v_and_b32 v125, 1, v100
  v_cmp_ne_u32 vcc, s49, v125
  s_cbranch_vccz mcok_135
  s_cmp_eq_u32 s29, 0
  s_cbranch_scc1 mcok_135
  s_sub_u32 s29, s29, 1
  buffer_load_dwordx4 v[100:103], v112, s[4:7], s44 offen offset:0 sc1
  s_waitcnt vmcnt(1)
  v_and_b32 v125, 1, v88
  v_cmp_ne_u32 vcc, s49, v125
  s_cbranch_vccnz mcl_137
mcu_138:
  v_dot2_f32_bf16 v32, v88, s34, v32
  v_dot2_f32_bf16 v33, v88, s35, v33
  v_dot2_f32_bf16 v34, v89, s34, v34
  v_dot2_f32_bf16 v35, v89, s35, v35
  v_dot2_f32_bf16 v36, v90, s34, v36
  v_dot2_f32_bf16 v37, v90, s35, v37
  v_dot2_f32_bf16 v38, v91, s34, v38
  v_dot2_f32_bf16 v39, v91, s35, v39
  s_branch mcj_136
kvc_139:
  s_lshl_b32 s25, s52, 9
  s_add_u32 s25, s25, s54
  buffer_load_dword v125, off, s[4:7], s25 sc1
  s_waitcnt vmcnt(0)
  v_readfirstlane_b32 s26, v125
  s_cmp_lg_u32 s26, 0
  s_cbranch_scc1 kvb_140
  s_cmp_eq_u32 s29, 0
  s_cbranch_scc1 kvb_140
  s_sub_u32 s29, s29, 1
  s_branch kvc_139
spr_141:
  s_cmp_eq_u32 s29, 0
  s_cbranch_scc1 spok_142
  s_sub_u32 s29, s29, 1
  buffer_load_dwordx2 v[88:89], v86, s[4:7], s46 offen offset:0 sc1
  s_waitcnt vmcnt(0)
  v_and_b32 v125, 1, v88
  v_cmp_ne_u32 vcc, s49, v125
  s_cbranch_vccnz spr_141
  s_branch spok_142
PR_151:
  s_cmp_eq_u32 s29, 0
  s_cbranch_scc1 Pok_152
  s_sub_u32 s29, s29, 1
  buffer_load_dwordx4 v[0:3], v125, s[4:7], s48 offen offset:0 sc1
  buffer_load_dwordx4 v[4:7], v125, s[4:7], s48 offen offset:2048 sc1
  buffer_load_dwordx4 v[8:11], v125, s[4:7], s69 offen offset:0 sc1
  buffer_load_dwordx4 v[12:15], v125, s[4:7], s69 offen offset:2048 sc1
  s_waitcnt vmcnt(7)
  v_mfma_f32_16x16x32_bf16 v[100:103], v[16:19], v[96:99], 0
  s_waitcnt vmcnt(6)
  v_mfma_f32_16x16x32_bf16 v[100:103], v[20:23], v[96:99], v[100:103]
  v_bitop3_b32 v106, v16, v20, s49 bitop3:0x7e
  s_waitcnt vmcnt(5)
  v_mfma_f32_16x16x32_bf16 v[100:103], v[24:27], v[96:99], v[100:103]
  v_bitop3_b32 v106, v106, v24, s49 bitop3:0xf6
  s_waitcnt vmcnt(4)
  v_mfma_f32_16x16x32_bf16 v[100:103], v[28:31], v[96:99], v[100:103]
  v_bitop3_b32 v106, v106, v28, s49 bitop3:0xf6
  v_and_b32 v106, 1, v106
  v_cmp_ne_u32 vcc, 0, v106
  s_cbranch_vccz Pok_152
PL_153:
  buffer_load_dwordx4 v[16:19], v125, s[4:7], s48 offen offset:0 sc1
  buffer_load_dwordx4 v[20:23], v125, s[4:7], s48 offen offset:2048 sc1
  buffer_load_dwordx4 v[24:27], v125, s[4:7], s69 offen offset:0 sc1
  buffer_load_dwordx4 v[28:31], v125, s[4:7], s69 offen offset:2048 sc1
  s_waitcnt vmcnt(7)
  v_mfma_f32_16x16x32_bf16 v[100:103], v[0:3], v[96:99], 0
  s_waitcnt vmcnt(6)
  v_mfma_f32_16x16x32_bf16 v[100:103], v[4:7], v[96:99], v[100:103]
  v_bitop3_b32 v106, v0, v4, s49 bitop3:0x7e
  s_waitcnt vmcnt(5)
  v_mfma_f32_16x16x32_bf16 v[100:103], v[8:11], v[96:99], v[100:103]
  v_bitop3_b32 v106, v106, v8, s49 bitop3:0xf6
  s_waitcnt vmcnt(4)
  v_mfma_f32_16x16x32_bf16 v[100:103], v[12:15], v[96:99], v[100:103]
  v_bitop3_b32 v106, v106, v12, s49 bitop3:0xf6
  v_and_b32 v106, 1, v106
  v_cmp_ne_u32 vcc, 0, v106
  s_cbranch_vccz Pok_152
  s_cmp_eq_u32 s29, 0
  s_cbranch_scc1 Pok_152
  s_sub_u32 s29, s29, 1
  buffer_load_dwordx4 v[0:3], v125, s[4:7], s48 offen offset:0 sc1
  buffer_load_dwordx4 v[4:7], v125, s[4:7], s48 offen offset:2048 sc1
  buffer_load_dwordx4 v[8:11], v125, s[4:7], s69 offen offset:0 sc1
  buffer_load_dwordx4 v[12:15], v125, s[4:7], s69 offen offset:2048 sc1
  s_waitcnt vmcnt(7)
  v_mfma_f32_16x16x32_bf16 v[100:103], v[16:19], v[96:99], 0
  s_waitcnt vmcnt(6)
  v_mfma_f32_16x16x32_bf16 v[100:103], v[20:23], v[96:99], v[100:103]
  v_bitop3_b32 v106, v16, v20, s49 bitop3:0x7e
  s_waitcnt vmcnt(5)
  v_mfma_f32_16x16x32_bf16 v[100:103], v[24:27], v[96:99], v[100:103]
  v_bitop3_b32 v106, v106, v24, s49 bitop3:0xf6
  s_waitcnt vmcnt(4)
  v_mfma_f32_16x16x32_bf16 v[100:103], v[28:31], v[96:99], v[100:103]
  v_bitop3_b32 v106, v106, v28, s49 bitop3:0xf6
  v_and_b32 v106, 1, v106
  v_cmp_ne_u32 vcc, 0, v106
  s_cbranch_vccnz PL_153
  s_branch Pok_152
dpra_154:
  s_cmp_eq_u32 s29, 0
  s_cbranch_scc1 dpoka_157
  s_sub_u32 s29, s29, 1
  buffer_load_dwordx4 v[80:83], v112, s[4:7], s40 offen sc1
  buffer_load_dwordx4 v[84:87], v112, s[4:7], s67 offen sc1
  s_waitcnt vmcnt(2)
  v_max3_u32 v106, v88, v89, v90
  v_max3_u32 v107, v91, v92, v93
  v_max3_u32 v106, v106, v94, v95
  v_max_u32 v106, v106, v107
  v_cmp_eq_u32 vcc, -1, v106
  s_cbranch_vccz dpub_155
dpl_175:
  buffer_load_dwordx4 v[88:91], v112, s[4:7], s40 offen sc1
  buffer_load_dwordx4 v[92:95], v112, s[4:7], s67 offen sc1
  s_waitcnt vmcnt(2)
  v_max3_u32 v106, v80, v81, v82
  v_max3_u32 v107, v83, v84, v85
  v_max3_u32 v106, v106, v86, v87
  v_max_u32 v106, v106, v107
  v_cmp_eq_u32 vcc, -1, v106
  s_cbranch_vccz dpoka_157
  s_cmp_eq_u32 s29, 0
  s_cbranch_scc1 dpoka_157
  s_sub_u32 s29, s29, 1
  buffer_load_dwordx4 v[80:83], v112, s[4:7], s40 offen sc1
  buffer_load_dwordx4 v[84:87], v112, s[4:7], s67 offen sc1
  s_waitcnt vmcnt(2)
  v_max3_u32 v106, v88, v89, v90
  v_max3_u32 v107, v91, v92, v93
  v_max3_u32 v106, v106, v94, v95
  v_max_u32 v106, v106, v107
  v_cmp_eq_u32 vcc, -1, v106
  s_cbranch_vccnz dpl_175
dpub_155:
  ds_write_b128 v125, v[88:91]
  ds_write_b128 v125, v[92:95] offset:4096
  v_smfmac_f32_16x16x64_bf16 v[32:35], v[88:91], a[0:7], v113
  v_smfmac_f32_16x16x64_bf16 v[40:43], v[88:91], a[128:135], v113
  v_smfmac_f32_16x16x64_bf16 v[36:39], v[88:91], a[8:15], v113
  v_smfmac_f32_16x16x64_bf16 v[44:47], v[88:91], a[136:143], v113
  s_waitcnt lgkmcnt(0)
  s_barrier
  ds_read_b128 v[4:7], v100 offset:0
  ds_read_b128 v[8:11], v101 offset:0
  ds_read_b128 v[12:15], v102 offset:0
  ds_read_b128 v[20:23], v100 offset:4096
  ds_read_b128 v[24:27], v101 offset:4096
  ds_read_b128 v[28:31], v102 offset:4096
  ds_read_b128 v[0:3], v125 offset:0
  ds_read_b128 v[16:19], v125 offset:4096
  v_smfmac_f32_16x16x64_bf16 v[32:35], v[92:95], a[64:71], v113
  s_mov_b64 exec, s[96:97]
  buffer_store_dword v126, off, s[4:7], s50 sc1
  s_mov_b64 exec, -1
  v_smfmac_f32_16x16x64_bf16 v[40:43], v[92:95], a[192:199], v113
  v_smfmac_f32_16x16x64_bf16 v[36:39], v[92:95], a[72:79], v113
  v_smfmac_f32_16x16x64_bf16 v[44:47], v[92:95], a[200:207], v113
  s_branch dpj_156
mcc_160:
  s_cmp_eq_u32 s29, 0
  s_cbranch_scc1 mcok_161
  s_sub_u32 s29, s29, 1
mcl_163:
  buffer_load_dwordx4 v[100:103], v112, s[4:7], s44 offen offset:0 sc1
  s_waitcnt vmcnt(0)
  v_and_b32 v125, 1, v100
  v_cmp_ne_u32 vcc, s49, v125
  s_cbranch_vccz mcok_161
  s_cmp_eq_u32 s29, 0
  s_cbranch_scc1 mcok_161
  s_sub_u32 s29, s29, 1
  s_branch mcl_163
spr_171:
  s_cmp_eq_u32 s29, 0
  s_cbranch_scc1 spok_172
  s_sub_u32 s29, s29, 1
  buffer_load_dwordx2 v[88:89], v86, s[4:7], s46 offen offset:0 sc1
  s_waitcnt vmcnt(0)
  v_and_b32 v125, 1, v88
  v_cmp_ne_u32 vcc, s49, v125
  s_cbranch_vccnz spr_171
  s_branch spok_172
loop5done_127:
chain_end_25:
  s_branch k_dump_2
gemm_24:
  s_sub_u32 s37, s31, 64
  s_mov_b32 s29, 0x40000
  s_and_b32 s40, s37, 31
  s_lshr_b32 s23, s37, 5
  s_and_b32 s41, s23, 1
  s_lshr_b32 s42, s23, 1
  s_lshl_b32 s23, s41, 4
  s_and_b32 s41, s40, 1
  s_lshr_b32 s40, s40, 1
  s_add_u32 s40, s40, s23
  s_cmp_lg_u32 s42, 0
  s_cbranch_scc1 g1i_180
  s_load_dwordx2 s[8:9], s[0:1], 0
  s_load_dwordx2 s[32:33], s[0:1], 8
  s_waitcnt lgkmcnt(0)
  s_mov_b32 s10, 4194304
  s_mov_b32 s11, 0x00020000
  s_mov_b32 s34, 16384
  s_mov_b32 s35, 0x00020000
  v_and_b32 v1, 63, v0
  v_lshrrev_b32 v2, 3, v1
  v_and_b32 v3, 7, v1
  v_lshlrev_b32 v4, 11, v2
  v_lshl_add_u32 v4, v3, 4, v4
  s_lshl_b32 s23, s37, 16
  s_lshl_b32 s24, s14, 14
  s_add_u32 s23, s23, s24
  buffer_load_dwordx4 v[16:19], v4, s[8:11], s23 offen offset:0
  buffer_load_dwordx4 v[20:23], v4, s[8:11], s23 offen offset:128
  buffer_load_dwordx4 v[24:27], v4, s[8:11], s23 offen offset:256
  buffer_load_dwordx4 v[28:31], v4, s[8:11], s23 offen offset:384
  buffer_load_dwordx4 v[32:35], v4, s[8:11], s23 offen offset:512
  buffer_load_dwordx4 v[36:39], v4, s[8:11], s23 offen offset:640
  buffer_load_dwordx4 v[40:43], v4, s[8:11], s23 offen offset:768
  buffer_load_dwordx4 v[44:47], v4, s[8:11], s23 offen offset:896
  buffer_load_dwordx4 v[48:51], v4, s[8:11], s23 offen offset:1024
  buffer_load_dwordx4 v[52:55], v4, s[8:11], s23 offen offset:1152
  buffer_load_dwordx4 v[56:59], v4, s[8:11], s23 offen offset:1280
  buffer_load_dwordx4 v[60:63], v4, s[8:11], s23 offen offset:1408
  buffer_load_dwordx4 v[64:67], v4, s[8:11], s23 offen offset:1536
  buffer_load_dwordx4 v[68:71], v4, s[8:11], s23 offen offset:1664
  buffer_load_dwordx4 v[72:75], v4, s[8:11], s23 offen offset:1792
  buffer_load_dwordx4 v[76:79], v4, s[8:11], s23 offen offset:1920
  s_lshl_b32 s24, s37, 12
  v_lshlrev_b32 v5, 4, v0
  v_add_u32 v5, s24, v5
  v_mov_b32 v6, -1
  v_mov_b32 v7, 0
  v_cmp_gt_u32 vcc, 196608, v5
  s_nop 1
  v_cndmask_b32 v6, v6, v7, vcc
  v_mov_b32 v224, v6
  v_mov_b32 v225, v6
  v_mov_b32 v226, v6
  v_mov_b32 v227, v6
  v_mov_b32 v228, -1
  v_mov_b32 v229, -1
  v_mov_b32 v230, -1
  v_mov_b32 v231, -1
  v_subrev_u32 v7, 196608, v5
  v_cmp_gt_u32 vcc, 0x8000, v7
  v_and_b32 v6, 0x2000, v7
  v_cmp_eq_u32 s[24:25], 0, v6
  s_and_b64 vcc, vcc, s[24:25]
  s_and_saveexec_b64 s[26:27], vcc
  s_cbranch_execz in_nomem_181
  v_lshrrev_b32 v6, 4, v7
  v_and_b32 v6, 7, v6
  v_lshlrev_b32 v6, 11, v6
  v_lshrrev_b32 v8, 14, v7
  v_lshl_add_u32 v6, v8, 10, v6
  v_lshrrev_b32 v7, 7, v7
  v_and_b32 v7, 63, v7
  v_lshl_add_u32 v6, v7, 4, v6
  buffer_load_dwordx4 v[224:227], v6, s[32:35], 0 offen
  s_waitcnt vmcnt(0)
in_nomem_181:
  s_mov_b64 exec, s[26:27]
  buffer_store_dwordx4 v[224:227], v5, s[4:7], 0 offen sc1
  s_mov_b32 s24, 1048576
  buffer_store_dwordx4 v[228:231], v5, s[4:7], s24 offen sc1
  s_mov_b32 s24, 1310720
  buffer_store_dwordx4 v[228:231], v5, s[4:7], s24 offen sc1
  s_mov_b32 s24, 1572864
  buffer_store_dwordx4 v[228:231], v5, s[4:7], s24 offen sc1
  s_mov_b32 s24, 1835008
  buffer_store_dwordx4 v[228:231], v5, s[4:7], s24 offen sc1
  s_mov_b32 s24, 150994944
  buffer_store_dwordx4 v[228:231], v5, s[4:7], s24 offen sc1
  s_mov_b32 s24, 151257088
  buffer_store_dwordx4 v[228:231], v5, s[4:7], s24 offen sc1
  s_mov_b32 s24, 151519232
  buffer_store_dwordx4 v[228:231], v5, s[4:7], s24 offen sc1
  s_mov_b32 s24, 151781376
  buffer_store_dwordx4 v[228:231], v5, s[4:7], s24 offen sc1
  s_mov_b32 s24, 152043520
  buffer_store_dwordx4 v[228:231], v5, s[4:7], s24 offen sc1
  s_mov_b32 s24, 152305664
  buffer_store_dwordx4 v[228:231], v5, s[4:7], s24 offen sc1
  s_waitcnt vmcnt(11)
  v_and_b32 v97, 0xffff0000, v16
  v_lshlrev_b32 v96, 16, v16
  v_and_b32 v99, 0xffff0000, v17
  v_lshlrev_b32 v98, 16, v17
  v_and_b32 v101, 0xffff0000, v18
  v_lshlrev_b32 v100, 16, v18
  v_and_b32 v103, 0xffff0000, v19
  v_lshlrev_b32 v102, 16, v19
  v_and_b32 v105, 0xffff0000, v20
  v_lshlrev_b32 v104, 16, v20
  v_and_b32 v107, 0xffff0000, v21
  v_lshlrev_b32 v106, 16, v21
  v_and_b32 v109, 0xffff0000, v22
  v_lshlrev_b32 v108, 16, v22
  v_and_b32 v111, 0xffff0000, v23
  v_lshlrev_b32 v110, 16, v23
  v_and_b32 v113, 0xffff0000, v24
  v_lshlrev_b32 v112, 16, v24
  v_and_b32 v115, 0xffff0000, v25
  v_lshlrev_b32 v114, 16, v25
  v_and_b32 v117, 0xffff0000, v26
  v_lshlrev_b32 v116, 16, v26
  v_and_b32 v119, 0xffff0000, v27
  v_lshlrev_b32 v118, 16, v27
  v_and_b32 v121, 0xffff0000, v28
  v_lshlrev_b32 v120, 16, v28
  v_and_b32 v123, 0xffff0000, v29
  v_lshlrev_b32 v122, 16, v29
  v_and_b32 v125, 0xffff0000, v30
  v_lshlrev_b32 v124, 16, v30
  v_and_b32 v127, 0xffff0000, v31
  v_lshlrev_b32 v126, 16, v31
  v_and_b32 v129, 0xffff0000, v32
  v_lshlrev_b32 v128, 16, v32
  v_and_b32 v131, 0xffff0000, v33
  v_lshlrev_b32 v130, 16, v33
  v_and_b32 v133, 0xffff0000, v34
  v_lshlrev_b32 v132, 16, v34
  v_and_b32 v135, 0xffff0000, v35
  v_lshlrev_b32 v134, 16, v35
  v_and_b32 v137, 0xffff0000, v36
  v_lshlrev_b32 v136, 16, v36
  v_and_b32 v139, 0xffff0000, v37
  v_lshlrev_b32 v138, 16, v37
  v_and_b32 v141, 0xffff0000, v38
  v_lshlrev_b32 v140, 16, v38
  v_and_b32 v143, 0xffff0000, v39
  v_lshlrev_b32 v142, 16, v39
  v_and_b32 v145, 0xffff0000, v40
  v_lshlrev_b32 v144, 16, v40
  v_and_b32 v147, 0xffff0000, v41
  v_lshlrev_b32 v146, 16, v41
  v_and_b32 v149, 0xffff0000, v42
  v_lshlrev_b32 v148, 16, v42
  v_and_b32 v151, 0xffff0000, v43
  v_lshlrev_b32 v150, 16, v43
  v_and_b32 v153, 0xffff0000, v44
  v_lshlrev_b32 v152, 16, v44
  v_and_b32 v155, 0xffff0000, v45
  v_lshlrev_b32 v154, 16, v45
  v_and_b32 v157, 0xffff0000, v46
  v_lshlrev_b32 v156, 16, v46
  v_and_b32 v159, 0xffff0000, v47
  v_lshlrev_b32 v158, 16, v47
  v_and_b32 v161, 0xffff0000, v48
  v_lshlrev_b32 v160, 16, v48
  v_and_b32 v163, 0xffff0000, v49
  v_lshlrev_b32 v162, 16, v49
  v_and_b32 v165, 0xffff0000, v50
  v_lshlrev_b32 v164, 16, v50
  v_and_b32 v167, 0xffff0000, v51
  v_lshlrev_b32 v166, 16, v51
  v_and_b32 v169, 0xffff0000, v52
  v_lshlrev_b32 v168, 16, v52
  v_and_b32 v171, 0xffff0000, v53
  v_lshlrev_b32 v170, 16, v53
  v_and_b32 v173, 0xffff0000, v54
  v_lshlrev_b32 v172, 16, v54
  v_and_b32 v175, 0xffff0000, v55
  v_lshlrev_b32 v174, 16, v55
  v_and_b32 v177, 0xffff0000, v56
  v_lshlrev_b32 v176, 16, v56
  v_and_b32 v179, 0xffff0000, v57
  v_lshlrev_b32 v178, 16, v57
  v_and_b32 v181, 0xffff0000, v58
  v_lshlrev_b32 v180, 16, v58
  v_and_b32 v183, 0xffff0000, v59
  v_lshlrev_b32 v182, 16, v59
  v_and_b32 v185, 0xffff0000, v60
  v_lshlrev_b32 v184, 16, v60
  v_and_b32 v187, 0xffff0000, v61
  v_lshlrev_b32 v186, 16, v61
  v_and_b32 v189, 0xffff0000, v62
  v_lshlrev_b32 v188, 16, v62
  v_and_b32 v191, 0xffff0000, v63
  v_lshlrev_b32 v190, 16, v63
  v_and_b32 v193, 0xffff0000, v64
  v_lshlrev_b32 v192, 16, v64
  v_and_b32 v195, 0xffff0000, v65
  v_lshlrev_b32 v194, 16, v65
  v_and_b32 v197, 0xffff0000, v66
  v_lshlrev_b32 v196, 16, v66
  v_and_b32 v199, 0xffff0000, v67
  v_lshlrev_b32 v198, 16, v67
  v_and_b32 v201, 0xffff0000, v68
  v_lshlrev_b32 v200, 16, v68
  v_and_b32 v203, 0xffff0000, v69
  v_lshlrev_b32 v202, 16, v69
  v_and_b32 v205, 0xffff0000, v70
  v_lshlrev_b32 v204, 16, v70
  v_and_b32 v207, 0xffff0000, v71
  v_lshlrev_b32 v206, 16, v71
  v_and_b32 v209, 0xffff0000, v72
  v_lshlrev_b32 v208, 16, v72
  v_and_b32 v211, 0xffff0000, v73
  v_lshlrev_b32 v210, 16, v73
  v_and_b32 v213, 0xffff0000, v74
  v_lshlrev_b32 v212, 16, v74
  v_and_b32 v215, 0xffff0000, v75
  v_lshlrev_b32 v214, 16, v75
  v_and_b32 v217, 0xffff0000, v76
  v_lshlrev_b32 v216, 16, v76
  v_and_b32 v219, 0xffff0000, v77
  v_lshlrev_b32 v218, 16, v77
  v_and_b32 v221, 0xffff0000, v78
  v_lshlrev_b32 v220, 16, v78
  v_and_b32 v223, 0xffff0000, v79
  v_lshlrev_b32 v222, 16, v79
  v_pk_add_f32 v[8:9], v[96:97], v[98:99]
  v_pk_add_f32 v[10:11], v[100:101], v[102:103]
  v_pk_add_f32 v[8:9], v[8:9], v[104:105]
  v_pk_add_f32 v[10:11], v[10:11], v[106:107]
  v_pk_add_f32 v[8:9], v[8:9], v[108:109]
  v_pk_add_f32 v[10:11], v[10:11], v[110:111]
  v_pk_add_f32 v[8:9], v[8:9], v[112:113]
  v_pk_add_f32 v[10:11], v[10:11], v[114:115]
  v_pk_add_f32 v[8:9], v[8:9], v[116:117]
  v_pk_add_f32 v[10:11], v[10:11], v[118:119]
  v_pk_add_f32 v[8:9], v[8:9], v[120:121]
  v_pk_add_f32 v[10:11], v[10:11], v[122:123]
  v_pk_add_f32 v[8:9], v[8:9], v[124:125]
  v_pk_add_f32 v[10:11], v[10:11], v[126:127]
  v_pk_add_f32 v[8:9], v[8:9], v[128:129]
  v_pk_add_f32 v[10:11], v[10:11], v[130:131]
  v_pk_add_f32 v[8:9], v[8:9], v[132:133]
  v_pk_add_f32 v[10:11], v[10:11], v[134:135]
  v_pk_add_f32 v[8:9], v[8:9], v[136:137]
  v_pk_add_f32 v[10:11], v[10:11], v[138:139]
  v_pk_add_f32 v[8:9], v[8:9], v[140:141]
  v_pk_add_f32 v[10:11], v[10:11], v[142:143]
  v_pk_add_f32 v[8:9], v[8:9], v[144:145]
  v_pk_add_f32 v[10:11], v[10:11], v[146:147]
  v_pk_add_f32 v[8:9], v[8:9], v[148:149]
  v_pk_add_f32 v[10:11], v[10:11], v[150:151]
  v_pk_add_f32 v[8:9], v[8:9], v[152:153]
  v_pk_add_f32 v[10:11], v[10:11], v[154:155]
  v_pk_add_f32 v[8:9], v[8:9], v[156:157]
  v_pk_add_f32 v[10:11], v[10:11], v[158:159]
  v_pk_add_f32 v[8:9], v[8:9], v[160:161]
  v_pk_add_f32 v[10:11], v[10:11], v[162:163]
  v_pk_add_f32 v[8:9], v[8:9], v[164:165]
  v_pk_add_f32 v[10:11], v[10:11], v[166:167]
  v_pk_add_f32 v[8:9], v[8:9], v[168:169]
  v_pk_add_f32 v[10:11], v[10:11], v[170:171]
  v_pk_add_f32 v[8:9], v[8:9], v[172:173]
  v_pk_add_f32 v[10:11], v[10:11], v[174:175]
  v_pk_add_f32 v[8:9], v[8:9], v[176:177]
  v_pk_add_f32 v[10:11], v[10:11], v[178:179]
  v_pk_add_f32 v[8:9], v[8:9], v[180:181]
  v_pk_add_f32 v[10:11], v[10:11], v[182:183]
  v_pk_add_f32 v[8:9], v[8:9], v[184:185]
  v_pk_add_f32 v[10:11], v[10:11], v[186:187]
  v_pk_add_f32 v[8:9], v[8:9], v[188:189]
  v_pk_add_f32 v[10:11], v[10:11], v[190:191]
  v_pk_add_f32 v[8:9], v[8:9], v[192:193]
  v_pk_add_f32 v[10:11], v[10:11], v[194:195]
  v_pk_add_f32 v[8:9], v[8:9], v[196:197]
  v_pk_add_f32 v[10:11], v[10:11], v[198:199]
  v_pk_add_f32 v[8:9], v[8:9], v[200:201]
  v_pk_add_f32 v[10:11], v[10:11], v[202:203]
  v_pk_add_f32 v[8:9], v[8:9], v[204:205]
  v_pk_add_f32 v[10:11], v[10:11], v[206:207]
  v_pk_add_f32 v[8:9], v[8:9], v[208:209]
  v_pk_add_f32 v[10:11], v[10:11], v[210:211]
  v_pk_add_f32 v[8:9], v[8:9], v[212:213]
  v_pk_add_f32 v[10:11], v[10:11], v[214:215]
  v_pk_add_f32 v[8:9], v[8:9], v[216:217]
  v_pk_add_f32 v[10:11], v[10:11], v[218:219]
  v_pk_add_f32 v[8:9], v[8:9], v[220:221]
  v_pk_add_f32 v[10:11], v[10:11], v[222:223]
  v_pk_add_f32 v[8:9], v[8:9], v[10:11]
  v_add_f32 v8, v8, v9
  s_nop 1
  v_add_f32_dpp v9, v8, v8 quad_perm:[1,0,3,2] row_mask:0xf bank_mask:0xf
  s_nop 1
  v_add_f32_dpp v8, v9, v9 quad_perm:[2,3,0,1] row_mask:0xf bank_mask:0xf
  s_nop 1
  v_add_f32_dpp v9, v8, v8 row_half_mirror row_mask:0xf bank_mask:0xf
  v_mov_b32 v8, v9
  v_mul_f32 v8, 0x3a800000, v8
  v_pk_add_f32 v[96:97], v[96:97], v[8:9] op_sel_hi:[1,0] neg_lo:[0,1] neg_hi:[0,1]
  v_pk_add_f32 v[98:99], v[98:99], v[8:9] op_sel_hi:[1,0] neg_lo:[0,1] neg_hi:[0,1]
  v_pk_add_f32 v[100:101], v[100:101], v[8:9] op_sel_hi:[1,0] neg_lo:[0,1] neg_hi:[0,1]
  v_pk_add_f32 v[102:103], v[102:103], v[8:9] op_sel_hi:[1,0] neg_lo:[0,1] neg_hi:[0,1]
  v_pk_add_f32 v[104:105], v[104:105], v[8:9] op_sel_hi:[1,0] neg_lo:[0,1] neg_hi:[0,1]
  v_pk_add_f32 v[106:107], v[106:107], v[8:9] op_sel_hi:[1,0] neg_lo:[0,1] neg_hi:[0,1]
  v_pk_add_f32 v[108:109], v[108:109], v[8:9] op_sel_hi:[1,0] neg_lo:[0,1] neg_hi:[0,1]
  v_pk_add_f32 v[110:111], v[110:111], v[8:9] op_sel_hi:[1,0] neg_lo:[0,1] neg_hi:[0,1]
  v_pk_add_f32 v[112:113], v[112:113], v[8:9] op_sel_hi:[1,0] neg_lo:[0,1] neg_hi:[0,1]
  v_pk_add_f32 v[114:115], v[114:115], v[8:9] op_sel_hi:[1,0] neg_lo:[0,1] neg_hi:[0,1]
  v_pk_add_f32 v[116:117], v[116:117], v[8:9] op_sel_hi:[1,0] neg_lo:[0,1] neg_hi:[0,1]
  v_pk_add_f32 v[118:119], v[118:119], v[8:9] op_sel_hi:[1,0] neg_lo:[0,1] neg_hi:[0,1]
  v_pk_add_f32 v[120:121], v[120:121], v[8:9] op_sel_hi:[1,0] neg_lo:[0,1] neg_hi:[0,1]
  v_pk_add_f32 v[122:123], v[122:123], v[8:9] op_sel_hi:[1,0] neg_lo:[0,1] neg_hi:[0,1]
  v_pk_add_f32 v[124:125], v[124:125], v[8:9] op_sel_hi:[1,0] neg_lo:[0,1] neg_hi:[0,1]
  v_pk_add_f32 v[126:127], v[126:127], v[8:9] op_sel_hi:[1,0] neg_lo:[0,1] neg_hi:[0,1]
  v_pk_add_f32 v[128:129], v[128:129], v[8:9] op_sel_hi:[1,0] neg_lo:[0,1] neg_hi:[0,1]
  v_pk_add_f32 v[130:131], v[130:131], v[8:9] op_sel_hi:[1,0] neg_lo:[0,1] neg_hi:[0,1]
  v_pk_add_f32 v[132:133], v[132:133], v[8:9] op_sel_hi:[1,0] neg_lo:[0,1] neg_hi:[0,1]
  v_pk_add_f32 v[134:135], v[134:135], v[8:9] op_sel_hi:[1,0] neg_lo:[0,1] neg_hi:[0,1]
  v_pk_add_f32 v[136:137], v[136:137], v[8:9] op_sel_hi:[1,0] neg_lo:[0,1] neg_hi:[0,1]
  v_pk_add_f32 v[138:139], v[138:139], v[8:9] op_sel_hi:[1,0] neg_lo:[0,1] neg_hi:[0,1]
  v_pk_add_f32 v[140:141], v[140:141], v[8:9] op_sel_hi:[1,0] neg_lo:[0,1] neg_hi:[0,1]
  v_pk_add_f32 v[142:143], v[142:143], v[8:9] op_sel_hi:[1,0] neg_lo:[0,1] neg_hi:[0,1]
  v_pk_add_f32 v[144:145], v[144:145], v[8:9] op_sel_hi:[1,0] neg_lo:[0,1] neg_hi:[0,1]
  v_pk_add_f32 v[146:147], v[146:147], v[8:9] op_sel_hi:[1,0] neg_lo:[0,1] neg_hi:[0,1]
  v_pk_add_f32 v[148:149], v[148:149], v[8:9] op_sel_hi:[1,0] neg_lo:[0,1] neg_hi:[0,1]
  v_pk_add_f32 v[150:151], v[150:151], v[8:9] op_sel_hi:[1,0] neg_lo:[0,1] neg_hi:[0,1]
  v_pk_add_f32 v[152:153], v[152:153], v[8:9] op_sel_hi:[1,0] neg_lo:[0,1] neg_hi:[0,1]
  v_pk_add_f32 v[154:155], v[154:155], v[8:9] op_sel_hi:[1,0] neg_lo:[0,1] neg_hi:[0,1]
  v_pk_add_f32 v[156:157], v[156:157], v[8:9] op_sel_hi:[1,0] neg_lo:[0,1] neg_hi:[0,1]
  v_pk_add_f32 v[158:159], v[158:159], v[8:9] op_sel_hi:[1,0] neg_lo:[0,1] neg_hi:[0,1]
  v_pk_add_f32 v[160:161], v[160:161], v[8:9] op_sel_hi:[1,0] neg_lo:[0,1] neg_hi:[0,1]
  v_pk_add_f32 v[162:163], v[162:163], v[8:9] op_sel_hi:[1,0] neg_lo:[0,1] neg_hi:[0,1]
  v_pk_add_f32 v[164:165], v[164:165], v[8:9] op_sel_hi:[1,0] neg_lo:[0,1] neg_hi:[0,1]
  v_pk_add_f32 v[166:167], v[166:167], v[8:9] op_sel_hi:[1,0] neg_lo:[0,1] neg_hi:[0,1]
  v_pk_add_f32 v[168:169], v[168:169], v[8:9] op_sel_hi:[1,0] neg_lo:[0,1] neg_hi:[0,1]
  v_pk_add_f32 v[170:171], v[170:171], v[8:9] op_sel_hi:[1,0] neg_lo:[0,1] neg_hi:[0,1]
  v_pk_add_f32 v[172:173], v[172:173], v[8:9] op_sel_hi:[1,0] neg_lo:[0,1] neg_hi:[0,1]
  v_pk_add_f32 v[174:175], v[174:175], v[8:9] op_sel_hi:[1,0] neg_lo:[0,1] neg_hi:[0,1]
  v_pk_add_f32 v[176:177], v[176:177], v[8:9] op_sel_hi:[1,0] neg_lo:[0,1] neg_hi:[0,1]
  v_pk_add_f32 v[178:179], v[178:179], v[8:9] op_sel_hi:[1,0] neg_lo:[0,1] neg_hi:[0,1]
  v_pk_add_f32 v[180:181], v[180:181], v[8:9] op_sel_hi:[1,0] neg_lo:[0,1] neg_hi:[0,1]
  v_pk_add_f32 v[182:183], v[182:183], v[8:9] op_sel_hi:[1,0] neg_lo:[0,1] neg_hi:[0,1]
  v_pk_add_f32 v[184:185], v[184:185], v[8:9] op_sel_hi:[1,0] neg_lo:[0,1] neg_hi:[0,1]
  v_pk_add_f32 v[186:187], v[186:187], v[8:9] op_sel_hi:[1,0] neg_lo:[0,1] neg_hi:[0,1]
  v_pk_add_f32 v[188:189], v[188:189], v[8:9] op_sel_hi:[1,0] neg_lo:[0,1] neg_hi:[0,1]
  v_pk_add_f32 v[190:191], v[190:191], v[8:9] op_sel_hi:[1,0] neg_lo:[0,1] neg_hi:[0,1]
  v_pk_add_f32 v[192:193], v[192:193], v[8:9] op_sel_hi:[1,0] neg_lo:[0,1] neg_hi:[0,1]
  v_pk_add_f32 v[194:195], v[194:195], v[8:9] op_sel_hi:[1,0] neg_lo:[0,1] neg_hi:[0,1]
  v_pk_add_f32 v[196:197], v[196:197], v[8:9] op_sel_hi:[1,0] neg_lo:[0,1] neg_hi:[0,1]
  v_pk_add_f32 v[198:199], v[198:199], v[8:9] op_sel_hi:[1,0] neg_lo:[0,1] neg_hi:[0,1]
  v_pk_add_f32 v[200:201], v[200:201], v[8:9] op_sel_hi:[1,0] neg_lo:[0,1] neg_hi:[0,1]
  v_pk_add_f32 v[202:203], v[202:203], v[8:9] op_sel_hi:[1,0] neg_lo:[0,1] neg_hi:[0,1]
  v_pk_add_f32 v[204:205], v[204:205], v[8:9] op_sel_hi:[1,0] neg_lo:[0,1] neg_hi:[0,1]
  v_pk_add_f32 v[206:207], v[206:207], v[8:9] op_sel_hi:[1,0] neg_lo:[0,1] neg_hi:[0,1]
  v_pk_add_f32 v[208:209], v[208:209], v[8:9] op_sel_hi:[1,0] neg_lo:[0,1] neg_hi:[0,1]
  v_pk_add_f32 v[210:211], v[210:211], v[8:9] op_sel_hi:[1,0] neg_lo:[0,1] neg_hi:[0,1]
  v_pk_add_f32 v[212:213], v[212:213], v[8:9] op_sel_hi:[1,0] neg_lo:[0,1] neg_hi:[0,1]
  v_pk_add_f32 v[214:215], v[214:215], v[8:9] op_sel_hi:[1,0] neg_lo:[0,1] neg_hi:[0,1]
  v_pk_add_f32 v[216:217], v[216:217], v[8:9] op_sel_hi:[1,0] neg_lo:[0,1] neg_hi:[0,1]
  v_pk_add_f32 v[218:219], v[218:219], v[8:9] op_sel_hi:[1,0] neg_lo:[0,1] neg_hi:[0,1]
  v_pk_add_f32 v[220:221], v[220:221], v[8:9] op_sel_hi:[1,0] neg_lo:[0,1] neg_hi:[0,1]
  v_pk_add_f32 v[222:223], v[222:223], v[8:9] op_sel_hi:[1,0] neg_lo:[0,1] neg_hi:[0,1]
  v_pk_mul_f32 v[8:9], v[96:97], v[96:97]
  v_pk_mul_f32 v[10:11], v[98:99], v[98:99]
  v_pk_fma_f32 v[8:9], v[100:101], v[100:101], v[8:9]
  v_pk_fma_f32 v[10:11], v[102:103], v[102:103], v[10:11]
  v_pk_fma_f32 v[8:9], v[104:105], v[104:105], v[8:9]
  v_pk_fma_f32 v[10:11], v[106:107], v[106:107], v[10:11]
  v_pk_fma_f32 v[8:9], v[108:109], v[108:109], v[8:9]
  v_pk_fma_f32 v[10:11], v[110:111], v[110:111], v[10:11]
  v_pk_fma_f32 v[8:9], v[112:113], v[112:113], v[8:9]
  v_pk_fma_f32 v[10:11], v[114:115], v[114:115], v[10:11]
  v_pk_fma_f32 v[8:9], v[116:117], v[116:117], v[8:9]
  v_pk_fma_f32 v[10:11], v[118:119], v[118:119], v[10:11]
  v_pk_fma_f32 v[8:9], v[120:121], v[120:121], v[8:9]
  v_pk_fma_f32 v[10:11], v[122:123], v[122:123], v[10:11]
  v_pk_fma_f32 v[8:9], v[124:125], v[124:125], v[8:9]
  v_pk_fma_f32 v[10:11], v[126:127], v[126:127], v[10:11]
  v_pk_fma_f32 v[8:9], v[128:129], v[128:129], v[8:9]
  v_pk_fma_f32 v[10:11], v[130:131], v[130:131], v[10:11]
  v_pk_fma_f32 v[8:9], v[132:133], v[132:133], v[8:9]
  v_pk_fma_f32 v[10:11], v[134:135], v[134:135], v[10:11]
  v_pk_fma_f32 v[8:9], v[136:137], v[136:137], v[8:9]
  v_pk_fma_f32 v[10:11], v[138:139], v[138:139], v[10:11]
  v_pk_fma_f32 v[8:9], v[140:141], v[140:141], v[8:9]
  v_pk_fma_f32 v[10:11], v[142:143], v[142:143], v[10:11]
  v_pk_fma_f32 v[8:9], v[144:145], v[144:145], v[8:9]
  v_pk_fma_f32 v[10:11], v[146:147], v[146:147], v[10:11]
  v_pk_fma_f32 v[8:9], v[148:149], v[148:149], v[8:9]
  v_pk_fma_f32 v[10:11], v[150:151], v[150:151], v[10:11]
  v_pk_fma_f32 v[8:9], v[152:153], v[152:153], v[8:9]
  v_pk_fma_f32 v[10:11], v[154:155], v[154:155], v[10:11]
  v_pk_fma_f32 v[8:9], v[156:157], v[156:157], v[8:9]
  v_pk_fma_f32 v[10:11], v[158:159], v[158:159], v[10:11]
  v_pk_fma_f32 v[8:9], v[160:161], v[160:161], v[8:9]
  v_pk_fma_f32 v[10:11], v[162:163], v[162:163], v[10:11]
  v_pk_fma_f32 v[8:9], v[164:165], v[164:165], v[8:9]
  v_pk_fma_f32 v[10:11], v[166:167], v[166:167], v[10:11]
  v_pk_fma_f32 v[8:9], v[168:169], v[168:169], v[8:9]
  v_pk_fma_f32 v[10:11], v[170:171], v[170:171], v[10:11]
  v_pk_fma_f32 v[8:9], v[172:173], v[172:173], v[8:9]
  v_pk_fma_f32 v[10:11], v[174:175], v[174:175], v[10:11]
  v_pk_fma_f32 v[8:9], v[176:177], v[176:177], v[8:9]
  v_pk_fma_f32 v[10:11], v[178:179], v[178:179], v[10:11]
  v_pk_fma_f32 v[8:9], v[180:181], v[180:181], v[8:9]
  v_pk_fma_f32 v[10:11], v[182:183], v[182:183], v[10:11]
  v_pk_fma_f32 v[8:9], v[184:185], v[184:185], v[8:9]
  v_pk_fma_f32 v[10:11], v[186:187], v[186:187], v[10:11]
  v_pk_fma_f32 v[8:9], v[188:189], v[188:189], v[8:9]
  v_pk_fma_f32 v[10:11], v[190:191], v[190:191], v[10:11]
  v_pk_fma_f32 v[8:9], v[192:193], v[192:193], v[8:9]
  v_pk_fma_f32 v[10:11], v[194:195], v[194:195], v[10:11]
  v_pk_fma_f32 v[8:9], v[196:197], v[196:197], v[8:9]
  v_pk_fma_f32 v[10:11], v[198:199], v[198:199], v[10:11]
  v_pk_fma_f32 v[8:9], v[200:201], v[200:201], v[8:9]
  v_pk_fma_f32 v[10:11], v[202:203], v[202:203], v[10:11]
  v_pk_fma_f32 v[8:9], v[204:205], v[204:205], v[8:9]
  v_pk_fma_f32 v[10:11], v[206:207], v[206:207], v[10:11]
  v_pk_fma_f32 v[8:9], v[208:209], v[208:209], v[8:9]
  v_pk_fma_f32 v[10:11], v[210:211], v[210:211], v[10:11]
  v_pk_fma_f32 v[8:9], v[212:213], v[212:213], v[8:9]
  v_pk_fma_f32 v[10:11], v[214:215], v[214:215], v[10:11]
  v_pk_fma_f32 v[8:9], v[216:217], v[216:217], v[8:9]
  v_pk_fma_f32 v[10:11], v[218:219], v[218:219], v[10:11]
  v_pk_fma_f32 v[8:9], v[220:221], v[220:221], v[8:9]
  v_pk_fma_f32 v[10:11], v[222:223], v[222:223], v[10:11]
  v_pk_add_f32 v[8:9], v[8:9], v[10:11]
  v_add_f32 v8, v8, v9
  s_nop 1
  v_add_f32_dpp v9, v8, v8 quad_perm:[1,0,3,2] row_mask:0xf bank_mask:0xf
  s_nop 1
  v_add_f32_dpp v8, v9, v9 quad_perm:[2,3,0,1] row_mask:0xf bank_mask:0xf
  s_nop 1
  v_add_f32_dpp v9, v8, v8 row_half_mirror row_mask:0xf bank_mask:0xf
  v_mov_b32 v8, v9
  v_mov_b32 v9, 0x3727c5ac
  v_fmac_f32 v9, 0x3a800000, v8
  v_rsq_f32 v8, v9
  v_lshlrev_b32 v6, 9, v3
  v_lshl_add_u32 v6, v2, 4, v6
  s_lshl_b32 s23, s37, 16
  s_lshl_b32 s24, s14, 7
  s_add_u32 s23, s23, s24
  s_add_u32 s23, s23, 16777216
  v_pk_mul_f32 v[96:97], v[96:97], v[8:9] op_sel_hi:[1,0]
  v_pk_mul_f32 v[98:99], v[98:99], v[8:9] op_sel_hi:[1,0]
  v_pk_mul_f32 v[100:101], v[100:101], v[8:9] op_sel_hi:[1,0]
  v_pk_mul_f32 v[102:103], v[102:103], v[8:9] op_sel_hi:[1,0]
  v_cvt_pk_bf16_f32 v16, v96, v97
  v_cvt_pk_bf16_f32 v17, v98, v99
  v_cvt_pk_bf16_f32 v18, v100, v101
  v_cvt_pk_bf16_f32 v19, v102, v103
  buffer_store_dwordx4 v[16:19], v6, s[4:7], s23 offen sc1
  s_add_u32 s23, s23, 4096
  v_pk_mul_f32 v[104:105], v[104:105], v[8:9] op_sel_hi:[1,0]
  v_pk_mul_f32 v[106:107], v[106:107], v[8:9] op_sel_hi:[1,0]
  v_pk_mul_f32 v[108:109], v[108:109], v[8:9] op_sel_hi:[1,0]
  v_pk_mul_f32 v[110:111], v[110:111], v[8:9] op_sel_hi:[1,0]
  v_cvt_pk_bf16_f32 v20, v104, v105
  v_cvt_pk_bf16_f32 v21, v106, v107
  v_cvt_pk_bf16_f32 v22, v108, v109
  v_cvt_pk_bf16_f32 v23, v110, v111
  buffer_store_dwordx4 v[20:23], v6, s[4:7], s23 offen sc1
  s_add_u32 s23, s23, 4096
  v_pk_mul_f32 v[112:113], v[112:113], v[8:9] op_sel_hi:[1,0]
  v_pk_mul_f32 v[114:115], v[114:115], v[8:9] op_sel_hi:[1,0]
  v_pk_mul_f32 v[116:117], v[116:117], v[8:9] op_sel_hi:[1,0]
  v_pk_mul_f32 v[118:119], v[118:119], v[8:9] op_sel_hi:[1,0]
  v_cvt_pk_bf16_f32 v24, v112, v113
  v_cvt_pk_bf16_f32 v25, v114, v115
  v_cvt_pk_bf16_f32 v26, v116, v117
  v_cvt_pk_bf16_f32 v27, v118, v119
  buffer_store_dwordx4 v[24:27], v6, s[4:7], s23 offen sc1
  s_add_u32 s23, s23, 4096
  v_pk_mul_f32 v[120:121], v[120:121], v[8:9] op_sel_hi:[1,0]
  v_pk_mul_f32 v[122:123], v[122:123], v[8:9] op_sel_hi:[1,0]
  v_pk_mul_f32 v[124:125], v[124:125], v[8:9] op_sel_hi:[1,0]
  v_pk_mul_f32 v[126:127], v[126:127], v[8:9] op_sel_hi:[1,0]
  v_cvt_pk_bf16_f32 v28, v120, v121
  v_cvt_pk_bf16_f32 v29, v122, v123
  v_cvt_pk_bf16_f32 v30, v124, v125
  v_cvt_pk_bf16_f32 v31, v126, v127
  buffer_store_dwordx4 v[28:31], v6, s[4:7], s23 offen sc1
  s_add_u32 s23, s23, 4096
  v_pk_mul_f32 v[128:129], v[128:129], v[8:9] op_sel_hi:[1,0]
  v_pk_mul_f32 v[130:131], v[130:131], v[8:9] op_sel_hi:[1,0]
  v_pk_mul_f32 v[132:133], v[132:133], v[8:9] op_sel_hi:[1,0]
  v_pk_mul_f32 v[134:135], v[134:135], v[8:9] op_sel_hi:[1,0]
  v_cvt_pk_bf16_f32 v32, v128, v129
  v_cvt_pk_bf16_f32 v33, v130, v131
  v_cvt_pk_bf16_f32 v34, v132, v133
  v_cvt_pk_bf16_f32 v35, v134, v135
  buffer_store_dwordx4 v[32:35], v6, s[4:7], s23 offen sc1
  s_add_u32 s23, s23, 4096
  v_pk_mul_f32 v[136:137], v[136:137], v[8:9] op_sel_hi:[1,0]
  v_pk_mul_f32 v[138:139], v[138:139], v[8:9] op_sel_hi:[1,0]
  v_pk_mul_f32 v[140:141], v[140:141], v[8:9] op_sel_hi:[1,0]
  v_pk_mul_f32 v[142:143], v[142:143], v[8:9] op_sel_hi:[1,0]
  v_cvt_pk_bf16_f32 v36, v136, v137
  v_cvt_pk_bf16_f32 v37, v138, v139
  v_cvt_pk_bf16_f32 v38, v140, v141
  v_cvt_pk_bf16_f32 v39, v142, v143
  buffer_store_dwordx4 v[36:39], v6, s[4:7], s23 offen sc1
  s_add_u32 s23, s23, 4096
  v_pk_mul_f32 v[144:145], v[144:145], v[8:9] op_sel_hi:[1,0]
  v_pk_mul_f32 v[146:147], v[146:147], v[8:9] op_sel_hi:[1,0]
  v_pk_mul_f32 v[148:149], v[148:149], v[8:9] op_sel_hi:[1,0]
  v_pk_mul_f32 v[150:151], v[150:151], v[8:9] op_sel_hi:[1,0]
  v_cvt_pk_bf16_f32 v40, v144, v145
  v_cvt_pk_bf16_f32 v41, v146, v147
  v_cvt_pk_bf16_f32 v42, v148, v149
  v_cvt_pk_bf16_f32 v43, v150, v151
  buffer_store_dwordx4 v[40:43], v6, s[4:7], s23 offen sc1
  s_add_u32 s23, s23, 4096
  v_pk_mul_f32 v[152:153], v[152:153], v[8:9] op_sel_hi:[1,0]
  v_pk_mul_f32 v[154:155], v[154:155], v[8:9] op_sel_hi:[1,0]
  v_pk_mul_f32 v[156:157], v[156:157], v[8:9] op_sel_hi:[1,0]
  v_pk_mul_f32 v[158:159], v[158:159], v[8:9] op_sel_hi:[1,0]
  v_cvt_pk_bf16_f32 v44, v152, v153
  v_cvt_pk_bf16_f32 v45, v154, v155
  v_cvt_pk_bf16_f32 v46, v156, v157
  v_cvt_pk_bf16_f32 v47, v158, v159
  buffer_store_dwordx4 v[44:47], v6, s[4:7], s23 offen sc1
  s_add_u32 s23, s23, 4096
  v_pk_mul_f32 v[160:161], v[160:161], v[8:9] op_sel_hi:[1,0]
  v_pk_mul_f32 v[162:163], v[162:163], v[8:9] op_sel_hi:[1,0]
  v_pk_mul_f32 v[164:165], v[164:165], v[8:9] op_sel_hi:[1,0]
  v_pk_mul_f32 v[166:167], v[166:167], v[8:9] op_sel_hi:[1,0]
  v_cvt_pk_bf16_f32 v48, v160, v161
  v_cvt_pk_bf16_f32 v49, v162, v163
  v_cvt_pk_bf16_f32 v50, v164, v165
  v_cvt_pk_bf16_f32 v51, v166, v167
  buffer_store_dwordx4 v[48:51], v6, s[4:7], s23 offen sc1
  s_add_u32 s23, s23, 4096
  v_pk_mul_f32 v[168:169], v[168:169], v[8:9] op_sel_hi:[1,0]
  v_pk_mul_f32 v[170:171], v[170:171], v[8:9] op_sel_hi:[1,0]
  v_pk_mul_f32 v[172:173], v[172:173], v[8:9] op_sel_hi:[1,0]
  v_pk_mul_f32 v[174:175], v[174:175], v[8:9] op_sel_hi:[1,0]
  v_cvt_pk_bf16_f32 v52, v168, v169
  v_cvt_pk_bf16_f32 v53, v170, v171
  v_cvt_pk_bf16_f32 v54, v172, v173
  v_cvt_pk_bf16_f32 v55, v174, v175
  buffer_store_dwordx4 v[52:55], v6, s[4:7], s23 offen sc1
  s_add_u32 s23, s23, 4096
  v_pk_mul_f32 v[176:177], v[176:177], v[8:9] op_sel_hi:[1,0]
  v_pk_mul_f32 v[178:179], v[178:179], v[8:9] op_sel_hi:[1,0]
  v_pk_mul_f32 v[180:181], v[180:181], v[8:9] op_sel_hi:[1,0]
  v_pk_mul_f32 v[182:183], v[182:183], v[8:9] op_sel_hi:[1,0]
  v_cvt_pk_bf16_f32 v56, v176, v177
  v_cvt_pk_bf16_f32 v57, v178, v179
  v_cvt_pk_bf16_f32 v58, v180, v181
  v_cvt_pk_bf16_f32 v59, v182, v183
  buffer_store_dwordx4 v[56:59], v6, s[4:7], s23 offen sc1
  s_add_u32 s23, s23, 4096
  v_pk_mul_f32 v[184:185], v[184:185], v[8:9] op_sel_hi:[1,0]
  v_pk_mul_f32 v[186:187], v[186:187], v[8:9] op_sel_hi:[1,0]
  v_pk_mul_f32 v[188:189], v[188:189], v[8:9] op_sel_hi:[1,0]
  v_pk_mul_f32 v[190:191], v[190:191], v[8:9] op_sel_hi:[1,0]
  v_cvt_pk_bf16_f32 v60, v184, v185
  v_cvt_pk_bf16_f32 v61, v186, v187
  v_cvt_pk_bf16_f32 v62, v188, v189
  v_cvt_pk_bf16_f32 v63, v190, v191
  buffer_store_dwordx4 v[60:63], v6, s[4:7], s23 offen sc1
  s_add_u32 s23, s23, 4096
  v_pk_mul_f32 v[192:193], v[192:193], v[8:9] op_sel_hi:[1,0]
  v_pk_mul_f32 v[194:195], v[194:195], v[8:9] op_sel_hi:[1,0]
  v_pk_mul_f32 v[196:197], v[196:197], v[8:9] op_sel_hi:[1,0]
  v_pk_mul_f32 v[198:199], v[198:199], v[8:9] op_sel_hi:[1,0]
  v_cvt_pk_bf16_f32 v64, v192, v193
  v_cvt_pk_bf16_f32 v65, v194, v195
  v_cvt_pk_bf16_f32 v66, v196, v197
  v_cvt_pk_bf16_f32 v67, v198, v199
  buffer_store_dwordx4 v[64:67], v6, s[4:7], s23 offen sc1
  s_add_u32 s23, s23, 4096
  v_pk_mul_f32 v[200:201], v[200:201], v[8:9] op_sel_hi:[1,0]
  v_pk_mul_f32 v[202:203], v[202:203], v[8:9] op_sel_hi:[1,0]
  v_pk_mul_f32 v[204:205], v[204:205], v[8:9] op_sel_hi:[1,0]
  v_pk_mul_f32 v[206:207], v[206:207], v[8:9] op_sel_hi:[1,0]
  v_cvt_pk_bf16_f32 v68, v200, v201
  v_cvt_pk_bf16_f32 v69, v202, v203
  v_cvt_pk_bf16_f32 v70, v204, v205
  v_cvt_pk_bf16_f32 v71, v206, v207
  buffer_store_dwordx4 v[68:71], v6, s[4:7], s23 offen sc1
  s_add_u32 s23, s23, 4096
  v_pk_mul_f32 v[208:209], v[208:209], v[8:9] op_sel_hi:[1,0]
  v_pk_mul_f32 v[210:211], v[210:211], v[8:9] op_sel_hi:[1,0]
  v_pk_mul_f32 v[212:213], v[212:213], v[8:9] op_sel_hi:[1,0]
  v_pk_mul_f32 v[214:215], v[214:215], v[8:9] op_sel_hi:[1,0]
  v_cvt_pk_bf16_f32 v72, v208, v209
  v_cvt_pk_bf16_f32 v73, v210, v211
  v_cvt_pk_bf16_f32 v74, v212, v213
  v_cvt_pk_bf16_f32 v75, v214, v215
  buffer_store_dwordx4 v[72:75], v6, s[4:7], s23 offen sc1
  s_add_u32 s23, s23, 4096
  v_pk_mul_f32 v[216:217], v[216:217], v[8:9] op_sel_hi:[1,0]
  v_pk_mul_f32 v[218:219], v[218:219], v[8:9] op_sel_hi:[1,0]
  v_pk_mul_f32 v[220:221], v[220:221], v[8:9] op_sel_hi:[1,0]
  v_pk_mul_f32 v[222:223], v[222:223], v[8:9] op_sel_hi:[1,0]
  v_cvt_pk_bf16_f32 v76, v216, v217
  v_cvt_pk_bf16_f32 v77, v218, v219
  v_cvt_pk_bf16_f32 v78, v220, v221
  v_cvt_pk_bf16_f32 v79, v222, v223
  buffer_store_dwordx4 v[76:79], v6, s[4:7], s23 offen sc1
  s_waitcnt vmcnt(0)
  s_barrier
  s_cmp_lg_u32 s14, 0
  s_cbranch_scc1 isig_182
  s_and_b32 s23, s37, 3
  s_lshl_b32 s23, s23, 6
  v_mov_b32 v2, 1
  s_lshl_b32 s24, s56, 16
  s_add_u32 s24, s24, 1
  v_mov_b32 v2, s24
  s_mov_b64 exec, 1
  buffer_atomic_add v2, off, s[60:63], s23 offset:8 sc1
  s_mov_b64 exec, -1
isig_182:
g1i_180:
  s_lshl_b32 s23, s42, 3
  s_add_u32 s23, s23, 16
  s_load_dwordx2 s[44:45], s[0:1], 16
  s_load_dwordx2 s[46:47], s[0:1], 24
  s_load_dwordx2 s[48:49], s[0:1], 32
  s_waitcnt lgkmcnt(0)
  s_cmp_eq_u32 s42, 0
  s_cselect_b32 s8, s44, s46
  s_cselect_b32 s9, s45, s47
  s_cmp_eq_u32 s42, 2
  s_cselect_b32 s8, s48, s8
  s_cselect_b32 s9, s49, s9
  s_mov_b32 s10, 8388608
  s_mov_b32 s11, 0x00020000
  s_lshl_b32 s39, s40, 8
  s_lshl_b32 s23, s14, 6
  s_add_u32 s39, s39, s23
  v_and_b32 v10, 63, v0
  v_lshrrev_b32 v11, 2, v10
  s_mov_b32 s23, 8192
  v_mul_lo_u32 v11, v11, s23
  v_and_b32 v12, 3, v10
  v_lshl_add_u32 v8, v12, 4, v11
  s_lshl_b32 s24, s14, 15
  v_lshrrev_b32 v11, 5, v10
  v_lshlrev_b32 v11, 9, v11
  v_lshrrev_b32 v12, 2, v10
  v_and_b32 v12, 3, v12
  v_lshl_add_u32 v11, v12, 6, v11
  v_lshrrev_b32 v12, 4, v10
  v_and_b32 v12, 1, v12
  v_lshl_add_u32 v11, v12, 5, v11
  v_and_b32 v12, 1, v10
  v_lshl_add_u32 v11, v12, 4, v11
  v_lshrrev_b32 v12, 1, v10
  v_and_b32 v12, 1, v12
  v_lshl_add_u32 v11, v12, 3, v11
  v_add_u32 v9, s24, v11
  s_mov_b32 s23, s39
  s_add_u32 m0, s24, 0
  s_nop 0
  buffer_load_dwordx4 v8, s[8:11], s23 offen lds
  s_add_u32 s23, s23, 131072
  s_add_u32 m0, s24, 1024
  s_nop 0
  buffer_load_dwordx4 v8, s[8:11], s23 offen lds
  s_add_u32 s23, s23, 131072
  s_add_u32 m0, s24, 2048
  s_nop 0
  buffer_load_dwordx4 v8, s[8:11], s23 offen lds
  s_add_u32 s23, s23, 131072
  s_add_u32 m0, s24, 3072
  s_nop 0
  buffer_load_dwordx4 v8, s[8:11], s23 offen lds
  s_add_u32 s23, s23, 131072
  s_add_u32 m0, s24, 4096
  s_nop 0
  buffer_load_dwordx4 v8, s[8:11], s23 offen lds
  s_add_u32 s23, s23, 131072
  s_add_u32 m0, s24, 5120
  s_nop 0
  buffer_load_dwordx4 v8, s[8:11], s23 offen lds
  s_add_u32 s23, s23, 131072
  s_add_u32 m0, s24, 6144
  s_nop 0
  buffer_load_dwordx4 v8, s[8:11], s23 offen lds
  s_add_u32 s23, s23, 131072
  s_add_u32 m0, s24, 7168
  s_nop 0
  buffer_load_dwordx4 v8, s[8:11], s23 offen lds
  s_add_u32 s23, s23, 131072
  s_add_u32 m0, s24, 8192
  s_nop 0
  buffer_load_dwordx4 v8, s[8:11], s23 offen lds
  s_add_u32 s23, s23, 131072
  s_add_u32 m0, s24, 9216
  s_nop 0
  buffer_load_dwordx4 v8, s[8:11], s23 offen lds
  s_add_u32 s23, s23, 131072
  s_add_u32 m0, s24, 10240
  s_nop 0
  buffer_load_dwordx4 v8, s[8:11], s23 offen lds
  s_add_u32 s23, s23, 131072
  s_add_u32 m0, s24, 11264
  s_nop 0
  buffer_load_dwordx4 v8, s[8:11], s23 offen lds
  s_add_u32 s23, s23, 131072
  s_add_u32 m0, s24, 12288
  s_nop 0
  buffer_load_dwordx4 v8, s[8:11], s23 offen lds
  s_add_u32 s23, s23, 131072
  s_add_u32 m0, s24, 13312
  s_nop 0
  buffer_load_dwordx4 v8, s[8:11], s23 offen lds
  s_add_u32 s23, s23, 131072
  s_add_u32 m0, s24, 14336
  s_nop 0
  buffer_load_dwordx4 v8, s[8:11], s23 offen lds
  s_add_u32 s23, s23, 131072
  s_add_u32 m0, s24, 15360
  s_nop 0
  buffer_load_dwordx4 v8, s[8:11], s23 offen lds
  s_add_u32 s23, s23, 131072
  s_add_u32 m0, s24, 16384
  s_nop 0
  buffer_load_dwordx4 v8, s[8:11], s23 offen lds
  s_add_u32 s23, s23, 131072
  s_add_u32 m0, s24, 17408
  s_nop 0
  buffer_load_dwordx4 v8, s[8:11], s23 offen lds
  s_add_u32 s23, s23, 131072
  s_add_u32 m0, s24, 18432
  s_nop 0
  buffer_load_dwordx4 v8, s[8:11], s23 offen lds
  s_add_u32 s23, s23, 131072
  s_add_u32 m0, s24, 19456
  s_nop 0
  buffer_load_dwordx4 v8, s[8:11], s23 offen lds
  s_add_u32 s23, s23, 131072
  s_add_u32 m0, s24, 20480
  s_nop 0
  buffer_load_dwordx4 v8, s[8:11], s23 offen lds
  s_add_u32 s23, s23, 131072
  s_add_u32 m0, s24, 21504
  s_nop 0
  buffer_load_dwordx4 v8, s[8:11], s23 offen lds
  s_add_u32 s23, s23, 131072
  s_add_u32 m0, s24, 22528
  s_nop 0
  buffer_load_dwordx4 v8, s[8:11], s23 offen lds
  s_add_u32 s23, s23, 131072
  s_add_u32 m0, s24, 23552
  s_nop 0
  buffer_load_dwordx4 v8, s[8:11], s23 offen lds
  s_add_u32 s23, s23, 131072
  s_add_u32 m0, s24, 24576
  s_nop 0
  buffer_load_dwordx4 v8, s[8:11], s23 offen lds
  s_add_u32 s23, s23, 131072
  s_add_u32 m0, s24, 25600
  s_nop 0
  buffer_load_dwordx4 v8, s[8:11], s23 offen lds
  s_add_u32 s23, s23, 131072
  s_add_u32 m0, s24, 26624
  s_nop 0
  buffer_load_dwordx4 v8, s[8:11], s23 offen lds
  s_add_u32 s23, s23, 131072
  s_add_u32 m0, s24, 27648
  s_nop 0
  buffer_load_dwordx4 v8, s[8:11], s23 offen lds
  s_add_u32 s23, s23, 131072
  s_add_u32 m0, s24, 28672
  s_nop 0
  buffer_load_dwordx4 v8, s[8:11], s23 offen lds
  s_add_u32 s23, s23, 131072
  s_add_u32 m0, s24, 29696
  s_nop 0
  buffer_load_dwordx4 v8, s[8:11], s23 offen lds
  s_add_u32 s23, s23, 131072
  s_add_u32 m0, s24, 30720
  s_nop 0
  buffer_load_dwordx4 v8, s[8:11], s23 offen lds
  s_add_u32 s23, s23, 131072
  s_add_u32 m0, s24, 31744
  s_nop 0
  buffer_load_dwordx4 v8, s[8:11], s23 offen lds
  s_add_u32 s23, s23, 131072
  s_waitcnt vmcnt(16)
  ds_read_b64_tr_b16 a[0:1], v9 offset:0
  ds_read_b64_tr_b16 a[2:3], v9 offset:256
  ds_read_b64_tr_b16 a[4:5], v9 offset:1024
  ds_read_b64_tr_b16 a[6:7], v9 offset:1280
  ds_read_b64_tr_b16 a[8:9], v9 offset:2048
  ds_read_b64_tr_b16 a[10:11], v9 offset:2304
  ds_read_b64_tr_b16 a[12:13], v9 offset:3072
  ds_read_b64_tr_b16 a[14:15], v9 offset:3328
  s_waitcnt lgkmcnt(4)
  ds_read_b64_tr_b16 a[16:17], v9 offset:4096
  ds_read_b64_tr_b16 a[18:19], v9 offset:4352
  ds_read_b64_tr_b16 a[20:21], v9 offset:5120
  ds_read_b64_tr_b16 a[22:23], v9 offset:5376
  ds_read_b64_tr_b16 a[24:25], v9 offset:6144
  ds_read_b64_tr_b16 a[26:27], v9 offset:6400
  ds_read_b64_tr_b16 a[28:29], v9 offset:7168
  ds_read_b64_tr_b16 a[30:31], v9 offset:7424
  s_waitcnt lgkmcnt(4)
  ds_read_b64_tr_b16 a[32:33], v9 offset:8192
  ds_read_b64_tr_b16 a[34:35], v9 offset:8448
  ds_read_b64_tr_b16 a[36:37], v9 offset:9216
  ds_read_b64_tr_b16 a[38:39], v9 offset:9472
  ds_read_b64_tr_b16 a[40:41], v9 offset:10240
  ds_read_b64_tr_b16 a[42:43], v9 offset:10496
  ds_read_b64_tr_b16 a[44:45], v9 offset:11264
  ds_read_b64_tr_b16 a[46:47], v9 offset:11520
  s_waitcnt lgkmcnt(4)
  ds_read_b64_tr_b16 a[48:49], v9 offset:12288
  ds_read_b64_tr_b16 a[50:51], v9 offset:12544
  ds_read_b64_tr_b16 a[52:53], v9 offset:13312
  ds_read_b64_tr_b16 a[54:55], v9 offset:13568
  ds_read_b64_tr_b16 a[56:57], v9 offset:14336
  ds_read_b64_tr_b16 a[58:59], v9 offset:14592
  ds_read_b64_tr_b16 a[60:61], v9 offset:15360
  ds_read_b64_tr_b16 a[62:63], v9 offset:15616
  s_waitcnt lgkmcnt(4)
  s_waitcnt lgkmcnt(0)
  s_add_u32 m0, s24, 0
  s_nop 0
  buffer_load_dwordx4 v8, s[8:11], s23 offen lds
  s_add_u32 s23, s23, 131072
  s_add_u32 m0, s24, 1024
  s_nop 0
  buffer_load_dwordx4 v8, s[8:11], s23 offen lds
  s_add_u32 s23, s23, 131072
  s_add_u32 m0, s24, 2048
  s_nop 0
  buffer_load_dwordx4 v8, s[8:11], s23 offen lds
  s_add_u32 s23, s23, 131072
  s_add_u32 m0, s24, 3072
  s_nop 0
  buffer_load_dwordx4 v8, s[8:11], s23 offen lds
  s_add_u32 s23, s23, 131072
  s_add_u32 m0, s24, 4096
  s_nop 0
  buffer_load_dwordx4 v8, s[8:11], s23 offen lds
  s_add_u32 s23, s23, 131072
  s_add_u32 m0, s24, 5120
  s_nop 0
  buffer_load_dwordx4 v8, s[8:11], s23 offen lds
  s_add_u32 s23, s23, 131072
  s_add_u32 m0, s24, 6144
  s_nop 0
  buffer_load_dwordx4 v8, s[8:11], s23 offen lds
  s_add_u32 s23, s23, 131072
  s_add_u32 m0, s24, 7168
  s_nop 0
  buffer_load_dwordx4 v8, s[8:11], s23 offen lds
  s_add_u32 s23, s23, 131072
  s_add_u32 m0, s24, 8192
  s_nop 0
  buffer_load_dwordx4 v8, s[8:11], s23 offen lds
  s_add_u32 s23, s23, 131072
  s_add_u32 m0, s24, 9216
  s_nop 0
  buffer_load_dwordx4 v8, s[8:11], s23 offen lds
  s_add_u32 s23, s23, 131072
  s_add_u32 m0, s24, 10240
  s_nop 0
  buffer_load_dwordx4 v8, s[8:11], s23 offen lds
  s_add_u32 s23, s23, 131072
  s_add_u32 m0, s24, 11264
  s_nop 0
  buffer_load_dwordx4 v8, s[8:11], s23 offen lds
  s_add_u32 s23, s23, 131072
  s_add_u32 m0, s24, 12288
  s_nop 0
  buffer_load_dwordx4 v8, s[8:11], s23 offen lds
  s_add_u32 s23, s23, 131072
  s_add_u32 m0, s24, 13312
  s_nop 0
  buffer_load_dwordx4 v8, s[8:11], s23 offen lds
  s_add_u32 s23, s23, 131072
  s_add_u32 m0, s24, 14336
  s_nop 0
  buffer_load_dwordx4 v8, s[8:11], s23 offen lds
  s_add_u32 s23, s23, 131072
  s_add_u32 m0, s24, 15360
  s_nop 0
  buffer_load_dwordx4 v8, s[8:11], s23 offen lds
  s_add_u32 s23, s23, 131072
  s_waitcnt vmcnt(16)
  ds_read_b64_tr_b16 a[64:65], v9 offset:16384
  ds_read_b64_tr_b16 a[66:67], v9 offset:16640
  ds_read_b64_tr_b16 a[68:69], v9 offset:17408
  ds_read_b64_tr_b16 a[70:71], v9 offset:17664
  ds_read_b64_tr_b16 a[72:73], v9 offset:18432
  ds_read_b64_tr_b16 a[74:75], v9 offset:18688
  ds_read_b64_tr_b16 a[76:77], v9 offset:19456
  ds_read_b64_tr_b16 a[78:79], v9 offset:19712
  s_waitcnt lgkmcnt(4)
  ds_read_b64_tr_b16 a[80:81], v9 offset:20480
  ds_read_b64_tr_b16 a[82:83], v9 offset:20736
  ds_read_b64_tr_b16 a[84:85], v9 offset:21504
  ds_read_b64_tr_b16 a[86:87], v9 offset:21760
  ds_read_b64_tr_b16 a[88:89], v9 offset:22528
  ds_read_b64_tr_b16 a[90:91], v9 offset:22784
  ds_read_b64_tr_b16 a[92:93], v9 offset:23552
  ds_read_b64_tr_b16 a[94:95], v9 offset:23808
  s_waitcnt lgkmcnt(4)
  ds_read_b64_tr_b16 a[96:97], v9 offset:24576
  ds_read_b64_tr_b16 a[98:99], v9 offset:24832
  ds_read_b64_tr_b16 a[100:101], v9 offset:25600
  ds_read_b64_tr_b16 a[102:103], v9 offset:25856
  ds_read_b64_tr_b16 a[104:105], v9 offset:26624
  ds_read_b64_tr_b16 a[106:107], v9 offset:26880
  ds_read_b64_tr_b16 a[108:109], v9 offset:27648
  ds_read_b64_tr_b16 a[110:111], v9 offset:27904
  s_waitcnt lgkmcnt(4)
  ds_read_b64_tr_b16 a[112:113], v9 offset:28672
  ds_read_b64_tr_b16 a[114:115], v9 offset:28928
  ds_read_b64_tr_b16 a[116:117], v9 offset:29696
  ds_read_b64_tr_b16 a[118:119], v9 offset:29952
  ds_read_b64_tr_b16 a[120:121], v9 offset:30720
  ds_read_b64_tr_b16 a[122:123], v9 offset:30976
  ds_read_b64_tr_b16 a[124:125], v9 offset:31744
  ds_read_b64_tr_b16 a[126:127], v9 offset:32000
  s_waitcnt lgkmcnt(4)
  s_waitcnt lgkmcnt(0)
  s_add_u32 m0, s24, 16384
  s_nop 0
  buffer_load_dwordx4 v8, s[8:11], s23 offen lds
  s_add_u32 s23, s23, 131072
  s_add_u32 m0, s24, 17408
  s_nop 0
  buffer_load_dwordx4 v8, s[8:11], s23 offen lds
  s_add_u32 s23, s23, 131072
  s_add_u32 m0, s24, 18432
  s_nop 0
  buffer_load_dwordx4 v8, s[8:11], s23 offen lds
  s_add_u32 s23, s23, 131072
  s_add_u32 m0, s24, 19456
  s_nop 0
  buffer_load_dwordx4 v8, s[8:11], s23 offen lds
  s_add_u32 s23, s23, 131072
  s_add_u32 m0, s24, 20480
  s_nop 0
  buffer_load_dwordx4 v8, s[8:11], s23 offen lds
  s_add_u32 s23, s23, 131072
  s_add_u32 m0, s24, 21504
  s_nop 0
  buffer_load_dwordx4 v8, s[8:11], s23 offen lds
  s_add_u32 s23, s23, 131072
  s_add_u32 m0, s24, 22528
  s_nop 0
  buffer_load_dwordx4 v8, s[8:11], s23 offen lds
  s_add_u32 s23, s23, 131072
  s_add_u32 m0, s24, 23552
  s_nop 0
  buffer_load_dwordx4 v8, s[8:11], s23 offen lds
  s_add_u32 s23, s23, 131072
  s_add_u32 m0, s24, 24576
  s_nop 0
  buffer_load_dwordx4 v8, s[8:11], s23 offen lds
  s_add_u32 s23, s23, 131072
  s_add_u32 m0, s24, 25600
  s_nop 0
  buffer_load_dwordx4 v8, s[8:11], s23 offen lds
  s_add_u32 s23, s23, 131072
  s_add_u32 m0, s24, 26624
  s_nop 0
  buffer_load_dwordx4 v8, s[8:11], s23 offen lds
  s_add_u32 s23, s23, 131072
  s_add_u32 m0, s24, 27648
  s_nop 0
  buffer_load_dwordx4 v8, s[8:11], s23 offen lds
  s_add_u32 s23, s23, 131072
  s_add_u32 m0, s24, 28672
  s_nop 0
  buffer_load_dwordx4 v8, s[8:11], s23 offen lds
  s_add_u32 s23, s23, 131072
  s_add_u32 m0, s24, 29696
  s_nop 0
  buffer_load_dwordx4 v8, s[8:11], s23 offen lds
  s_add_u32 s23, s23, 131072
  s_add_u32 m0, s24, 30720
  s_nop 0
  buffer_load_dwordx4 v8, s[8:11], s23 offen lds
  s_add_u32 s23, s23, 131072
  s_add_u32 m0, s24, 31744
  s_nop 0
  buffer_load_dwordx4 v8, s[8:11], s23 offen lds
  s_add_u32 s23, s23, 131072
  s_waitcnt vmcnt(16)
  ds_read_b64_tr_b16 a[128:129], v9 offset:0
  ds_read_b64_tr_b16 a[130:131], v9 offset:256
  ds_read_b64_tr_b16 a[132:133], v9 offset:1024
  ds_read_b64_tr_b16 a[134:135], v9 offset:1280
  ds_read_b64_tr_b16 a[136:137], v9 offset:2048
  ds_read_b64_tr_b16 a[138:139], v9 offset:2304
  ds_read_b64_tr_b16 a[140:141], v9 offset:3072
  ds_read_b64_tr_b16 a[142:143], v9 offset:3328
  s_waitcnt lgkmcnt(4)
  ds_read_b64_tr_b16 a[144:145], v9 offset:4096
  ds_read_b64_tr_b16 a[146:147], v9 offset:4352
  ds_read_b64_tr_b16 a[148:149], v9 offset:5120
  ds_read_b64_tr_b16 a[150:151], v9 offset:5376
  ds_read_b64_tr_b16 a[152:153], v9 offset:6144
  ds_read_b64_tr_b16 a[154:155], v9 offset:6400
  ds_read_b64_tr_b16 a[156:157], v9 offset:7168
  ds_read_b64_tr_b16 a[158:159], v9 offset:7424
  s_waitcnt lgkmcnt(4)
  ds_read_b64_tr_b16 a[160:161], v9 offset:8192
  ds_read_b64_tr_b16 a[162:163], v9 offset:8448
  ds_read_b64_tr_b16 a[164:165], v9 offset:9216
  ds_read_b64_tr_b16 a[166:167], v9 offset:9472
  ds_read_b64_tr_b16 a[168:169], v9 offset:10240
  ds_read_b64_tr_b16 a[170:171], v9 offset:10496
  ds_read_b64_tr_b16 a[172:173], v9 offset:11264
  ds_read_b64_tr_b16 a[174:175], v9 offset:11520
  s_waitcnt lgkmcnt(4)
  ds_read_b64_tr_b16 a[176:177], v9 offset:12288
  ds_read_b64_tr_b16 a[178:179], v9 offset:12544
  ds_read_b64_tr_b16 a[180:181], v9 offset:13312
  ds_read_b64_tr_b16 a[182:183], v9 offset:13568
  ds_read_b64_tr_b16 a[184:185], v9 offset:14336
  ds_read_b64_tr_b16 a[186:187], v9 offset:14592
  ds_read_b64_tr_b16 a[188:189], v9 offset:15360
  ds_read_b64_tr_b16 a[190:191], v9 offset:15616
  s_waitcnt lgkmcnt(4)
  s_waitcnt lgkmcnt(0)
  s_waitcnt vmcnt(0)
  ds_read_b64_tr_b16 a[192:193], v9 offset:16384
  ds_read_b64_tr_b16 a[194:195], v9 offset:16640
  ds_read_b64_tr_b16 a[196:197], v9 offset:17408
  ds_read_b64_tr_b16 a[198:199], v9 offset:17664
  ds_read_b64_tr_b16 a[200:201], v9 offset:18432
  ds_read_b64_tr_b16 a[202:203], v9 offset:18688
  ds_read_b64_tr_b16 a[204:205], v9 offset:19456
  ds_read_b64_tr_b16 a[206:207], v9 offset:19712
  s_waitcnt lgkmcnt(4)
  ds_read_b64_tr_b16 a[208:209], v9 offset:20480
  ds_read_b64_tr_b16 a[210:211], v9 offset:20736
  ds_read_b64_tr_b16 a[212:213], v9 offset:21504
  ds_read_b64_tr_b16 a[214:215], v9 offset:21760
  ds_read_b64_tr_b16 a[216:217], v9 offset:22528
  ds_read_b64_tr_b16 a[218:219], v9 offset:22784
  ds_read_b64_tr_b16 a[220:221], v9 offset:23552
  ds_read_b64_tr_b16 a[222:223], v9 offset:23808
  s_waitcnt lgkmcnt(4)
  ds_read_b64_tr_b16 a[224:225], v9 offset:24576
  ds_read_b64_tr_b16 a[226:227], v9 offset:24832
  ds_read_b64_tr_b16 a[228:229], v9 offset:25600
  ds_read_b64_tr_b16 a[230:231], v9 offset:25856
  ds_read_b64_tr_b16 a[232:233], v9 offset:26624
  ds_read_b64_tr_b16 a[234:235], v9 offset:26880
  ds_read_b64_tr_b16 a[236:237], v9 offset:27648
  ds_read_b64_tr_b16 a[238:239], v9 offset:27904
  s_waitcnt lgkmcnt(4)
  ds_read_b64_tr_b16 a[240:241], v9 offset:28672
  ds_read_b64_tr_b16 a[242:243], v9 offset:28928
  ds_read_b64_tr_b16 a[244:245], v9 offset:29696
  ds_read_b64_tr_b16 a[246:247], v9 offset:29952
  ds_read_b64_tr_b16 a[248:249], v9 offset:30720
  ds_read_b64_tr_b16 a[250:251], v9 offset:30976
  ds_read_b64_tr_b16 a[252:253], v9 offset:31744
  ds_read_b64_tr_b16 a[254:255], v9 offset:32000
  s_waitcnt lgkmcnt(4)
  s_waitcnt lgkmcnt(0)
  s_cmp_lg_u32 s14, 0
  s_cbranch_scc1 iw_183
  s_mov_b32 s24, 0x40000
  v_and_b32 v12, 3, v0
  v_lshlrev_b32 v12, 6, v12
iwp_184:
  buffer_load_dword v13, v12, s[60:63], 0 offen offset:8 sc1
  s_waitcnt vmcnt(0)
  v_readlane_b32 s23, v13, 0
  v_readlane_b32 s25, v13, 1
  s_add_u32 s23, s23, s25
  v_readlane_b32 s25, v13, 2
  s_add_u32 s23, s23, s25
  v_readlane_b32 s25, v13, 3
  s_add_u32 s23, s23, s25
  s_and_b32 s25, s23, 0xffff
  s_cmp_ge_u32 s25, 64
  s_cbranch_scc1 iw_183
  s_cmp_eq_u32 s24, 0
  s_cbranch_scc1 iw_183
  s_sub_u32 s24, s24, 1
  s_branch iwp_184
iw_183:
  s_mov_b32 s16, s41
  s_mov_b32 s18, 16777216
  s_mov_b32 s20, 4096
  s_lshl_b32 s19, s42, 24
  s_add_u32 s19, s19, 33554432
  s_lshl_b32 s23, s40, 13
  s_add_u32 s19, s19, s23
  s_lshl_b32 s23, s14, 11
  s_add_u32 s19, s19, s23
  s_lshl_b32 s21, s40, 4
  s_lshl_b32 s23, s42, 2
  s_add_u32 s21, s21, s23
  s_add_u32 s21, s21, 65536
  s_cmp_eq_u32 s42, 2
  s_cbranch_scc1 g1v_177
  v_and_b32 v8, 63, v0
  v_lshlrev_b32 v1, 4, v8
  v_mov_b32 v2, v1
  v_mov_b32 v3, v1
  v_mov_b32 v6, 1
  s_cmp_eq_u32 s42, 2
  s_mov_b32 s52, 4194304
  s_cselect_b32 s52, 8388608, s52
  s_lshl_b32 s23, s40, 11
  s_add_u32 s52, s52, s23
  s_lshl_b32 s23, s14, 9
  s_add_u32 s52, s52, s23
  s_cmp_eq_u32 s42, 0
  s_cselect_b32 s52, 0, s52
  v_and_b32 v12, 63, v0
  v_lshlrev_b32 v12, 3, v12
  v_mov_b32 v10, -1
  v_mov_b32 v11, -1
  s_mul_i32 s38, s14, 16384
  s_add_u32 s18, s18, s38
  s_mov_b32 s28, 0
  s_mov_b32 s22, 0
  v_mov_b32 v7, 131072
  s_barrier
  s_mul_i32 s23, s16, 65536
  s_add_u32 s23, s23, s18
  s_add_u32 s24, s28, s38
  s_mov_b32 m0, s24
  s_nop 0
  buffer_load_dwordx4 v1, s[4:7], s23 offen offset:0 sc1 lds
  buffer_load_dwordx4 v1, s[4:7], s23 offen offset:1024 sc1 lds
  buffer_load_dwordx4 v1, s[4:7], s23 offen offset:2048 sc1 lds
  buffer_load_dwordx4 v1, s[4:7], s23 offen offset:3072 sc1 lds
  s_add_u32 s23, s23, 4096
  s_add_u32 s24, s24, 4096
  s_mov_b32 m0, s24
  s_nop 0
  buffer_load_dwordx4 v1, s[4:7], s23 offen offset:0 sc1 lds
  buffer_load_dwordx4 v1, s[4:7], s23 offen offset:1024 sc1 lds
  buffer_load_dwordx4 v1, s[4:7], s23 offen offset:2048 sc1 lds
  buffer_load_dwordx4 v1, s[4:7], s23 offen offset:3072 sc1 lds
  s_add_u32 s23, s23, 4096
  s_add_u32 s24, s24, 4096
  s_mov_b32 m0, s24
  s_nop 0
  buffer_load_dwordx4 v1, s[4:7], s23 offen offset:0 sc1 lds
  buffer_load_dwordx4 v1, s[4:7], s23 offen offset:1024 sc1 lds
  buffer_load_dwordx4 v1, s[4:7], s23 offen offset:2048 sc1 lds
  buffer_load_dwordx4 v1, s[4:7], s23 offen offset:3072 sc1 lds
  s_add_u32 s23, s23, 4096
  s_add_u32 s24, s24, 4096
  s_mov_b32 m0, s24
  s_nop 0
  buffer_load_dwordx4 v1, s[4:7], s23 offen offset:0 sc1 lds
  buffer_load_dwordx4 v1, s[4:7], s23 offen offset:1024 sc1 lds
  buffer_load_dwordx4 v1, s[4:7], s23 offen offset:2048 sc1 lds
  buffer_load_dwordx4 v1, s[4:7], s23 offen offset:3072 sc1 lds
  s_add_u32 s17, s16, 2
  v_mov_b32 v4, 0
  s_cmp_ge_u32 s17, 64
  s_cbranch_scc1 lf_185
  v_mov_b32 v4, 1
lf_185:
  s_waitcnt vmcnt(0)
  s_cmp_lg_u32 s14, 0
  s_cbranch_scc1 w0_189
  ds_write_b32 v7, v4
  s_waitcnt lgkmcnt(0)
w0_189:
  s_barrier
  ds_read_b32 v5, v7
  ds_read_b128 v[16:19], v2 offset:0
  ds_read_b128 v[20:23], v2 offset:1024
  ds_read_b128 v[24:27], v2 offset:2048
  ds_read_b128 v[28:31], v2 offset:3072
  ds_read_b128 v[32:35], v2 offset:4096
  ds_read_b128 v[36:39], v2 offset:5120
  ds_read_b128 v[40:43], v2 offset:6144
  v_xor_b32 v7, 4, v7
g1qkdec_186:
  s_waitcnt lgkmcnt(7)
  v_readfirstlane_b32 s36, v5
  s_cmp_ge_u32 s36, 1
  s_cbranch_scc0 g1qknpre_187
  s_add_u32 s15, s17, 2
  v_mov_b32 v4, 0
  s_cmp_ge_u32 s15, 64
  s_cbranch_scc1 lf_190
  v_mov_b32 v4, 1
lf_190:
  s_mul_i32 s26, s17, 65536
  s_add_u32 s26, s26, s18
  s_xor_b32 s27, s28, 0x10000
  s_add_u32 s27, s27, s38
  s_waitcnt lgkmcnt(6)
  v_mfma_f32_32x32x16_bf16 v[48:63], a[0:3], v[16:19], 0
  ds_read_b128 v[44:47], v2 offset:7168
  s_mov_b32 m0, s27
  s_nop 0
  buffer_load_dwordx4 v1, s[4:7], s26 offen offset:0 sc1 lds
  s_waitcnt lgkmcnt(6)
  v_mfma_f32_32x32x16_bf16 v[48:63], a[4:7], v[20:23], v[48:63]
  ds_read_b128 v[16:19], v2 offset:8192
  s_waitcnt lgkmcnt(6)
  v_mfma_f32_32x32x16_bf16 v[48:63], a[8:11], v[24:27], v[48:63]
  ds_read_b128 v[20:23], v2 offset:9216
  buffer_load_dwordx4 v1, s[4:7], s26 offen offset:1024 sc1 lds
  s_waitcnt lgkmcnt(6)
  v_mfma_f32_32x32x16_bf16 v[48:63], a[12:15], v[28:31], v[48:63]
  ds_read_b128 v[24:27], v2 offset:10240
  s_waitcnt lgkmcnt(6)
  v_mfma_f32_32x32x16_bf16 v[48:63], a[16:19], v[32:35], v[48:63]
  ds_read_b128 v[28:31], v2 offset:11264
  buffer_load_dwordx4 v1, s[4:7], s26 offen offset:2048 sc1 lds
  s_waitcnt lgkmcnt(6)
  v_mfma_f32_32x32x16_bf16 v[48:63], a[20:23], v[36:39], v[48:63]
  ds_read_b128 v[32:35], v2 offset:12288
  s_waitcnt lgkmcnt(6)
  v_mfma_f32_32x32x16_bf16 v[48:63], a[24:27], v[40:43], v[48:63]
  ds_read_b128 v[36:39], v2 offset:13312
  buffer_load_dwordx4 v1, s[4:7], s26 offen offset:3072 sc1 lds
  s_add_u32 s26, s26, 4096
  s_add_u32 s27, s27, 4096
  s_waitcnt lgkmcnt(6)
  v_mfma_f32_32x32x16_bf16 v[48:63], a[28:31], v[44:47], v[48:63]
  ds_read_b128 v[40:43], v2 offset:14336
  s_waitcnt lgkmcnt(6)
  v_mfma_f32_32x32x16_bf16 v[48:63], a[32:35], v[16:19], v[48:63]
  ds_read_b128 v[44:47], v2 offset:15360
  s_mov_b32 m0, s27
  s_nop 0
  buffer_load_dwordx4 v1, s[4:7], s26 offen offset:0 sc1 lds
  s_waitcnt lgkmcnt(6)
  v_mfma_f32_32x32x16_bf16 v[48:63], a[36:39], v[20:23], v[48:63]
  ds_read_b128 v[16:19], v2 offset:16384
  s_waitcnt lgkmcnt(6)
  v_mfma_f32_32x32x16_bf16 v[48:63], a[40:43], v[24:27], v[48:63]
  ds_read_b128 v[20:23], v2 offset:17408
  buffer_load_dwordx4 v1, s[4:7], s26 offen offset:1024 sc1 lds
  s_waitcnt lgkmcnt(6)
  v_mfma_f32_32x32x16_bf16 v[48:63], a[44:47], v[28:31], v[48:63]
  ds_read_b128 v[24:27], v2 offset:18432
  s_waitcnt lgkmcnt(6)
  v_mfma_f32_32x32x16_bf16 v[48:63], a[48:51], v[32:35], v[48:63]
  ds_read_b128 v[28:31], v2 offset:19456
  buffer_load_dwordx4 v1, s[4:7], s26 offen offset:2048 sc1 lds
  s_waitcnt lgkmcnt(6)
  v_mfma_f32_32x32x16_bf16 v[48:63], a[52:55], v[36:39], v[48:63]
  ds_read_b128 v[32:35], v2 offset:20480
  s_waitcnt lgkmcnt(6)
  v_mfma_f32_32x32x16_bf16 v[48:63], a[56:59], v[40:43], v[48:63]
  ds_read_b128 v[36:39], v2 offset:21504
  buffer_load_dwordx4 v1, s[4:7], s26 offen offset:3072 sc1 lds
  s_add_u32 s26, s26, 4096
  s_add_u32 s27, s27, 4096
  s_waitcnt lgkmcnt(6)
  v_mfma_f32_32x32x16_bf16 v[48:63], a[60:63], v[44:47], v[48:63]
  ds_read_b128 v[40:43], v2 offset:22528
  s_waitcnt lgkmcnt(6)
  v_mfma_f32_32x32x16_bf16 v[48:63], a[64:67], v[16:19], v[48:63]
  ds_read_b128 v[44:47], v2 offset:23552
  s_mov_b32 m0, s27
  s_nop 0
  buffer_load_dwordx4 v1, s[4:7], s26 offen offset:0 sc1 lds
  s_waitcnt lgkmcnt(6)
  v_mfma_f32_32x32x16_bf16 v[48:63], a[68:71], v[20:23], v[48:63]
  ds_read_b128 v[16:19], v2 offset:24576
  s_waitcnt lgkmcnt(6)
  v_mfma_f32_32x32x16_bf16 v[48:63], a[72:75], v[24:27], v[48:63]
  ds_read_b128 v[20:23], v2 offset:25600
  buffer_load_dwordx4 v1, s[4:7], s26 offen offset:1024 sc1 lds
  s_waitcnt lgkmcnt(6)
  v_mfma_f32_32x32x16_bf16 v[48:63], a[76:79], v[28:31], v[48:63]
  ds_read_b128 v[24:27], v2 offset:26624
  s_waitcnt lgkmcnt(6)
  v_mfma_f32_32x32x16_bf16 v[48:63], a[80:83], v[32:35], v[48:63]
  ds_read_b128 v[28:31], v2 offset:27648
  buffer_load_dwordx4 v1, s[4:7], s26 offen offset:2048 sc1 lds
  s_waitcnt lgkmcnt(6)
  v_mfma_f32_32x32x16_bf16 v[48:63], a[84:87], v[36:39], v[48:63]
  ds_read_b128 v[32:35], v2 offset:28672
  s_waitcnt lgkmcnt(6)
  v_mfma_f32_32x32x16_bf16 v[48:63], a[88:91], v[40:43], v[48:63]
  ds_read_b128 v[36:39], v2 offset:29696
  buffer_load_dwordx4 v1, s[4:7], s26 offen offset:3072 sc1 lds
  s_add_u32 s26, s26, 4096
  s_add_u32 s27, s27, 4096
  s_waitcnt lgkmcnt(6)
  v_mfma_f32_32x32x16_bf16 v[48:63], a[92:95], v[44:47], v[48:63]
  ds_read_b128 v[40:43], v2 offset:30720
  s_waitcnt lgkmcnt(6)
  v_mfma_f32_32x32x16_bf16 v[48:63], a[96:99], v[16:19], v[48:63]
  ds_read_b128 v[44:47], v2 offset:31744
  s_cmp_eq_u32 s22, 0
  s_cbranch_scc1 nsig_191
  s_waitcnt vmcnt(12)
  s_barrier
  s_cmp_lg_u32 s14, 0
  s_cbranch_scc1 sig_192
  s_mov_b64 exec, 1
  buffer_atomic_add v6, off, s[4:7], s22 sc1
  s_mov_b64 exec, -1
sig_192:
  s_mov_b32 s22, 0
nsig_191:
  s_mov_b32 m0, s27
  s_nop 0
  buffer_load_dwordx4 v1, s[4:7], s26 offen offset:0 sc1 lds
  s_waitcnt lgkmcnt(6)
  v_mfma_f32_32x32x16_bf16 v[48:63], a[100:103], v[20:23], v[48:63]
  ds_read_b128 v[16:19], v2 offset:32768
  s_waitcnt lgkmcnt(6)
  v_mfma_f32_32x32x16_bf16 v[48:63], a[104:107], v[24:27], v[48:63]
  ds_read_b128 v[20:23], v2 offset:33792
  buffer_load_dwordx4 v1, s[4:7], s26 offen offset:1024 sc1 lds
  s_waitcnt lgkmcnt(6)
  v_mfma_f32_32x32x16_bf16 v[48:63], a[108:111], v[28:31], v[48:63]
  ds_read_b128 v[24:27], v2 offset:34816
  s_waitcnt lgkmcnt(6)
  v_mfma_f32_32x32x16_bf16 v[48:63], a[112:115], v[32:35], v[48:63]
  ds_read_b128 v[28:31], v2 offset:35840
  buffer_load_dwordx4 v1, s[4:7], s26 offen offset:2048 sc1 lds
  s_waitcnt lgkmcnt(6)
  v_mfma_f32_32x32x16_bf16 v[48:63], a[116:119], v[36:39], v[48:63]
  ds_read_b128 v[32:35], v2 offset:36864
  s_waitcnt lgkmcnt(6)
  v_mfma_f32_32x32x16_bf16 v[48:63], a[120:123], v[40:43], v[48:63]
  ds_read_b128 v[36:39], v2 offset:37888
  buffer_load_dwordx4 v1, s[4:7], s26 offen offset:3072 sc1 lds
  s_waitcnt lgkmcnt(6)
  v_mfma_f32_32x32x16_bf16 v[48:63], a[124:127], v[44:47], v[48:63]
  ds_read_b128 v[40:43], v2 offset:38912
  s_waitcnt lgkmcnt(6)
  v_mfma_f32_32x32x16_bf16 v[48:63], a[128:131], v[16:19], v[48:63]
  ds_read_b128 v[44:47], v2 offset:39936
  s_waitcnt lgkmcnt(6)
  v_mfma_f32_32x32x16_bf16 v[48:63], a[132:135], v[20:23], v[48:63]
  ds_read_b128 v[16:19], v2 offset:40960
  s_waitcnt lgkmcnt(6)
  v_mfma_f32_32x32x16_bf16 v[48:63], a[136:139], v[24:27], v[48:63]
  ds_read_b128 v[20:23], v2 offset:41984
  s_waitcnt lgkmcnt(6)
  v_mfma_f32_32x32x16_bf16 v[48:63], a[140:143], v[28:31], v[48:63]
  ds_read_b128 v[24:27], v2 offset:43008
  s_waitcnt lgkmcnt(6)
  v_mfma_f32_32x32x16_bf16 v[48:63], a[144:147], v[32:35], v[48:63]
  ds_read_b128 v[28:31], v2 offset:44032
  s_waitcnt lgkmcnt(6)
  v_mfma_f32_32x32x16_bf16 v[48:63], a[148:151], v[36:39], v[48:63]
  ds_read_b128 v[32:35], v2 offset:45056
  s_waitcnt lgkmcnt(6)
  v_mfma_f32_32x32x16_bf16 v[48:63], a[152:155], v[40:43], v[48:63]
  ds_read_b128 v[36:39], v2 offset:46080
  s_waitcnt lgkmcnt(6)
  v_mfma_f32_32x32x16_bf16 v[48:63], a[156:159], v[44:47], v[48:63]
  ds_read_b128 v[40:43], v2 offset:47104
  s_waitcnt lgkmcnt(6)
  v_mfma_f32_32x32x16_bf16 v[48:63], a[160:163], v[16:19], v[48:63]
  ds_read_b128 v[44:47], v2 offset:48128
  s_waitcnt lgkmcnt(6)
  v_mfma_f32_32x32x16_bf16 v[48:63], a[164:167], v[20:23], v[48:63]
  ds_read_b128 v[16:19], v2 offset:49152
  s_waitcnt lgkmcnt(6)
  v_mfma_f32_32x32x16_bf16 v[48:63], a[168:171], v[24:27], v[48:63]
  ds_read_b128 v[20:23], v2 offset:50176
  s_waitcnt lgkmcnt(6)
  v_mfma_f32_32x32x16_bf16 v[48:63], a[172:175], v[28:31], v[48:63]
  ds_read_b128 v[24:27], v2 offset:51200
  s_waitcnt lgkmcnt(6)
  v_mfma_f32_32x32x16_bf16 v[48:63], a[176:179], v[32:35], v[48:63]
  ds_read_b128 v[28:31], v2 offset:52224
  s_cmp_lg_u32 s14, 0
  s_cbranch_scc1 w0_193
  ds_write_b32 v7, v4
w0_193:
  s_waitcnt lgkmcnt(6)
  v_mfma_f32_32x32x16_bf16 v[48:63], a[180:183], v[36:39], v[48:63]
  ds_read_b128 v[32:35], v2 offset:53248
  s_waitcnt lgkmcnt(6)
  v_mfma_f32_32x32x16_bf16 v[48:63], a[184:187], v[40:43], v[48:63]
  ds_read_b128 v[36:39], v2 offset:54272
  s_waitcnt lgkmcnt(6)
  v_mfma_f32_32x32x16_bf16 v[48:63], a[188:191], v[44:47], v[48:63]
  ds_read_b128 v[40:43], v2 offset:55296
  s_waitcnt lgkmcnt(6)
  v_mfma_f32_32x32x16_bf16 v[48:63], a[192:195], v[16:19], v[48:63]
  ds_read_b128 v[44:47], v2 offset:56320
  s_waitcnt lgkmcnt(6)
  v_mfma_f32_32x32x16_bf16 v[48:63], a[196:199], v[20:23], v[48:63]
  ds_read_b128 v[16:19], v2 offset:57344
  s_waitcnt lgkmcnt(6)
  v_mfma_f32_32x32x16_bf16 v[48:63], a[200:203], v[24:27], v[48:63]
  ds_read_b128 v[20:23], v2 offset:58368
  s_waitcnt lgkmcnt(6)
  v_mfma_f32_32x32x16_bf16 v[48:63], a[204:207], v[28:31], v[48:63]
  ds_read_b128 v[24:27], v2 offset:59392
  s_waitcnt lgkmcnt(6)
  v_mfma_f32_32x32x16_bf16 v[48:63], a[208:211], v[32:35], v[48:63]
  ds_read_b128 v[28:31], v2 offset:60416
  s_waitcnt lgkmcnt(6)
  v_mfma_f32_32x32x16_bf16 v[48:63], a[212:215], v[36:39], v[48:63]
  ds_read_b128 v[32:35], v2 offset:61440
  s_waitcnt lgkmcnt(6)
  v_mfma_f32_32x32x16_bf16 v[48:63], a[216:219], v[40:43], v[48:63]
  ds_read_b128 v[36:39], v2 offset:62464
  s_waitcnt lgkmcnt(6)
  v_mfma_f32_32x32x16_bf16 v[48:63], a[220:223], v[44:47], v[48:63]
  ds_read_b128 v[40:43], v2 offset:63488
  s_waitcnt lgkmcnt(6)
  v_mfma_f32_32x32x16_bf16 v[48:63], a[224:227], v[16:19], v[48:63]
  ds_read_b128 v[44:47], v2 offset:64512
  s_waitcnt lgkmcnt(6)
  v_mfma_f32_32x32x16_bf16 v[48:63], a[228:231], v[20:23], v[48:63]
  s_waitcnt lgkmcnt(5)
  v_mfma_f32_32x32x16_bf16 v[48:63], a[232:235], v[24:27], v[48:63]
  s_waitcnt lgkmcnt(4)
  v_mfma_f32_32x32x16_bf16 v[48:63], a[236:239], v[28:31], v[48:63]
  s_waitcnt lgkmcnt(3)
  v_mfma_f32_32x32x16_bf16 v[48:63], a[240:243], v[32:35], v[48:63]
  s_waitcnt lgkmcnt(2)
  v_mfma_f32_32x32x16_bf16 v[48:63], a[244:247], v[36:39], v[48:63]
  s_waitcnt lgkmcnt(1)
  v_mfma_f32_32x32x16_bf16 v[48:63], a[248:251], v[40:43], v[48:63]
  s_waitcnt lgkmcnt(0)
  v_mfma_f32_32x32x16_bf16 v[48:63], a[252:255], v[44:47], v[48:63]
  s_waitcnt vmcnt(0)
  s_barrier
  v_xor_b32 v2, 0x10000, v2
  ds_read_b32 v5, v7
  ds_read_b128 v[16:19], v2 offset:0
  ds_read_b128 v[20:23], v2 offset:1024
  ds_read_b128 v[24:27], v2 offset:2048
  ds_read_b128 v[28:31], v2 offset:3072
  ds_read_b128 v[32:35], v2 offset:4096
  ds_read_b128 v[36:39], v2 offset:5120
  ds_read_b128 v[40:43], v2 offset:6144
  v_xor_b32 v7, 4, v7
  s_mul_i32 s23, s16, 262144
  s_add_u32 s23, s23, s19
  v_cvt_pk_bf16_f32 v80, v48, v49
  v_cvt_pk_bf16_f32 v81, v50, v51
  v_cvt_pk_bf16_f32 v82, v52, v53
  v_cvt_pk_bf16_f32 v83, v54, v55
  v_cvt_pk_bf16_f32 v84, v56, v57
  v_cvt_pk_bf16_f32 v85, v58, v59
  v_cvt_pk_bf16_f32 v86, v60, v61
  v_cvt_pk_bf16_f32 v87, v62, v63
  buffer_store_dwordx4 v[80:83], v3, s[4:7], s23 offen sc1
  buffer_store_dwordx4 v[84:87], v3, s[4:7], s23 offen offset:1024 sc1
  s_cmp_eq_u32 s52, 0
  s_cbranch_scc1 mark_194
  s_cmp_lt_u32 s16, 57
  s_cbranch_scc1 mark_194
  s_lshl_b32 s24, s16, 16
  s_add_u32 s24, s24, s52
  buffer_store_dwordx2 v[10:11], v12, s[4:7], s24 offen sc1
mark_194:
  s_mul_i32 s22, s16, 512
  s_add_u32 s22, s22, s21
  s_mov_b32 s16, s17
  s_add_u32 s17, s16, 2
  s_xor_b32 s28, s28, 0x10000
  s_branch g1qkdec_186
g1qknpre_187:
  s_waitcnt lgkmcnt(6)
  v_mfma_f32_32x32x16_bf16 v[48:63], a[0:3], v[16:19], 0
  ds_read_b128 v[44:47], v2 offset:7168
  s_waitcnt lgkmcnt(6)
  v_mfma_f32_32x32x16_bf16 v[48:63], a[4:7], v[20:23], v[48:63]
  ds_read_b128 v[16:19], v2 offset:8192
  s_waitcnt lgkmcnt(6)
  v_mfma_f32_32x32x16_bf16 v[48:63], a[8:11], v[24:27], v[48:63]
  ds_read_b128 v[20:23], v2 offset:9216
  s_waitcnt lgkmcnt(6)
  v_mfma_f32_32x32x16_bf16 v[48:63], a[12:15], v[28:31], v[48:63]
  ds_read_b128 v[24:27], v2 offset:10240
  s_waitcnt lgkmcnt(6)
  v_mfma_f32_32x32x16_bf16 v[48:63], a[16:19], v[32:35], v[48:63]
  ds_read_b128 v[28:31], v2 offset:11264
  s_waitcnt lgkmcnt(6)
  v_mfma_f32_32x32x16_bf16 v[48:63], a[20:23], v[36:39], v[48:63]
  ds_read_b128 v[32:35], v2 offset:12288
  s_waitcnt lgkmcnt(6)
  v_mfma_f32_32x32x16_bf16 v[48:63], a[24:27], v[40:43], v[48:63]
  ds_read_b128 v[36:39], v2 offset:13312
  s_waitcnt lgkmcnt(6)
  v_mfma_f32_32x32x16_bf16 v[48:63], a[28:31], v[44:47], v[48:63]
  ds_read_b128 v[40:43], v2 offset:14336
  s_waitcnt lgkmcnt(6)
  v_mfma_f32_32x32x16_bf16 v[48:63], a[32:35], v[16:19], v[48:63]
  ds_read_b128 v[44:47], v2 offset:15360
  s_waitcnt lgkmcnt(6)
  v_mfma_f32_32x32x16_bf16 v[48:63], a[36:39], v[20:23], v[48:63]
  ds_read_b128 v[16:19], v2 offset:16384
  s_waitcnt lgkmcnt(6)
  v_mfma_f32_32x32x16_bf16 v[48:63], a[40:43], v[24:27], v[48:63]
  ds_read_b128 v[20:23], v2 offset:17408
  s_waitcnt lgkmcnt(6)
  v_mfma_f32_32x32x16_bf16 v[48:63], a[44:47], v[28:31], v[48:63]
  ds_read_b128 v[24:27], v2 offset:18432
  s_waitcnt lgkmcnt(6)
  v_mfma_f32_32x32x16_bf16 v[48:63], a[48:51], v[32:35], v[48:63]
  ds_read_b128 v[28:31], v2 offset:19456
  s_waitcnt lgkmcnt(6)
  v_mfma_f32_32x32x16_bf16 v[48:63], a[52:55], v[36:39], v[48:63]
  ds_read_b128 v[32:35], v2 offset:20480
  s_waitcnt lgkmcnt(6)
  v_mfma_f32_32x32x16_bf16 v[48:63], a[56:59], v[40:43], v[48:63]
  ds_read_b128 v[36:39], v2 offset:21504
  s_waitcnt lgkmcnt(6)
  v_mfma_f32_32x32x16_bf16 v[48:63], a[60:63], v[44:47], v[48:63]
  ds_read_b128 v[40:43], v2 offset:22528
  s_waitcnt lgkmcnt(6)
  v_mfma_f32_32x32x16_bf16 v[48:63], a[64:67], v[16:19], v[48:63]
  ds_read_b128 v[44:47], v2 offset:23552
  s_waitcnt lgkmcnt(6)
  v_mfma_f32_32x32x16_bf16 v[48:63], a[68:71], v[20:23], v[48:63]
  ds_read_b128 v[16:19], v2 offset:24576
  s_waitcnt lgkmcnt(6)
  v_mfma_f32_32x32x16_bf16 v[48:63], a[72:75], v[24:27], v[48:63]
  ds_read_b128 v[20:23], v2 offset:25600
  s_waitcnt lgkmcnt(6)
  v_mfma_f32_32x32x16_bf16 v[48:63], a[76:79], v[28:31], v[48:63]
  ds_read_b128 v[24:27], v2 offset:26624
  s_waitcnt lgkmcnt(6)
  v_mfma_f32_32x32x16_bf16 v[48:63], a[80:83], v[32:35], v[48:63]
  ds_read_b128 v[28:31], v2 offset:27648
  s_waitcnt lgkmcnt(6)
  v_mfma_f32_32x32x16_bf16 v[48:63], a[84:87], v[36:39], v[48:63]
  ds_read_b128 v[32:35], v2 offset:28672
  s_waitcnt lgkmcnt(6)
  v_mfma_f32_32x32x16_bf16 v[48:63], a[88:91], v[40:43], v[48:63]
  ds_read_b128 v[36:39], v2 offset:29696
  s_waitcnt lgkmcnt(6)
  v_mfma_f32_32x32x16_bf16 v[48:63], a[92:95], v[44:47], v[48:63]
  ds_read_b128 v[40:43], v2 offset:30720
  s_waitcnt lgkmcnt(6)
  v_mfma_f32_32x32x16_bf16 v[48:63], a[96:99], v[16:19], v[48:63]
  ds_read_b128 v[44:47], v2 offset:31744
  s_cmp_eq_u32 s22, 0
  s_cbranch_scc1 nsig_195
  s_waitcnt vmcnt(0)
  s_barrier
  s_cmp_lg_u32 s14, 0
  s_cbranch_scc1 sig_196
  s_mov_b64 exec, 1
  buffer_atomic_add v6, off, s[4:7], s22 sc1
  s_mov_b64 exec, -1
sig_196:
  s_mov_b32 s22, 0
nsig_195:
  s_waitcnt lgkmcnt(6)
  v_mfma_f32_32x32x16_bf16 v[48:63], a[100:103], v[20:23], v[48:63]
  ds_read_b128 v[16:19], v2 offset:32768
  s_waitcnt lgkmcnt(6)
  v_mfma_f32_32x32x16_bf16 v[48:63], a[104:107], v[24:27], v[48:63]
  ds_read_b128 v[20:23], v2 offset:33792
  s_waitcnt lgkmcnt(6)
  v_mfma_f32_32x32x16_bf16 v[48:63], a[108:111], v[28:31], v[48:63]
  ds_read_b128 v[24:27], v2 offset:34816
  s_waitcnt lgkmcnt(6)
  v_mfma_f32_32x32x16_bf16 v[48:63], a[112:115], v[32:35], v[48:63]
  ds_read_b128 v[28:31], v2 offset:35840
  s_waitcnt lgkmcnt(6)
  v_mfma_f32_32x32x16_bf16 v[48:63], a[116:119], v[36:39], v[48:63]
  ds_read_b128 v[32:35], v2 offset:36864
  s_waitcnt lgkmcnt(6)
  v_mfma_f32_32x32x16_bf16 v[48:63], a[120:123], v[40:43], v[48:63]
  ds_read_b128 v[36:39], v2 offset:37888
  s_waitcnt lgkmcnt(6)
  v_mfma_f32_32x32x16_bf16 v[48:63], a[124:127], v[44:47], v[48:63]
  ds_read_b128 v[40:43], v2 offset:38912
  s_waitcnt lgkmcnt(6)
  v_mfma_f32_32x32x16_bf16 v[48:63], a[128:131], v[16:19], v[48:63]
  ds_read_b128 v[44:47], v2 offset:39936
  s_waitcnt lgkmcnt(6)
  v_mfma_f32_32x32x16_bf16 v[48:63], a[132:135], v[20:23], v[48:63]
  ds_read_b128 v[16:19], v2 offset:40960
  s_waitcnt lgkmcnt(6)
  v_mfma_f32_32x32x16_bf16 v[48:63], a[136:139], v[24:27], v[48:63]
  ds_read_b128 v[20:23], v2 offset:41984
  s_waitcnt lgkmcnt(6)
  v_mfma_f32_32x32x16_bf16 v[48:63], a[140:143], v[28:31], v[48:63]
  ds_read_b128 v[24:27], v2 offset:43008
  s_waitcnt lgkmcnt(6)
  v_mfma_f32_32x32x16_bf16 v[48:63], a[144:147], v[32:35], v[48:63]
  ds_read_b128 v[28:31], v2 offset:44032
  s_waitcnt lgkmcnt(6)
  v_mfma_f32_32x32x16_bf16 v[48:63], a[148:151], v[36:39], v[48:63]
  ds_read_b128 v[32:35], v2 offset:45056
  s_waitcnt lgkmcnt(6)
  v_mfma_f32_32x32x16_bf16 v[48:63], a[152:155], v[40:43], v[48:63]
  ds_read_b128 v[36:39], v2 offset:46080
  s_waitcnt lgkmcnt(6)
  v_mfma_f32_32x32x16_bf16 v[48:63], a[156:159], v[44:47], v[48:63]
  ds_read_b128 v[40:43], v2 offset:47104
  s_waitcnt lgkmcnt(6)
  v_mfma_f32_32x32x16_bf16 v[48:63], a[160:163], v[16:19], v[48:63]
  ds_read_b128 v[44:47], v2 offset:48128
  s_waitcnt lgkmcnt(6)
  v_mfma_f32_32x32x16_bf16 v[48:63], a[164:167], v[20:23], v[48:63]
  ds_read_b128 v[16:19], v2 offset:49152
  s_waitcnt lgkmcnt(6)
  v_mfma_f32_32x32x16_bf16 v[48:63], a[168:171], v[24:27], v[48:63]
  ds_read_b128 v[20:23], v2 offset:50176
  s_waitcnt lgkmcnt(6)
  v_mfma_f32_32x32x16_bf16 v[48:63], a[172:175], v[28:31], v[48:63]
  ds_read_b128 v[24:27], v2 offset:51200
  s_waitcnt lgkmcnt(6)
  v_mfma_f32_32x32x16_bf16 v[48:63], a[176:179], v[32:35], v[48:63]
  ds_read_b128 v[28:31], v2 offset:52224
  s_waitcnt lgkmcnt(6)
  v_mfma_f32_32x32x16_bf16 v[48:63], a[180:183], v[36:39], v[48:63]
  ds_read_b128 v[32:35], v2 offset:53248
  s_waitcnt lgkmcnt(6)
  v_mfma_f32_32x32x16_bf16 v[48:63], a[184:187], v[40:43], v[48:63]
  ds_read_b128 v[36:39], v2 offset:54272
  s_waitcnt lgkmcnt(6)
  v_mfma_f32_32x32x16_bf16 v[48:63], a[188:191], v[44:47], v[48:63]
  ds_read_b128 v[40:43], v2 offset:55296
  s_waitcnt lgkmcnt(6)
  v_mfma_f32_32x32x16_bf16 v[48:63], a[192:195], v[16:19], v[48:63]
  ds_read_b128 v[44:47], v2 offset:56320
  s_waitcnt lgkmcnt(6)
  v_mfma_f32_32x32x16_bf16 v[48:63], a[196:199], v[20:23], v[48:63]
  ds_read_b128 v[16:19], v2 offset:57344
  s_waitcnt lgkmcnt(6)
  v_mfma_f32_32x32x16_bf16 v[48:63], a[200:203], v[24:27], v[48:63]
  ds_read_b128 v[20:23], v2 offset:58368
  s_waitcnt lgkmcnt(6)
  v_mfma_f32_32x32x16_bf16 v[48:63], a[204:207], v[28:31], v[48:63]
  ds_read_b128 v[24:27], v2 offset:59392
  s_waitcnt lgkmcnt(6)
  v_mfma_f32_32x32x16_bf16 v[48:63], a[208:211], v[32:35], v[48:63]
  ds_read_b128 v[28:31], v2 offset:60416
  s_waitcnt lgkmcnt(6)
  v_mfma_f32_32x32x16_bf16 v[48:63], a[212:215], v[36:39], v[48:63]
  ds_read_b128 v[32:35], v2 offset:61440
  s_waitcnt lgkmcnt(6)
  v_mfma_f32_32x32x16_bf16 v[48:63], a[216:219], v[40:43], v[48:63]
  ds_read_b128 v[36:39], v2 offset:62464
  s_waitcnt lgkmcnt(6)
  v_mfma_f32_32x32x16_bf16 v[48:63], a[220:223], v[44:47], v[48:63]
  ds_read_b128 v[40:43], v2 offset:63488
  s_waitcnt lgkmcnt(6)
  v_mfma_f32_32x32x16_bf16 v[48:63], a[224:227], v[16:19], v[48:63]
  ds_read_b128 v[44:47], v2 offset:64512
  s_waitcnt lgkmcnt(6)
  v_mfma_f32_32x32x16_bf16 v[48:63], a[228:231], v[20:23], v[48:63]
  s_waitcnt lgkmcnt(5)
  v_mfma_f32_32x32x16_bf16 v[48:63], a[232:235], v[24:27], v[48:63]
  s_waitcnt lgkmcnt(4)
  v_mfma_f32_32x32x16_bf16 v[48:63], a[236:239], v[28:31], v[48:63]
  s_waitcnt lgkmcnt(3)
  v_mfma_f32_32x32x16_bf16 v[48:63], a[240:243], v[32:35], v[48:63]
  s_waitcnt lgkmcnt(2)
  v_mfma_f32_32x32x16_bf16 v[48:63], a[244:247], v[36:39], v[48:63]
  s_waitcnt lgkmcnt(1)
  v_mfma_f32_32x32x16_bf16 v[48:63], a[248:251], v[40:43], v[48:63]
  s_waitcnt lgkmcnt(0)
  v_mfma_f32_32x32x16_bf16 v[48:63], a[252:255], v[44:47], v[48:63]
g1qkepi_197:
  s_mul_i32 s23, s16, 262144
  s_add_u32 s23, s23, s19
  s_nop 9
  v_cvt_pk_bf16_f32 v80, v48, v49
  v_cvt_pk_bf16_f32 v81, v50, v51
  v_cvt_pk_bf16_f32 v82, v52, v53
  v_cvt_pk_bf16_f32 v83, v54, v55
  v_cvt_pk_bf16_f32 v84, v56, v57
  v_cvt_pk_bf16_f32 v85, v58, v59
  v_cvt_pk_bf16_f32 v86, v60, v61
  v_cvt_pk_bf16_f32 v87, v62, v63
  buffer_store_dwordx4 v[80:83], v3, s[4:7], s23 offen sc1
  buffer_store_dwordx4 v[84:87], v3, s[4:7], s23 offen offset:1024 sc1
  s_cmp_eq_u32 s52, 0
  s_cbranch_scc1 mark_198
  s_cmp_lt_u32 s16, 57
  s_cbranch_scc1 mark_198
  s_lshl_b32 s24, s16, 16
  s_add_u32 s24, s24, s52
  buffer_store_dwordx2 v[10:11], v12, s[4:7], s24 offen sc1
mark_198:
  s_mul_i32 s25, s16, 512
  s_add_u32 s25, s25, s21
  s_waitcnt vmcnt(0)
  s_barrier
  s_cmp_lg_u32 s14, 0
  s_cbranch_scc1 sig_199
  s_mov_b64 exec, 1
  buffer_atomic_add v6, off, s[4:7], s25 sc1
  s_mov_b64 exec, -1
sig_199:
  s_cmp_ge_u32 s17, 64
  s_cbranch_scc1 g1qkdone_188
  s_mul_i32 s23, s17, 65536
  s_add_u32 s23, s23, s18
  s_xor_b32 s24, s28, 0x10000
  s_add_u32 s24, s24, s38
  s_mov_b32 m0, s24
  s_nop 0
  buffer_load_dwordx4 v1, s[4:7], s23 offen offset:0 sc1 lds
  buffer_load_dwordx4 v1, s[4:7], s23 offen offset:1024 sc1 lds
  buffer_load_dwordx4 v1, s[4:7], s23 offen offset:2048 sc1 lds
  buffer_load_dwordx4 v1, s[4:7], s23 offen offset:3072 sc1 lds
  s_add_u32 s23, s23, 4096
  s_add_u32 s24, s24, 4096
  s_mov_b32 m0, s24
  s_nop 0
  buffer_load_dwordx4 v1, s[4:7], s23 offen offset:0 sc1 lds
  buffer_load_dwordx4 v1, s[4:7], s23 offen offset:1024 sc1 lds
  buffer_load_dwordx4 v1, s[4:7], s23 offen offset:2048 sc1 lds
  buffer_load_dwordx4 v1, s[4:7], s23 offen offset:3072 sc1 lds
  s_add_u32 s23, s23, 4096
  s_add_u32 s24, s24, 4096
  s_mov_b32 m0, s24
  s_nop 0
  buffer_load_dwordx4 v1, s[4:7], s23 offen offset:0 sc1 lds
  buffer_load_dwordx4 v1, s[4:7], s23 offen offset:1024 sc1 lds
  buffer_load_dwordx4 v1, s[4:7], s23 offen offset:2048 sc1 lds
  buffer_load_dwordx4 v1, s[4:7], s23 offen offset:3072 sc1 lds
  s_add_u32 s23, s23, 4096
  s_add_u32 s24, s24, 4096
  s_mov_b32 m0, s24
  s_nop 0
  buffer_load_dwordx4 v1, s[4:7], s23 offen offset:0 sc1 lds
  buffer_load_dwordx4 v1, s[4:7], s23 offen offset:1024 sc1 lds
  buffer_load_dwordx4 v1, s[4:7], s23 offen offset:2048 sc1 lds
  buffer_load_dwordx4 v1, s[4:7], s23 offen offset:3072 sc1 lds
  s_mov_b32 s16, s17
  s_add_u32 s17, s16, 2
  s_xor_b32 s28, s28, 0x10000
  v_mov_b32 v4, 0
  s_cmp_ge_u32 s17, 64
  s_cbranch_scc1 lf_200
  v_mov_b32 v4, 1
lf_200:
  s_waitcnt vmcnt(0)
  s_cmp_lg_u32 s14, 0
  s_cbranch_scc1 w0_201
  ds_write_b32 v7, v4
  s_waitcnt lgkmcnt(0)
w0_201:
  s_barrier
  v_xor_b32 v2, 0x10000, v2
  ds_read_b32 v5, v7
  ds_read_b128 v[16:19], v2 offset:0
  ds_read_b128 v[20:23], v2 offset:1024
  ds_read_b128 v[24:27], v2 offset:2048
  ds_read_b128 v[28:31], v2 offset:3072
  ds_read_b128 v[32:35], v2 offset:4096
  ds_read_b128 v[36:39], v2 offset:5120
  ds_read_b128 v[40:43], v2 offset:6144
  v_xor_b32 v7, 4, v7
  s_branch g1qkdec_186
g1qkdone_188:
  s_waitcnt vmcnt(0)
  s_barrier
  s_branch g1e_179
g1v_177:
  v_and_b32 v8, 63, v0
  v_lshlrev_b32 v1, 4, v8
  v_lshrrev_b32 v9, 5, v8
  v_lshlrev_b32 v9, 9, v9
  v_and_b32 v10, 7, v8
  v_and_b32 v11, 8, v8
  v_lshl_or_b32 v10, v11, 1, v10
  v_and_b32 v11, 16, v8
  v_lshrrev_b32 v11, 1, v11
  v_or_b32 v10, v10, v11
  v_lshl_add_u32 v2, v10, 4, v9
  v_and_b32 v10, 19, v8
  v_and_b32 v11, 4, v8
  v_lshl_or_b32 v10, v11, 1, v10
  v_and_b32 v11, 8, v8
  v_lshrrev_b32 v11, 1, v11
  v_or_b32 v10, v10, v11
  v_lshl_add_u32 v3, v10, 4, v9
  v_mov_b32 v6, 1
  s_cmp_eq_u32 s42, 2
  s_mov_b32 s52, 4194304
  s_cselect_b32 s52, 8388608, s52
  s_lshl_b32 s23, s40, 11
  s_add_u32 s52, s52, s23
  s_lshl_b32 s23, s14, 9
  s_add_u32 s52, s52, s23
  s_cmp_eq_u32 s42, 0
  s_cselect_b32 s52, 0, s52
  v_and_b32 v12, 63, v0
  v_lshlrev_b32 v12, 3, v12
  v_mov_b32 v10, -1
  v_mov_b32 v11, -1
  s_mul_i32 s38, s14, 16384
  s_add_u32 s18, s18, s38
  s_mov_b32 s28, 0
  s_mov_b32 s22, 0
  v_mov_b32 v7, 131072
  s_barrier
  s_mul_i32 s23, s16, 65536
  s_add_u32 s23, s23, s18
  s_add_u32 s24, s28, s38
  s_mov_b32 m0, s24
  s_nop 0
  buffer_load_dwordx4 v1, s[4:7], s23 offen offset:0 sc1 lds
  buffer_load_dwordx4 v1, s[4:7], s23 offen offset:1024 sc1 lds
  buffer_load_dwordx4 v1, s[4:7], s23 offen offset:2048 sc1 lds
  buffer_load_dwordx4 v1, s[4:7], s23 offen offset:3072 sc1 lds
  s_add_u32 s23, s23, 4096
  s_add_u32 s24, s24, 4096
  s_mov_b32 m0, s24
  s_nop 0
  buffer_load_dwordx4 v1, s[4:7], s23 offen offset:0 sc1 lds
  buffer_load_dwordx4 v1, s[4:7], s23 offen offset:1024 sc1 lds
  buffer_load_dwordx4 v1, s[4:7], s23 offen offset:2048 sc1 lds
  buffer_load_dwordx4 v1, s[4:7], s23 offen offset:3072 sc1 lds
  s_add_u32 s23, s23, 4096
  s_add_u32 s24, s24, 4096
  s_mov_b32 m0, s24
  s_nop 0
  buffer_load_dwordx4 v1, s[4:7], s23 offen offset:0 sc1 lds
  buffer_load_dwordx4 v1, s[4:7], s23 offen offset:1024 sc1 lds
  buffer_load_dwordx4 v1, s[4:7], s23 offen offset:2048 sc1 lds
  buffer_load_dwordx4 v1, s[4:7], s23 offen offset:3072 sc1 lds
  s_add_u32 s23, s23, 4096
  s_add_u32 s24, s24, 4096
  s_mov_b32 m0, s24
  s_nop 0
  buffer_load_dwordx4 v1, s[4:7], s23 offen offset:0 sc1 lds
  buffer_load_dwordx4 v1, s[4:7], s23 offen offset:1024 sc1 lds
  buffer_load_dwordx4 v1, s[4:7], s23 offen offset:2048 sc1 lds
  buffer_load_dwordx4 v1, s[4:7], s23 offen offset:3072 sc1 lds
  s_add_u32 s17, s16, 2
  v_mov_b32 v4, 0
  s_cmp_ge_u32 s17, 64
  s_cbranch_scc1 lf_202
  v_mov_b32 v4, 1
lf_202:
  s_waitcnt vmcnt(0)
  s_cmp_lg_u32 s14, 0
  s_cbranch_scc1 w0_206
  ds_write_b32 v7, v4
  s_waitcnt lgkmcnt(0)
w0_206:
  s_barrier
  ds_read_b32 v5, v7
  ds_read_b128 v[16:19], v2 offset:0
  ds_read_b128 v[20:23], v2 offset:1024
  ds_read_b128 v[24:27], v2 offset:2048
  ds_read_b128 v[28:31], v2 offset:3072
  ds_read_b128 v[32:35], v2 offset:4096
  ds_read_b128 v[36:39], v2 offset:5120
  ds_read_b128 v[40:43], v2 offset:6144
  v_xor_b32 v7, 4, v7
g1vdec_203:
  s_waitcnt lgkmcnt(7)
  v_readfirstlane_b32 s36, v5
  s_cmp_ge_u32 s36, 1
  s_cbranch_scc0 g1vnpre_204
  s_add_u32 s15, s17, 2
  v_mov_b32 v4, 0
  s_cmp_ge_u32 s15, 64
  s_cbranch_scc1 lf_207
  v_mov_b32 v4, 1
lf_207:
  s_mul_i32 s26, s17, 65536
  s_add_u32 s26, s26, s18
  s_xor_b32 s27, s28, 0x10000
  s_add_u32 s27, s27, s38
  s_waitcnt lgkmcnt(6)
  v_mfma_f32_32x32x16_bf16 v[48:63], v[16:19], a[0:3], 0
  ds_read_b128 v[44:47], v2 offset:7168
  s_mov_b32 m0, s27
  s_nop 0
  buffer_load_dwordx4 v1, s[4:7], s26 offen offset:0 sc1 lds
  s_waitcnt lgkmcnt(6)
  v_mfma_f32_32x32x16_bf16 v[48:63], v[20:23], a[4:7], v[48:63]
  ds_read_b128 v[16:19], v2 offset:8192
  s_waitcnt lgkmcnt(6)
  v_mfma_f32_32x32x16_bf16 v[48:63], v[24:27], a[8:11], v[48:63]
  ds_read_b128 v[20:23], v2 offset:9216
  buffer_load_dwordx4 v1, s[4:7], s26 offen offset:1024 sc1 lds
  s_waitcnt lgkmcnt(6)
  v_mfma_f32_32x32x16_bf16 v[48:63], v[28:31], a[12:15], v[48:63]
  ds_read_b128 v[24:27], v2 offset:10240
  s_waitcnt lgkmcnt(6)
  v_mfma_f32_32x32x16_bf16 v[48:63], v[32:35], a[16:19], v[48:63]
  ds_read_b128 v[28:31], v2 offset:11264
  buffer_load_dwordx4 v1, s[4:7], s26 offen offset:2048 sc1 lds
  s_waitcnt lgkmcnt(6)
  v_mfma_f32_32x32x16_bf16 v[48:63], v[36:39], a[20:23], v[48:63]
  ds_read_b128 v[32:35], v2 offset:12288
  s_waitcnt lgkmcnt(6)
  v_mfma_f32_32x32x16_bf16 v[48:63], v[40:43], a[24:27], v[48:63]
  ds_read_b128 v[36:39], v2 offset:13312
  buffer_load_dwordx4 v1, s[4:7], s26 offen offset:3072 sc1 lds
  s_add_u32 s26, s26, 4096
  s_add_u32 s27, s27, 4096
  s_waitcnt lgkmcnt(6)
  v_mfma_f32_32x32x16_bf16 v[48:63], v[44:47], a[28:31], v[48:63]
  ds_read_b128 v[40:43], v2 offset:14336
  s_waitcnt lgkmcnt(6)
  v_mfma_f32_32x32x16_bf16 v[48:63], v[16:19], a[32:35], v[48:63]
  ds_read_b128 v[44:47], v2 offset:15360
  s_mov_b32 m0, s27
  s_nop 0
  buffer_load_dwordx4 v1, s[4:7], s26 offen offset:0 sc1 lds
  s_waitcnt lgkmcnt(6)
  v_mfma_f32_32x32x16_bf16 v[48:63], v[20:23], a[36:39], v[48:63]
  ds_read_b128 v[16:19], v2 offset:16384
  s_waitcnt lgkmcnt(6)
  v_mfma_f32_32x32x16_bf16 v[48:63], v[24:27], a[40:43], v[48:63]
  ds_read_b128 v[20:23], v2 offset:17408
  buffer_load_dwordx4 v1, s[4:7], s26 offen offset:1024 sc1 lds
  s_waitcnt lgkmcnt(6)
  v_mfma_f32_32x32x16_bf16 v[48:63], v[28:31], a[44:47], v[48:63]
  ds_read_b128 v[24:27], v2 offset:18432
  s_waitcnt lgkmcnt(6)
  v_mfma_f32_32x32x16_bf16 v[48:63], v[32:35], a[48:51], v[48:63]
  ds_read_b128 v[28:31], v2 offset:19456
  buffer_load_dwordx4 v1, s[4:7], s26 offen offset:2048 sc1 lds
  s_waitcnt lgkmcnt(6)
  v_mfma_f32_32x32x16_bf16 v[48:63], v[36:39], a[52:55], v[48:63]
  ds_read_b128 v[32:35], v2 offset:20480
  s_waitcnt lgkmcnt(6)
  v_mfma_f32_32x32x16_bf16 v[48:63], v[40:43], a[56:59], v[48:63]
  ds_read_b128 v[36:39], v2 offset:21504
  buffer_load_dwordx4 v1, s[4:7], s26 offen offset:3072 sc1 lds
  s_add_u32 s26, s26, 4096
  s_add_u32 s27, s27, 4096
  s_waitcnt lgkmcnt(6)
  v_mfma_f32_32x32x16_bf16 v[48:63], v[44:47], a[60:63], v[48:63]
  ds_read_b128 v[40:43], v2 offset:22528
  s_waitcnt lgkmcnt(6)
  v_mfma_f32_32x32x16_bf16 v[48:63], v[16:19], a[64:67], v[48:63]
  ds_read_b128 v[44:47], v2 offset:23552
  s_mov_b32 m0, s27
  s_nop 0
  buffer_load_dwordx4 v1, s[4:7], s26 offen offset:0 sc1 lds
  s_waitcnt lgkmcnt(6)
  v_mfma_f32_32x32x16_bf16 v[48:63], v[20:23], a[68:71], v[48:63]
  ds_read_b128 v[16:19], v2 offset:24576
  s_waitcnt lgkmcnt(6)
  v_mfma_f32_32x32x16_bf16 v[48:63], v[24:27], a[72:75], v[48:63]
  ds_read_b128 v[20:23], v2 offset:25600
  buffer_load_dwordx4 v1, s[4:7], s26 offen offset:1024 sc1 lds
  s_waitcnt lgkmcnt(6)
  v_mfma_f32_32x32x16_bf16 v[48:63], v[28:31], a[76:79], v[48:63]
  ds_read_b128 v[24:27], v2 offset:26624
  s_waitcnt lgkmcnt(6)
  v_mfma_f32_32x32x16_bf16 v[48:63], v[32:35], a[80:83], v[48:63]
  ds_read_b128 v[28:31], v2 offset:27648
  buffer_load_dwordx4 v1, s[4:7], s26 offen offset:2048 sc1 lds
  s_waitcnt lgkmcnt(6)
  v_mfma_f32_32x32x16_bf16 v[48:63], v[36:39], a[84:87], v[48:63]
  ds_read_b128 v[32:35], v2 offset:28672
  s_waitcnt lgkmcnt(6)
  v_mfma_f32_32x32x16_bf16 v[48:63], v[40:43], a[88:91], v[48:63]
  ds_read_b128 v[36:39], v2 offset:29696
  buffer_load_dwordx4 v1, s[4:7], s26 offen offset:3072 sc1 lds
  s_add_u32 s26, s26, 4096
  s_add_u32 s27, s27, 4096
  s_waitcnt lgkmcnt(6)
  v_mfma_f32_32x32x16_bf16 v[48:63], v[44:47], a[92:95], v[48:63]
  ds_read_b128 v[40:43], v2 offset:30720
  s_waitcnt lgkmcnt(6)
  v_mfma_f32_32x32x16_bf16 v[48:63], v[16:19], a[96:99], v[48:63]
  ds_read_b128 v[44:47], v2 offset:31744
  s_cmp_eq_u32 s22, 0
  s_cbranch_scc1 nsig_208
  s_waitcnt vmcnt(12)
  s_barrier
  s_cmp_lg_u32 s14, 0
  s_cbranch_scc1 sig_209
  s_mov_b64 exec, 1
  buffer_atomic_add v6, off, s[4:7], s22 sc1
  s_mov_b64 exec, -1
sig_209:
  s_mov_b32 s22, 0
nsig_208:
  s_mov_b32 m0, s27
  s_nop 0
  buffer_load_dwordx4 v1, s[4:7], s26 offen offset:0 sc1 lds
  s_waitcnt lgkmcnt(6)
  v_mfma_f32_32x32x16_bf16 v[48:63], v[20:23], a[100:103], v[48:63]
  ds_read_b128 v[16:19], v2 offset:32768
  s_waitcnt lgkmcnt(6)
  v_mfma_f32_32x32x16_bf16 v[48:63], v[24:27], a[104:107], v[48:63]
  ds_read_b128 v[20:23], v2 offset:33792
  buffer_load_dwordx4 v1, s[4:7], s26 offen offset:1024 sc1 lds
  s_waitcnt lgkmcnt(6)
  v_mfma_f32_32x32x16_bf16 v[48:63], v[28:31], a[108:111], v[48:63]
  ds_read_b128 v[24:27], v2 offset:34816
  s_waitcnt lgkmcnt(6)
  v_mfma_f32_32x32x16_bf16 v[48:63], v[32:35], a[112:115], v[48:63]
  ds_read_b128 v[28:31], v2 offset:35840
  buffer_load_dwordx4 v1, s[4:7], s26 offen offset:2048 sc1 lds
  s_waitcnt lgkmcnt(6)
  v_mfma_f32_32x32x16_bf16 v[48:63], v[36:39], a[116:119], v[48:63]
  ds_read_b128 v[32:35], v2 offset:36864
  s_waitcnt lgkmcnt(6)
  v_mfma_f32_32x32x16_bf16 v[48:63], v[40:43], a[120:123], v[48:63]
  ds_read_b128 v[36:39], v2 offset:37888
  buffer_load_dwordx4 v1, s[4:7], s26 offen offset:3072 sc1 lds
  s_waitcnt lgkmcnt(6)
  v_mfma_f32_32x32x16_bf16 v[48:63], v[44:47], a[124:127], v[48:63]
  ds_read_b128 v[40:43], v2 offset:38912
  s_waitcnt lgkmcnt(6)
  v_mfma_f32_32x32x16_bf16 v[48:63], v[16:19], a[128:131], v[48:63]
  ds_read_b128 v[44:47], v2 offset:39936
  s_waitcnt lgkmcnt(6)
  v_mfma_f32_32x32x16_bf16 v[48:63], v[20:23], a[132:135], v[48:63]
  ds_read_b128 v[16:19], v2 offset:40960
  s_waitcnt lgkmcnt(6)
  v_mfma_f32_32x32x16_bf16 v[48:63], v[24:27], a[136:139], v[48:63]
  ds_read_b128 v[20:23], v2 offset:41984
  s_waitcnt lgkmcnt(6)
  v_mfma_f32_32x32x16_bf16 v[48:63], v[28:31], a[140:143], v[48:63]
  ds_read_b128 v[24:27], v2 offset:43008
  s_waitcnt lgkmcnt(6)
  v_mfma_f32_32x32x16_bf16 v[48:63], v[32:35], a[144:147], v[48:63]
  ds_read_b128 v[28:31], v2 offset:44032
  s_waitcnt lgkmcnt(6)
  v_mfma_f32_32x32x16_bf16 v[48:63], v[36:39], a[148:151], v[48:63]
  ds_read_b128 v[32:35], v2 offset:45056
  s_waitcnt lgkmcnt(6)
  v_mfma_f32_32x32x16_bf16 v[48:63], v[40:43], a[152:155], v[48:63]
  ds_read_b128 v[36:39], v2 offset:46080
  s_waitcnt lgkmcnt(6)
  v_mfma_f32_32x32x16_bf16 v[48:63], v[44:47], a[156:159], v[48:63]
  ds_read_b128 v[40:43], v2 offset:47104
  s_waitcnt lgkmcnt(6)
  v_mfma_f32_32x32x16_bf16 v[48:63], v[16:19], a[160:163], v[48:63]
  ds_read_b128 v[44:47], v2 offset:48128
  s_waitcnt lgkmcnt(6)
  v_mfma_f32_32x32x16_bf16 v[48:63], v[20:23], a[164:167], v[48:63]
  ds_read_b128 v[16:19], v2 offset:49152
  s_waitcnt lgkmcnt(6)
  v_mfma_f32_32x32x16_bf16 v[48:63], v[24:27], a[168:171], v[48:63]
  ds_read_b128 v[20:23], v2 offset:50176
  s_waitcnt lgkmcnt(6)
  v_mfma_f32_32x32x16_bf16 v[48:63], v[28:31], a[172:175], v[48:63]
  ds_read_b128 v[24:27], v2 offset:51200
  s_waitcnt lgkmcnt(6)
  v_mfma_f32_32x32x16_bf16 v[48:63], v[32:35], a[176:179], v[48:63]
  ds_read_b128 v[28:31], v2 offset:52224
  s_cmp_lg_u32 s14, 0
  s_cbranch_scc1 w0_210
  ds_write_b32 v7, v4
w0_210:
  s_waitcnt lgkmcnt(6)
  v_mfma_f32_32x32x16_bf16 v[48:63], v[36:39], a[180:183], v[48:63]
  ds_read_b128 v[32:35], v2 offset:53248
  s_waitcnt lgkmcnt(6)
  v_mfma_f32_32x32x16_bf16 v[48:63], v[40:43], a[184:187], v[48:63]
  ds_read_b128 v[36:39], v2 offset:54272
  s_waitcnt lgkmcnt(6)
  v_mfma_f32_32x32x16_bf16 v[48:63], v[44:47], a[188:191], v[48:63]
  ds_read_b128 v[40:43], v2 offset:55296
  s_waitcnt lgkmcnt(6)
  v_mfma_f32_32x32x16_bf16 v[48:63], v[16:19], a[192:195], v[48:63]
  ds_read_b128 v[44:47], v2 offset:56320
  s_waitcnt lgkmcnt(6)
  v_mfma_f32_32x32x16_bf16 v[48:63], v[20:23], a[196:199], v[48:63]
  ds_read_b128 v[16:19], v2 offset:57344
  s_waitcnt lgkmcnt(6)
  v_mfma_f32_32x32x16_bf16 v[48:63], v[24:27], a[200:203], v[48:63]
  ds_read_b128 v[20:23], v2 offset:58368
  s_waitcnt lgkmcnt(6)
  v_mfma_f32_32x32x16_bf16 v[48:63], v[28:31], a[204:207], v[48:63]
  ds_read_b128 v[24:27], v2 offset:59392
  s_waitcnt lgkmcnt(6)
  v_mfma_f32_32x32x16_bf16 v[48:63], v[32:35], a[208:211], v[48:63]
  ds_read_b128 v[28:31], v2 offset:60416
  s_waitcnt lgkmcnt(6)
  v_mfma_f32_32x32x16_bf16 v[48:63], v[36:39], a[212:215], v[48:63]
  ds_read_b128 v[32:35], v2 offset:61440
  s_waitcnt lgkmcnt(6)
  v_mfma_f32_32x32x16_bf16 v[48:63], v[40:43], a[216:219], v[48:63]
  ds_read_b128 v[36:39], v2 offset:62464
  s_waitcnt lgkmcnt(6)
  v_mfma_f32_32x32x16_bf16 v[48:63], v[44:47], a[220:223], v[48:63]
  ds_read_b128 v[40:43], v2 offset:63488
  s_waitcnt lgkmcnt(6)
  v_mfma_f32_32x32x16_bf16 v[48:63], v[16:19], a[224:227], v[48:63]
  ds_read_b128 v[44:47], v2 offset:64512
  s_waitcnt lgkmcnt(6)
  v_mfma_f32_32x32x16_bf16 v[48:63], v[20:23], a[228:231], v[48:63]
  s_waitcnt lgkmcnt(5)
  v_mfma_f32_32x32x16_bf16 v[48:63], v[24:27], a[232:235], v[48:63]
  s_waitcnt lgkmcnt(4)
  v_mfma_f32_32x32x16_bf16 v[48:63], v[28:31], a[236:239], v[48:63]
  s_waitcnt lgkmcnt(3)
  v_mfma_f32_32x32x16_bf16 v[48:63], v[32:35], a[240:243], v[48:63]
  s_waitcnt lgkmcnt(2)
  v_mfma_f32_32x32x16_bf16 v[48:63], v[36:39], a[244:247], v[48:63]
  s_waitcnt lgkmcnt(1)
  v_mfma_f32_32x32x16_bf16 v[48:63], v[40:43], a[248:251], v[48:63]
  s_waitcnt lgkmcnt(0)
  v_mfma_f32_32x32x16_bf16 v[48:63], v[44:47], a[252:255], v[48:63]
  s_waitcnt vmcnt(0)
  s_barrier
  v_xor_b32 v2, 0x10000, v2
  ds_read_b32 v5, v7
  ds_read_b128 v[16:19], v2 offset:0
  ds_read_b128 v[20:23], v2 offset:1024
  ds_read_b128 v[24:27], v2 offset:2048
  ds_read_b128 v[28:31], v2 offset:3072
  ds_read_b128 v[32:35], v2 offset:4096
  ds_read_b128 v[36:39], v2 offset:5120
  ds_read_b128 v[40:43], v2 offset:6144
  v_xor_b32 v7, 4, v7
  s_mul_i32 s23, s16, 262144
  s_add_u32 s23, s23, s19
  v_cvt_pk_bf16_f32 v80, v48, v49
  v_cvt_pk_bf16_f32 v81, v50, v51
  v_cvt_pk_bf16_f32 v82, v52, v53
  v_cvt_pk_bf16_f32 v83, v54, v55
  v_cvt_pk_bf16_f32 v84, v56, v57
  v_cvt_pk_bf16_f32 v85, v58, v59
  v_cvt_pk_bf16_f32 v86, v60, v61
  v_cvt_pk_bf16_f32 v87, v62, v63
  buffer_store_dwordx4 v[80:83], v3, s[4:7], s23 offen sc1
  buffer_store_dwordx4 v[84:87], v3, s[4:7], s23 offen offset:1024 sc1
  s_cmp_lt_u32 s16, 57
  s_cbranch_scc1 mark_211
  s_lshl_b32 s24, s16, 16
  s_add_u32 s24, s24, s52
  buffer_store_dwordx2 v[10:11], v12, s[4:7], s24 offen sc1
mark_211:
  s_mul_i32 s22, s16, 512
  s_add_u32 s22, s22, s21
  s_mov_b32 s16, s17
  s_add_u32 s17, s16, 2
  s_xor_b32 s28, s28, 0x10000
  s_branch g1vdec_203
g1vnpre_204:
  s_waitcnt lgkmcnt(6)
  v_mfma_f32_32x32x16_bf16 v[48:63], v[16:19], a[0:3], 0
  ds_read_b128 v[44:47], v2 offset:7168
  s_waitcnt lgkmcnt(6)
  v_mfma_f32_32x32x16_bf16 v[48:63], v[20:23], a[4:7], v[48:63]
  ds_read_b128 v[16:19], v2 offset:8192
  s_waitcnt lgkmcnt(6)
  v_mfma_f32_32x32x16_bf16 v[48:63], v[24:27], a[8:11], v[48:63]
  ds_read_b128 v[20:23], v2 offset:9216
  s_waitcnt lgkmcnt(6)
  v_mfma_f32_32x32x16_bf16 v[48:63], v[28:31], a[12:15], v[48:63]
  ds_read_b128 v[24:27], v2 offset:10240
  s_waitcnt lgkmcnt(6)
  v_mfma_f32_32x32x16_bf16 v[48:63], v[32:35], a[16:19], v[48:63]
  ds_read_b128 v[28:31], v2 offset:11264
  s_waitcnt lgkmcnt(6)
  v_mfma_f32_32x32x16_bf16 v[48:63], v[36:39], a[20:23], v[48:63]
  ds_read_b128 v[32:35], v2 offset:12288
  s_waitcnt lgkmcnt(6)
  v_mfma_f32_32x32x16_bf16 v[48:63], v[40:43], a[24:27], v[48:63]
  ds_read_b128 v[36:39], v2 offset:13312
  s_waitcnt lgkmcnt(6)
  v_mfma_f32_32x32x16_bf16 v[48:63], v[44:47], a[28:31], v[48:63]
  ds_read_b128 v[40:43], v2 offset:14336
  s_waitcnt lgkmcnt(6)
  v_mfma_f32_32x32x16_bf16 v[48:63], v[16:19], a[32:35], v[48:63]
  ds_read_b128 v[44:47], v2 offset:15360
  s_waitcnt lgkmcnt(6)
  v_mfma_f32_32x32x16_bf16 v[48:63], v[20:23], a[36:39], v[48:63]
  ds_read_b128 v[16:19], v2 offset:16384
  s_waitcnt lgkmcnt(6)
  v_mfma_f32_32x32x16_bf16 v[48:63], v[24:27], a[40:43], v[48:63]
  ds_read_b128 v[20:23], v2 offset:17408
  s_waitcnt lgkmcnt(6)
  v_mfma_f32_32x32x16_bf16 v[48:63], v[28:31], a[44:47], v[48:63]
  ds_read_b128 v[24:27], v2 offset:18432
  s_waitcnt lgkmcnt(6)
  v_mfma_f32_32x32x16_bf16 v[48:63], v[32:35], a[48:51], v[48:63]
  ds_read_b128 v[28:31], v2 offset:19456
  s_waitcnt lgkmcnt(6)
  v_mfma_f32_32x32x16_bf16 v[48:63], v[36:39], a[52:55], v[48:63]
  ds_read_b128 v[32:35], v2 offset:20480
  s_waitcnt lgkmcnt(6)
  v_mfma_f32_32x32x16_bf16 v[48:63], v[40:43], a[56:59], v[48:63]
  ds_read_b128 v[36:39], v2 offset:21504
  s_waitcnt lgkmcnt(6)
  v_mfma_f32_32x32x16_bf16 v[48:63], v[44:47], a[60:63], v[48:63]
  ds_read_b128 v[40:43], v2 offset:22528
  s_waitcnt lgkmcnt(6)
  v_mfma_f32_32x32x16_bf16 v[48:63], v[16:19], a[64:67], v[48:63]
  ds_read_b128 v[44:47], v2 offset:23552
  s_waitcnt lgkmcnt(6)
  v_mfma_f32_32x32x16_bf16 v[48:63], v[20:23], a[68:71], v[48:63]
  ds_read_b128 v[16:19], v2 offset:24576
  s_waitcnt lgkmcnt(6)
  v_mfma_f32_32x32x16_bf16 v[48:63], v[24:27], a[72:75], v[48:63]
  ds_read_b128 v[20:23], v2 offset:25600
  s_waitcnt lgkmcnt(6)
  v_mfma_f32_32x32x16_bf16 v[48:63], v[28:31], a[76:79], v[48:63]
  ds_read_b128 v[24:27], v2 offset:26624
  s_waitcnt lgkmcnt(6)
  v_mfma_f32_32x32x16_bf16 v[48:63], v[32:35], a[80:83], v[48:63]
  ds_read_b128 v[28:31], v2 offset:27648
  s_waitcnt lgkmcnt(6)
  v_mfma_f32_32x32x16_bf16 v[48:63], v[36:39], a[84:87], v[48:63]
  ds_read_b128 v[32:35], v2 offset:28672
  s_waitcnt lgkmcnt(6)
  v_mfma_f32_32x32x16_bf16 v[48:63], v[40:43], a[88:91], v[48:63]
  ds_read_b128 v[36:39], v2 offset:29696
  s_waitcnt lgkmcnt(6)
  v_mfma_f32_32x32x16_bf16 v[48:63], v[44:47], a[92:95], v[48:63]
  ds_read_b128 v[40:43], v2 offset:30720
  s_waitcnt lgkmcnt(6)
  v_mfma_f32_32x32x16_bf16 v[48:63], v[16:19], a[96:99], v[48:63]
  ds_read_b128 v[44:47], v2 offset:31744
  s_cmp_eq_u32 s22, 0
  s_cbranch_scc1 nsig_212
  s_waitcnt vmcnt(0)
  s_barrier
  s_cmp_lg_u32 s14, 0
  s_cbranch_scc1 sig_213
  s_mov_b64 exec, 1
  buffer_atomic_add v6, off, s[4:7], s22 sc1
  s_mov_b64 exec, -1
sig_213:
  s_mov_b32 s22, 0
nsig_212:
  s_waitcnt lgkmcnt(6)
  v_mfma_f32_32x32x16_bf16 v[48:63], v[20:23], a[100:103], v[48:63]
  ds_read_b128 v[16:19], v2 offset:32768
  s_waitcnt lgkmcnt(6)
  v_mfma_f32_32x32x16_bf16 v[48:63], v[24:27], a[104:107], v[48:63]
  ds_read_b128 v[20:23], v2 offset:33792
  s_waitcnt lgkmcnt(6)
  v_mfma_f32_32x32x16_bf16 v[48:63], v[28:31], a[108:111], v[48:63]
  ds_read_b128 v[24:27], v2 offset:34816
  s_waitcnt lgkmcnt(6)
  v_mfma_f32_32x32x16_bf16 v[48:63], v[32:35], a[112:115], v[48:63]
  ds_read_b128 v[28:31], v2 offset:35840
  s_waitcnt lgkmcnt(6)
  v_mfma_f32_32x32x16_bf16 v[48:63], v[36:39], a[116:119], v[48:63]
  ds_read_b128 v[32:35], v2 offset:36864
  s_waitcnt lgkmcnt(6)
  v_mfma_f32_32x32x16_bf16 v[48:63], v[40:43], a[120:123], v[48:63]
  ds_read_b128 v[36:39], v2 offset:37888
  s_waitcnt lgkmcnt(6)
  v_mfma_f32_32x32x16_bf16 v[48:63], v[44:47], a[124:127], v[48:63]
  ds_read_b128 v[40:43], v2 offset:38912
  s_waitcnt lgkmcnt(6)
  v_mfma_f32_32x32x16_bf16 v[48:63], v[16:19], a[128:131], v[48:63]
  ds_read_b128 v[44:47], v2 offset:39936
  s_waitcnt lgkmcnt(6)
  v_mfma_f32_32x32x16_bf16 v[48:63], v[20:23], a[132:135], v[48:63]
  ds_read_b128 v[16:19], v2 offset:40960
  s_waitcnt lgkmcnt(6)
  v_mfma_f32_32x32x16_bf16 v[48:63], v[24:27], a[136:139], v[48:63]
  ds_read_b128 v[20:23], v2 offset:41984
  s_waitcnt lgkmcnt(6)
  v_mfma_f32_32x32x16_bf16 v[48:63], v[28:31], a[140:143], v[48:63]
  ds_read_b128 v[24:27], v2 offset:43008
  s_waitcnt lgkmcnt(6)
  v_mfma_f32_32x32x16_bf16 v[48:63], v[32:35], a[144:147], v[48:63]
  ds_read_b128 v[28:31], v2 offset:44032
  s_waitcnt lgkmcnt(6)
  v_mfma_f32_32x32x16_bf16 v[48:63], v[36:39], a[148:151], v[48:63]
  ds_read_b128 v[32:35], v2 offset:45056
  s_waitcnt lgkmcnt(6)
  v_mfma_f32_32x32x16_bf16 v[48:63], v[40:43], a[152:155], v[48:63]
  ds_read_b128 v[36:39], v2 offset:46080
  s_waitcnt lgkmcnt(6)
  v_mfma_f32_32x32x16_bf16 v[48:63], v[44:47], a[156:159], v[48:63]
  ds_read_b128 v[40:43], v2 offset:47104
  s_waitcnt lgkmcnt(6)
  v_mfma_f32_32x32x16_bf16 v[48:63], v[16:19], a[160:163], v[48:63]
  ds_read_b128 v[44:47], v2 offset:48128
  s_waitcnt lgkmcnt(6)
  v_mfma_f32_32x32x16_bf16 v[48:63], v[20:23], a[164:167], v[48:63]
  ds_read_b128 v[16:19], v2 offset:49152
  s_waitcnt lgkmcnt(6)
  v_mfma_f32_32x32x16_bf16 v[48:63], v[24:27], a[168:171], v[48:63]
  ds_read_b128 v[20:23], v2 offset:50176
  s_waitcnt lgkmcnt(6)
  v_mfma_f32_32x32x16_bf16 v[48:63], v[28:31], a[172:175], v[48:63]
  ds_read_b128 v[24:27], v2 offset:51200
  s_waitcnt lgkmcnt(6)
  v_mfma_f32_32x32x16_bf16 v[48:63], v[32:35], a[176:179], v[48:63]
  ds_read_b128 v[28:31], v2 offset:52224
  s_waitcnt lgkmcnt(6)
  v_mfma_f32_32x32x16_bf16 v[48:63], v[36:39], a[180:183], v[48:63]
  ds_read_b128 v[32:35], v2 offset:53248
  s_waitcnt lgkmcnt(6)
  v_mfma_f32_32x32x16_bf16 v[48:63], v[40:43], a[184:187], v[48:63]
  ds_read_b128 v[36:39], v2 offset:54272
  s_waitcnt lgkmcnt(6)
  v_mfma_f32_32x32x16_bf16 v[48:63], v[44:47], a[188:191], v[48:63]
  ds_read_b128 v[40:43], v2 offset:55296
  s_waitcnt lgkmcnt(6)
  v_mfma_f32_32x32x16_bf16 v[48:63], v[16:19], a[192:195], v[48:63]
  ds_read_b128 v[44:47], v2 offset:56320
  s_waitcnt lgkmcnt(6)
  v_mfma_f32_32x32x16_bf16 v[48:63], v[20:23], a[196:199], v[48:63]
  ds_read_b128 v[16:19], v2 offset:57344
  s_waitcnt lgkmcnt(6)
  v_mfma_f32_32x32x16_bf16 v[48:63], v[24:27], a[200:203], v[48:63]
  ds_read_b128 v[20:23], v2 offset:58368
  s_waitcnt lgkmcnt(6)
  v_mfma_f32_32x32x16_bf16 v[48:63], v[28:31], a[204:207], v[48:63]
  ds_read_b128 v[24:27], v2 offset:59392
  s_waitcnt lgkmcnt(6)
  v_mfma_f32_32x32x16_bf16 v[48:63], v[32:35], a[208:211], v[48:63]
  ds_read_b128 v[28:31], v2 offset:60416
  s_waitcnt lgkmcnt(6)
  v_mfma_f32_32x32x16_bf16 v[48:63], v[36:39], a[212:215], v[48:63]
  ds_read_b128 v[32:35], v2 offset:61440
  s_waitcnt lgkmcnt(6)
  v_mfma_f32_32x32x16_bf16 v[48:63], v[40:43], a[216:219], v[48:63]
  ds_read_b128 v[36:39], v2 offset:62464
  s_waitcnt lgkmcnt(6)
  v_mfma_f32_32x32x16_bf16 v[48:63], v[44:47], a[220:223], v[48:63]
  ds_read_b128 v[40:43], v2 offset:63488
  s_waitcnt lgkmcnt(6)
  v_mfma_f32_32x32x16_bf16 v[48:63], v[16:19], a[224:227], v[48:63]
  ds_read_b128 v[44:47], v2 offset:64512
  s_waitcnt lgkmcnt(6)
  v_mfma_f32_32x32x16_bf16 v[48:63], v[20:23], a[228:231], v[48:63]
  s_waitcnt lgkmcnt(5)
  v_mfma_f32_32x32x16_bf16 v[48:63], v[24:27], a[232:235], v[48:63]
  s_waitcnt lgkmcnt(4)
  v_mfma_f32_32x32x16_bf16 v[48:63], v[28:31], a[236:239], v[48:63]
  s_waitcnt lgkmcnt(3)
  v_mfma_f32_32x32x16_bf16 v[48:63], v[32:35], a[240:243], v[48:63]
  s_waitcnt lgkmcnt(2)
  v_mfma_f32_32x32x16_bf16 v[48:63], v[36:39], a[244:247], v[48:63]
  s_waitcnt lgkmcnt(1)
  v_mfma_f32_32x32x16_bf16 v[48:63], v[40:43], a[248:251], v[48:63]
  s_waitcnt lgkmcnt(0)
  v_mfma_f32_32x32x16_bf16 v[48:63], v[44:47], a[252:255], v[48:63]
g1vepi_214:
  s_mul_i32 s23, s16, 262144
  s_add_u32 s23, s23, s19
  s_nop 9
  v_cvt_pk_bf16_f32 v80, v48, v49
  v_cvt_pk_bf16_f32 v81, v50, v51
  v_cvt_pk_bf16_f32 v82, v52, v53
  v_cvt_pk_bf16_f32 v83, v54, v55
  v_cvt_pk_bf16_f32 v84, v56, v57
  v_cvt_pk_bf16_f32 v85, v58, v59
  v_cvt_pk_bf16_f32 v86, v60, v61
  v_cvt_pk_bf16_f32 v87, v62, v63
  buffer_store_dwordx4 v[80:83], v3, s[4:7], s23 offen sc1
  buffer_store_dwordx4 v[84:87], v3, s[4:7], s23 offen offset:1024 sc1
  s_cmp_lt_u32 s16, 57
  s_cbranch_scc1 mark_215
  s_lshl_b32 s24, s16, 16
  s_add_u32 s24, s24, s52
  buffer_store_dwordx2 v[10:11], v12, s[4:7], s24 offen sc1
mark_215:
  s_mul_i32 s25, s16, 512
  s_add_u32 s25, s25, s21
  s_waitcnt vmcnt(0)
  s_barrier
  s_cmp_lg_u32 s14, 0
  s_cbranch_scc1 sig_216
  s_mov_b64 exec, 1
  buffer_atomic_add v6, off, s[4:7], s25 sc1
  s_mov_b64 exec, -1
sig_216:
  s_cmp_ge_u32 s17, 64
  s_cbranch_scc1 g1vdone_205
  s_mul_i32 s23, s17, 65536
  s_add_u32 s23, s23, s18
  s_xor_b32 s24, s28, 0x10000
  s_add_u32 s24, s24, s38
  s_mov_b32 m0, s24
  s_nop 0
  buffer_load_dwordx4 v1, s[4:7], s23 offen offset:0 sc1 lds
  buffer_load_dwordx4 v1, s[4:7], s23 offen offset:1024 sc1 lds
  buffer_load_dwordx4 v1, s[4:7], s23 offen offset:2048 sc1 lds
  buffer_load_dwordx4 v1, s[4:7], s23 offen offset:3072 sc1 lds
  s_add_u32 s23, s23, 4096
  s_add_u32 s24, s24, 4096
  s_mov_b32 m0, s24
  s_nop 0
  buffer_load_dwordx4 v1, s[4:7], s23 offen offset:0 sc1 lds
  buffer_load_dwordx4 v1, s[4:7], s23 offen offset:1024 sc1 lds
  buffer_load_dwordx4 v1, s[4:7], s23 offen offset:2048 sc1 lds
  buffer_load_dwordx4 v1, s[4:7], s23 offen offset:3072 sc1 lds
  s_add_u32 s23, s23, 4096
  s_add_u32 s24, s24, 4096
  s_mov_b32 m0, s24
  s_nop 0
  buffer_load_dwordx4 v1, s[4:7], s23 offen offset:0 sc1 lds
  buffer_load_dwordx4 v1, s[4:7], s23 offen offset:1024 sc1 lds
  buffer_load_dwordx4 v1, s[4:7], s23 offen offset:2048 sc1 lds
  buffer_load_dwordx4 v1, s[4:7], s23 offen offset:3072 sc1 lds
  s_add_u32 s23, s23, 4096
  s_add_u32 s24, s24, 4096
  s_mov_b32 m0, s24
  s_nop 0
  buffer_load_dwordx4 v1, s[4:7], s23 offen offset:0 sc1 lds
  buffer_load_dwordx4 v1, s[4:7], s23 offen offset:1024 sc1 lds
  buffer_load_dwordx4 v1, s[4:7], s23 offen offset:2048 sc1 lds
  buffer_load_dwordx4 v1, s[4:7], s23 offen offset:3072 sc1 lds
  s_mov_b32 s16, s17
  s_add_u32 s17, s16, 2
  s_xor_b32 s28, s28, 0x10000
  v_mov_b32 v4, 0
  s_cmp_ge_u32 s17, 64
  s_cbranch_scc1 lf_217
  v_mov_b32 v4, 1
lf_217:
  s_waitcnt vmcnt(0)
  s_cmp_lg_u32 s14, 0
  s_cbranch_scc1 w0_218
  ds_write_b32 v7, v4
  s_waitcnt lgkmcnt(0)
w0_218:
  s_barrier
  v_xor_b32 v2, 0x10000, v2
  ds_read_b32 v5, v7
  ds_read_b128 v[16:19], v2 offset:0
  ds_read_b128 v[20:23], v2 offset:1024
  ds_read_b128 v[24:27], v2 offset:2048
  ds_read_b128 v[28:31], v2 offset:3072
  ds_read_b128 v[32:35], v2 offset:4096
  ds_read_b128 v[36:39], v2 offset:5120
  ds_read_b128 v[40:43], v2 offset:6144
  v_xor_b32 v7, 4, v7
  s_branch g1vdec_203
g1vdone_205:
  s_waitcnt vmcnt(0)
  s_barrier
g1e_179:
  s_lshr_b32 s43, s37, 5
  s_mov_b32 s44, 0
  s_cmp_eq_u32 s43, 0
  s_cselect_b32 s44, 0x15140504, s44
  s_cmp_eq_u32 s43, 1
  s_cselect_b32 s44, 0x130f0706, s44
  s_cmp_eq_u32 s43, 2
  s_cselect_b32 s44, 0x16080100, s44
  s_cmp_eq_u32 s43, 3
  s_cselect_b32 s44, 0x17090302, s44
  s_cmp_eq_u32 s43, 4
  s_cselect_b32 s44, 0x11100b0a, s44
  s_cmp_eq_u32 s43, 5
  s_cselect_b32 s44, 0x120e0d0c, s44
  s_lshr_b32 s43, s37, 3
  s_and_b32 s43, s43, 3
  s_lshl_b32 s43, s43, 3
  s_lshr_b32 s44, s44, s43
  s_and_b32 s44, s44, 0xff
  s_lshl_b32 s44, s44, 3
  s_and_b32 s37, s37, 7
  s_or_b32 s37, s37, s44
  s_and_b32 s43, s37, 31
  s_cmp_ge_u32 s37, 160
  s_cbranch_scc1 rc_222
  s_cmp_ge_u32 s37, 128
  s_cbranch_scc1 r2_221
  s_cmp_ge_u32 s37, 64
  s_cbranch_scc1 r4_220
  s_cmp_ge_u32 s37, 32
  s_cbranch_scc1 r5_219
  s_lshr_b32 s40, s43, 3
  s_and_b32 s41, s43, 7
  s_load_dwordx2 s[8:9], s[0:1], 40
  s_waitcnt lgkmcnt(0)
  s_mov_b32 s10, 8388608
  s_mov_b32 s11, 0x00020000
  s_lshl_b32 s42, s41, 2
  s_add_u32 s42, s42, s14
  s_mul_i32 s39, s40, 2097152
  s_lshl_b32 s23, s42, 6
  s_add_u32 s39, s39, s23
  s_lshl_b32 s19, s40, 22
  s_add_u32 s19, s19, 100663296
  s_lshl_b32 s23, s42, 11
  s_add_u32 s19, s19, s23
  v_and_b32 v8, 63, v0
  v_lshlrev_b32 v1, 4, v8
  v_mov_b32 v2, v1
  v_mov_b32 v3, v1
  v_mov_b32 v6, 1
  v_and_b32 v10, 63, v0
  v_lshrrev_b32 v11, 2, v10
  s_mov_b32 s23, 2048
  v_mul_lo_u32 v11, v11, s23
  v_and_b32 v12, 3, v10
  v_lshl_add_u32 v8, v12, 4, v11
  s_lshl_b32 s24, s14, 15
  v_lshrrev_b32 v11, 5, v10
  v_lshlrev_b32 v11, 9, v11
  v_lshrrev_b32 v12, 2, v10
  v_and_b32 v12, 3, v12
  v_lshl_add_u32 v11, v12, 6, v11
  v_lshrrev_b32 v12, 4, v10
  v_and_b32 v12, 1, v12
  v_lshl_add_u32 v11, v12, 5, v11
  v_and_b32 v12, 1, v10
  v_lshl_add_u32 v11, v12, 4, v11
  v_lshrrev_b32 v12, 1, v10
  v_and_b32 v12, 1, v12
  v_lshl_add_u32 v11, v12, 3, v11
  v_add_u32 v9, s24, v11
  s_mov_b32 s23, s39
  s_add_u32 m0, s24, 0
  s_nop 0
  buffer_load_dwordx4 v8, s[8:11], s23 offen lds
  s_add_u32 s23, s23, 32768
  s_add_u32 m0, s24, 1024
  s_nop 0
  buffer_load_dwordx4 v8, s[8:11], s23 offen lds
  s_add_u32 s23, s23, 32768
  s_add_u32 m0, s24, 2048
  s_nop 0
  buffer_load_dwordx4 v8, s[8:11], s23 offen lds
  s_add_u32 s23, s23, 32768
  s_add_u32 m0, s24, 3072
  s_nop 0
  buffer_load_dwordx4 v8, s[8:11], s23 offen lds
  s_add_u32 s23, s23, 32768
  s_add_u32 m0, s24, 4096
  s_nop 0
  buffer_load_dwordx4 v8, s[8:11], s23 offen lds
  s_add_u32 s23, s23, 32768
  s_add_u32 m0, s24, 5120
  s_nop 0
  buffer_load_dwordx4 v8, s[8:11], s23 offen lds
  s_add_u32 s23, s23, 32768
  s_add_u32 m0, s24, 6144
  s_nop 0
  buffer_load_dwordx4 v8, s[8:11], s23 offen lds
  s_add_u32 s23, s23, 32768
  s_add_u32 m0, s24, 7168
  s_nop 0
  buffer_load_dwordx4 v8, s[8:11], s23 offen lds
  s_add_u32 s23, s23, 32768
  s_add_u32 m0, s24, 8192
  s_nop 0
  buffer_load_dwordx4 v8, s[8:11], s23 offen lds
  s_add_u32 s23, s23, 32768
  s_add_u32 m0, s24, 9216
  s_nop 0
  buffer_load_dwordx4 v8, s[8:11], s23 offen lds
  s_add_u32 s23, s23, 32768
  s_add_u32 m0, s24, 10240
  s_nop 0
  buffer_load_dwordx4 v8, s[8:11], s23 offen lds
  s_add_u32 s23, s23, 32768
  s_add_u32 m0, s24, 11264
  s_nop 0
  buffer_load_dwordx4 v8, s[8:11], s23 offen lds
  s_add_u32 s23, s23, 32768
  s_add_u32 m0, s24, 12288
  s_nop 0
  buffer_load_dwordx4 v8, s[8:11], s23 offen lds
  s_add_u32 s23, s23, 32768
  s_add_u32 m0, s24, 13312
  s_nop 0
  buffer_load_dwordx4 v8, s[8:11], s23 offen lds
  s_add_u32 s23, s23, 32768
  s_add_u32 m0, s24, 14336
  s_nop 0
  buffer_load_dwordx4 v8, s[8:11], s23 offen lds
  s_add_u32 s23, s23, 32768
  s_add_u32 m0, s24, 15360
  s_nop 0
  buffer_load_dwordx4 v8, s[8:11], s23 offen lds
  s_add_u32 s23, s23, 32768
  s_add_u32 m0, s24, 16384
  s_nop 0
  buffer_load_dwordx4 v8, s[8:11], s23 offen lds
  s_add_u32 s23, s23, 32768
  s_add_u32 m0, s24, 17408
  s_nop 0
  buffer_load_dwordx4 v8, s[8:11], s23 offen lds
  s_add_u32 s23, s23, 32768
  s_add_u32 m0, s24, 18432
  s_nop 0
  buffer_load_dwordx4 v8, s[8:11], s23 offen lds
  s_add_u32 s23, s23, 32768
  s_add_u32 m0, s24, 19456
  s_nop 0
  buffer_load_dwordx4 v8, s[8:11], s23 offen lds
  s_add_u32 s23, s23, 32768
  s_add_u32 m0, s24, 20480
  s_nop 0
  buffer_load_dwordx4 v8, s[8:11], s23 offen lds
  s_add_u32 s23, s23, 32768
  s_add_u32 m0, s24, 21504
  s_nop 0
  buffer_load_dwordx4 v8, s[8:11], s23 offen lds
  s_add_u32 s23, s23, 32768
  s_add_u32 m0, s24, 22528
  s_nop 0
  buffer_load_dwordx4 v8, s[8:11], s23 offen lds
  s_add_u32 s23, s23, 32768
  s_add_u32 m0, s24, 23552
  s_nop 0
  buffer_load_dwordx4 v8, s[8:11], s23 offen lds
  s_add_u32 s23, s23, 32768
  s_add_u32 m0, s24, 24576
  s_nop 0
  buffer_load_dwordx4 v8, s[8:11], s23 offen lds
  s_add_u32 s23, s23, 32768
  s_add_u32 m0, s24, 25600
  s_nop 0
  buffer_load_dwordx4 v8, s[8:11], s23 offen lds
  s_add_u32 s23, s23, 32768
  s_add_u32 m0, s24, 26624
  s_nop 0
  buffer_load_dwordx4 v8, s[8:11], s23 offen lds
  s_add_u32 s23, s23, 32768
  s_add_u32 m0, s24, 27648
  s_nop 0
  buffer_load_dwordx4 v8, s[8:11], s23 offen lds
  s_add_u32 s23, s23, 32768
  s_add_u32 m0, s24, 28672
  s_nop 0
  buffer_load_dwordx4 v8, s[8:11], s23 offen lds
  s_add_u32 s23, s23, 32768
  s_add_u32 m0, s24, 29696
  s_nop 0
  buffer_load_dwordx4 v8, s[8:11], s23 offen lds
  s_add_u32 s23, s23, 32768
  s_add_u32 m0, s24, 30720
  s_nop 0
  buffer_load_dwordx4 v8, s[8:11], s23 offen lds
  s_add_u32 s23, s23, 32768
  s_add_u32 m0, s24, 31744
  s_nop 0
  buffer_load_dwordx4 v8, s[8:11], s23 offen lds
  s_add_u32 s23, s23, 32768
  s_waitcnt vmcnt(16)
  ds_read_b64_tr_b16 a[0:1], v9 offset:0
  ds_read_b64_tr_b16 a[2:3], v9 offset:256
  ds_read_b64_tr_b16 a[4:5], v9 offset:1024
  ds_read_b64_tr_b16 a[6:7], v9 offset:1280
  ds_read_b64_tr_b16 a[8:9], v9 offset:2048
  ds_read_b64_tr_b16 a[10:11], v9 offset:2304
  ds_read_b64_tr_b16 a[12:13], v9 offset:3072
  ds_read_b64_tr_b16 a[14:15], v9 offset:3328
  s_waitcnt lgkmcnt(4)
  ds_read_b64_tr_b16 a[16:17], v9 offset:4096
  ds_read_b64_tr_b16 a[18:19], v9 offset:4352
  ds_read_b64_tr_b16 a[20:21], v9 offset:5120
  ds_read_b64_tr_b16 a[22:23], v9 offset:5376
  ds_read_b64_tr_b16 a[24:25], v9 offset:6144
  ds_read_b64_tr_b16 a[26:27], v9 offset:6400
  ds_read_b64_tr_b16 a[28:29], v9 offset:7168
  ds_read_b64_tr_b16 a[30:31], v9 offset:7424
  s_waitcnt lgkmcnt(4)
  ds_read_b64_tr_b16 a[32:33], v9 offset:8192
  ds_read_b64_tr_b16 a[34:35], v9 offset:8448
  ds_read_b64_tr_b16 a[36:37], v9 offset:9216
  ds_read_b64_tr_b16 a[38:39], v9 offset:9472
  ds_read_b64_tr_b16 a[40:41], v9 offset:10240
  ds_read_b64_tr_b16 a[42:43], v9 offset:10496
  ds_read_b64_tr_b16 a[44:45], v9 offset:11264
  ds_read_b64_tr_b16 a[46:47], v9 offset:11520
  s_waitcnt lgkmcnt(4)
  ds_read_b64_tr_b16 a[48:49], v9 offset:12288
  ds_read_b64_tr_b16 a[50:51], v9 offset:12544
  ds_read_b64_tr_b16 a[52:53], v9 offset:13312
  ds_read_b64_tr_b16 a[54:55], v9 offset:13568
  ds_read_b64_tr_b16 a[56:57], v9 offset:14336
  ds_read_b64_tr_b16 a[58:59], v9 offset:14592
  ds_read_b64_tr_b16 a[60:61], v9 offset:15360
  ds_read_b64_tr_b16 a[62:63], v9 offset:15616
  s_waitcnt lgkmcnt(4)
  s_waitcnt lgkmcnt(0)
  s_add_u32 m0, s24, 0
  s_nop 0
  buffer_load_dwordx4 v8, s[8:11], s23 offen lds
  s_add_u32 s23, s23, 32768
  s_add_u32 m0, s24, 1024
  s_nop 0
  buffer_load_dwordx4 v8, s[8:11], s23 offen lds
  s_add_u32 s23, s23, 32768
  s_add_u32 m0, s24, 2048
  s_nop 0
  buffer_load_dwordx4 v8, s[8:11], s23 offen lds
  s_add_u32 s23, s23, 32768
  s_add_u32 m0, s24, 3072
  s_nop 0
  buffer_load_dwordx4 v8, s[8:11], s23 offen lds
  s_add_u32 s23, s23, 32768
  s_add_u32 m0, s24, 4096
  s_nop 0
  buffer_load_dwordx4 v8, s[8:11], s23 offen lds
  s_add_u32 s23, s23, 32768
  s_add_u32 m0, s24, 5120
  s_nop 0
  buffer_load_dwordx4 v8, s[8:11], s23 offen lds
  s_add_u32 s23, s23, 32768
  s_add_u32 m0, s24, 6144
  s_nop 0
  buffer_load_dwordx4 v8, s[8:11], s23 offen lds
  s_add_u32 s23, s23, 32768
  s_add_u32 m0, s24, 7168
  s_nop 0
  buffer_load_dwordx4 v8, s[8:11], s23 offen lds
  s_add_u32 s23, s23, 32768
  s_add_u32 m0, s24, 8192
  s_nop 0
  buffer_load_dwordx4 v8, s[8:11], s23 offen lds
  s_add_u32 s23, s23, 32768
  s_add_u32 m0, s24, 9216
  s_nop 0
  buffer_load_dwordx4 v8, s[8:11], s23 offen lds
  s_add_u32 s23, s23, 32768
  s_add_u32 m0, s24, 10240
  s_nop 0
  buffer_load_dwordx4 v8, s[8:11], s23 offen lds
  s_add_u32 s23, s23, 32768
  s_add_u32 m0, s24, 11264
  s_nop 0
  buffer_load_dwordx4 v8, s[8:11], s23 offen lds
  s_add_u32 s23, s23, 32768
  s_add_u32 m0, s24, 12288
  s_nop 0
  buffer_load_dwordx4 v8, s[8:11], s23 offen lds
  s_add_u32 s23, s23, 32768
  s_add_u32 m0, s24, 13312
  s_nop 0
  buffer_load_dwordx4 v8, s[8:11], s23 offen lds
  s_add_u32 s23, s23, 32768
  s_add_u32 m0, s24, 14336
  s_nop 0
  buffer_load_dwordx4 v8, s[8:11], s23 offen lds
  s_add_u32 s23, s23, 32768
  s_add_u32 m0, s24, 15360
  s_nop 0
  buffer_load_dwordx4 v8, s[8:11], s23 offen lds
  s_add_u32 s23, s23, 32768
  s_waitcnt vmcnt(16)
  ds_read_b64_tr_b16 a[64:65], v9 offset:16384
  ds_read_b64_tr_b16 a[66:67], v9 offset:16640
  ds_read_b64_tr_b16 a[68:69], v9 offset:17408
  ds_read_b64_tr_b16 a[70:71], v9 offset:17664
  ds_read_b64_tr_b16 a[72:73], v9 offset:18432
  ds_read_b64_tr_b16 a[74:75], v9 offset:18688
  ds_read_b64_tr_b16 a[76:77], v9 offset:19456
  ds_read_b64_tr_b16 a[78:79], v9 offset:19712
  s_waitcnt lgkmcnt(4)
  ds_read_b64_tr_b16 a[80:81], v9 offset:20480
  ds_read_b64_tr_b16 a[82:83], v9 offset:20736
  ds_read_b64_tr_b16 a[84:85], v9 offset:21504
  ds_read_b64_tr_b16 a[86:87], v9 offset:21760
  ds_read_b64_tr_b16 a[88:89], v9 offset:22528
  ds_read_b64_tr_b16 a[90:91], v9 offset:22784
  ds_read_b64_tr_b16 a[92:93], v9 offset:23552
  ds_read_b64_tr_b16 a[94:95], v9 offset:23808
  s_waitcnt lgkmcnt(4)
  ds_read_b64_tr_b16 a[96:97], v9 offset:24576
  ds_read_b64_tr_b16 a[98:99], v9 offset:24832
  ds_read_b64_tr_b16 a[100:101], v9 offset:25600
  ds_read_b64_tr_b16 a[102:103], v9 offset:25856
  ds_read_b64_tr_b16 a[104:105], v9 offset:26624
  ds_read_b64_tr_b16 a[106:107], v9 offset:26880
  ds_read_b64_tr_b16 a[108:109], v9 offset:27648
  ds_read_b64_tr_b16 a[110:111], v9 offset:27904
  s_waitcnt lgkmcnt(4)
  ds_read_b64_tr_b16 a[112:113], v9 offset:28672
  ds_read_b64_tr_b16 a[114:115], v9 offset:28928
  ds_read_b64_tr_b16 a[116:117], v9 offset:29696
  ds_read_b64_tr_b16 a[118:119], v9 offset:29952
  ds_read_b64_tr_b16 a[120:121], v9 offset:30720
  ds_read_b64_tr_b16 a[122:123], v9 offset:30976
  ds_read_b64_tr_b16 a[124:125], v9 offset:31744
  ds_read_b64_tr_b16 a[126:127], v9 offset:32000
  s_waitcnt lgkmcnt(4)
  s_waitcnt lgkmcnt(0)
  s_add_u32 m0, s24, 16384
  s_nop 0
  buffer_load_dwordx4 v8, s[8:11], s23 offen lds
  s_add_u32 s23, s23, 32768
  s_add_u32 m0, s24, 17408
  s_nop 0
  buffer_load_dwordx4 v8, s[8:11], s23 offen lds
  s_add_u32 s23, s23, 32768
  s_add_u32 m0, s24, 18432
  s_nop 0
  buffer_load_dwordx4 v8, s[8:11], s23 offen lds
  s_add_u32 s23, s23, 32768
  s_add_u32 m0, s24, 19456
  s_nop 0
  buffer_load_dwordx4 v8, s[8:11], s23 offen lds
  s_add_u32 s23, s23, 32768
  s_add_u32 m0, s24, 20480
  s_nop 0
  buffer_load_dwordx4 v8, s[8:11], s23 offen lds
  s_add_u32 s23, s23, 32768
  s_add_u32 m0, s24, 21504
  s_nop 0
  buffer_load_dwordx4 v8, s[8:11], s23 offen lds
  s_add_u32 s23, s23, 32768
  s_add_u32 m0, s24, 22528
  s_nop 0
  buffer_load_dwordx4 v8, s[8:11], s23 offen lds
  s_add_u32 s23, s23, 32768
  s_add_u32 m0, s24, 23552
  s_nop 0
  buffer_load_dwordx4 v8, s[8:11], s23 offen lds
  s_add_u32 s23, s23, 32768
  s_add_u32 m0, s24, 24576
  s_nop 0
  buffer_load_dwordx4 v8, s[8:11], s23 offen lds
  s_add_u32 s23, s23, 32768
  s_add_u32 m0, s24, 25600
  s_nop 0
  buffer_load_dwordx4 v8, s[8:11], s23 offen lds
  s_add_u32 s23, s23, 32768
  s_add_u32 m0, s24, 26624
  s_nop 0
  buffer_load_dwordx4 v8, s[8:11], s23 offen lds
  s_add_u32 s23, s23, 32768
  s_add_u32 m0, s24, 27648
  s_nop 0
  buffer_load_dwordx4 v8, s[8:11], s23 offen lds
  s_add_u32 s23, s23, 32768
  s_add_u32 m0, s24, 28672
  s_nop 0
  buffer_load_dwordx4 v8, s[8:11], s23 offen lds
  s_add_u32 s23, s23, 32768
  s_add_u32 m0, s24, 29696
  s_nop 0
  buffer_load_dwordx4 v8, s[8:11], s23 offen lds
  s_add_u32 s23, s23, 32768
  s_add_u32 m0, s24, 30720
  s_nop 0
  buffer_load_dwordx4 v8, s[8:11], s23 offen lds
  s_add_u32 s23, s23, 32768
  s_add_u32 m0, s24, 31744
  s_nop 0
  buffer_load_dwordx4 v8, s[8:11], s23 offen lds
  s_add_u32 s23, s23, 32768
  s_waitcnt vmcnt(16)
  ds_read_b64_tr_b16 a[128:129], v9 offset:0
  ds_read_b64_tr_b16 a[130:131], v9 offset:256
  ds_read_b64_tr_b16 a[132:133], v9 offset:1024
  ds_read_b64_tr_b16 a[134:135], v9 offset:1280
  ds_read_b64_tr_b16 a[136:137], v9 offset:2048
  ds_read_b64_tr_b16 a[138:139], v9 offset:2304
  ds_read_b64_tr_b16 a[140:141], v9 offset:3072
  ds_read_b64_tr_b16 a[142:143], v9 offset:3328
  s_waitcnt lgkmcnt(4)
  ds_read_b64_tr_b16 a[144:145], v9 offset:4096
  ds_read_b64_tr_b16 a[146:147], v9 offset:4352
  ds_read_b64_tr_b16 a[148:149], v9 offset:5120
  ds_read_b64_tr_b16 a[150:151], v9 offset:5376
  ds_read_b64_tr_b16 a[152:153], v9 offset:6144
  ds_read_b64_tr_b16 a[154:155], v9 offset:6400
  ds_read_b64_tr_b16 a[156:157], v9 offset:7168
  ds_read_b64_tr_b16 a[158:159], v9 offset:7424
  s_waitcnt lgkmcnt(4)
  ds_read_b64_tr_b16 a[160:161], v9 offset:8192
  ds_read_b64_tr_b16 a[162:163], v9 offset:8448
  ds_read_b64_tr_b16 a[164:165], v9 offset:9216
  ds_read_b64_tr_b16 a[166:167], v9 offset:9472
  ds_read_b64_tr_b16 a[168:169], v9 offset:10240
  ds_read_b64_tr_b16 a[170:171], v9 offset:10496
  ds_read_b64_tr_b16 a[172:173], v9 offset:11264
  ds_read_b64_tr_b16 a[174:175], v9 offset:11520
  s_waitcnt lgkmcnt(4)
  ds_read_b64_tr_b16 a[176:177], v9 offset:12288
  ds_read_b64_tr_b16 a[178:179], v9 offset:12544
  ds_read_b64_tr_b16 a[180:181], v9 offset:13312
  ds_read_b64_tr_b16 a[182:183], v9 offset:13568
  ds_read_b64_tr_b16 a[184:185], v9 offset:14336
  ds_read_b64_tr_b16 a[186:187], v9 offset:14592
  ds_read_b64_tr_b16 a[188:189], v9 offset:15360
  ds_read_b64_tr_b16 a[190:191], v9 offset:15616
  s_waitcnt lgkmcnt(4)
  s_waitcnt lgkmcnt(0)
  s_waitcnt vmcnt(0)
  ds_read_b64_tr_b16 a[192:193], v9 offset:16384
  ds_read_b64_tr_b16 a[194:195], v9 offset:16640
  ds_read_b64_tr_b16 a[196:197], v9 offset:17408
  ds_read_b64_tr_b16 a[198:199], v9 offset:17664
  ds_read_b64_tr_b16 a[200:201], v9 offset:18432
  ds_read_b64_tr_b16 a[202:203], v9 offset:18688
  ds_read_b64_tr_b16 a[204:205], v9 offset:19456
  ds_read_b64_tr_b16 a[206:207], v9 offset:19712
  s_waitcnt lgkmcnt(4)
  ds_read_b64_tr_b16 a[208:209], v9 offset:20480
  ds_read_b64_tr_b16 a[210:211], v9 offset:20736
  ds_read_b64_tr_b16 a[212:213], v9 offset:21504
  ds_read_b64_tr_b16 a[214:215], v9 offset:21760
  ds_read_b64_tr_b16 a[216:217], v9 offset:22528
  ds_read_b64_tr_b16 a[218:219], v9 offset:22784
  ds_read_b64_tr_b16 a[220:221], v9 offset:23552
  ds_read_b64_tr_b16 a[222:223], v9 offset:23808
  s_waitcnt lgkmcnt(4)
  ds_read_b64_tr_b16 a[224:225], v9 offset:24576
  ds_read_b64_tr_b16 a[226:227], v9 offset:24832
  ds_read_b64_tr_b16 a[228:229], v9 offset:25600
  ds_read_b64_tr_b16 a[230:231], v9 offset:25856
  ds_read_b64_tr_b16 a[232:233], v9 offset:26624
  ds_read_b64_tr_b16 a[234:235], v9 offset:26880
  ds_read_b64_tr_b16 a[236:237], v9 offset:27648
  ds_read_b64_tr_b16 a[238:239], v9 offset:27904
  s_waitcnt lgkmcnt(4)
  ds_read_b64_tr_b16 a[240:241], v9 offset:28672
  ds_read_b64_tr_b16 a[242:243], v9 offset:28928
  ds_read_b64_tr_b16 a[244:245], v9 offset:29696
  ds_read_b64_tr_b16 a[246:247], v9 offset:29952
  ds_read_b64_tr_b16 a[248:249], v9 offset:30720
  ds_read_b64_tr_b16 a[250:251], v9 offset:30976
  ds_read_b64_tr_b16 a[252:253], v9 offset:31744
  ds_read_b64_tr_b16 a[254:255], v9 offset:32000
  s_waitcnt lgkmcnt(4)
  s_waitcnt lgkmcnt(0)
  s_mov_b32 s16, 0
  s_mul_i32 s18, s40, 65536
  s_add_u32 s18, s18, 83886080
  s_lshl_b32 s20, s40, 6
  s_add_u32 s20, s20, 20480
  s_mov_b32 s21, 8192
  s_mul_i32 s38, s14, 16384
  s_add_u32 s18, s18, s38
  s_mov_b32 s28, 0
  s_mov_b32 s22, 0
  v_mov_b32 v7, 131072
  s_cmp_lg_u32 s14, 0
  s_cbranch_scc1 w0_223
  s_mul_i32 s23, s16, 256
  s_add_u32 s23, s23, s20
p0_224:
  buffer_load_dword v5, off, s[4:7], s23 sc1
  s_waitcnt vmcnt(0)
  v_readfirstlane_b32 s24, v5
  s_cmp_ge_u32 s24, 8
  s_cbranch_scc1 p0ok_225
  s_cmp_eq_u32 s29, 0
  s_cbranch_scc1 p0ok_225
  s_sub_u32 s29, s29, 1
  s_branch p0_224
p0ok_225:
w0_223:
  s_barrier
  s_barrier
  s_mul_i32 s23, s16, 262144
  s_add_u32 s23, s23, s18
  s_add_u32 s24, s28, s38
  s_mov_b32 m0, s24
  s_nop 0
  buffer_load_dwordx4 v1, s[4:7], s23 offen offset:0 sc1 lds
  buffer_load_dwordx4 v1, s[4:7], s23 offen offset:1024 sc1 lds
  buffer_load_dwordx4 v1, s[4:7], s23 offen offset:2048 sc1 lds
  buffer_load_dwordx4 v1, s[4:7], s23 offen offset:3072 sc1 lds
  s_add_u32 s23, s23, 4096
  s_add_u32 s24, s24, 4096
  s_mov_b32 m0, s24
  s_nop 0
  buffer_load_dwordx4 v1, s[4:7], s23 offen offset:0 sc1 lds
  buffer_load_dwordx4 v1, s[4:7], s23 offen offset:1024 sc1 lds
  buffer_load_dwordx4 v1, s[4:7], s23 offen offset:2048 sc1 lds
  buffer_load_dwordx4 v1, s[4:7], s23 offen offset:3072 sc1 lds
  s_add_u32 s23, s23, 4096
  s_add_u32 s24, s24, 4096
  s_mov_b32 m0, s24
  s_nop 0
  buffer_load_dwordx4 v1, s[4:7], s23 offen offset:0 sc1 lds
  buffer_load_dwordx4 v1, s[4:7], s23 offen offset:1024 sc1 lds
  buffer_load_dwordx4 v1, s[4:7], s23 offen offset:2048 sc1 lds
  buffer_load_dwordx4 v1, s[4:7], s23 offen offset:3072 sc1 lds
  s_add_u32 s23, s23, 4096
  s_add_u32 s24, s24, 4096
  s_mov_b32 m0, s24
  s_nop 0
  buffer_load_dwordx4 v1, s[4:7], s23 offen offset:0 sc1 lds
  buffer_load_dwordx4 v1, s[4:7], s23 offen offset:1024 sc1 lds
  buffer_load_dwordx4 v1, s[4:7], s23 offen offset:2048 sc1 lds
  buffer_load_dwordx4 v1, s[4:7], s23 offen offset:3072 sc1 lds
  s_add_u32 s17, s16, 1
  v_mov_b32 v4, 0
  s_cmp_ge_u32 s17, 64
  s_cbranch_scc1 lf_226
  s_cmp_lg_u32 s14, 0
  s_cbranch_scc1 lf_226
  s_mul_i32 s23, s17, 256
  s_add_u32 s23, s23, s20
  buffer_load_dword v4, off, s[4:7], s23 sc1
lf_226:
  s_waitcnt vmcnt(0)
  s_cmp_lg_u32 s14, 0
  s_cbranch_scc1 w0_230
  ds_write_b32 v7, v4
  s_waitcnt lgkmcnt(0)
w0_230:
  s_barrier
  ds_read_b32 v5, v7
  ds_read_b128 v[16:19], v2 offset:0
  ds_read_b128 v[20:23], v2 offset:1024
  ds_read_b128 v[24:27], v2 offset:2048
  ds_read_b128 v[28:31], v2 offset:3072
  ds_read_b128 v[32:35], v2 offset:4096
  ds_read_b128 v[36:39], v2 offset:5120
  ds_read_b128 v[40:43], v2 offset:6144
  v_xor_b32 v7, 4, v7
g3dec_227:
  s_waitcnt lgkmcnt(7)
  v_readfirstlane_b32 s36, v5
  s_cmp_ge_u32 s36, 8
  s_cbranch_scc0 g3npre_228
  s_add_u32 s15, s17, 1
  v_mov_b32 v4, 0
  s_cmp_ge_u32 s15, 64
  s_cbranch_scc1 lf_231
  s_cmp_lg_u32 s14, 0
  s_cbranch_scc1 lf_231
  s_mul_i32 s23, s15, 256
  s_add_u32 s23, s23, s20
  buffer_load_dword v4, off, s[4:7], s23 sc1
lf_231:
  s_mul_i32 s26, s17, 262144
  s_add_u32 s26, s26, s18
  s_xor_b32 s27, s28, 0x10000
  s_add_u32 s27, s27, s38
  s_waitcnt lgkmcnt(6)
  v_mfma_f32_32x32x16_bf16 v[48:63], a[0:3], v[16:19], 0
  ds_read_b128 v[44:47], v2 offset:7168
  s_mov_b32 m0, s27
  s_nop 0
  buffer_load_dwordx4 v1, s[4:7], s26 offen offset:0 sc1 lds
  s_waitcnt lgkmcnt(6)
  v_mfma_f32_32x32x16_bf16 v[48:63], a[4:7], v[20:23], v[48:63]
  ds_read_b128 v[16:19], v2 offset:8192
  s_waitcnt lgkmcnt(6)
  v_mfma_f32_32x32x16_bf16 v[48:63], a[8:11], v[24:27], v[48:63]
  ds_read_b128 v[20:23], v2 offset:9216
  buffer_load_dwordx4 v1, s[4:7], s26 offen offset:1024 sc1 lds
  s_waitcnt lgkmcnt(6)
  v_mfma_f32_32x32x16_bf16 v[48:63], a[12:15], v[28:31], v[48:63]
  ds_read_b128 v[24:27], v2 offset:10240
  s_waitcnt lgkmcnt(6)
  v_mfma_f32_32x32x16_bf16 v[48:63], a[16:19], v[32:35], v[48:63]
  ds_read_b128 v[28:31], v2 offset:11264
  buffer_load_dwordx4 v1, s[4:7], s26 offen offset:2048 sc1 lds
  s_waitcnt lgkmcnt(6)
  v_mfma_f32_32x32x16_bf16 v[48:63], a[20:23], v[36:39], v[48:63]
  ds_read_b128 v[32:35], v2 offset:12288
  s_waitcnt lgkmcnt(6)
  v_mfma_f32_32x32x16_bf16 v[48:63], a[24:27], v[40:43], v[48:63]
  ds_read_b128 v[36:39], v2 offset:13312
  buffer_load_dwordx4 v1, s[4:7], s26 offen offset:3072 sc1 lds
  s_add_u32 s26, s26, 4096
  s_add_u32 s27, s27, 4096
  s_waitcnt lgkmcnt(6)
  v_mfma_f32_32x32x16_bf16 v[48:63], a[28:31], v[44:47], v[48:63]
  ds_read_b128 v[40:43], v2 offset:14336
  s_waitcnt lgkmcnt(6)
  v_mfma_f32_32x32x16_bf16 v[48:63], a[32:35], v[16:19], v[48:63]
  ds_read_b128 v[44:47], v2 offset:15360
  s_mov_b32 m0, s27
  s_nop 0
  buffer_load_dwordx4 v1, s[4:7], s26 offen offset:0 sc1 lds
  s_waitcnt lgkmcnt(6)
  v_mfma_f32_32x32x16_bf16 v[48:63], a[36:39], v[20:23], v[48:63]
  ds_read_b128 v[16:19], v2 offset:16384
  s_waitcnt lgkmcnt(6)
  v_mfma_f32_32x32x16_bf16 v[48:63], a[40:43], v[24:27], v[48:63]
  ds_read_b128 v[20:23], v2 offset:17408
  buffer_load_dwordx4 v1, s[4:7], s26 offen offset:1024 sc1 lds
  s_waitcnt lgkmcnt(6)
  v_mfma_f32_32x32x16_bf16 v[48:63], a[44:47], v[28:31], v[48:63]
  ds_read_b128 v[24:27], v2 offset:18432
  s_waitcnt lgkmcnt(6)
  v_mfma_f32_32x32x16_bf16 v[48:63], a[48:51], v[32:35], v[48:63]
  ds_read_b128 v[28:31], v2 offset:19456
  buffer_load_dwordx4 v1, s[4:7], s26 offen offset:2048 sc1 lds
  s_waitcnt lgkmcnt(6)
  v_mfma_f32_32x32x16_bf16 v[48:63], a[52:55], v[36:39], v[48:63]
  ds_read_b128 v[32:35], v2 offset:20480
  s_waitcnt lgkmcnt(6)
  v_mfma_f32_32x32x16_bf16 v[48:63], a[56:59], v[40:43], v[48:63]
  ds_read_b128 v[36:39], v2 offset:21504
  buffer_load_dwordx4 v1, s[4:7], s26 offen offset:3072 sc1 lds
  s_add_u32 s26, s26, 4096
  s_add_u32 s27, s27, 4096
  s_waitcnt lgkmcnt(6)
  v_mfma_f32_32x32x16_bf16 v[48:63], a[60:63], v[44:47], v[48:63]
  ds_read_b128 v[40:43], v2 offset:22528
  s_waitcnt lgkmcnt(6)
  v_mfma_f32_32x32x16_bf16 v[48:63], a[64:67], v[16:19], v[48:63]
  ds_read_b128 v[44:47], v2 offset:23552
  s_mov_b32 m0, s27
  s_nop 0
  buffer_load_dwordx4 v1, s[4:7], s26 offen offset:0 sc1 lds
  s_waitcnt lgkmcnt(6)
  v_mfma_f32_32x32x16_bf16 v[48:63], a[68:71], v[20:23], v[48:63]
  ds_read_b128 v[16:19], v2 offset:24576
  s_waitcnt lgkmcnt(6)
  v_mfma_f32_32x32x16_bf16 v[48:63], a[72:75], v[24:27], v[48:63]
  ds_read_b128 v[20:23], v2 offset:25600
  buffer_load_dwordx4 v1, s[4:7], s26 offen offset:1024 sc1 lds
  s_waitcnt lgkmcnt(6)
  v_mfma_f32_32x32x16_bf16 v[48:63], a[76:79], v[28:31], v[48:63]
  ds_read_b128 v[24:27], v2 offset:26624
  s_waitcnt lgkmcnt(6)
  v_mfma_f32_32x32x16_bf16 v[48:63], a[80:83], v[32:35], v[48:63]
  ds_read_b128 v[28:31], v2 offset:27648
  buffer_load_dwordx4 v1, s[4:7], s26 offen offset:2048 sc1 lds
  s_waitcnt lgkmcnt(6)
  v_mfma_f32_32x32x16_bf16 v[48:63], a[84:87], v[36:39], v[48:63]
  ds_read_b128 v[32:35], v2 offset:28672
  s_waitcnt lgkmcnt(6)
  v_mfma_f32_32x32x16_bf16 v[48:63], a[88:91], v[40:43], v[48:63]
  ds_read_b128 v[36:39], v2 offset:29696
  buffer_load_dwordx4 v1, s[4:7], s26 offen offset:3072 sc1 lds
  s_add_u32 s26, s26, 4096
  s_add_u32 s27, s27, 4096
  s_waitcnt lgkmcnt(6)
  v_mfma_f32_32x32x16_bf16 v[48:63], a[92:95], v[44:47], v[48:63]
  ds_read_b128 v[40:43], v2 offset:30720
  s_waitcnt lgkmcnt(6)
  v_mfma_f32_32x32x16_bf16 v[48:63], a[96:99], v[16:19], v[48:63]
  ds_read_b128 v[44:47], v2 offset:31744
  s_cmp_eq_u32 s22, 0
  s_cbranch_scc1 nsig_232
  s_waitcnt vmcnt(12)
  s_barrier
  s_cmp_lg_u32 s14, 0
  s_cbranch_scc1 sig_233
  s_mov_b64 exec, 1
  buffer_atomic_add v6, off, s[4:7], s22 sc1
  s_mov_b64 exec, -1
sig_233:
  s_mov_b32 s22, 0
nsig_232:
  s_mov_b32 m0, s27
  s_nop 0
  buffer_load_dwordx4 v1, s[4:7], s26 offen offset:0 sc1 lds
  s_waitcnt lgkmcnt(6)
  v_mfma_f32_32x32x16_bf16 v[48:63], a[100:103], v[20:23], v[48:63]
  ds_read_b128 v[16:19], v2 offset:32768
  s_waitcnt lgkmcnt(6)
  v_mfma_f32_32x32x16_bf16 v[48:63], a[104:107], v[24:27], v[48:63]
  ds_read_b128 v[20:23], v2 offset:33792
  buffer_load_dwordx4 v1, s[4:7], s26 offen offset:1024 sc1 lds
  s_waitcnt lgkmcnt(6)
  v_mfma_f32_32x32x16_bf16 v[48:63], a[108:111], v[28:31], v[48:63]
  ds_read_b128 v[24:27], v2 offset:34816
  s_waitcnt lgkmcnt(6)
  v_mfma_f32_32x32x16_bf16 v[48:63], a[112:115], v[32:35], v[48:63]
  ds_read_b128 v[28:31], v2 offset:35840
  buffer_load_dwordx4 v1, s[4:7], s26 offen offset:2048 sc1 lds
  s_waitcnt lgkmcnt(6)
  v_mfma_f32_32x32x16_bf16 v[48:63], a[116:119], v[36:39], v[48:63]
  ds_read_b128 v[32:35], v2 offset:36864
  s_waitcnt lgkmcnt(6)
  v_mfma_f32_32x32x16_bf16 v[48:63], a[120:123], v[40:43], v[48:63]
  ds_read_b128 v[36:39], v2 offset:37888
  buffer_load_dwordx4 v1, s[4:7], s26 offen offset:3072 sc1 lds
  s_waitcnt lgkmcnt(6)
  v_mfma_f32_32x32x16_bf16 v[48:63], a[124:127], v[44:47], v[48:63]
  ds_read_b128 v[40:43], v2 offset:38912
  s_waitcnt lgkmcnt(6)
  v_mfma_f32_32x32x16_bf16 v[48:63], a[128:131], v[16:19], v[48:63]
  ds_read_b128 v[44:47], v2 offset:39936
  s_waitcnt lgkmcnt(6)
  v_mfma_f32_32x32x16_bf16 v[48:63], a[132:135], v[20:23], v[48:63]
  ds_read_b128 v[16:19], v2 offset:40960
  s_waitcnt lgkmcnt(6)
  v_mfma_f32_32x32x16_bf16 v[48:63], a[136:139], v[24:27], v[48:63]
  ds_read_b128 v[20:23], v2 offset:41984
  s_waitcnt lgkmcnt(6)
  v_mfma_f32_32x32x16_bf16 v[48:63], a[140:143], v[28:31], v[48:63]
  ds_read_b128 v[24:27], v2 offset:43008
  s_waitcnt lgkmcnt(6)
  v_mfma_f32_32x32x16_bf16 v[48:63], a[144:147], v[32:35], v[48:63]
  ds_read_b128 v[28:31], v2 offset:44032
  s_waitcnt lgkmcnt(6)
  v_mfma_f32_32x32x16_bf16 v[48:63], a[148:151], v[36:39], v[48:63]
  ds_read_b128 v[32:35], v2 offset:45056
  s_waitcnt lgkmcnt(6)
  v_mfma_f32_32x32x16_bf16 v[48:63], a[152:155], v[40:43], v[48:63]
  ds_read_b128 v[36:39], v2 offset:46080
  s_waitcnt lgkmcnt(6)
  v_mfma_f32_32x32x16_bf16 v[48:63], a[156:159], v[44:47], v[48:63]
  ds_read_b128 v[40:43], v2 offset:47104
  s_waitcnt lgkmcnt(6)
  v_mfma_f32_32x32x16_bf16 v[48:63], a[160:163], v[16:19], v[48:63]
  ds_read_b128 v[44:47], v2 offset:48128
  s_waitcnt lgkmcnt(6)
  v_mfma_f32_32x32x16_bf16 v[48:63], a[164:167], v[20:23], v[48:63]
  ds_read_b128 v[16:19], v2 offset:49152
  s_waitcnt lgkmcnt(6)
  v_mfma_f32_32x32x16_bf16 v[48:63], a[168:171], v[24:27], v[48:63]
  ds_read_b128 v[20:23], v2 offset:50176
  s_waitcnt lgkmcnt(6)
  v_mfma_f32_32x32x16_bf16 v[48:63], a[172:175], v[28:31], v[48:63]
  ds_read_b128 v[24:27], v2 offset:51200
  s_waitcnt lgkmcnt(6)
  v_mfma_f32_32x32x16_bf16 v[48:63], a[176:179], v[32:35], v[48:63]
  ds_read_b128 v[28:31], v2 offset:52224
  s_cmp_lg_u32 s14, 0
  s_cbranch_scc1 w0_234
  s_waitcnt vmcnt(16)
  ds_write_b32 v7, v4
w0_234:
  s_waitcnt lgkmcnt(6)
  v_mfma_f32_32x32x16_bf16 v[48:63], a[180:183], v[36:39], v[48:63]
  ds_read_b128 v[32:35], v2 offset:53248
  s_waitcnt lgkmcnt(6)
  v_mfma_f32_32x32x16_bf16 v[48:63], a[184:187], v[40:43], v[48:63]
  ds_read_b128 v[36:39], v2 offset:54272
  s_waitcnt lgkmcnt(6)
  v_mfma_f32_32x32x16_bf16 v[48:63], a[188:191], v[44:47], v[48:63]
  ds_read_b128 v[40:43], v2 offset:55296
  s_waitcnt lgkmcnt(6)
  v_mfma_f32_32x32x16_bf16 v[48:63], a[192:195], v[16:19], v[48:63]
  ds_read_b128 v[44:47], v2 offset:56320
  s_waitcnt lgkmcnt(6)
  v_mfma_f32_32x32x16_bf16 v[48:63], a[196:199], v[20:23], v[48:63]
  ds_read_b128 v[16:19], v2 offset:57344
  s_waitcnt lgkmcnt(6)
  v_mfma_f32_32x32x16_bf16 v[48:63], a[200:203], v[24:27], v[48:63]
  ds_read_b128 v[20:23], v2 offset:58368
  s_waitcnt lgkmcnt(6)
  v_mfma_f32_32x32x16_bf16 v[48:63], a[204:207], v[28:31], v[48:63]
  ds_read_b128 v[24:27], v2 offset:59392
  s_waitcnt lgkmcnt(6)
  v_mfma_f32_32x32x16_bf16 v[48:63], a[208:211], v[32:35], v[48:63]
  ds_read_b128 v[28:31], v2 offset:60416
  s_waitcnt lgkmcnt(6)
  v_mfma_f32_32x32x16_bf16 v[48:63], a[212:215], v[36:39], v[48:63]
  ds_read_b128 v[32:35], v2 offset:61440
  s_waitcnt lgkmcnt(6)
  v_mfma_f32_32x32x16_bf16 v[48:63], a[216:219], v[40:43], v[48:63]
  ds_read_b128 v[36:39], v2 offset:62464
  s_waitcnt lgkmcnt(6)
  v_mfma_f32_32x32x16_bf16 v[48:63], a[220:223], v[44:47], v[48:63]
  ds_read_b128 v[40:43], v2 offset:63488
  s_waitcnt lgkmcnt(6)
  v_mfma_f32_32x32x16_bf16 v[48:63], a[224:227], v[16:19], v[48:63]
  ds_read_b128 v[44:47], v2 offset:64512
  s_waitcnt lgkmcnt(6)
  v_mfma_f32_32x32x16_bf16 v[48:63], a[228:231], v[20:23], v[48:63]
  s_waitcnt lgkmcnt(5)
  v_mfma_f32_32x32x16_bf16 v[48:63], a[232:235], v[24:27], v[48:63]
  s_waitcnt lgkmcnt(4)
  v_mfma_f32_32x32x16_bf16 v[48:63], a[236:239], v[28:31], v[48:63]
  s_waitcnt lgkmcnt(3)
  v_mfma_f32_32x32x16_bf16 v[48:63], a[240:243], v[32:35], v[48:63]
  s_waitcnt lgkmcnt(2)
  v_mfma_f32_32x32x16_bf16 v[48:63], a[244:247], v[36:39], v[48:63]
  s_waitcnt lgkmcnt(1)
  v_mfma_f32_32x32x16_bf16 v[48:63], a[248:251], v[40:43], v[48:63]
  s_waitcnt lgkmcnt(0)
  v_mfma_f32_32x32x16_bf16 v[48:63], a[252:255], v[44:47], v[48:63]
  s_waitcnt vmcnt(0)
  s_barrier
  v_xor_b32 v2, 0x10000, v2
  ds_read_b32 v5, v7
  ds_read_b128 v[16:19], v2 offset:0
  ds_read_b128 v[20:23], v2 offset:1024
  ds_read_b128 v[24:27], v2 offset:2048
  ds_read_b128 v[28:31], v2 offset:3072
  ds_read_b128 v[32:35], v2 offset:4096
  ds_read_b128 v[36:39], v2 offset:5120
  ds_read_b128 v[40:43], v2 offset:6144
  v_xor_b32 v7, 4, v7
  s_mul_i32 s23, s16, 65536
  s_add_u32 s23, s23, s19
  v_cvt_pk_bf16_f32 v80, v48, v49
  v_cvt_pk_bf16_f32 v81, v50, v51
  v_cvt_pk_bf16_f32 v82, v52, v53
  v_cvt_pk_bf16_f32 v83, v54, v55
  v_cvt_pk_bf16_f32 v84, v56, v57
  v_cvt_pk_bf16_f32 v85, v58, v59
  v_cvt_pk_bf16_f32 v86, v60, v61
  v_cvt_pk_bf16_f32 v87, v62, v63
  buffer_store_dwordx4 v[80:83], v3, s[4:7], s23 offen sc1
  buffer_store_dwordx4 v[84:87], v3, s[4:7], s23 offen offset:1024 sc1
  s_mul_i32 s22, s16, 64
  s_add_u32 s22, s22, s21
  s_mov_b32 s16, s17
  s_add_u32 s17, s16, 1
  s_xor_b32 s28, s28, 0x10000
  s_branch g3dec_227
g3npre_228:
  s_waitcnt lgkmcnt(6)
  v_mfma_f32_32x32x16_bf16 v[48:63], a[0:3], v[16:19], 0
  ds_read_b128 v[44:47], v2 offset:7168
  s_waitcnt lgkmcnt(6)
  v_mfma_f32_32x32x16_bf16 v[48:63], a[4:7], v[20:23], v[48:63]
  ds_read_b128 v[16:19], v2 offset:8192
  s_waitcnt lgkmcnt(6)
  v_mfma_f32_32x32x16_bf16 v[48:63], a[8:11], v[24:27], v[48:63]
  ds_read_b128 v[20:23], v2 offset:9216
  s_waitcnt lgkmcnt(6)
  v_mfma_f32_32x32x16_bf16 v[48:63], a[12:15], v[28:31], v[48:63]
  ds_read_b128 v[24:27], v2 offset:10240
  s_waitcnt lgkmcnt(6)
  v_mfma_f32_32x32x16_bf16 v[48:63], a[16:19], v[32:35], v[48:63]
  ds_read_b128 v[28:31], v2 offset:11264
  s_waitcnt lgkmcnt(6)
  v_mfma_f32_32x32x16_bf16 v[48:63], a[20:23], v[36:39], v[48:63]
  ds_read_b128 v[32:35], v2 offset:12288
  s_waitcnt lgkmcnt(6)
  v_mfma_f32_32x32x16_bf16 v[48:63], a[24:27], v[40:43], v[48:63]
  ds_read_b128 v[36:39], v2 offset:13312
  s_waitcnt lgkmcnt(6)
  v_mfma_f32_32x32x16_bf16 v[48:63], a[28:31], v[44:47], v[48:63]
  ds_read_b128 v[40:43], v2 offset:14336
  s_waitcnt lgkmcnt(6)
  v_mfma_f32_32x32x16_bf16 v[48:63], a[32:35], v[16:19], v[48:63]
  ds_read_b128 v[44:47], v2 offset:15360
  s_waitcnt lgkmcnt(6)
  v_mfma_f32_32x32x16_bf16 v[48:63], a[36:39], v[20:23], v[48:63]
  ds_read_b128 v[16:19], v2 offset:16384
  s_waitcnt lgkmcnt(6)
  v_mfma_f32_32x32x16_bf16 v[48:63], a[40:43], v[24:27], v[48:63]
  ds_read_b128 v[20:23], v2 offset:17408
  s_waitcnt lgkmcnt(6)
  v_mfma_f32_32x32x16_bf16 v[48:63], a[44:47], v[28:31], v[48:63]
  ds_read_b128 v[24:27], v2 offset:18432
  s_waitcnt lgkmcnt(6)
  v_mfma_f32_32x32x16_bf16 v[48:63], a[48:51], v[32:35], v[48:63]
  ds_read_b128 v[28:31], v2 offset:19456
  s_waitcnt lgkmcnt(6)
  v_mfma_f32_32x32x16_bf16 v[48:63], a[52:55], v[36:39], v[48:63]
  ds_read_b128 v[32:35], v2 offset:20480
  s_waitcnt lgkmcnt(6)
  v_mfma_f32_32x32x16_bf16 v[48:63], a[56:59], v[40:43], v[48:63]
  ds_read_b128 v[36:39], v2 offset:21504
  s_waitcnt lgkmcnt(6)
  v_mfma_f32_32x32x16_bf16 v[48:63], a[60:63], v[44:47], v[48:63]
  ds_read_b128 v[40:43], v2 offset:22528
  s_waitcnt lgkmcnt(6)
  v_mfma_f32_32x32x16_bf16 v[48:63], a[64:67], v[16:19], v[48:63]
  ds_read_b128 v[44:47], v2 offset:23552
  s_waitcnt lgkmcnt(6)
  v_mfma_f32_32x32x16_bf16 v[48:63], a[68:71], v[20:23], v[48:63]
  ds_read_b128 v[16:19], v2 offset:24576
  s_waitcnt lgkmcnt(6)
  v_mfma_f32_32x32x16_bf16 v[48:63], a[72:75], v[24:27], v[48:63]
  ds_read_b128 v[20:23], v2 offset:25600
  s_waitcnt lgkmcnt(6)
  v_mfma_f32_32x32x16_bf16 v[48:63], a[76:79], v[28:31], v[48:63]
  ds_read_b128 v[24:27], v2 offset:26624
  s_waitcnt lgkmcnt(6)
  v_mfma_f32_32x32x16_bf16 v[48:63], a[80:83], v[32:35], v[48:63]
  ds_read_b128 v[28:31], v2 offset:27648
  s_waitcnt lgkmcnt(6)
  v_mfma_f32_32x32x16_bf16 v[48:63], a[84:87], v[36:39], v[48:63]
  ds_read_b128 v[32:35], v2 offset:28672
  s_waitcnt lgkmcnt(6)
  v_mfma_f32_32x32x16_bf16 v[48:63], a[88:91], v[40:43], v[48:63]
  ds_read_b128 v[36:39], v2 offset:29696
  s_waitcnt lgkmcnt(6)
  v_mfma_f32_32x32x16_bf16 v[48:63], a[92:95], v[44:47], v[48:63]
  ds_read_b128 v[40:43], v2 offset:30720
  s_waitcnt lgkmcnt(6)
  v_mfma_f32_32x32x16_bf16 v[48:63], a[96:99], v[16:19], v[48:63]
  ds_read_b128 v[44:47], v2 offset:31744
  s_cmp_eq_u32 s22, 0
  s_cbranch_scc1 nsig_235
  s_waitcnt vmcnt(0)
  s_barrier
  s_cmp_lg_u32 s14, 0
  s_cbranch_scc1 sig_236
  s_mov_b64 exec, 1
  buffer_atomic_add v6, off, s[4:7], s22 sc1
  s_mov_b64 exec, -1
sig_236:
  s_mov_b32 s22, 0
nsig_235:
  s_waitcnt lgkmcnt(6)
  v_mfma_f32_32x32x16_bf16 v[48:63], a[100:103], v[20:23], v[48:63]
  ds_read_b128 v[16:19], v2 offset:32768
  s_waitcnt lgkmcnt(6)
  v_mfma_f32_32x32x16_bf16 v[48:63], a[104:107], v[24:27], v[48:63]
  ds_read_b128 v[20:23], v2 offset:33792
  s_waitcnt lgkmcnt(6)
  v_mfma_f32_32x32x16_bf16 v[48:63], a[108:111], v[28:31], v[48:63]
  ds_read_b128 v[24:27], v2 offset:34816
  s_waitcnt lgkmcnt(6)
  v_mfma_f32_32x32x16_bf16 v[48:63], a[112:115], v[32:35], v[48:63]
  ds_read_b128 v[28:31], v2 offset:35840
  s_waitcnt lgkmcnt(6)
  v_mfma_f32_32x32x16_bf16 v[48:63], a[116:119], v[36:39], v[48:63]
  ds_read_b128 v[32:35], v2 offset:36864
  s_waitcnt lgkmcnt(6)
  v_mfma_f32_32x32x16_bf16 v[48:63], a[120:123], v[40:43], v[48:63]
  ds_read_b128 v[36:39], v2 offset:37888
  s_waitcnt lgkmcnt(6)
  v_mfma_f32_32x32x16_bf16 v[48:63], a[124:127], v[44:47], v[48:63]
  ds_read_b128 v[40:43], v2 offset:38912
  s_waitcnt lgkmcnt(6)
  v_mfma_f32_32x32x16_bf16 v[48:63], a[128:131], v[16:19], v[48:63]
  ds_read_b128 v[44:47], v2 offset:39936
  s_waitcnt lgkmcnt(6)
  v_mfma_f32_32x32x16_bf16 v[48:63], a[132:135], v[20:23], v[48:63]
  ds_read_b128 v[16:19], v2 offset:40960
  s_waitcnt lgkmcnt(6)
  v_mfma_f32_32x32x16_bf16 v[48:63], a[136:139], v[24:27], v[48:63]
  ds_read_b128 v[20:23], v2 offset:41984
  s_waitcnt lgkmcnt(6)
  v_mfma_f32_32x32x16_bf16 v[48:63], a[140:143], v[28:31], v[48:63]
  ds_read_b128 v[24:27], v2 offset:43008
  s_waitcnt lgkmcnt(6)
  v_mfma_f32_32x32x16_bf16 v[48:63], a[144:147], v[32:35], v[48:63]
  ds_read_b128 v[28:31], v2 offset:44032
  s_waitcnt lgkmcnt(6)
  v_mfma_f32_32x32x16_bf16 v[48:63], a[148:151], v[36:39], v[48:63]
  ds_read_b128 v[32:35], v2 offset:45056
  s_waitcnt lgkmcnt(6)
  v_mfma_f32_32x32x16_bf16 v[48:63], a[152:155], v[40:43], v[48:63]
  ds_read_b128 v[36:39], v2 offset:46080
  s_waitcnt lgkmcnt(6)
  v_mfma_f32_32x32x16_bf16 v[48:63], a[156:159], v[44:47], v[48:63]
  ds_read_b128 v[40:43], v2 offset:47104
  s_waitcnt lgkmcnt(6)
  v_mfma_f32_32x32x16_bf16 v[48:63], a[160:163], v[16:19], v[48:63]
  ds_read_b128 v[44:47], v2 offset:48128
  s_waitcnt lgkmcnt(6)
  v_mfma_f32_32x32x16_bf16 v[48:63], a[164:167], v[20:23], v[48:63]
  ds_read_b128 v[16:19], v2 offset:49152
  s_waitcnt lgkmcnt(6)
  v_mfma_f32_32x32x16_bf16 v[48:63], a[168:171], v[24:27], v[48:63]
  ds_read_b128 v[20:23], v2 offset:50176
  s_waitcnt lgkmcnt(6)
  v_mfma_f32_32x32x16_bf16 v[48:63], a[172:175], v[28:31], v[48:63]
  ds_read_b128 v[24:27], v2 offset:51200
  s_waitcnt lgkmcnt(6)
  v_mfma_f32_32x32x16_bf16 v[48:63], a[176:179], v[32:35], v[48:63]
  ds_read_b128 v[28:31], v2 offset:52224
  s_waitcnt lgkmcnt(6)
  v_mfma_f32_32x32x16_bf16 v[48:63], a[180:183], v[36:39], v[48:63]
  ds_read_b128 v[32:35], v2 offset:53248
  s_waitcnt lgkmcnt(6)
  v_mfma_f32_32x32x16_bf16 v[48:63], a[184:187], v[40:43], v[48:63]
  ds_read_b128 v[36:39], v2 offset:54272
  s_waitcnt lgkmcnt(6)
  v_mfma_f32_32x32x16_bf16 v[48:63], a[188:191], v[44:47], v[48:63]
  ds_read_b128 v[40:43], v2 offset:55296
  s_waitcnt lgkmcnt(6)
  v_mfma_f32_32x32x16_bf16 v[48:63], a[192:195], v[16:19], v[48:63]
  ds_read_b128 v[44:47], v2 offset:56320
  s_waitcnt lgkmcnt(6)
  v_mfma_f32_32x32x16_bf16 v[48:63], a[196:199], v[20:23], v[48:63]
  ds_read_b128 v[16:19], v2 offset:57344
  s_waitcnt lgkmcnt(6)
  v_mfma_f32_32x32x16_bf16 v[48:63], a[200:203], v[24:27], v[48:63]
  ds_read_b128 v[20:23], v2 offset:58368
  s_waitcnt lgkmcnt(6)
  v_mfma_f32_32x32x16_bf16 v[48:63], a[204:207], v[28:31], v[48:63]
  ds_read_b128 v[24:27], v2 offset:59392
  s_waitcnt lgkmcnt(6)
  v_mfma_f32_32x32x16_bf16 v[48:63], a[208:211], v[32:35], v[48:63]
  ds_read_b128 v[28:31], v2 offset:60416
  s_waitcnt lgkmcnt(6)
  v_mfma_f32_32x32x16_bf16 v[48:63], a[212:215], v[36:39], v[48:63]
  ds_read_b128 v[32:35], v2 offset:61440
  s_waitcnt lgkmcnt(6)
  v_mfma_f32_32x32x16_bf16 v[48:63], a[216:219], v[40:43], v[48:63]
  ds_read_b128 v[36:39], v2 offset:62464
  s_waitcnt lgkmcnt(6)
  v_mfma_f32_32x32x16_bf16 v[48:63], a[220:223], v[44:47], v[48:63]
  ds_read_b128 v[40:43], v2 offset:63488
  s_waitcnt lgkmcnt(6)
  v_mfma_f32_32x32x16_bf16 v[48:63], a[224:227], v[16:19], v[48:63]
  ds_read_b128 v[44:47], v2 offset:64512
  s_waitcnt lgkmcnt(6)
  v_mfma_f32_32x32x16_bf16 v[48:63], a[228:231], v[20:23], v[48:63]
  s_waitcnt lgkmcnt(5)
  v_mfma_f32_32x32x16_bf16 v[48:63], a[232:235], v[24:27], v[48:63]
  s_waitcnt lgkmcnt(4)
  v_mfma_f32_32x32x16_bf16 v[48:63], a[236:239], v[28:31], v[48:63]
  s_waitcnt lgkmcnt(3)
  v_mfma_f32_32x32x16_bf16 v[48:63], a[240:243], v[32:35], v[48:63]
  s_waitcnt lgkmcnt(2)
  v_mfma_f32_32x32x16_bf16 v[48:63], a[244:247], v[36:39], v[48:63]
  s_waitcnt lgkmcnt(1)
  v_mfma_f32_32x32x16_bf16 v[48:63], a[248:251], v[40:43], v[48:63]
  s_waitcnt lgkmcnt(0)
  v_mfma_f32_32x32x16_bf16 v[48:63], a[252:255], v[44:47], v[48:63]
g3epi_237:
  s_mul_i32 s23, s16, 65536
  s_add_u32 s23, s23, s19
  s_nop 9
  v_cvt_pk_bf16_f32 v80, v48, v49
  v_cvt_pk_bf16_f32 v81, v50, v51
  v_cvt_pk_bf16_f32 v82, v52, v53
  v_cvt_pk_bf16_f32 v83, v54, v55
  v_cvt_pk_bf16_f32 v84, v56, v57
  v_cvt_pk_bf16_f32 v85, v58, v59
  v_cvt_pk_bf16_f32 v86, v60, v61
  v_cvt_pk_bf16_f32 v87, v62, v63
  buffer_store_dwordx4 v[80:83], v3, s[4:7], s23 offen sc1
  buffer_store_dwordx4 v[84:87], v3, s[4:7], s23 offen offset:1024 sc1
  s_mul_i32 s25, s16, 64
  s_add_u32 s25, s25, s21
  s_cmp_lg_u32 s14, 0
  s_cbranch_scc1 w0_238
  s_cmp_ge_u32 s17, 64
  s_cbranch_scc1 p3f_239
  s_mul_i32 s23, s17, 256
  s_add_u32 s23, s23, s20
  s_add_u32 s27, s17, 1
  s_min_u32 s26, s27, 63
  s_mul_i32 s26, s26, 256
  s_add_u32 s26, s26, s20
  buffer_load_dword v5, off, s[4:7], s23 sc1
  buffer_load_dword v4, off, s[4:7], s26 sc1
p3f_239:
w0_238:
  s_waitcnt vmcnt(0)
  s_barrier
  s_cmp_lg_u32 s14, 0
  s_cbranch_scc1 sig_240
  s_mov_b64 exec, 1
  buffer_atomic_add v6, off, s[4:7], s25 sc1
  s_mov_b64 exec, -1
sig_240:
  s_cmp_ge_u32 s17, 64
  s_cbranch_scc1 g3done_229
  s_cmp_lg_u32 s14, 0
  s_cbranch_scc1 w0_242
  s_branch p3c_246
p3_243:
  buffer_load_dword v5, off, s[4:7], s23 sc1
  buffer_load_dword v4, off, s[4:7], s26 sc1
  s_waitcnt vmcnt(0)
p3c_246:
  v_readfirstlane_b32 s24, v5
  s_cmp_ge_u32 s24, 8
  s_cbranch_scc1 p3ok_244
  s_cmp_eq_u32 s29, 0
  s_cbranch_scc1 p3ok_244
  s_sub_u32 s29, s29, 1
  s_branch p3_243
p3ok_244:
  s_cmp_lt_u32 s27, 64
  s_cbranch_scc1 p3z_245
  v_mov_b32 v4, 0
p3z_245:
  ds_write_b32 v7, v4
  s_waitcnt lgkmcnt(0)
w0_242:
  s_barrier
  ds_read_b32 v5, v7
  s_mul_i32 s23, s17, 262144
  s_add_u32 s23, s23, s18
  s_sub_u32 s23, s23, s38
  s_lshl_b32 s24, s14, 10
  s_add_u32 s23, s23, s24
  s_xor_b32 s25, s28, 0x10000
  s_add_u32 s24, s24, s25
  s_mov_b32 m0, s24
  s_nop 0
  buffer_load_dwordx4 v1, s[4:7], s23 offen sc1 lds
  s_add_u32 s23, s23, 4096
  s_add_u32 s24, s24, 4096
  s_mov_b32 m0, s24
  s_nop 0
  buffer_load_dwordx4 v1, s[4:7], s23 offen sc1 lds
  s_add_u32 s23, s23, 4096
  s_add_u32 s24, s24, 4096
  s_mov_b32 m0, s24
  s_nop 0
  buffer_load_dwordx4 v1, s[4:7], s23 offen sc1 lds
  s_add_u32 s23, s23, 4096
  s_add_u32 s24, s24, 4096
  s_mov_b32 m0, s24
  s_nop 0
  buffer_load_dwordx4 v1, s[4:7], s23 offen sc1 lds
  s_add_u32 s23, s23, 4096
  s_add_u32 s24, s24, 4096
  s_mov_b32 m0, s24
  s_nop 0
  buffer_load_dwordx4 v1, s[4:7], s23 offen sc1 lds
  s_add_u32 s23, s23, 4096
  s_add_u32 s24, s24, 4096
  s_mov_b32 m0, s24
  s_nop 0
  buffer_load_dwordx4 v1, s[4:7], s23 offen sc1 lds
  s_add_u32 s23, s23, 4096
  s_add_u32 s24, s24, 4096
  s_mov_b32 m0, s24
  s_nop 0
  buffer_load_dwordx4 v1, s[4:7], s23 offen sc1 lds
  s_add_u32 s23, s23, 4096
  s_add_u32 s24, s24, 4096
  s_mov_b32 m0, s24
  s_nop 0
  buffer_load_dwordx4 v1, s[4:7], s23 offen sc1 lds
  s_add_u32 s23, s23, 4096
  s_add_u32 s24, s24, 4096
  s_mov_b32 m0, s24
  s_nop 0
  buffer_load_dwordx4 v1, s[4:7], s23 offen sc1 lds
  s_add_u32 s23, s23, 4096
  s_add_u32 s24, s24, 4096
  s_mov_b32 m0, s24
  s_nop 0
  buffer_load_dwordx4 v1, s[4:7], s23 offen sc1 lds
  s_add_u32 s23, s23, 4096
  s_add_u32 s24, s24, 4096
  s_mov_b32 m0, s24
  s_nop 0
  buffer_load_dwordx4 v1, s[4:7], s23 offen sc1 lds
  s_add_u32 s23, s23, 4096
  s_add_u32 s24, s24, 4096
  s_mov_b32 m0, s24
  s_nop 0
  buffer_load_dwordx4 v1, s[4:7], s23 offen sc1 lds
  s_add_u32 s23, s23, 4096
  s_add_u32 s24, s24, 4096
  s_mov_b32 m0, s24
  s_nop 0
  buffer_load_dwordx4 v1, s[4:7], s23 offen sc1 lds
  s_add_u32 s23, s23, 4096
  s_add_u32 s24, s24, 4096
  s_mov_b32 m0, s24
  s_nop 0
  buffer_load_dwordx4 v1, s[4:7], s23 offen sc1 lds
  s_add_u32 s23, s23, 4096
  s_add_u32 s24, s24, 4096
  s_mov_b32 m0, s24
  s_nop 0
  buffer_load_dwordx4 v1, s[4:7], s23 offen sc1 lds
  s_add_u32 s23, s23, 4096
  s_add_u32 s24, s24, 4096
  s_mov_b32 m0, s24
  s_nop 0
  buffer_load_dwordx4 v1, s[4:7], s23 offen sc1 lds
  s_mov_b32 s16, s17
  s_add_u32 s17, s16, 1
  s_xor_b32 s28, s28, 0x10000
  s_waitcnt lgkmcnt(0)
  v_readfirstlane_b32 s36, v5
  s_cmp_ge_u32 s36, 8
  s_cbranch_scc0 g3chase_241
  s_waitcnt vmcnt(0)
  s_barrier
  v_xor_b32 v2, 0x10000, v2
  ds_read_b32 v5, v7
  ds_read_b128 v[16:19], v2 offset:0
  ds_read_b128 v[20:23], v2 offset:1024
  ds_read_b128 v[24:27], v2 offset:2048
  ds_read_b128 v[28:31], v2 offset:3072
  ds_read_b128 v[32:35], v2 offset:4096
  ds_read_b128 v[36:39], v2 offset:5120
  ds_read_b128 v[40:43], v2 offset:6144
  v_xor_b32 v7, 4, v7
  s_branch g3dec_227
g3chase_241:
  v_xor_b32 v2, 0x10000, v2
  s_waitcnt vmcnt(12)
  s_barrier
  ds_read_b128 v[16:19], v2 offset:0
  ds_read_b128 v[20:23], v2 offset:1024
  ds_read_b128 v[24:27], v2 offset:2048
  ds_read_b128 v[28:31], v2 offset:3072
  ds_read_b128 v[32:35], v2 offset:4096
  ds_read_b128 v[36:39], v2 offset:5120
  ds_read_b128 v[40:43], v2 offset:6144
  s_waitcnt lgkmcnt(6)
  v_mfma_f32_32x32x16_bf16 v[48:63], a[0:3], v[16:19], 0
  ds_read_b128 v[44:47], v2 offset:7168
  s_waitcnt lgkmcnt(6)
  v_mfma_f32_32x32x16_bf16 v[48:63], a[4:7], v[20:23], v[48:63]
  ds_read_b128 v[16:19], v2 offset:8192
  s_waitcnt lgkmcnt(6)
  v_mfma_f32_32x32x16_bf16 v[48:63], a[8:11], v[24:27], v[48:63]
  ds_read_b128 v[20:23], v2 offset:9216
  s_waitcnt lgkmcnt(6)
  v_mfma_f32_32x32x16_bf16 v[48:63], a[12:15], v[28:31], v[48:63]
  ds_read_b128 v[24:27], v2 offset:10240
  s_waitcnt lgkmcnt(6)
  v_mfma_f32_32x32x16_bf16 v[48:63], a[16:19], v[32:35], v[48:63]
  ds_read_b128 v[28:31], v2 offset:11264
  s_waitcnt lgkmcnt(6)
  v_mfma_f32_32x32x16_bf16 v[48:63], a[20:23], v[36:39], v[48:63]
  ds_read_b128 v[32:35], v2 offset:12288
  s_waitcnt lgkmcnt(6)
  v_mfma_f32_32x32x16_bf16 v[48:63], a[24:27], v[40:43], v[48:63]
  ds_read_b128 v[36:39], v2 offset:13312
  s_waitcnt lgkmcnt(6)
  v_mfma_f32_32x32x16_bf16 v[48:63], a[28:31], v[44:47], v[48:63]
  ds_read_b128 v[40:43], v2 offset:14336
  s_waitcnt lgkmcnt(6)
  v_mfma_f32_32x32x16_bf16 v[48:63], a[32:35], v[16:19], v[48:63]
  ds_read_b128 v[44:47], v2 offset:15360
  s_waitcnt lgkmcnt(6)
  v_mfma_f32_32x32x16_bf16 v[48:63], a[36:39], v[20:23], v[48:63]
  s_waitcnt vmcnt(8)
  s_barrier
  ds_read_b128 v[16:19], v2 offset:16384
  s_waitcnt lgkmcnt(6)
  v_mfma_f32_32x32x16_bf16 v[48:63], a[40:43], v[24:27], v[48:63]
  ds_read_b128 v[20:23], v2 offset:17408
  s_waitcnt lgkmcnt(6)
  v_mfma_f32_32x32x16_bf16 v[48:63], a[44:47], v[28:31], v[48:63]
  ds_read_b128 v[24:27], v2 offset:18432
  s_waitcnt lgkmcnt(6)
  v_mfma_f32_32x32x16_bf16 v[48:63], a[48:51], v[32:35], v[48:63]
  ds_read_b128 v[28:31], v2 offset:19456
  s_waitcnt lgkmcnt(6)
  v_mfma_f32_32x32x16_bf16 v[48:63], a[52:55], v[36:39], v[48:63]
  ds_read_b128 v[32:35], v2 offset:20480
  s_waitcnt lgkmcnt(6)
  v_mfma_f32_32x32x16_bf16 v[48:63], a[56:59], v[40:43], v[48:63]
  ds_read_b128 v[36:39], v2 offset:21504
  s_waitcnt lgkmcnt(6)
  v_mfma_f32_32x32x16_bf16 v[48:63], a[60:63], v[44:47], v[48:63]
  ds_read_b128 v[40:43], v2 offset:22528
  s_waitcnt lgkmcnt(6)
  v_mfma_f32_32x32x16_bf16 v[48:63], a[64:67], v[16:19], v[48:63]
  ds_read_b128 v[44:47], v2 offset:23552
  s_waitcnt lgkmcnt(6)
  v_mfma_f32_32x32x16_bf16 v[48:63], a[68:71], v[20:23], v[48:63]
  ds_read_b128 v[16:19], v2 offset:24576
  s_waitcnt lgkmcnt(6)
  v_mfma_f32_32x32x16_bf16 v[48:63], a[72:75], v[24:27], v[48:63]
  ds_read_b128 v[20:23], v2 offset:25600
  s_waitcnt lgkmcnt(6)
  v_mfma_f32_32x32x16_bf16 v[48:63], a[76:79], v[28:31], v[48:63]
  ds_read_b128 v[24:27], v2 offset:26624
  s_waitcnt lgkmcnt(6)
  v_mfma_f32_32x32x16_bf16 v[48:63], a[80:83], v[32:35], v[48:63]
  ds_read_b128 v[28:31], v2 offset:27648
  s_waitcnt lgkmcnt(6)
  v_mfma_f32_32x32x16_bf16 v[48:63], a[84:87], v[36:39], v[48:63]
  ds_read_b128 v[32:35], v2 offset:28672
  s_waitcnt lgkmcnt(6)
  v_mfma_f32_32x32x16_bf16 v[48:63], a[88:91], v[40:43], v[48:63]
  ds_read_b128 v[36:39], v2 offset:29696
  s_waitcnt lgkmcnt(6)
  v_mfma_f32_32x32x16_bf16 v[48:63], a[92:95], v[44:47], v[48:63]
  ds_read_b128 v[40:43], v2 offset:30720
  s_waitcnt lgkmcnt(6)
  v_mfma_f32_32x32x16_bf16 v[48:63], a[96:99], v[16:19], v[48:63]
  ds_read_b128 v[44:47], v2 offset:31744
  s_waitcnt lgkmcnt(6)
  v_mfma_f32_32x32x16_bf16 v[48:63], a[100:103], v[20:23], v[48:63]
  s_waitcnt vmcnt(4)
  s_barrier
  ds_read_b128 v[16:19], v2 offset:32768
  s_waitcnt lgkmcnt(6)
  v_mfma_f32_32x32x16_bf16 v[48:63], a[104:107], v[24:27], v[48:63]
  ds_read_b128 v[20:23], v2 offset:33792
  s_waitcnt lgkmcnt(6)
  v_mfma_f32_32x32x16_bf16 v[48:63], a[108:111], v[28:31], v[48:63]
  ds_read_b128 v[24:27], v2 offset:34816
  s_waitcnt lgkmcnt(6)
  v_mfma_f32_32x32x16_bf16 v[48:63], a[112:115], v[32:35], v[48:63]
  ds_read_b128 v[28:31], v2 offset:35840
  s_waitcnt lgkmcnt(6)
  v_mfma_f32_32x32x16_bf16 v[48:63], a[116:119], v[36:39], v[48:63]
  ds_read_b128 v[32:35], v2 offset:36864
  s_waitcnt lgkmcnt(6)
  v_mfma_f32_32x32x16_bf16 v[48:63], a[120:123], v[40:43], v[48:63]
  ds_read_b128 v[36:39], v2 offset:37888
  s_waitcnt lgkmcnt(6)
  v_mfma_f32_32x32x16_bf16 v[48:63], a[124:127], v[44:47], v[48:63]
  ds_read_b128 v[40:43], v2 offset:38912
  s_waitcnt lgkmcnt(6)
  v_mfma_f32_32x32x16_bf16 v[48:63], a[128:131], v[16:19], v[48:63]
  ds_read_b128 v[44:47], v2 offset:39936
  s_waitcnt lgkmcnt(6)
  v_mfma_f32_32x32x16_bf16 v[48:63], a[132:135], v[20:23], v[48:63]
  ds_read_b128 v[16:19], v2 offset:40960
  s_waitcnt lgkmcnt(6)
  v_mfma_f32_32x32x16_bf16 v[48:63], a[136:139], v[24:27], v[48:63]
  ds_read_b128 v[20:23], v2 offset:41984
  s_waitcnt lgkmcnt(6)
  v_mfma_f32_32x32x16_bf16 v[48:63], a[140:143], v[28:31], v[48:63]
  ds_read_b128 v[24:27], v2 offset:43008
  s_waitcnt lgkmcnt(6)
  v_mfma_f32_32x32x16_bf16 v[48:63], a[144:147], v[32:35], v[48:63]
  ds_read_b128 v[28:31], v2 offset:44032
  s_waitcnt lgkmcnt(6)
  v_mfma_f32_32x32x16_bf16 v[48:63], a[148:151], v[36:39], v[48:63]
  ds_read_b128 v[32:35], v2 offset:45056
  s_waitcnt lgkmcnt(6)
  v_mfma_f32_32x32x16_bf16 v[48:63], a[152:155], v[40:43], v[48:63]
  ds_read_b128 v[36:39], v2 offset:46080
  s_waitcnt lgkmcnt(6)
  v_mfma_f32_32x32x16_bf16 v[48:63], a[156:159], v[44:47], v[48:63]
  ds_read_b128 v[40:43], v2 offset:47104
  s_waitcnt lgkmcnt(6)
  v_mfma_f32_32x32x16_bf16 v[48:63], a[160:163], v[16:19], v[48:63]
  ds_read_b128 v[44:47], v2 offset:48128
  s_waitcnt lgkmcnt(6)
  v_mfma_f32_32x32x16_bf16 v[48:63], a[164:167], v[20:23], v[48:63]
  s_waitcnt vmcnt(0)
  s_barrier
  ds_read_b128 v[16:19], v2 offset:49152
  s_waitcnt lgkmcnt(6)
  v_mfma_f32_32x32x16_bf16 v[48:63], a[168:171], v[24:27], v[48:63]
  ds_read_b128 v[20:23], v2 offset:50176
  s_waitcnt lgkmcnt(6)
  v_mfma_f32_32x32x16_bf16 v[48:63], a[172:175], v[28:31], v[48:63]
  ds_read_b128 v[24:27], v2 offset:51200
  s_waitcnt lgkmcnt(6)
  v_mfma_f32_32x32x16_bf16 v[48:63], a[176:179], v[32:35], v[48:63]
  ds_read_b128 v[28:31], v2 offset:52224
  s_waitcnt lgkmcnt(6)
  v_mfma_f32_32x32x16_bf16 v[48:63], a[180:183], v[36:39], v[48:63]
  ds_read_b128 v[32:35], v2 offset:53248
  s_waitcnt lgkmcnt(6)
  v_mfma_f32_32x32x16_bf16 v[48:63], a[184:187], v[40:43], v[48:63]
  ds_read_b128 v[36:39], v2 offset:54272
  s_waitcnt lgkmcnt(6)
  v_mfma_f32_32x32x16_bf16 v[48:63], a[188:191], v[44:47], v[48:63]
  ds_read_b128 v[40:43], v2 offset:55296
  s_waitcnt lgkmcnt(6)
  v_mfma_f32_32x32x16_bf16 v[48:63], a[192:195], v[16:19], v[48:63]
  ds_read_b128 v[44:47], v2 offset:56320
  s_waitcnt lgkmcnt(6)
  v_mfma_f32_32x32x16_bf16 v[48:63], a[196:199], v[20:23], v[48:63]
  ds_read_b128 v[16:19], v2 offset:57344
  s_waitcnt lgkmcnt(6)
  v_mfma_f32_32x32x16_bf16 v[48:63], a[200:203], v[24:27], v[48:63]
  ds_read_b128 v[20:23], v2 offset:58368
  s_waitcnt lgkmcnt(6)
  v_mfma_f32_32x32x16_bf16 v[48:63], a[204:207], v[28:31], v[48:63]
  ds_read_b128 v[24:27], v2 offset:59392
  s_waitcnt lgkmcnt(6)
  v_mfma_f32_32x32x16_bf16 v[48:63], a[208:211], v[32:35], v[48:63]
  ds_read_b128 v[28:31], v2 offset:60416
  s_waitcnt lgkmcnt(6)
  v_mfma_f32_32x32x16_bf16 v[48:63], a[212:215], v[36:39], v[48:63]
  ds_read_b128 v[32:35], v2 offset:61440
  s_waitcnt lgkmcnt(6)
  v_mfma_f32_32x32x16_bf16 v[48:63], a[216:219], v[40:43], v[48:63]
  ds_read_b128 v[36:39], v2 offset:62464
  s_waitcnt lgkmcnt(6)
  v_mfma_f32_32x32x16_bf16 v[48:63], a[220:223], v[44:47], v[48:63]
  ds_read_b128 v[40:43], v2 offset:63488
  s_waitcnt lgkmcnt(6)
  v_mfma_f32_32x32x16_bf16 v[48:63], a[224:227], v[16:19], v[48:63]
  ds_read_b128 v[44:47], v2 offset:64512
  s_waitcnt lgkmcnt(6)
  v_mfma_f32_32x32x16_bf16 v[48:63], a[228:231], v[20:23], v[48:63]
  s_waitcnt lgkmcnt(5)
  v_mfma_f32_32x32x16_bf16 v[48:63], a[232:235], v[24:27], v[48:63]
  s_waitcnt lgkmcnt(4)
  v_mfma_f32_32x32x16_bf16 v[48:63], a[236:239], v[28:31], v[48:63]
  s_waitcnt lgkmcnt(3)
  v_mfma_f32_32x32x16_bf16 v[48:63], a[240:243], v[32:35], v[48:63]
  s_waitcnt lgkmcnt(2)
  v_mfma_f32_32x32x16_bf16 v[48:63], a[244:247], v[36:39], v[48:63]
  s_waitcnt lgkmcnt(1)
  v_mfma_f32_32x32x16_bf16 v[48:63], a[248:251], v[40:43], v[48:63]
  s_waitcnt lgkmcnt(0)
  v_mfma_f32_32x32x16_bf16 v[48:63], a[252:255], v[44:47], v[48:63]
  s_branch g3epi_237
g3done_229:
  s_waitcnt vmcnt(0)
  s_barrier
  s_branch k_dump_2
r5_219:
  s_lshr_b32 s40, s43, 3
  s_and_b32 s41, s43, 7
  s_load_dwordx2 s[8:9], s[0:1], 80
  s_waitcnt lgkmcnt(0)
  s_mov_b32 s10, 7340032
  s_mov_b32 s11, 0x00020000
  s_lshl_b32 s42, s41, 2
  s_add_u32 s42, s42, s14
  s_mul_i32 s39, s40, 1835008
  s_lshl_b32 s23, s42, 6
  s_add_u32 s39, s39, s23
  s_lshl_b32 s19, s40, 22
  s_add_u32 s19, s19, 134217728
  s_lshl_b32 s23, s42, 11
  s_add_u32 s19, s19, s23
  v_and_b32 v8, 63, v0
  v_lshlrev_b32 v1, 4, v8
  v_mov_b32 v2, v1
  v_mov_b32 v3, v1
  v_mov_b32 v6, 1
  v_mov_b32 v80, -1
  v_mov_b32 v81, -1
  v_mov_b32 v82, -1
  v_mov_b32 v83, -1
  s_add_u32 s23, s19, 4128768
  buffer_store_dwordx4 v[80:83], v3, s[4:7], s23 offen offset:0 sc1
  buffer_store_dwordx4 v[80:83], v3, s[4:7], s23 offen offset:1024 sc1
  v_and_b32 v10, 63, v0
  v_lshrrev_b32 v11, 2, v10
  s_mov_b32 s23, 2048
  v_mul_lo_u32 v11, v11, s23
  v_and_b32 v12, 3, v10
  v_lshl_add_u32 v8, v12, 4, v11
  s_lshl_b32 s24, s14, 15
  v_lshrrev_b32 v11, 5, v10
  v_lshlrev_b32 v11, 9, v11
  v_lshrrev_b32 v12, 2, v10
  v_and_b32 v12, 3, v12
  v_lshl_add_u32 v11, v12, 6, v11
  v_lshrrev_b32 v12, 4, v10
  v_and_b32 v12, 1, v12
  v_lshl_add_u32 v11, v12, 5, v11
  v_and_b32 v12, 1, v10
  v_lshl_add_u32 v11, v12, 4, v11
  v_lshrrev_b32 v12, 1, v10
  v_and_b32 v12, 1, v12
  v_lshl_add_u32 v11, v12, 3, v11
  v_add_u32 v9, s24, v11
  s_mov_b32 s23, s39
  s_add_u32 m0, s24, 0
  s_nop 0
  buffer_load_dwordx4 v8, s[8:11], s23 offen lds
  s_add_u32 s23, s23, 32768
  s_add_u32 m0, s24, 1024
  s_nop 0
  buffer_load_dwordx4 v8, s[8:11], s23 offen lds
  s_add_u32 s23, s23, 32768
  s_add_u32 m0, s24, 2048
  s_nop 0
  buffer_load_dwordx4 v8, s[8:11], s23 offen lds
  s_add_u32 s23, s23, 32768
  s_add_u32 m0, s24, 3072
  s_nop 0
  buffer_load_dwordx4 v8, s[8:11], s23 offen lds
  s_add_u32 s23, s23, 32768
  s_add_u32 m0, s24, 4096
  s_nop 0
  buffer_load_dwordx4 v8, s[8:11], s23 offen lds
  s_add_u32 s23, s23, 32768
  s_add_u32 m0, s24, 5120
  s_nop 0
  buffer_load_dwordx4 v8, s[8:11], s23 offen lds
  s_add_u32 s23, s23, 32768
  s_add_u32 m0, s24, 6144
  s_nop 0
  buffer_load_dwordx4 v8, s[8:11], s23 offen lds
  s_add_u32 s23, s23, 32768
  s_add_u32 m0, s24, 7168
  s_nop 0
  buffer_load_dwordx4 v8, s[8:11], s23 offen lds
  s_add_u32 s23, s23, 32768
  s_add_u32 m0, s24, 8192
  s_nop 0
  buffer_load_dwordx4 v8, s[8:11], s23 offen lds
  s_add_u32 s23, s23, 32768
  s_add_u32 m0, s24, 9216
  s_nop 0
  buffer_load_dwordx4 v8, s[8:11], s23 offen lds
  s_add_u32 s23, s23, 32768
  s_add_u32 m0, s24, 10240
  s_nop 0
  buffer_load_dwordx4 v8, s[8:11], s23 offen lds
  s_add_u32 s23, s23, 32768
  s_add_u32 m0, s24, 11264
  s_nop 0
  buffer_load_dwordx4 v8, s[8:11], s23 offen lds
  s_add_u32 s23, s23, 32768
  s_add_u32 m0, s24, 12288
  s_nop 0
  buffer_load_dwordx4 v8, s[8:11], s23 offen lds
  s_add_u32 s23, s23, 32768
  s_add_u32 m0, s24, 13312
  s_nop 0
  buffer_load_dwordx4 v8, s[8:11], s23 offen lds
  s_add_u32 s23, s23, 32768
  s_add_u32 m0, s24, 14336
  s_nop 0
  buffer_load_dwordx4 v8, s[8:11], s23 offen lds
  s_add_u32 s23, s23, 32768
  s_add_u32 m0, s24, 15360
  s_nop 0
  buffer_load_dwordx4 v8, s[8:11], s23 offen lds
  s_add_u32 s23, s23, 32768
  s_add_u32 m0, s24, 16384
  s_nop 0
  buffer_load_dwordx4 v8, s[8:11], s23 offen lds
  s_add_u32 s23, s23, 32768
  s_add_u32 m0, s24, 17408
  s_nop 0
  buffer_load_dwordx4 v8, s[8:11], s23 offen lds
  s_add_u32 s23, s23, 32768
  s_add_u32 m0, s24, 18432
  s_nop 0
  buffer_load_dwordx4 v8, s[8:11], s23 offen lds
  s_add_u32 s23, s23, 32768
  s_add_u32 m0, s24, 19456
  s_nop 0
  buffer_load_dwordx4 v8, s[8:11], s23 offen lds
  s_add_u32 s23, s23, 32768
  s_add_u32 m0, s24, 20480
  s_nop 0
  buffer_load_dwordx4 v8, s[8:11], s23 offen lds
  s_add_u32 s23, s23, 32768
  s_add_u32 m0, s24, 21504
  s_nop 0
  buffer_load_dwordx4 v8, s[8:11], s23 offen lds
  s_add_u32 s23, s23, 32768
  s_add_u32 m0, s24, 22528
  s_nop 0
  buffer_load_dwordx4 v8, s[8:11], s23 offen lds
  s_add_u32 s23, s23, 32768
  s_add_u32 m0, s24, 23552
  s_nop 0
  buffer_load_dwordx4 v8, s[8:11], s23 offen lds
  s_add_u32 s23, s23, 32768
  s_add_u32 m0, s24, 24576
  s_nop 0
  buffer_load_dwordx4 v8, s[8:11], s23 offen lds
  s_add_u32 s23, s23, 32768
  s_add_u32 m0, s24, 25600
  s_nop 0
  buffer_load_dwordx4 v8, s[8:11], s23 offen lds
  s_add_u32 s23, s23, 32768
  s_add_u32 m0, s24, 26624
  s_nop 0
  buffer_load_dwordx4 v8, s[8:11], s23 offen lds
  s_add_u32 s23, s23, 32768
  s_add_u32 m0, s24, 27648
  s_nop 0
  buffer_load_dwordx4 v8, s[8:11], s23 offen lds
  s_add_u32 s23, s23, 32768
  s_add_u32 m0, s24, 28672
  s_nop 0
  buffer_load_dwordx4 v8, s[8:11], s23 offen lds
  s_add_u32 s23, s23, 32768
  s_add_u32 m0, s24, 29696
  s_nop 0
  buffer_load_dwordx4 v8, s[8:11], s23 offen lds
  s_add_u32 s23, s23, 32768
  s_add_u32 m0, s24, 30720
  s_nop 0
  buffer_load_dwordx4 v8, s[8:11], s23 offen lds
  s_add_u32 s23, s23, 32768
  s_add_u32 m0, s24, 31744
  s_nop 0
  buffer_load_dwordx4 v8, s[8:11], s23 offen lds
  s_add_u32 s23, s23, 32768
  s_waitcnt vmcnt(16)
  ds_read_b64_tr_b16 a[0:1], v9 offset:0
  ds_read_b64_tr_b16 a[2:3], v9 offset:256
  ds_read_b64_tr_b16 a[4:5], v9 offset:1024
  ds_read_b64_tr_b16 a[6:7], v9 offset:1280
  ds_read_b64_tr_b16 a[8:9], v9 offset:2048
  ds_read_b64_tr_b16 a[10:11], v9 offset:2304
  ds_read_b64_tr_b16 a[12:13], v9 offset:3072
  ds_read_b64_tr_b16 a[14:15], v9 offset:3328
  s_waitcnt lgkmcnt(4)
  ds_read_b64_tr_b16 a[16:17], v9 offset:4096
  ds_read_b64_tr_b16 a[18:19], v9 offset:4352
  ds_read_b64_tr_b16 a[20:21], v9 offset:5120
  ds_read_b64_tr_b16 a[22:23], v9 offset:5376
  ds_read_b64_tr_b16 a[24:25], v9 offset:6144
  ds_read_b64_tr_b16 a[26:27], v9 offset:6400
  ds_read_b64_tr_b16 a[28:29], v9 offset:7168
  ds_read_b64_tr_b16 a[30:31], v9 offset:7424
  s_waitcnt lgkmcnt(4)
  ds_read_b64_tr_b16 a[32:33], v9 offset:8192
  ds_read_b64_tr_b16 a[34:35], v9 offset:8448
  ds_read_b64_tr_b16 a[36:37], v9 offset:9216
  ds_read_b64_tr_b16 a[38:39], v9 offset:9472
  ds_read_b64_tr_b16 a[40:41], v9 offset:10240
  ds_read_b64_tr_b16 a[42:43], v9 offset:10496
  ds_read_b64_tr_b16 a[44:45], v9 offset:11264
  ds_read_b64_tr_b16 a[46:47], v9 offset:11520
  s_waitcnt lgkmcnt(4)
  ds_read_b64_tr_b16 a[48:49], v9 offset:12288
  ds_read_b64_tr_b16 a[50:51], v9 offset:12544
  ds_read_b64_tr_b16 a[52:53], v9 offset:13312
  ds_read_b64_tr_b16 a[54:55], v9 offset:13568
  ds_read_b64_tr_b16 a[56:57], v9 offset:14336
  ds_read_b64_tr_b16 a[58:59], v9 offset:14592
  ds_read_b64_tr_b16 a[60:61], v9 offset:15360
  ds_read_b64_tr_b16 a[62:63], v9 offset:15616
  s_waitcnt lgkmcnt(4)
  s_waitcnt lgkmcnt(0)
  s_add_u32 m0, s24, 0
  s_nop 0
  buffer_load_dwordx4 v8, s[8:11], s23 offen lds
  s_add_u32 s23, s23, 32768
  s_add_u32 m0, s24, 1024
  s_nop 0
  buffer_load_dwordx4 v8, s[8:11], s23 offen lds
  s_add_u32 s23, s23, 32768
  s_add_u32 m0, s24, 2048
  s_nop 0
  buffer_load_dwordx4 v8, s[8:11], s23 offen lds
  s_add_u32 s23, s23, 32768
  s_add_u32 m0, s24, 3072
  s_nop 0
  buffer_load_dwordx4 v8, s[8:11], s23 offen lds
  s_add_u32 s23, s23, 32768
  s_add_u32 m0, s24, 4096
  s_nop 0
  buffer_load_dwordx4 v8, s[8:11], s23 offen lds
  s_add_u32 s23, s23, 32768
  s_add_u32 m0, s24, 5120
  s_nop 0
  buffer_load_dwordx4 v8, s[8:11], s23 offen lds
  s_add_u32 s23, s23, 32768
  s_add_u32 m0, s24, 6144
  s_nop 0
  buffer_load_dwordx4 v8, s[8:11], s23 offen lds
  s_add_u32 s23, s23, 32768
  s_add_u32 m0, s24, 7168
  s_nop 0
  buffer_load_dwordx4 v8, s[8:11], s23 offen lds
  s_add_u32 s23, s23, 32768
  s_add_u32 m0, s24, 8192
  s_nop 0
  buffer_load_dwordx4 v8, s[8:11], s23 offen lds
  s_add_u32 s23, s23, 32768
  s_add_u32 m0, s24, 9216
  s_nop 0
  buffer_load_dwordx4 v8, s[8:11], s23 offen lds
  s_add_u32 s23, s23, 32768
  s_add_u32 m0, s24, 10240
  s_nop 0
  buffer_load_dwordx4 v8, s[8:11], s23 offen lds
  s_add_u32 s23, s23, 32768
  s_add_u32 m0, s24, 11264
  s_nop 0
  buffer_load_dwordx4 v8, s[8:11], s23 offen lds
  s_add_u32 s23, s23, 32768
  s_add_u32 m0, s24, 12288
  s_nop 0
  buffer_load_dwordx4 v8, s[8:11], s23 offen lds
  s_add_u32 s23, s23, 32768
  s_add_u32 m0, s24, 13312
  s_nop 0
  buffer_load_dwordx4 v8, s[8:11], s23 offen lds
  s_add_u32 s23, s23, 32768
  s_add_u32 m0, s24, 14336
  s_nop 0
  buffer_load_dwordx4 v8, s[8:11], s23 offen lds
  s_add_u32 s23, s23, 32768
  s_add_u32 m0, s24, 15360
  s_nop 0
  buffer_load_dwordx4 v8, s[8:11], s23 offen lds
  s_add_u32 s23, s23, 32768
  s_waitcnt vmcnt(16)
  ds_read_b64_tr_b16 a[64:65], v9 offset:16384
  ds_read_b64_tr_b16 a[66:67], v9 offset:16640
  ds_read_b64_tr_b16 a[68:69], v9 offset:17408
  ds_read_b64_tr_b16 a[70:71], v9 offset:17664
  ds_read_b64_tr_b16 a[72:73], v9 offset:18432
  ds_read_b64_tr_b16 a[74:75], v9 offset:18688
  ds_read_b64_tr_b16 a[76:77], v9 offset:19456
  ds_read_b64_tr_b16 a[78:79], v9 offset:19712
  s_waitcnt lgkmcnt(4)
  ds_read_b64_tr_b16 a[80:81], v9 offset:20480
  ds_read_b64_tr_b16 a[82:83], v9 offset:20736
  ds_read_b64_tr_b16 a[84:85], v9 offset:21504
  ds_read_b64_tr_b16 a[86:87], v9 offset:21760
  ds_read_b64_tr_b16 a[88:89], v9 offset:22528
  ds_read_b64_tr_b16 a[90:91], v9 offset:22784
  ds_read_b64_tr_b16 a[92:93], v9 offset:23552
  ds_read_b64_tr_b16 a[94:95], v9 offset:23808
  s_waitcnt lgkmcnt(4)
  ds_read_b64_tr_b16 a[96:97], v9 offset:24576
  ds_read_b64_tr_b16 a[98:99], v9 offset:24832
  ds_read_b64_tr_b16 a[100:101], v9 offset:25600
  ds_read_b64_tr_b16 a[102:103], v9 offset:25856
  ds_read_b64_tr_b16 a[104:105], v9 offset:26624
  ds_read_b64_tr_b16 a[106:107], v9 offset:26880
  ds_read_b64_tr_b16 a[108:109], v9 offset:27648
  ds_read_b64_tr_b16 a[110:111], v9 offset:27904
  s_waitcnt lgkmcnt(4)
  ds_read_b64_tr_b16 a[112:113], v9 offset:28672
  ds_read_b64_tr_b16 a[114:115], v9 offset:28928
  ds_read_b64_tr_b16 a[116:117], v9 offset:29696
  ds_read_b64_tr_b16 a[118:119], v9 offset:29952
  ds_read_b64_tr_b16 a[120:121], v9 offset:30720
  ds_read_b64_tr_b16 a[122:123], v9 offset:30976
  ds_read_b64_tr_b16 a[124:125], v9 offset:31744
  ds_read_b64_tr_b16 a[126:127], v9 offset:32000
  s_waitcnt lgkmcnt(4)
  s_waitcnt lgkmcnt(0)
  s_add_u32 m0, s24, 16384
  s_nop 0
  buffer_load_dwordx4 v8, s[8:11], s23 offen lds
  s_add_u32 s23, s23, 32768
  s_add_u32 m0, s24, 17408
  s_nop 0
  buffer_load_dwordx4 v8, s[8:11], s23 offen lds
  s_add_u32 s23, s23, 32768
  s_add_u32 m0, s24, 18432
  s_nop 0
  buffer_load_dwordx4 v8, s[8:11], s23 offen lds
  s_add_u32 s23, s23, 32768
  s_add_u32 m0, s24, 19456
  s_nop 0
  buffer_load_dwordx4 v8, s[8:11], s23 offen lds
  s_add_u32 s23, s23, 32768
  s_add_u32 m0, s24, 20480
  s_nop 0
  buffer_load_dwordx4 v8, s[8:11], s23 offen lds
  s_add_u32 s23, s23, 32768
  s_add_u32 m0, s24, 21504
  s_nop 0
  buffer_load_dwordx4 v8, s[8:11], s23 offen lds
  s_add_u32 s23, s23, 32768
  s_add_u32 m0, s24, 22528
  s_nop 0
  buffer_load_dwordx4 v8, s[8:11], s23 offen lds
  s_add_u32 s23, s23, 32768
  s_add_u32 m0, s24, 23552
  s_nop 0
  buffer_load_dwordx4 v8, s[8:11], s23 offen lds
  s_add_u32 s23, s23, 32768
  s_waitcnt vmcnt(8)
  ds_read_b64_tr_b16 a[128:129], v9 offset:0
  ds_read_b64_tr_b16 a[130:131], v9 offset:256
  ds_read_b64_tr_b16 a[132:133], v9 offset:1024
  ds_read_b64_tr_b16 a[134:135], v9 offset:1280
  ds_read_b64_tr_b16 a[136:137], v9 offset:2048
  ds_read_b64_tr_b16 a[138:139], v9 offset:2304
  ds_read_b64_tr_b16 a[140:141], v9 offset:3072
  ds_read_b64_tr_b16 a[142:143], v9 offset:3328
  s_waitcnt lgkmcnt(4)
  ds_read_b64_tr_b16 a[144:145], v9 offset:4096
  ds_read_b64_tr_b16 a[146:147], v9 offset:4352
  ds_read_b64_tr_b16 a[148:149], v9 offset:5120
  ds_read_b64_tr_b16 a[150:151], v9 offset:5376
  ds_read_b64_tr_b16 a[152:153], v9 offset:6144
  ds_read_b64_tr_b16 a[154:155], v9 offset:6400
  ds_read_b64_tr_b16 a[156:157], v9 offset:7168
  ds_read_b64_tr_b16 a[158:159], v9 offset:7424
  s_waitcnt lgkmcnt(4)
  ds_read_b64_tr_b16 a[160:161], v9 offset:8192
  ds_read_b64_tr_b16 a[162:163], v9 offset:8448
  ds_read_b64_tr_b16 a[164:165], v9 offset:9216
  ds_read_b64_tr_b16 a[166:167], v9 offset:9472
  ds_read_b64_tr_b16 a[168:169], v9 offset:10240
  ds_read_b64_tr_b16 a[170:171], v9 offset:10496
  ds_read_b64_tr_b16 a[172:173], v9 offset:11264
  ds_read_b64_tr_b16 a[174:175], v9 offset:11520
  s_waitcnt lgkmcnt(4)
  ds_read_b64_tr_b16 a[176:177], v9 offset:12288
  ds_read_b64_tr_b16 a[178:179], v9 offset:12544
  ds_read_b64_tr_b16 a[180:181], v9 offset:13312
  ds_read_b64_tr_b16 a[182:183], v9 offset:13568
  ds_read_b64_tr_b16 a[184:185], v9 offset:14336
  ds_read_b64_tr_b16 a[186:187], v9 offset:14592
  ds_read_b64_tr_b16 a[188:189], v9 offset:15360
  ds_read_b64_tr_b16 a[190:191], v9 offset:15616
  s_waitcnt lgkmcnt(4)
  s_waitcnt lgkmcnt(0)
  s_waitcnt vmcnt(0)
  ds_read_b64_tr_b16 a[192:193], v9 offset:16384
  ds_read_b64_tr_b16 a[194:195], v9 offset:16640
  ds_read_b64_tr_b16 a[196:197], v9 offset:17408
  ds_read_b64_tr_b16 a[198:199], v9 offset:17664
  ds_read_b64_tr_b16 a[200:201], v9 offset:18432
  ds_read_b64_tr_b16 a[202:203], v9 offset:18688
  ds_read_b64_tr_b16 a[204:205], v9 offset:19456
  ds_read_b64_tr_b16 a[206:207], v9 offset:19712
  s_waitcnt lgkmcnt(4)
  ds_read_b64_tr_b16 a[208:209], v9 offset:20480
  ds_read_b64_tr_b16 a[210:211], v9 offset:20736
  ds_read_b64_tr_b16 a[212:213], v9 offset:21504
  ds_read_b64_tr_b16 a[214:215], v9 offset:21760
  ds_read_b64_tr_b16 a[216:217], v9 offset:22528
  ds_read_b64_tr_b16 a[218:219], v9 offset:22784
  ds_read_b64_tr_b16 a[220:221], v9 offset:23552
  ds_read_b64_tr_b16 a[222:223], v9 offset:23808
  s_waitcnt lgkmcnt(4)
  s_waitcnt lgkmcnt(0)
  s_mov_b32 s16, 0
  s_mul_i32 s18, s40, 57344
  s_add_u32 s18, s18, 117440512
  s_lshl_b32 s20, s40, 6
  s_add_u32 s20, s20, 36864
  s_mov_b32 s21, 16384
  s_mul_i32 s38, s14, 14336
  s_add_u32 s18, s18, s38
  s_mov_b32 s28, 0
  s_mov_b32 s22, 0
  v_mov_b32 v7, 131072
  s_cmp_lg_u32 s14, 0
  s_cbranch_scc1 w0_247
  s_mul_i32 s23, s16, 256
  s_add_u32 s23, s23, s20
p0_248:
  buffer_load_dword v5, off, s[4:7], s23 sc1
  s_waitcnt vmcnt(0)
  v_readfirstlane_b32 s24, v5
  s_cmp_ge_u32 s24, 14
  s_cbranch_scc1 p0ok_249
  s_cmp_eq_u32 s29, 0
  s_cbranch_scc1 p0ok_249
  s_sub_u32 s29, s29, 1
  s_branch p0_248
p0ok_249:
w0_247:
  s_barrier
  s_barrier
  s_mul_i32 s23, s16, 229376
  s_add_u32 s23, s23, s18
  s_add_u32 s24, s28, s38
  s_mov_b32 m0, s24
  s_nop 0
  buffer_load_dwordx4 v1, s[4:7], s23 offen offset:0 sc1 lds
  buffer_load_dwordx4 v1, s[4:7], s23 offen offset:1024 sc1 lds
  buffer_load_dwordx4 v1, s[4:7], s23 offen offset:2048 sc1 lds
  buffer_load_dwordx4 v1, s[4:7], s23 offen offset:3072 sc1 lds
  s_add_u32 s23, s23, 4096
  s_add_u32 s24, s24, 4096
  s_mov_b32 m0, s24
  s_nop 0
  buffer_load_dwordx4 v1, s[4:7], s23 offen offset:0 sc1 lds
  buffer_load_dwordx4 v1, s[4:7], s23 offen offset:1024 sc1 lds
  buffer_load_dwordx4 v1, s[4:7], s23 offen offset:2048 sc1 lds
  buffer_load_dwordx4 v1, s[4:7], s23 offen offset:3072 sc1 lds
  s_add_u32 s23, s23, 4096
  s_add_u32 s24, s24, 4096
  s_mov_b32 m0, s24
  s_nop 0
  buffer_load_dwordx4 v1, s[4:7], s23 offen offset:0 sc1 lds
  buffer_load_dwordx4 v1, s[4:7], s23 offen offset:1024 sc1 lds
  buffer_load_dwordx4 v1, s[4:7], s23 offen offset:2048 sc1 lds
  buffer_load_dwordx4 v1, s[4:7], s23 offen offset:3072 sc1 lds
  s_add_u32 s23, s23, 4096
  s_add_u32 s24, s24, 4096
  s_mov_b32 m0, s24
  s_nop 0
  buffer_load_dwordx4 v1, s[4:7], s23 offen offset:0 sc1 lds
  buffer_load_dwordx4 v1, s[4:7], s23 offen offset:1024 sc1 lds
  s_add_u32 s17, s16, 1
  v_mov_b32 v4, 0
  s_cmp_ge_u32 s17, 64
  s_cbranch_scc1 lf_250
  s_cmp_lg_u32 s14, 0
  s_cbranch_scc1 lf_250
  s_mul_i32 s23, s17, 256
  s_add_u32 s23, s23, s20
  buffer_load_dword v4, off, s[4:7], s23 sc1
lf_250:
  s_waitcnt vmcnt(0)
  s_cmp_lg_u32 s14, 0
  s_cbranch_scc1 w0_254
  ds_write_b32 v7, v4
  s_waitcnt lgkmcnt(0)
w0_254:
  s_barrier
  ds_read_b32 v5, v7
  ds_read_b128 v[16:19], v2 offset:0
  ds_read_b128 v[20:23], v2 offset:1024
  ds_read_b128 v[24:27], v2 offset:2048
  ds_read_b128 v[28:31], v2 offset:3072
  ds_read_b128 v[32:35], v2 offset:4096
  ds_read_b128 v[36:39], v2 offset:5120
  ds_read_b128 v[40:43], v2 offset:6144
  v_xor_b32 v7, 4, v7
g5dec_251:
  s_waitcnt lgkmcnt(7)
  v_readfirstlane_b32 s36, v5
  s_cmp_ge_u32 s36, 14
  s_cbranch_scc0 g5npre_252
  s_add_u32 s15, s17, 1
  v_mov_b32 v4, 0
  s_cmp_ge_u32 s15, 64
  s_cbranch_scc1 lf_255
  s_cmp_lg_u32 s14, 0
  s_cbranch_scc1 lf_255
  s_mul_i32 s23, s15, 256
  s_add_u32 s23, s23, s20
  buffer_load_dword v4, off, s[4:7], s23 sc1
lf_255:
  s_mul_i32 s26, s17, 229376
  s_add_u32 s26, s26, s18
  s_xor_b32 s27, s28, 0x10000
  s_add_u32 s27, s27, s38
  s_waitcnt lgkmcnt(6)
  v_mfma_f32_32x32x16_bf16 v[48:63], a[0:3], v[16:19], 0
  ds_read_b128 v[44:47], v2 offset:7168
  s_mov_b32 m0, s27
  s_nop 0
  buffer_load_dwordx4 v1, s[4:7], s26 offen offset:0 sc1 lds
  s_waitcnt lgkmcnt(6)
  v_mfma_f32_32x32x16_bf16 v[48:63], a[4:7], v[20:23], v[48:63]
  ds_read_b128 v[16:19], v2 offset:8192
  s_waitcnt lgkmcnt(6)
  v_mfma_f32_32x32x16_bf16 v[48:63], a[8:11], v[24:27], v[48:63]
  ds_read_b128 v[20:23], v2 offset:9216
  buffer_load_dwordx4 v1, s[4:7], s26 offen offset:1024 sc1 lds
  s_waitcnt lgkmcnt(6)
  v_mfma_f32_32x32x16_bf16 v[48:63], a[12:15], v[28:31], v[48:63]
  ds_read_b128 v[24:27], v2 offset:10240
  s_waitcnt lgkmcnt(6)
  v_mfma_f32_32x32x16_bf16 v[48:63], a[16:19], v[32:35], v[48:63]
  ds_read_b128 v[28:31], v2 offset:11264
  buffer_load_dwordx4 v1, s[4:7], s26 offen offset:2048 sc1 lds
  s_waitcnt lgkmcnt(6)
  v_mfma_f32_32x32x16_bf16 v[48:63], a[20:23], v[36:39], v[48:63]
  ds_read_b128 v[32:35], v2 offset:12288
  s_waitcnt lgkmcnt(6)
  v_mfma_f32_32x32x16_bf16 v[48:63], a[24:27], v[40:43], v[48:63]
  ds_read_b128 v[36:39], v2 offset:13312
  buffer_load_dwordx4 v1, s[4:7], s26 offen offset:3072 sc1 lds
  s_add_u32 s26, s26, 4096
  s_add_u32 s27, s27, 4096
  s_waitcnt lgkmcnt(6)
  v_mfma_f32_32x32x16_bf16 v[48:63], a[28:31], v[44:47], v[48:63]
  ds_read_b128 v[40:43], v2 offset:14336
  s_waitcnt lgkmcnt(6)
  v_mfma_f32_32x32x16_bf16 v[48:63], a[32:35], v[16:19], v[48:63]
  ds_read_b128 v[44:47], v2 offset:15360
  s_mov_b32 m0, s27
  s_nop 0
  buffer_load_dwordx4 v1, s[4:7], s26 offen offset:0 sc1 lds
  s_waitcnt lgkmcnt(6)
  v_mfma_f32_32x32x16_bf16 v[48:63], a[36:39], v[20:23], v[48:63]
  ds_read_b128 v[16:19], v2 offset:16384
  s_waitcnt lgkmcnt(6)
  v_mfma_f32_32x32x16_bf16 v[48:63], a[40:43], v[24:27], v[48:63]
  ds_read_b128 v[20:23], v2 offset:17408
  buffer_load_dwordx4 v1, s[4:7], s26 offen offset:1024 sc1 lds
  s_waitcnt lgkmcnt(6)
  v_mfma_f32_32x32x16_bf16 v[48:63], a[44:47], v[28:31], v[48:63]
  ds_read_b128 v[24:27], v2 offset:18432
  s_waitcnt lgkmcnt(6)
  v_mfma_f32_32x32x16_bf16 v[48:63], a[48:51], v[32:35], v[48:63]
  ds_read_b128 v[28:31], v2 offset:19456
  buffer_load_dwordx4 v1, s[4:7], s26 offen offset:2048 sc1 lds
  s_waitcnt lgkmcnt(6)
  v_mfma_f32_32x32x16_bf16 v[48:63], a[52:55], v[36:39], v[48:63]
  ds_read_b128 v[32:35], v2 offset:20480
  s_waitcnt lgkmcnt(6)
  v_mfma_f32_32x32x16_bf16 v[48:63], a[56:59], v[40:43], v[48:63]
  ds_read_b128 v[36:39], v2 offset:21504
  buffer_load_dwordx4 v1, s[4:7], s26 offen offset:3072 sc1 lds
  s_add_u32 s26, s26, 4096
  s_add_u32 s27, s27, 4096
  s_waitcnt lgkmcnt(6)
  v_mfma_f32_32x32x16_bf16 v[48:63], a[60:63], v[44:47], v[48:63]
  ds_read_b128 v[40:43], v2 offset:22528
  s_waitcnt lgkmcnt(6)
  v_mfma_f32_32x32x16_bf16 v[48:63], a[64:67], v[16:19], v[48:63]
  ds_read_b128 v[44:47], v2 offset:23552
  s_mov_b32 m0, s27
  s_nop 0
  buffer_load_dwordx4 v1, s[4:7], s26 offen offset:0 sc1 lds
  s_waitcnt lgkmcnt(6)
  v_mfma_f32_32x32x16_bf16 v[48:63], a[68:71], v[20:23], v[48:63]
  ds_read_b128 v[16:19], v2 offset:24576
  s_waitcnt lgkmcnt(6)
  v_mfma_f32_32x32x16_bf16 v[48:63], a[72:75], v[24:27], v[48:63]
  ds_read_b128 v[20:23], v2 offset:25600
  buffer_load_dwordx4 v1, s[4:7], s26 offen offset:1024 sc1 lds
  s_waitcnt lgkmcnt(6)
  v_mfma_f32_32x32x16_bf16 v[48:63], a[76:79], v[28:31], v[48:63]
  ds_read_b128 v[24:27], v2 offset:26624
  s_waitcnt lgkmcnt(6)
  v_mfma_f32_32x32x16_bf16 v[48:63], a[80:83], v[32:35], v[48:63]
  ds_read_b128 v[28:31], v2 offset:27648
  buffer_load_dwordx4 v1, s[4:7], s26 offen offset:2048 sc1 lds
  s_waitcnt lgkmcnt(6)
  v_mfma_f32_32x32x16_bf16 v[48:63], a[84:87], v[36:39], v[48:63]
  ds_read_b128 v[32:35], v2 offset:28672
  s_waitcnt lgkmcnt(6)
  v_mfma_f32_32x32x16_bf16 v[48:63], a[88:91], v[40:43], v[48:63]
  ds_read_b128 v[36:39], v2 offset:29696
  buffer_load_dwordx4 v1, s[4:7], s26 offen offset:3072 sc1 lds
  s_add_u32 s26, s26, 4096
  s_add_u32 s27, s27, 4096
  s_waitcnt lgkmcnt(6)
  v_mfma_f32_32x32x16_bf16 v[48:63], a[92:95], v[44:47], v[48:63]
  ds_read_b128 v[40:43], v2 offset:30720
  s_waitcnt lgkmcnt(6)
  v_mfma_f32_32x32x16_bf16 v[48:63], a[96:99], v[16:19], v[48:63]
  ds_read_b128 v[44:47], v2 offset:31744
  s_cmp_eq_u32 s22, 0
  s_cbranch_scc1 nsig_256
  s_waitcnt vmcnt(12)
  s_barrier
  s_cmp_lg_u32 s14, 0
  s_cbranch_scc1 sig_257
  s_mov_b64 exec, 1
  buffer_atomic_add v6, off, s[4:7], s22 sc1
  s_mov_b64 exec, -1
sig_257:
  s_mov_b32 s22, 0
nsig_256:
  s_mov_b32 m0, s27
  s_nop 0
  buffer_load_dwordx4 v1, s[4:7], s26 offen offset:0 sc1 lds
  s_waitcnt lgkmcnt(6)
  v_mfma_f32_32x32x16_bf16 v[48:63], a[100:103], v[20:23], v[48:63]
  ds_read_b128 v[16:19], v2 offset:32768
  s_waitcnt lgkmcnt(6)
  v_mfma_f32_32x32x16_bf16 v[48:63], a[104:107], v[24:27], v[48:63]
  ds_read_b128 v[20:23], v2 offset:33792
  buffer_load_dwordx4 v1, s[4:7], s26 offen offset:1024 sc1 lds
  s_waitcnt lgkmcnt(6)
  v_mfma_f32_32x32x16_bf16 v[48:63], a[108:111], v[28:31], v[48:63]
  ds_read_b128 v[24:27], v2 offset:34816
  s_waitcnt lgkmcnt(6)
  v_mfma_f32_32x32x16_bf16 v[48:63], a[112:115], v[32:35], v[48:63]
  ds_read_b128 v[28:31], v2 offset:35840
  s_waitcnt lgkmcnt(6)
  v_mfma_f32_32x32x16_bf16 v[48:63], a[116:119], v[36:39], v[48:63]
  ds_read_b128 v[32:35], v2 offset:36864
  s_waitcnt lgkmcnt(6)
  v_mfma_f32_32x32x16_bf16 v[48:63], a[120:123], v[40:43], v[48:63]
  ds_read_b128 v[36:39], v2 offset:37888
  s_waitcnt lgkmcnt(6)
  v_mfma_f32_32x32x16_bf16 v[48:63], a[124:127], v[44:47], v[48:63]
  ds_read_b128 v[40:43], v2 offset:38912
  s_waitcnt lgkmcnt(6)
  v_mfma_f32_32x32x16_bf16 v[48:63], a[128:131], v[16:19], v[48:63]
  ds_read_b128 v[44:47], v2 offset:39936
  s_waitcnt lgkmcnt(6)
  v_mfma_f32_32x32x16_bf16 v[48:63], a[132:135], v[20:23], v[48:63]
  ds_read_b128 v[16:19], v2 offset:40960
  s_waitcnt lgkmcnt(6)
  v_mfma_f32_32x32x16_bf16 v[48:63], a[136:139], v[24:27], v[48:63]
  ds_read_b128 v[20:23], v2 offset:41984
  s_waitcnt lgkmcnt(6)
  v_mfma_f32_32x32x16_bf16 v[48:63], a[140:143], v[28:31], v[48:63]
  ds_read_b128 v[24:27], v2 offset:43008
  s_waitcnt lgkmcnt(6)
  v_mfma_f32_32x32x16_bf16 v[48:63], a[144:147], v[32:35], v[48:63]
  ds_read_b128 v[28:31], v2 offset:44032
  s_waitcnt lgkmcnt(6)
  v_mfma_f32_32x32x16_bf16 v[48:63], a[148:151], v[36:39], v[48:63]
  ds_read_b128 v[32:35], v2 offset:45056
  s_waitcnt lgkmcnt(6)
  v_mfma_f32_32x32x16_bf16 v[48:63], a[152:155], v[40:43], v[48:63]
  ds_read_b128 v[36:39], v2 offset:46080
  s_waitcnt lgkmcnt(6)
  v_mfma_f32_32x32x16_bf16 v[48:63], a[156:159], v[44:47], v[48:63]
  ds_read_b128 v[40:43], v2 offset:47104
  s_waitcnt lgkmcnt(6)
  v_mfma_f32_32x32x16_bf16 v[48:63], a[160:163], v[16:19], v[48:63]
  ds_read_b128 v[44:47], v2 offset:48128
  s_waitcnt lgkmcnt(6)
  v_mfma_f32_32x32x16_bf16 v[48:63], a[164:167], v[20:23], v[48:63]
  ds_read_b128 v[16:19], v2 offset:49152
  s_waitcnt lgkmcnt(6)
  v_mfma_f32_32x32x16_bf16 v[48:63], a[168:171], v[24:27], v[48:63]
  ds_read_b128 v[20:23], v2 offset:50176
  s_waitcnt lgkmcnt(6)
  v_mfma_f32_32x32x16_bf16 v[48:63], a[172:175], v[28:31], v[48:63]
  ds_read_b128 v[24:27], v2 offset:51200
  s_waitcnt lgkmcnt(6)
  v_mfma_f32_32x32x16_bf16 v[48:63], a[176:179], v[32:35], v[48:63]
  ds_read_b128 v[28:31], v2 offset:52224
  s_cmp_lg_u32 s14, 0
  s_cbranch_scc1 w0_258
  s_waitcnt vmcnt(14)
  ds_write_b32 v7, v4
w0_258:
  s_waitcnt lgkmcnt(6)
  v_mfma_f32_32x32x16_bf16 v[48:63], a[180:183], v[36:39], v[48:63]
  ds_read_b128 v[32:35], v2 offset:53248
  s_waitcnt lgkmcnt(6)
  v_mfma_f32_32x32x16_bf16 v[48:63], a[184:187], v[40:43], v[48:63]
  ds_read_b128 v[36:39], v2 offset:54272
  s_waitcnt lgkmcnt(6)
  v_mfma_f32_32x32x16_bf16 v[48:63], a[188:191], v[44:47], v[48:63]
  ds_read_b128 v[40:43], v2 offset:55296
  s_waitcnt lgkmcnt(6)
  v_mfma_f32_32x32x16_bf16 v[48:63], a[192:195], v[16:19], v[48:63]
  ds_read_b128 v[44:47], v2 offset:56320
  s_waitcnt lgkmcnt(6)
  v_mfma_f32_32x32x16_bf16 v[48:63], a[196:199], v[20:23], v[48:63]
  s_waitcnt lgkmcnt(5)
  v_mfma_f32_32x32x16_bf16 v[48:63], a[200:203], v[24:27], v[48:63]
  s_waitcnt lgkmcnt(4)
  v_mfma_f32_32x32x16_bf16 v[48:63], a[204:207], v[28:31], v[48:63]
  s_waitcnt lgkmcnt(3)
  v_mfma_f32_32x32x16_bf16 v[48:63], a[208:211], v[32:35], v[48:63]
  s_waitcnt lgkmcnt(2)
  v_mfma_f32_32x32x16_bf16 v[48:63], a[212:215], v[36:39], v[48:63]
  s_waitcnt lgkmcnt(1)
  v_mfma_f32_32x32x16_bf16 v[48:63], a[216:219], v[40:43], v[48:63]
  s_waitcnt lgkmcnt(0)
  v_mfma_f32_32x32x16_bf16 v[48:63], a[220:223], v[44:47], v[48:63]
  s_waitcnt vmcnt(0)
  s_barrier
  v_xor_b32 v2, 0x10000, v2
  ds_read_b32 v5, v7
  ds_read_b128 v[16:19], v2 offset:0
  ds_read_b128 v[20:23], v2 offset:1024
  ds_read_b128 v[24:27], v2 offset:2048
  ds_read_b128 v[28:31], v2 offset:3072
  ds_read_b128 v[32:35], v2 offset:4096
  ds_read_b128 v[36:39], v2 offset:5120
  ds_read_b128 v[40:43], v2 offset:6144
  v_xor_b32 v7, 4, v7
  s_mul_i32 s23, s16, 65536
  s_add_u32 s23, s23, s19
  v_cvt_pk_bf16_f32 v80, v48, v49
  v_cvt_pk_bf16_f32 v81, v50, v51
  v_cvt_pk_bf16_f32 v82, v52, v53
  v_cvt_pk_bf16_f32 v83, v54, v55
  v_cvt_pk_bf16_f32 v84, v56, v57
  v_cvt_pk_bf16_f32 v85, v58, v59
  v_cvt_pk_bf16_f32 v86, v60, v61
  v_cvt_pk_bf16_f32 v87, v62, v63
  buffer_store_dwordx4 v[80:83], v3, s[4:7], s23 offen sc1
  buffer_store_dwordx4 v[84:87], v3, s[4:7], s23 offen offset:1024 sc1
  s_mul_i32 s22, s16, 64
  s_add_u32 s22, s22, s21
  s_mov_b32 s16, s17
  s_add_u32 s17, s16, 1
  s_xor_b32 s28, s28, 0x10000
  s_branch g5dec_251
g5npre_252:
  s_waitcnt lgkmcnt(6)
  v_mfma_f32_32x32x16_bf16 v[48:63], a[0:3], v[16:19], 0
  ds_read_b128 v[44:47], v2 offset:7168
  s_waitcnt lgkmcnt(6)
  v_mfma_f32_32x32x16_bf16 v[48:63], a[4:7], v[20:23], v[48:63]
  ds_read_b128 v[16:19], v2 offset:8192
  s_waitcnt lgkmcnt(6)
  v_mfma_f32_32x32x16_bf16 v[48:63], a[8:11], v[24:27], v[48:63]
  ds_read_b128 v[20:23], v2 offset:9216
  s_waitcnt lgkmcnt(6)
  v_mfma_f32_32x32x16_bf16 v[48:63], a[12:15], v[28:31], v[48:63]
  ds_read_b128 v[24:27], v2 offset:10240
  s_waitcnt lgkmcnt(6)
  v_mfma_f32_32x32x16_bf16 v[48:63], a[16:19], v[32:35], v[48:63]
  ds_read_b128 v[28:31], v2 offset:11264
  s_waitcnt lgkmcnt(6)
  v_mfma_f32_32x32x16_bf16 v[48:63], a[20:23], v[36:39], v[48:63]
  ds_read_b128 v[32:35], v2 offset:12288
  s_waitcnt lgkmcnt(6)
  v_mfma_f32_32x32x16_bf16 v[48:63], a[24:27], v[40:43], v[48:63]
  ds_read_b128 v[36:39], v2 offset:13312
  s_waitcnt lgkmcnt(6)
  v_mfma_f32_32x32x16_bf16 v[48:63], a[28:31], v[44:47], v[48:63]
  ds_read_b128 v[40:43], v2 offset:14336
  s_waitcnt lgkmcnt(6)
  v_mfma_f32_32x32x16_bf16 v[48:63], a[32:35], v[16:19], v[48:63]
  ds_read_b128 v[44:47], v2 offset:15360
  s_waitcnt lgkmcnt(6)
  v_mfma_f32_32x32x16_bf16 v[48:63], a[36:39], v[20:23], v[48:63]
  ds_read_b128 v[16:19], v2 offset:16384
  s_waitcnt lgkmcnt(6)
  v_mfma_f32_32x32x16_bf16 v[48:63], a[40:43], v[24:27], v[48:63]
  ds_read_b128 v[20:23], v2 offset:17408
  s_waitcnt lgkmcnt(6)
  v_mfma_f32_32x32x16_bf16 v[48:63], a[44:47], v[28:31], v[48:63]
  ds_read_b128 v[24:27], v2 offset:18432
  s_waitcnt lgkmcnt(6)
  v_mfma_f32_32x32x16_bf16 v[48:63], a[48:51], v[32:35], v[48:63]
  ds_read_b128 v[28:31], v2 offset:19456
  s_waitcnt lgkmcnt(6)
  v_mfma_f32_32x32x16_bf16 v[48:63], a[52:55], v[36:39], v[48:63]
  ds_read_b128 v[32:35], v2 offset:20480
  s_waitcnt lgkmcnt(6)
  v_mfma_f32_32x32x16_bf16 v[48:63], a[56:59], v[40:43], v[48:63]
  ds_read_b128 v[36:39], v2 offset:21504
  s_waitcnt lgkmcnt(6)
  v_mfma_f32_32x32x16_bf16 v[48:63], a[60:63], v[44:47], v[48:63]
  ds_read_b128 v[40:43], v2 offset:22528
  s_waitcnt lgkmcnt(6)
  v_mfma_f32_32x32x16_bf16 v[48:63], a[64:67], v[16:19], v[48:63]
  ds_read_b128 v[44:47], v2 offset:23552
  s_waitcnt lgkmcnt(6)
  v_mfma_f32_32x32x16_bf16 v[48:63], a[68:71], v[20:23], v[48:63]
  ds_read_b128 v[16:19], v2 offset:24576
  s_waitcnt lgkmcnt(6)
  v_mfma_f32_32x32x16_bf16 v[48:63], a[72:75], v[24:27], v[48:63]
  ds_read_b128 v[20:23], v2 offset:25600
  s_waitcnt lgkmcnt(6)
  v_mfma_f32_32x32x16_bf16 v[48:63], a[76:79], v[28:31], v[48:63]
  ds_read_b128 v[24:27], v2 offset:26624
  s_waitcnt lgkmcnt(6)
  v_mfma_f32_32x32x16_bf16 v[48:63], a[80:83], v[32:35], v[48:63]
  ds_read_b128 v[28:31], v2 offset:27648
  s_waitcnt lgkmcnt(6)
  v_mfma_f32_32x32x16_bf16 v[48:63], a[84:87], v[36:39], v[48:63]
  ds_read_b128 v[32:35], v2 offset:28672
  s_waitcnt lgkmcnt(6)
  v_mfma_f32_32x32x16_bf16 v[48:63], a[88:91], v[40:43], v[48:63]
  ds_read_b128 v[36:39], v2 offset:29696
  s_waitcnt lgkmcnt(6)
  v_mfma_f32_32x32x16_bf16 v[48:63], a[92:95], v[44:47], v[48:63]
  ds_read_b128 v[40:43], v2 offset:30720
  s_waitcnt lgkmcnt(6)
  v_mfma_f32_32x32x16_bf16 v[48:63], a[96:99], v[16:19], v[48:63]
  ds_read_b128 v[44:47], v2 offset:31744
  s_cmp_eq_u32 s22, 0
  s_cbranch_scc1 nsig_259
  s_waitcnt vmcnt(0)
  s_barrier
  s_cmp_lg_u32 s14, 0
  s_cbranch_scc1 sig_260
  s_mov_b64 exec, 1
  buffer_atomic_add v6, off, s[4:7], s22 sc1
  s_mov_b64 exec, -1
sig_260:
  s_mov_b32 s22, 0
nsig_259:
  s_waitcnt lgkmcnt(6)
  v_mfma_f32_32x32x16_bf16 v[48:63], a[100:103], v[20:23], v[48:63]
  ds_read_b128 v[16:19], v2 offset:32768
  s_waitcnt lgkmcnt(6)
  v_mfma_f32_32x32x16_bf16 v[48:63], a[104:107], v[24:27], v[48:63]
  ds_read_b128 v[20:23], v2 offset:33792
  s_waitcnt lgkmcnt(6)
  v_mfma_f32_32x32x16_bf16 v[48:63], a[108:111], v[28:31], v[48:63]
  ds_read_b128 v[24:27], v2 offset:34816
  s_waitcnt lgkmcnt(6)
  v_mfma_f32_32x32x16_bf16 v[48:63], a[112:115], v[32:35], v[48:63]
  ds_read_b128 v[28:31], v2 offset:35840
  s_waitcnt lgkmcnt(6)
  v_mfma_f32_32x32x16_bf16 v[48:63], a[116:119], v[36:39], v[48:63]
  ds_read_b128 v[32:35], v2 offset:36864
  s_waitcnt lgkmcnt(6)
  v_mfma_f32_32x32x16_bf16 v[48:63], a[120:123], v[40:43], v[48:63]
  ds_read_b128 v[36:39], v2 offset:37888
  s_waitcnt lgkmcnt(6)
  v_mfma_f32_32x32x16_bf16 v[48:63], a[124:127], v[44:47], v[48:63]
  ds_read_b128 v[40:43], v2 offset:38912
  s_waitcnt lgkmcnt(6)
  v_mfma_f32_32x32x16_bf16 v[48:63], a[128:131], v[16:19], v[48:63]
  ds_read_b128 v[44:47], v2 offset:39936
  s_waitcnt lgkmcnt(6)
  v_mfma_f32_32x32x16_bf16 v[48:63], a[132:135], v[20:23], v[48:63]
  ds_read_b128 v[16:19], v2 offset:40960
  s_waitcnt lgkmcnt(6)
  v_mfma_f32_32x32x16_bf16 v[48:63], a[136:139], v[24:27], v[48:63]
  ds_read_b128 v[20:23], v2 offset:41984
  s_waitcnt lgkmcnt(6)
  v_mfma_f32_32x32x16_bf16 v[48:63], a[140:143], v[28:31], v[48:63]
  ds_read_b128 v[24:27], v2 offset:43008
  s_waitcnt lgkmcnt(6)
  v_mfma_f32_32x32x16_bf16 v[48:63], a[144:147], v[32:35], v[48:63]
  ds_read_b128 v[28:31], v2 offset:44032
  s_waitcnt lgkmcnt(6)
  v_mfma_f32_32x32x16_bf16 v[48:63], a[148:151], v[36:39], v[48:63]
  ds_read_b128 v[32:35], v2 offset:45056
  s_waitcnt lgkmcnt(6)
  v_mfma_f32_32x32x16_bf16 v[48:63], a[152:155], v[40:43], v[48:63]
  ds_read_b128 v[36:39], v2 offset:46080
  s_waitcnt lgkmcnt(6)
  v_mfma_f32_32x32x16_bf16 v[48:63], a[156:159], v[44:47], v[48:63]
  ds_read_b128 v[40:43], v2 offset:47104
  s_waitcnt lgkmcnt(6)
  v_mfma_f32_32x32x16_bf16 v[48:63], a[160:163], v[16:19], v[48:63]
  ds_read_b128 v[44:47], v2 offset:48128
  s_waitcnt lgkmcnt(6)
  v_mfma_f32_32x32x16_bf16 v[48:63], a[164:167], v[20:23], v[48:63]
  ds_read_b128 v[16:19], v2 offset:49152
  s_waitcnt lgkmcnt(6)
  v_mfma_f32_32x32x16_bf16 v[48:63], a[168:171], v[24:27], v[48:63]
  ds_read_b128 v[20:23], v2 offset:50176
  s_waitcnt lgkmcnt(6)
  v_mfma_f32_32x32x16_bf16 v[48:63], a[172:175], v[28:31], v[48:63]
  ds_read_b128 v[24:27], v2 offset:51200
  s_waitcnt lgkmcnt(6)
  v_mfma_f32_32x32x16_bf16 v[48:63], a[176:179], v[32:35], v[48:63]
  ds_read_b128 v[28:31], v2 offset:52224
  s_waitcnt lgkmcnt(6)
  v_mfma_f32_32x32x16_bf16 v[48:63], a[180:183], v[36:39], v[48:63]
  ds_read_b128 v[32:35], v2 offset:53248
  s_waitcnt lgkmcnt(6)
  v_mfma_f32_32x32x16_bf16 v[48:63], a[184:187], v[40:43], v[48:63]
  ds_read_b128 v[36:39], v2 offset:54272
  s_waitcnt lgkmcnt(6)
  v_mfma_f32_32x32x16_bf16 v[48:63], a[188:191], v[44:47], v[48:63]
  ds_read_b128 v[40:43], v2 offset:55296
  s_waitcnt lgkmcnt(6)
  v_mfma_f32_32x32x16_bf16 v[48:63], a[192:195], v[16:19], v[48:63]
  ds_read_b128 v[44:47], v2 offset:56320
  s_waitcnt lgkmcnt(6)
  v_mfma_f32_32x32x16_bf16 v[48:63], a[196:199], v[20:23], v[48:63]
  s_waitcnt lgkmcnt(5)
  v_mfma_f32_32x32x16_bf16 v[48:63], a[200:203], v[24:27], v[48:63]
  s_waitcnt lgkmcnt(4)
  v_mfma_f32_32x32x16_bf16 v[48:63], a[204:207], v[28:31], v[48:63]
  s_waitcnt lgkmcnt(3)
  v_mfma_f32_32x32x16_bf16 v[48:63], a[208:211], v[32:35], v[48:63]
  s_waitcnt lgkmcnt(2)
  v_mfma_f32_32x32x16_bf16 v[48:63], a[212:215], v[36:39], v[48:63]
  s_waitcnt lgkmcnt(1)
  v_mfma_f32_32x32x16_bf16 v[48:63], a[216:219], v[40:43], v[48:63]
  s_waitcnt lgkmcnt(0)
  v_mfma_f32_32x32x16_bf16 v[48:63], a[220:223], v[44:47], v[48:63]
g5epi_261:
  s_mul_i32 s23, s16, 65536
  s_add_u32 s23, s23, s19
  s_nop 9
  v_cvt_pk_bf16_f32 v80, v48, v49
  v_cvt_pk_bf16_f32 v81, v50, v51
  v_cvt_pk_bf16_f32 v82, v52, v53
  v_cvt_pk_bf16_f32 v83, v54, v55
  v_cvt_pk_bf16_f32 v84, v56, v57
  v_cvt_pk_bf16_f32 v85, v58, v59
  v_cvt_pk_bf16_f32 v86, v60, v61
  v_cvt_pk_bf16_f32 v87, v62, v63
  buffer_store_dwordx4 v[80:83], v3, s[4:7], s23 offen sc1
  buffer_store_dwordx4 v[84:87], v3, s[4:7], s23 offen offset:1024 sc1
  s_mul_i32 s25, s16, 64
  s_add_u32 s25, s25, s21
  s_cmp_lg_u32 s14, 0
  s_cbranch_scc1 w0_262
  s_cmp_ge_u32 s17, 64
  s_cbranch_scc1 p3f_263
  s_mul_i32 s23, s17, 256
  s_add_u32 s23, s23, s20
  s_add_u32 s27, s17, 1
  s_min_u32 s26, s27, 63
  s_mul_i32 s26, s26, 256
  s_add_u32 s26, s26, s20
  buffer_load_dword v5, off, s[4:7], s23 sc1
  buffer_load_dword v4, off, s[4:7], s26 sc1
p3f_263:
w0_262:
  s_waitcnt vmcnt(0)
  s_barrier
  s_cmp_lg_u32 s14, 0
  s_cbranch_scc1 sig_264
  s_mov_b64 exec, 1
  buffer_atomic_add v6, off, s[4:7], s25 sc1
  s_mov_b64 exec, -1
sig_264:
  s_cmp_ge_u32 s17, 64
  s_cbranch_scc1 g5done_253
  s_cmp_lg_u32 s14, 0
  s_cbranch_scc1 w0_266
  s_branch p3c_270
p3_267:
  buffer_load_dword v5, off, s[4:7], s23 sc1
  buffer_load_dword v4, off, s[4:7], s26 sc1
  s_waitcnt vmcnt(0)
p3c_270:
  v_readfirstlane_b32 s24, v5
  s_cmp_ge_u32 s24, 14
  s_cbranch_scc1 p3ok_268
  s_cmp_eq_u32 s29, 0
  s_cbranch_scc1 p3ok_268
  s_sub_u32 s29, s29, 1
  s_branch p3_267
p3ok_268:
  s_cmp_lt_u32 s27, 64
  s_cbranch_scc1 p3z_269
  v_mov_b32 v4, 0
p3z_269:
  ds_write_b32 v7, v4
  s_waitcnt lgkmcnt(0)
w0_266:
  s_barrier
  ds_read_b32 v5, v7
  s_mul_i32 s23, s17, 229376
  s_add_u32 s23, s23, s18
  s_sub_u32 s23, s23, s38
  s_lshl_b32 s24, s14, 10
  s_add_u32 s23, s23, s24
  s_xor_b32 s25, s28, 0x10000
  s_add_u32 s24, s24, s25
  s_mov_b32 m0, s24
  s_nop 0
  buffer_load_dwordx4 v1, s[4:7], s23 offen sc1 lds
  s_add_u32 s23, s23, 4096
  s_add_u32 s24, s24, 4096
  s_mov_b32 m0, s24
  s_nop 0
  buffer_load_dwordx4 v1, s[4:7], s23 offen sc1 lds
  s_add_u32 s23, s23, 4096
  s_add_u32 s24, s24, 4096
  s_mov_b32 m0, s24
  s_nop 0
  buffer_load_dwordx4 v1, s[4:7], s23 offen sc1 lds
  s_add_u32 s23, s23, 4096
  s_add_u32 s24, s24, 4096
  s_mov_b32 m0, s24
  s_nop 0
  buffer_load_dwordx4 v1, s[4:7], s23 offen sc1 lds
  s_add_u32 s23, s23, 4096
  s_add_u32 s24, s24, 4096
  s_mov_b32 m0, s24
  s_nop 0
  buffer_load_dwordx4 v1, s[4:7], s23 offen sc1 lds
  s_add_u32 s23, s23, 4096
  s_add_u32 s24, s24, 4096
  s_mov_b32 m0, s24
  s_nop 0
  buffer_load_dwordx4 v1, s[4:7], s23 offen sc1 lds
  s_add_u32 s23, s23, 4096
  s_add_u32 s24, s24, 4096
  s_mov_b32 m0, s24
  s_nop 0
  buffer_load_dwordx4 v1, s[4:7], s23 offen sc1 lds
  s_add_u32 s23, s23, 4096
  s_add_u32 s24, s24, 4096
  s_mov_b32 m0, s24
  s_nop 0
  buffer_load_dwordx4 v1, s[4:7], s23 offen sc1 lds
  s_add_u32 s23, s23, 4096
  s_add_u32 s24, s24, 4096
  s_mov_b32 m0, s24
  s_nop 0
  buffer_load_dwordx4 v1, s[4:7], s23 offen sc1 lds
  s_add_u32 s23, s23, 4096
  s_add_u32 s24, s24, 4096
  s_mov_b32 m0, s24
  s_nop 0
  buffer_load_dwordx4 v1, s[4:7], s23 offen sc1 lds
  s_add_u32 s23, s23, 4096
  s_add_u32 s24, s24, 4096
  s_mov_b32 m0, s24
  s_nop 0
  buffer_load_dwordx4 v1, s[4:7], s23 offen sc1 lds
  s_add_u32 s23, s23, 4096
  s_add_u32 s24, s24, 4096
  s_mov_b32 m0, s24
  s_nop 0
  buffer_load_dwordx4 v1, s[4:7], s23 offen sc1 lds
  s_add_u32 s23, s23, 4096
  s_add_u32 s24, s24, 4096
  s_mov_b32 m0, s24
  s_nop 0
  buffer_load_dwordx4 v1, s[4:7], s23 offen sc1 lds
  s_add_u32 s23, s23, 4096
  s_add_u32 s24, s24, 4096
  s_mov_b32 m0, s24
  s_nop 0
  buffer_load_dwordx4 v1, s[4:7], s23 offen sc1 lds
  s_mov_b32 s16, s17
  s_add_u32 s17, s16, 1
  s_xor_b32 s28, s28, 0x10000
  s_waitcnt lgkmcnt(0)
  v_readfirstlane_b32 s36, v5
  s_cmp_ge_u32 s36, 14
  s_cbranch_scc0 g5chase_265
  s_waitcnt vmcnt(0)
  s_barrier
  v_xor_b32 v2, 0x10000, v2
  ds_read_b32 v5, v7
  ds_read_b128 v[16:19], v2 offset:0
  ds_read_b128 v[20:23], v2 offset:1024
  ds_read_b128 v[24:27], v2 offset:2048
  ds_read_b128 v[28:31], v2 offset:3072
  ds_read_b128 v[32:35], v2 offset:4096
  ds_read_b128 v[36:39], v2 offset:5120
  ds_read_b128 v[40:43], v2 offset:6144
  v_xor_b32 v7, 4, v7
  s_branch g5dec_251
g5chase_265:
  v_xor_b32 v2, 0x10000, v2
  s_waitcnt vmcnt(10)
  s_barrier
  ds_read_b128 v[16:19], v2 offset:0
  ds_read_b128 v[20:23], v2 offset:1024
  ds_read_b128 v[24:27], v2 offset:2048
  ds_read_b128 v[28:31], v2 offset:3072
  ds_read_b128 v[32:35], v2 offset:4096
  ds_read_b128 v[36:39], v2 offset:5120
  ds_read_b128 v[40:43], v2 offset:6144
  s_waitcnt lgkmcnt(6)
  v_mfma_f32_32x32x16_bf16 v[48:63], a[0:3], v[16:19], 0
  ds_read_b128 v[44:47], v2 offset:7168
  s_waitcnt lgkmcnt(6)
  v_mfma_f32_32x32x16_bf16 v[48:63], a[4:7], v[20:23], v[48:63]
  ds_read_b128 v[16:19], v2 offset:8192
  s_waitcnt lgkmcnt(6)
  v_mfma_f32_32x32x16_bf16 v[48:63], a[8:11], v[24:27], v[48:63]
  ds_read_b128 v[20:23], v2 offset:9216
  s_waitcnt lgkmcnt(6)
  v_mfma_f32_32x32x16_bf16 v[48:63], a[12:15], v[28:31], v[48:63]
  ds_read_b128 v[24:27], v2 offset:10240
  s_waitcnt lgkmcnt(6)
  v_mfma_f32_32x32x16_bf16 v[48:63], a[16:19], v[32:35], v[48:63]
  ds_read_b128 v[28:31], v2 offset:11264
  s_waitcnt lgkmcnt(6)
  v_mfma_f32_32x32x16_bf16 v[48:63], a[20:23], v[36:39], v[48:63]
  ds_read_b128 v[32:35], v2 offset:12288
  s_waitcnt lgkmcnt(6)
  v_mfma_f32_32x32x16_bf16 v[48:63], a[24:27], v[40:43], v[48:63]
  ds_read_b128 v[36:39], v2 offset:13312
  s_waitcnt lgkmcnt(6)
  v_mfma_f32_32x32x16_bf16 v[48:63], a[28:31], v[44:47], v[48:63]
  ds_read_b128 v[40:43], v2 offset:14336
  s_waitcnt lgkmcnt(6)
  v_mfma_f32_32x32x16_bf16 v[48:63], a[32:35], v[16:19], v[48:63]
  ds_read_b128 v[44:47], v2 offset:15360
  s_waitcnt lgkmcnt(6)
  v_mfma_f32_32x32x16_bf16 v[48:63], a[36:39], v[20:23], v[48:63]
  s_waitcnt vmcnt(6)
  s_barrier
  ds_read_b128 v[16:19], v2 offset:16384
  s_waitcnt lgkmcnt(6)
  v_mfma_f32_32x32x16_bf16 v[48:63], a[40:43], v[24:27], v[48:63]
  ds_read_b128 v[20:23], v2 offset:17408
  s_waitcnt lgkmcnt(6)
  v_mfma_f32_32x32x16_bf16 v[48:63], a[44:47], v[28:31], v[48:63]
  ds_read_b128 v[24:27], v2 offset:18432
  s_waitcnt lgkmcnt(6)
  v_mfma_f32_32x32x16_bf16 v[48:63], a[48:51], v[32:35], v[48:63]
  ds_read_b128 v[28:31], v2 offset:19456
  s_waitcnt lgkmcnt(6)
  v_mfma_f32_32x32x16_bf16 v[48:63], a[52:55], v[36:39], v[48:63]
  ds_read_b128 v[32:35], v2 offset:20480
  s_waitcnt lgkmcnt(6)
  v_mfma_f32_32x32x16_bf16 v[48:63], a[56:59], v[40:43], v[48:63]
  ds_read_b128 v[36:39], v2 offset:21504
  s_waitcnt lgkmcnt(6)
  v_mfma_f32_32x32x16_bf16 v[48:63], a[60:63], v[44:47], v[48:63]
  ds_read_b128 v[40:43], v2 offset:22528
  s_waitcnt lgkmcnt(6)
  v_mfma_f32_32x32x16_bf16 v[48:63], a[64:67], v[16:19], v[48:63]
  ds_read_b128 v[44:47], v2 offset:23552
  s_waitcnt lgkmcnt(6)
  v_mfma_f32_32x32x16_bf16 v[48:63], a[68:71], v[20:23], v[48:63]
  ds_read_b128 v[16:19], v2 offset:24576
  s_waitcnt lgkmcnt(6)
  v_mfma_f32_32x32x16_bf16 v[48:63], a[72:75], v[24:27], v[48:63]
  ds_read_b128 v[20:23], v2 offset:25600
  s_waitcnt lgkmcnt(6)
  v_mfma_f32_32x32x16_bf16 v[48:63], a[76:79], v[28:31], v[48:63]
  ds_read_b128 v[24:27], v2 offset:26624
  s_waitcnt lgkmcnt(6)
  v_mfma_f32_32x32x16_bf16 v[48:63], a[80:83], v[32:35], v[48:63]
  ds_read_b128 v[28:31], v2 offset:27648
  s_waitcnt lgkmcnt(6)
  v_mfma_f32_32x32x16_bf16 v[48:63], a[84:87], v[36:39], v[48:63]
  ds_read_b128 v[32:35], v2 offset:28672
  s_waitcnt lgkmcnt(6)
  v_mfma_f32_32x32x16_bf16 v[48:63], a[88:91], v[40:43], v[48:63]
  ds_read_b128 v[36:39], v2 offset:29696
  s_waitcnt lgkmcnt(6)
  v_mfma_f32_32x32x16_bf16 v[48:63], a[92:95], v[44:47], v[48:63]
  ds_read_b128 v[40:43], v2 offset:30720
  s_waitcnt lgkmcnt(6)
  v_mfma_f32_32x32x16_bf16 v[48:63], a[96:99], v[16:19], v[48:63]
  ds_read_b128 v[44:47], v2 offset:31744
  s_waitcnt lgkmcnt(6)
  v_mfma_f32_32x32x16_bf16 v[48:63], a[100:103], v[20:23], v[48:63]
  s_waitcnt vmcnt(2)
  s_barrier
  ds_read_b128 v[16:19], v2 offset:32768
  s_waitcnt lgkmcnt(6)
  v_mfma_f32_32x32x16_bf16 v[48:63], a[104:107], v[24:27], v[48:63]
  ds_read_b128 v[20:23], v2 offset:33792
  s_waitcnt lgkmcnt(6)
  v_mfma_f32_32x32x16_bf16 v[48:63], a[108:111], v[28:31], v[48:63]
  ds_read_b128 v[24:27], v2 offset:34816
  s_waitcnt lgkmcnt(6)
  v_mfma_f32_32x32x16_bf16 v[48:63], a[112:115], v[32:35], v[48:63]
  ds_read_b128 v[28:31], v2 offset:35840
  s_waitcnt lgkmcnt(6)
  v_mfma_f32_32x32x16_bf16 v[48:63], a[116:119], v[36:39], v[48:63]
  ds_read_b128 v[32:35], v2 offset:36864
  s_waitcnt lgkmcnt(6)
  v_mfma_f32_32x32x16_bf16 v[48:63], a[120:123], v[40:43], v[48:63]
  ds_read_b128 v[36:39], v2 offset:37888
  s_waitcnt lgkmcnt(6)
  v_mfma_f32_32x32x16_bf16 v[48:63], a[124:127], v[44:47], v[48:63]
  ds_read_b128 v[40:43], v2 offset:38912
  s_waitcnt lgkmcnt(6)
  v_mfma_f32_32x32x16_bf16 v[48:63], a[128:131], v[16:19], v[48:63]
  ds_read_b128 v[44:47], v2 offset:39936
  s_waitcnt lgkmcnt(6)
  v_mfma_f32_32x32x16_bf16 v[48:63], a[132:135], v[20:23], v[48:63]
  ds_read_b128 v[16:19], v2 offset:40960
  s_waitcnt lgkmcnt(6)
  v_mfma_f32_32x32x16_bf16 v[48:63], a[136:139], v[24:27], v[48:63]
  ds_read_b128 v[20:23], v2 offset:41984
  s_waitcnt lgkmcnt(6)
  v_mfma_f32_32x32x16_bf16 v[48:63], a[140:143], v[28:31], v[48:63]
  ds_read_b128 v[24:27], v2 offset:43008
  s_waitcnt lgkmcnt(6)
  v_mfma_f32_32x32x16_bf16 v[48:63], a[144:147], v[32:35], v[48:63]
  ds_read_b128 v[28:31], v2 offset:44032
  s_waitcnt lgkmcnt(6)
  v_mfma_f32_32x32x16_bf16 v[48:63], a[148:151], v[36:39], v[48:63]
  ds_read_b128 v[32:35], v2 offset:45056
  s_waitcnt lgkmcnt(6)
  v_mfma_f32_32x32x16_bf16 v[48:63], a[152:155], v[40:43], v[48:63]
  ds_read_b128 v[36:39], v2 offset:46080
  s_waitcnt lgkmcnt(6)
  v_mfma_f32_32x32x16_bf16 v[48:63], a[156:159], v[44:47], v[48:63]
  ds_read_b128 v[40:43], v2 offset:47104
  s_waitcnt lgkmcnt(6)
  v_mfma_f32_32x32x16_bf16 v[48:63], a[160:163], v[16:19], v[48:63]
  ds_read_b128 v[44:47], v2 offset:48128
  s_waitcnt lgkmcnt(6)
  v_mfma_f32_32x32x16_bf16 v[48:63], a[164:167], v[20:23], v[48:63]
  s_waitcnt vmcnt(0)
  s_barrier
  ds_read_b128 v[16:19], v2 offset:49152
  s_waitcnt lgkmcnt(6)
  v_mfma_f32_32x32x16_bf16 v[48:63], a[168:171], v[24:27], v[48:63]
  ds_read_b128 v[20:23], v2 offset:50176
  s_waitcnt lgkmcnt(6)
  v_mfma_f32_32x32x16_bf16 v[48:63], a[172:175], v[28:31], v[48:63]
  ds_read_b128 v[24:27], v2 offset:51200
  s_waitcnt lgkmcnt(6)
  v_mfma_f32_32x32x16_bf16 v[48:63], a[176:179], v[32:35], v[48:63]
  ds_read_b128 v[28:31], v2 offset:52224
  s_waitcnt lgkmcnt(6)
  v_mfma_f32_32x32x16_bf16 v[48:63], a[180:183], v[36:39], v[48:63]
  ds_read_b128 v[32:35], v2 offset:53248
  s_waitcnt lgkmcnt(6)
  v_mfma_f32_32x32x16_bf16 v[48:63], a[184:187], v[40:43], v[48:63]
  ds_read_b128 v[36:39], v2 offset:54272
  s_waitcnt lgkmcnt(6)
  v_mfma_f32_32x32x16_bf16 v[48:63], a[188:191], v[44:47], v[48:63]
  ds_read_b128 v[40:43], v2 offset:55296
  s_waitcnt lgkmcnt(6)
  v_mfma_f32_32x32x16_bf16 v[48:63], a[192:195], v[16:19], v[48:63]
  ds_read_b128 v[44:47], v2 offset:56320
  s_waitcnt lgkmcnt(6)
  v_mfma_f32_32x32x16_bf16 v[48:63], a[196:199], v[20:23], v[48:63]
  s_waitcnt lgkmcnt(5)
  v_mfma_f32_32x32x16_bf16 v[48:63], a[200:203], v[24:27], v[48:63]
  s_waitcnt lgkmcnt(4)
  v_mfma_f32_32x32x16_bf16 v[48:63], a[204:207], v[28:31], v[48:63]
  s_waitcnt lgkmcnt(3)
  v_mfma_f32_32x32x16_bf16 v[48:63], a[208:211], v[32:35], v[48:63]
  s_waitcnt lgkmcnt(2)
  v_mfma_f32_32x32x16_bf16 v[48:63], a[212:215], v[36:39], v[48:63]
  s_waitcnt lgkmcnt(1)
  v_mfma_f32_32x32x16_bf16 v[48:63], a[216:219], v[40:43], v[48:63]
  s_waitcnt lgkmcnt(0)
  v_mfma_f32_32x32x16_bf16 v[48:63], a[220:223], v[44:47], v[48:63]
  s_branch g5epi_261
g5done_253:
  s_waitcnt vmcnt(0)
  s_barrier
  s_branch k_dump_2
r4_220:
  s_sub_u32 s43, s37, 64
  s_cmp_ge_u32 s43, 56
  s_cbranch_scc0 rg4_272
  s_sub_u32 s43, s43, 40
  s_branch rc3_271
rg4_272:
  s_load_dwordx2 s[8:9], s[0:1], 64
  s_waitcnt lgkmcnt(0)
  s_mov_b32 s10, 7340032
  s_mov_b32 s11, 0x00020000
  s_load_dwordx2 s[32:33], s[0:1], 72
  s_waitcnt lgkmcnt(0)
  s_mov_b32 s34, 7340032
  s_mov_b32 s35, 0x00020000
  s_mul_i32 s41, s43, 4682
  s_lshr_b32 s41, s41, 16
  s_lshl_b32 s40, s43, 2
  s_add_u32 s40, s40, s14
  s_lshl_b32 s39, s40, 5
  v_and_b32 v10, 63, v0
  v_lshrrev_b32 v11, 5, v10
  v_lshlrev_b32 v11, 2, v11
  v_bfe_u32 v12, v10, 1, 2
  v_add_u32 v11, v11, v12
  s_mov_b32 s23, 7168
  v_mul_lo_u32 v11, v11, s23
  v_bfe_u32 v12, v10, 3, 2
  v_lshl_add_u32 v11, v12, 5, v11
  v_and_b32 v12, 1, v10
  v_lshl_add_u32 v8, v12, 4, v11
  v_lshrrev_b32 v11, 5, v10
  v_lshlrev_b32 v11, 10, v11
  v_bfe_u32 v12, v10, 2, 2
  v_lshl_add_u32 v11, v12, 5, v11
  v_bfe_u32 v12, v10, 4, 1
  v_lshl_add_u32 v11, v12, 12, v11
  v_and_b32 v12, 1, v10
  v_lshl_add_u32 v11, v12, 4, v11
  v_bfe_u32 v12, v10, 1, 1
  v_lshl_add_u32 v11, v12, 3, v11
  s_lshl_b32 s24, s14, 7
  v_add_u32 v9, s24, v11
  v_add_u32 v13, 0x10000, v9
  s_lshl_b32 s24, s14, 10
  s_and_b32 s23, s39, 0xffffff80
  s_mul_i32 s25, s14, 57344
  s_add_u32 s23, s23, s25
  s_add_u32 m0, s24, 0
  s_nop 0
  buffer_load_dwordx4 v8, s[8:11], s23 offen lds
  s_add_u32 m0, s24, 4096
  s_nop 0
  buffer_load_dwordx4 v8, s[32:35], s23 offen lds
  s_add_u32 s23, s23, 229376
  s_add_u32 m0, s24, 8192
  s_nop 0
  buffer_load_dwordx4 v8, s[8:11], s23 offen lds
  s_add_u32 m0, s24, 12288
  s_nop 0
  buffer_load_dwordx4 v8, s[32:35], s23 offen lds
  s_add_u32 s23, s23, 229376
  s_add_u32 m0, s24, 16384
  s_nop 0
  buffer_load_dwordx4 v8, s[8:11], s23 offen lds
  s_add_u32 m0, s24, 20480
  s_nop 0
  buffer_load_dwordx4 v8, s[32:35], s23 offen lds
  s_add_u32 s23, s23, 229376
  s_add_u32 m0, s24, 24576
  s_nop 0
  buffer_load_dwordx4 v8, s[8:11], s23 offen lds
  s_add_u32 m0, s24, 28672
  s_nop 0
  buffer_load_dwordx4 v8, s[32:35], s23 offen lds
  s_add_u32 s23, s23, 229376
  s_add_u32 m0, s24, 32768
  s_nop 0
  buffer_load_dwordx4 v8, s[8:11], s23 offen lds
  s_add_u32 m0, s24, 36864
  s_nop 0
  buffer_load_dwordx4 v8, s[32:35], s23 offen lds
  s_add_u32 s23, s23, 229376
  s_add_u32 m0, s24, 40960
  s_nop 0
  buffer_load_dwordx4 v8, s[8:11], s23 offen lds
  s_add_u32 m0, s24, 45056
  s_nop 0
  buffer_load_dwordx4 v8, s[32:35], s23 offen lds
  s_add_u32 s23, s23, 229376
  s_add_u32 m0, s24, 49152
  s_nop 0
  buffer_load_dwordx4 v8, s[8:11], s23 offen lds
  s_add_u32 m0, s24, 53248
  s_nop 0
  buffer_load_dwordx4 v8, s[32:35], s23 offen lds
  s_add_u32 s23, s23, 229376
  s_add_u32 m0, s24, 57344
  s_nop 0
  buffer_load_dwordx4 v8, s[8:11], s23 offen lds
  s_add_u32 m0, s24, 61440
  s_nop 0
  buffer_load_dwordx4 v8, s[32:35], s23 offen lds
  s_add_u32 s23, s23, 229376
  s_add_u32 m0, s24, 65536
  s_nop 0
  buffer_load_dwordx4 v8, s[8:11], s23 offen lds
  s_add_u32 m0, s24, 69632
  s_nop 0
  buffer_load_dwordx4 v8, s[32:35], s23 offen lds
  s_add_u32 s23, s23, 229376
  s_add_u32 m0, s24, 73728
  s_nop 0
  buffer_load_dwordx4 v8, s[8:11], s23 offen lds
  s_add_u32 m0, s24, 77824
  s_nop 0
  buffer_load_dwordx4 v8, s[32:35], s23 offen lds
  s_add_u32 s23, s23, 229376
  s_add_u32 m0, s24, 81920
  s_nop 0
  buffer_load_dwordx4 v8, s[8:11], s23 offen lds
  s_add_u32 m0, s24, 86016
  s_nop 0
  buffer_load_dwordx4 v8, s[32:35], s23 offen lds
  s_add_u32 s23, s23, 229376
  s_add_u32 m0, s24, 90112
  s_nop 0
  buffer_load_dwordx4 v8, s[8:11], s23 offen lds
  s_add_u32 m0, s24, 94208
  s_nop 0
  buffer_load_dwordx4 v8, s[32:35], s23 offen lds
  s_add_u32 s23, s23, 229376
  s_add_u32 m0, s24, 98304
  s_nop 0
  buffer_load_dwordx4 v8, s[8:11], s23 offen lds
  s_add_u32 m0, s24, 102400
  s_nop 0
  buffer_load_dwordx4 v8, s[32:35], s23 offen lds
  s_add_u32 s23, s23, 229376
  s_add_u32 m0, s24, 106496
  s_nop 0
  buffer_load_dwordx4 v8, s[8:11], s23 offen lds
  s_add_u32 m0, s24, 110592
  s_nop 0
  buffer_load_dwordx4 v8, s[32:35], s23 offen lds
  s_add_u32 s23, s23, 229376
  s_add_u32 m0, s24, 114688
  s_nop 0
  buffer_load_dwordx4 v8, s[8:11], s23 offen lds
  s_add_u32 m0, s24, 118784
  s_nop 0
  buffer_load_dwordx4 v8, s[32:35], s23 offen lds
  s_add_u32 s23, s23, 229376
  s_add_u32 m0, s24, 122880
  s_nop 0
  buffer_load_dwordx4 v8, s[8:11], s23 offen lds
  s_add_u32 m0, s24, 126976
  s_nop 0
  buffer_load_dwordx4 v8, s[32:35], s23 offen lds
  s_add_u32 s23, s23, 229376
  s_waitcnt vmcnt(16)
  s_barrier
  ds_read_b64_tr_b16 a[0:1], v9 offset:0
  ds_read_b64_tr_b16 a[2:3], v9 offset:512
  ds_read_b64_tr_b16 a[4:5], v9 offset:2048
  ds_read_b64_tr_b16 a[6:7], v9 offset:2560
  ds_read_b64_tr_b16 a[8:9], v9 offset:8192
  ds_read_b64_tr_b16 a[10:11], v9 offset:8704
  ds_read_b64_tr_b16 a[12:13], v9 offset:10240
  ds_read_b64_tr_b16 a[14:15], v9 offset:10752
  s_waitcnt lgkmcnt(4)
  ds_read_b64_tr_b16 a[16:17], v9 offset:16384
  ds_read_b64_tr_b16 a[18:19], v9 offset:16896
  ds_read_b64_tr_b16 a[20:21], v9 offset:18432
  ds_read_b64_tr_b16 a[22:23], v9 offset:18944
  ds_read_b64_tr_b16 a[24:25], v9 offset:24576
  ds_read_b64_tr_b16 a[26:27], v9 offset:25088
  ds_read_b64_tr_b16 a[28:29], v9 offset:26624
  ds_read_b64_tr_b16 a[30:31], v9 offset:27136
  s_waitcnt lgkmcnt(4)
  ds_read_b64_tr_b16 a[32:33], v9 offset:32768
  ds_read_b64_tr_b16 a[34:35], v9 offset:33280
  ds_read_b64_tr_b16 a[36:37], v9 offset:34816
  ds_read_b64_tr_b16 a[38:39], v9 offset:35328
  ds_read_b64_tr_b16 a[40:41], v9 offset:40960
  ds_read_b64_tr_b16 a[42:43], v9 offset:41472
  ds_read_b64_tr_b16 a[44:45], v9 offset:43008
  ds_read_b64_tr_b16 a[46:47], v9 offset:43520
  s_waitcnt lgkmcnt(4)
  ds_read_b64_tr_b16 a[48:49], v9 offset:49152
  ds_read_b64_tr_b16 a[50:51], v9 offset:49664
  ds_read_b64_tr_b16 a[52:53], v9 offset:51200
  ds_read_b64_tr_b16 a[54:55], v9 offset:51712
  ds_read_b64_tr_b16 a[56:57], v9 offset:57344
  ds_read_b64_tr_b16 a[58:59], v9 offset:57856
  ds_read_b64_tr_b16 a[60:61], v9 offset:59392
  ds_read_b64_tr_b16 a[62:63], v9 offset:59904
  s_waitcnt lgkmcnt(4)
  s_waitcnt lgkmcnt(0)
  s_barrier
  s_add_u32 m0, s24, 0
  s_nop 0
  buffer_load_dwordx4 v8, s[8:11], s23 offen lds
  s_add_u32 m0, s24, 4096
  s_nop 0
  buffer_load_dwordx4 v8, s[32:35], s23 offen lds
  s_add_u32 s23, s23, 229376
  s_add_u32 m0, s24, 8192
  s_nop 0
  buffer_load_dwordx4 v8, s[8:11], s23 offen lds
  s_add_u32 m0, s24, 12288
  s_nop 0
  buffer_load_dwordx4 v8, s[32:35], s23 offen lds
  s_add_u32 s23, s23, 229376
  s_add_u32 m0, s24, 16384
  s_nop 0
  buffer_load_dwordx4 v8, s[8:11], s23 offen lds
  s_add_u32 m0, s24, 20480
  s_nop 0
  buffer_load_dwordx4 v8, s[32:35], s23 offen lds
  s_add_u32 s23, s23, 229376
  s_add_u32 m0, s24, 24576
  s_nop 0
  buffer_load_dwordx4 v8, s[8:11], s23 offen lds
  s_add_u32 m0, s24, 28672
  s_nop 0
  buffer_load_dwordx4 v8, s[32:35], s23 offen lds
  s_add_u32 s23, s23, 229376
  s_add_u32 m0, s24, 32768
  s_nop 0
  buffer_load_dwordx4 v8, s[8:11], s23 offen lds
  s_add_u32 m0, s24, 36864
  s_nop 0
  buffer_load_dwordx4 v8, s[32:35], s23 offen lds
  s_add_u32 s23, s23, 229376
  s_add_u32 m0, s24, 40960
  s_nop 0
  buffer_load_dwordx4 v8, s[8:11], s23 offen lds
  s_add_u32 m0, s24, 45056
  s_nop 0
  buffer_load_dwordx4 v8, s[32:35], s23 offen lds
  s_add_u32 s23, s23, 229376
  s_add_u32 m0, s24, 49152
  s_nop 0
  buffer_load_dwordx4 v8, s[8:11], s23 offen lds
  s_add_u32 m0, s24, 53248
  s_nop 0
  buffer_load_dwordx4 v8, s[32:35], s23 offen lds
  s_add_u32 s23, s23, 229376
  s_add_u32 m0, s24, 57344
  s_nop 0
  buffer_load_dwordx4 v8, s[8:11], s23 offen lds
  s_add_u32 m0, s24, 61440
  s_nop 0
  buffer_load_dwordx4 v8, s[32:35], s23 offen lds
  s_add_u32 s23, s23, 229376
  s_waitcnt vmcnt(16)
  s_barrier
  ds_read_b64_tr_b16 a[64:65], v13 offset:0
  ds_read_b64_tr_b16 a[66:67], v13 offset:512
  ds_read_b64_tr_b16 a[68:69], v13 offset:2048
  ds_read_b64_tr_b16 a[70:71], v13 offset:2560
  ds_read_b64_tr_b16 a[72:73], v13 offset:8192
  ds_read_b64_tr_b16 a[74:75], v13 offset:8704
  ds_read_b64_tr_b16 a[76:77], v13 offset:10240
  ds_read_b64_tr_b16 a[78:79], v13 offset:10752
  s_waitcnt lgkmcnt(4)
  ds_read_b64_tr_b16 a[80:81], v13 offset:16384
  ds_read_b64_tr_b16 a[82:83], v13 offset:16896
  ds_read_b64_tr_b16 a[84:85], v13 offset:18432
  ds_read_b64_tr_b16 a[86:87], v13 offset:18944
  ds_read_b64_tr_b16 a[88:89], v13 offset:24576
  ds_read_b64_tr_b16 a[90:91], v13 offset:25088
  ds_read_b64_tr_b16 a[92:93], v13 offset:26624
  ds_read_b64_tr_b16 a[94:95], v13 offset:27136
  s_waitcnt lgkmcnt(4)
  ds_read_b64_tr_b16 a[96:97], v13 offset:32768
  ds_read_b64_tr_b16 a[98:99], v13 offset:33280
  ds_read_b64_tr_b16 a[100:101], v13 offset:34816
  ds_read_b64_tr_b16 a[102:103], v13 offset:35328
  ds_read_b64_tr_b16 a[104:105], v13 offset:40960
  ds_read_b64_tr_b16 a[106:107], v13 offset:41472
  ds_read_b64_tr_b16 a[108:109], v13 offset:43008
  ds_read_b64_tr_b16 a[110:111], v13 offset:43520
  s_waitcnt lgkmcnt(4)
  ds_read_b64_tr_b16 a[112:113], v13 offset:49152
  ds_read_b64_tr_b16 a[114:115], v13 offset:49664
  ds_read_b64_tr_b16 a[116:117], v13 offset:51200
  ds_read_b64_tr_b16 a[118:119], v13 offset:51712
  ds_read_b64_tr_b16 a[120:121], v13 offset:57344
  ds_read_b64_tr_b16 a[122:123], v13 offset:57856
  ds_read_b64_tr_b16 a[124:125], v13 offset:59392
  ds_read_b64_tr_b16 a[126:127], v13 offset:59904
  s_waitcnt lgkmcnt(4)
  s_waitcnt lgkmcnt(0)
  s_barrier
  s_add_u32 m0, s24, 65536
  s_nop 0
  buffer_load_dwordx4 v8, s[8:11], s23 offen lds
  s_add_u32 m0, s24, 69632
  s_nop 0
  buffer_load_dwordx4 v8, s[32:35], s23 offen lds
  s_add_u32 s23, s23, 229376
  s_add_u32 m0, s24, 73728
  s_nop 0
  buffer_load_dwordx4 v8, s[8:11], s23 offen lds
  s_add_u32 m0, s24, 77824
  s_nop 0
  buffer_load_dwordx4 v8, s[32:35], s23 offen lds
  s_add_u32 s23, s23, 229376
  s_add_u32 m0, s24, 81920
  s_nop 0
  buffer_load_dwordx4 v8, s[8:11], s23 offen lds
  s_add_u32 m0, s24, 86016
  s_nop 0
  buffer_load_dwordx4 v8, s[32:35], s23 offen lds
  s_add_u32 s23, s23, 229376
  s_add_u32 m0, s24, 90112
  s_nop 0
  buffer_load_dwordx4 v8, s[8:11], s23 offen lds
  s_add_u32 m0, s24, 94208
  s_nop 0
  buffer_load_dwordx4 v8, s[32:35], s23 offen lds
  s_add_u32 s23, s23, 229376
  s_add_u32 m0, s24, 98304
  s_nop 0
  buffer_load_dwordx4 v8, s[8:11], s23 offen lds
  s_add_u32 m0, s24, 102400
  s_nop 0
  buffer_load_dwordx4 v8, s[32:35], s23 offen lds
  s_add_u32 s23, s23, 229376
  s_add_u32 m0, s24, 106496
  s_nop 0
  buffer_load_dwordx4 v8, s[8:11], s23 offen lds
  s_add_u32 m0, s24, 110592
  s_nop 0
  buffer_load_dwordx4 v8, s[32:35], s23 offen lds
  s_add_u32 s23, s23, 229376
  s_add_u32 m0, s24, 114688
  s_nop 0
  buffer_load_dwordx4 v8, s[8:11], s23 offen lds
  s_add_u32 m0, s24, 118784
  s_nop 0
  buffer_load_dwordx4 v8, s[32:35], s23 offen lds
  s_add_u32 s23, s23, 229376
  s_add_u32 m0, s24, 122880
  s_nop 0
  buffer_load_dwordx4 v8, s[8:11], s23 offen lds
  s_add_u32 m0, s24, 126976
  s_nop 0
  buffer_load_dwordx4 v8, s[32:35], s23 offen lds
  s_add_u32 s23, s23, 229376
  s_waitcnt vmcnt(16)
  s_barrier
  ds_read_b64_tr_b16 a[128:129], v9 offset:0
  ds_read_b64_tr_b16 a[130:131], v9 offset:512
  ds_read_b64_tr_b16 a[132:133], v9 offset:2048
  ds_read_b64_tr_b16 a[134:135], v9 offset:2560
  ds_read_b64_tr_b16 a[136:137], v9 offset:8192
  ds_read_b64_tr_b16 a[138:139], v9 offset:8704
  ds_read_b64_tr_b16 a[140:141], v9 offset:10240
  ds_read_b64_tr_b16 a[142:143], v9 offset:10752
  s_waitcnt lgkmcnt(4)
  ds_read_b64_tr_b16 a[144:145], v9 offset:16384
  ds_read_b64_tr_b16 a[146:147], v9 offset:16896
  ds_read_b64_tr_b16 a[148:149], v9 offset:18432
  ds_read_b64_tr_b16 a[150:151], v9 offset:18944
  ds_read_b64_tr_b16 a[152:153], v9 offset:24576
  ds_read_b64_tr_b16 a[154:155], v9 offset:25088
  ds_read_b64_tr_b16 a[156:157], v9 offset:26624
  ds_read_b64_tr_b16 a[158:159], v9 offset:27136
  s_waitcnt lgkmcnt(4)
  ds_read_b64_tr_b16 a[160:161], v9 offset:32768
  ds_read_b64_tr_b16 a[162:163], v9 offset:33280
  ds_read_b64_tr_b16 a[164:165], v9 offset:34816
  ds_read_b64_tr_b16 a[166:167], v9 offset:35328
  ds_read_b64_tr_b16 a[168:169], v9 offset:40960
  ds_read_b64_tr_b16 a[170:171], v9 offset:41472
  ds_read_b64_tr_b16 a[172:173], v9 offset:43008
  ds_read_b64_tr_b16 a[174:175], v9 offset:43520
  s_waitcnt lgkmcnt(4)
  ds_read_b64_tr_b16 a[176:177], v9 offset:49152
  ds_read_b64_tr_b16 a[178:179], v9 offset:49664
  ds_read_b64_tr_b16 a[180:181], v9 offset:51200
  ds_read_b64_tr_b16 a[182:183], v9 offset:51712
  ds_read_b64_tr_b16 a[184:185], v9 offset:57344
  ds_read_b64_tr_b16 a[186:187], v9 offset:57856
  ds_read_b64_tr_b16 a[188:189], v9 offset:59392
  ds_read_b64_tr_b16 a[190:191], v9 offset:59904
  s_waitcnt lgkmcnt(4)
  s_waitcnt lgkmcnt(0)
  s_waitcnt vmcnt(0)
  s_barrier
  ds_read_b64_tr_b16 a[192:193], v13 offset:0
  ds_read_b64_tr_b16 a[194:195], v13 offset:512
  ds_read_b64_tr_b16 a[196:197], v13 offset:2048
  ds_read_b64_tr_b16 a[198:199], v13 offset:2560
  ds_read_b64_tr_b16 a[200:201], v13 offset:8192
  ds_read_b64_tr_b16 a[202:203], v13 offset:8704
  ds_read_b64_tr_b16 a[204:205], v13 offset:10240
  ds_read_b64_tr_b16 a[206:207], v13 offset:10752
  s_waitcnt lgkmcnt(4)
  ds_read_b64_tr_b16 a[208:209], v13 offset:16384
  ds_read_b64_tr_b16 a[210:211], v13 offset:16896
  ds_read_b64_tr_b16 a[212:213], v13 offset:18432
  ds_read_b64_tr_b16 a[214:215], v13 offset:18944
  ds_read_b64_tr_b16 a[216:217], v13 offset:24576
  ds_read_b64_tr_b16 a[218:219], v13 offset:25088
  ds_read_b64_tr_b16 a[220:221], v13 offset:26624
  ds_read_b64_tr_b16 a[222:223], v13 offset:27136
  s_waitcnt lgkmcnt(4)
  ds_read_b64_tr_b16 a[224:225], v13 offset:32768
  ds_read_b64_tr_b16 a[226:227], v13 offset:33280
  ds_read_b64_tr_b16 a[228:229], v13 offset:34816
  ds_read_b64_tr_b16 a[230:231], v13 offset:35328
  ds_read_b64_tr_b16 a[232:233], v13 offset:40960
  ds_read_b64_tr_b16 a[234:235], v13 offset:41472
  ds_read_b64_tr_b16 a[236:237], v13 offset:43008
  ds_read_b64_tr_b16 a[238:239], v13 offset:43520
  s_waitcnt lgkmcnt(4)
  ds_read_b64_tr_b16 a[240:241], v13 offset:49152
  ds_read_b64_tr_b16 a[242:243], v13 offset:49664
  ds_read_b64_tr_b16 a[244:245], v13 offset:51200
  ds_read_b64_tr_b16 a[246:247], v13 offset:51712
  ds_read_b64_tr_b16 a[248:249], v13 offset:57344
  ds_read_b64_tr_b16 a[250:251], v13 offset:57856
  ds_read_b64_tr_b16 a[252:253], v13 offset:59392
  ds_read_b64_tr_b16 a[254:255], v13 offset:59904
  s_waitcnt lgkmcnt(4)
  s_waitcnt lgkmcnt(0)
  s_mov_b32 s16, 0
  s_mov_b32 s18, 29360128
  s_mov_b32 s20, 12288
  s_lshl_b32 s19, s40, 10
  s_add_u32 s19, s19, 117440512
  s_lshl_b32 s21, s41, 6
  s_add_u32 s21, s21, 36864
  v_and_b32 v8, 63, v0
  v_lshlrev_b32 v1, 4, v8
  v_mov_b32 v2, v1
  v_mov_b32 v3, v1
  v_mov_b32 v6, 1
  s_mul_i32 s38, s14, 16384
  s_add_u32 s18, s18, s38
  s_mov_b32 s28, 0
  s_mov_b32 s22, 0
  v_mov_b32 v7, 131072
  s_cmp_lg_u32 s14, 0
  s_cbranch_scc1 w0_273
  s_mul_i32 s23, s16, 64
  s_add_u32 s23, s23, s20
p0_274:
  buffer_load_dword v5, off, s[4:7], s23 sc1
  s_waitcnt vmcnt(0)
  v_readfirstlane_b32 s24, v5
  s_cmp_ge_u32 s24, 8
  s_cbranch_scc1 p0ok_275
  s_cmp_eq_u32 s29, 0
  s_cbranch_scc1 p0ok_275
  s_sub_u32 s29, s29, 1
  s_branch p0_274
p0ok_275:
w0_273:
  s_barrier
  s_barrier
  s_mul_i32 s23, s16, 65536
  s_add_u32 s23, s23, s18
  s_add_u32 s24, s28, s38
  s_mov_b32 m0, s24
  s_nop 0
  buffer_load_dwordx4 v1, s[4:7], s23 offen offset:0 sc1 lds
  buffer_load_dwordx4 v1, s[4:7], s23 offen offset:1024 sc1 lds
  buffer_load_dwordx4 v1, s[4:7], s23 offen offset:2048 sc1 lds
  buffer_load_dwordx4 v1, s[4:7], s23 offen offset:3072 sc1 lds
  s_add_u32 s23, s23, 4096
  s_add_u32 s24, s24, 4096
  s_mov_b32 m0, s24
  s_nop 0
  buffer_load_dwordx4 v1, s[4:7], s23 offen offset:0 sc1 lds
  buffer_load_dwordx4 v1, s[4:7], s23 offen offset:1024 sc1 lds
  buffer_load_dwordx4 v1, s[4:7], s23 offen offset:2048 sc1 lds
  buffer_load_dwordx4 v1, s[4:7], s23 offen offset:3072 sc1 lds
  s_add_u32 s23, s23, 4096
  s_add_u32 s24, s24, 4096
  s_mov_b32 m0, s24
  s_nop 0
  buffer_load_dwordx4 v1, s[4:7], s23 offen offset:0 sc1 lds
  buffer_load_dwordx4 v1, s[4:7], s23 offen offset:1024 sc1 lds
  buffer_load_dwordx4 v1, s[4:7], s23 offen offset:2048 sc1 lds
  buffer_load_dwordx4 v1, s[4:7], s23 offen offset:3072 sc1 lds
  s_add_u32 s23, s23, 4096
  s_add_u32 s24, s24, 4096
  s_mov_b32 m0, s24
  s_nop 0
  buffer_load_dwordx4 v1, s[4:7], s23 offen offset:0 sc1 lds
  buffer_load_dwordx4 v1, s[4:7], s23 offen offset:1024 sc1 lds
  buffer_load_dwordx4 v1, s[4:7], s23 offen offset:2048 sc1 lds
  buffer_load_dwordx4 v1, s[4:7], s23 offen offset:3072 sc1 lds
  s_add_u32 s17, s16, 1
  v_mov_b32 v4, 0
  s_cmp_ge_u32 s17, 64
  s_cbranch_scc1 lf_276
  s_cmp_lg_u32 s14, 0
  s_cbranch_scc1 lf_276
  s_mul_i32 s23, s17, 64
  s_add_u32 s23, s23, s20
  buffer_load_dword v4, off, s[4:7], s23 sc1
lf_276:
  s_waitcnt vmcnt(0)
  s_cmp_lg_u32 s14, 0
  s_cbranch_scc1 w0_280
  ds_write_b32 v7, v4
  s_waitcnt lgkmcnt(0)
w0_280:
  s_barrier
  ds_read_b32 v5, v7
  ds_read_b128 v[16:19], v2 offset:0
  ds_read_b128 v[20:23], v2 offset:1024
  ds_read_b128 v[24:27], v2 offset:2048
  ds_read_b128 v[28:31], v2 offset:3072
  ds_read_b128 v[32:35], v2 offset:4096
  ds_read_b128 v[36:39], v2 offset:5120
  ds_read_b128 v[40:43], v2 offset:6144
  v_xor_b32 v7, 4, v7
g4dec_277:
  s_waitcnt lgkmcnt(7)
  v_readfirstlane_b32 s36, v5
  s_cmp_ge_u32 s36, 8
  s_cbranch_scc0 g4npre_278
  s_add_u32 s15, s17, 1
  v_mov_b32 v4, 0
  s_cmp_ge_u32 s15, 64
  s_cbranch_scc1 lf_281
  s_cmp_lg_u32 s14, 0
  s_cbranch_scc1 lf_281
  s_mul_i32 s23, s15, 64
  s_add_u32 s23, s23, s20
  buffer_load_dword v4, off, s[4:7], s23 sc1
lf_281:
  s_mul_i32 s26, s17, 65536
  s_add_u32 s26, s26, s18
  s_xor_b32 s27, s28, 0x10000
  s_add_u32 s27, s27, s38
  s_waitcnt lgkmcnt(6)
  v_mfma_f32_32x32x16_bf16 v[48:63], a[0:3], v[16:19], 0
  ds_read_b128 v[44:47], v2 offset:7168
  s_mov_b32 m0, s27
  s_nop 0
  buffer_load_dwordx4 v1, s[4:7], s26 offen offset:0 sc1 lds
  s_waitcnt lgkmcnt(6)
  v_mfma_f32_32x32x16_bf16 v[48:63], a[4:7], v[20:23], v[48:63]
  ds_read_b128 v[16:19], v2 offset:8192
  s_waitcnt lgkmcnt(6)
  v_mfma_f32_32x32x16_bf16 v[48:63], a[8:11], v[24:27], v[48:63]
  ds_read_b128 v[20:23], v2 offset:9216
  buffer_load_dwordx4 v1, s[4:7], s26 offen offset:1024 sc1 lds
  s_waitcnt lgkmcnt(6)
  v_mfma_f32_32x32x16_bf16 v[48:63], a[12:15], v[28:31], v[48:63]
  ds_read_b128 v[24:27], v2 offset:10240
  s_waitcnt lgkmcnt(6)
  v_mfma_f32_32x32x16_bf16 v[48:63], a[16:19], v[32:35], v[48:63]
  ds_read_b128 v[28:31], v2 offset:11264
  buffer_load_dwordx4 v1, s[4:7], s26 offen offset:2048 sc1 lds
  s_waitcnt lgkmcnt(6)
  v_mfma_f32_32x32x16_bf16 v[48:63], a[20:23], v[36:39], v[48:63]
  ds_read_b128 v[32:35], v2 offset:12288
  s_waitcnt lgkmcnt(6)
  v_mfma_f32_32x32x16_bf16 v[48:63], a[24:27], v[40:43], v[48:63]
  ds_read_b128 v[36:39], v2 offset:13312
  buffer_load_dwordx4 v1, s[4:7], s26 offen offset:3072 sc1 lds
  s_add_u32 s26, s26, 4096
  s_add_u32 s27, s27, 4096
  s_waitcnt lgkmcnt(6)
  v_mfma_f32_32x32x16_bf16 v[48:63], a[28:31], v[44:47], v[48:63]
  ds_read_b128 v[40:43], v2 offset:14336
  s_waitcnt lgkmcnt(6)
  v_mfma_f32_32x32x16_bf16 v[48:63], a[32:35], v[16:19], v[48:63]
  ds_read_b128 v[44:47], v2 offset:15360
  s_mov_b32 m0, s27
  s_nop 0
  buffer_load_dwordx4 v1, s[4:7], s26 offen offset:0 sc1 lds
  s_waitcnt lgkmcnt(6)
  v_mfma_f32_32x32x16_bf16 v[48:63], a[36:39], v[20:23], v[48:63]
  ds_read_b128 v[16:19], v2 offset:16384
  s_waitcnt lgkmcnt(6)
  v_mfma_f32_32x32x16_bf16 v[48:63], a[40:43], v[24:27], v[48:63]
  ds_read_b128 v[20:23], v2 offset:17408
  buffer_load_dwordx4 v1, s[4:7], s26 offen offset:1024 sc1 lds
  s_waitcnt lgkmcnt(6)
  v_mfma_f32_32x32x16_bf16 v[48:63], a[44:47], v[28:31], v[48:63]
  ds_read_b128 v[24:27], v2 offset:18432
  s_waitcnt lgkmcnt(6)
  v_mfma_f32_32x32x16_bf16 v[48:63], a[48:51], v[32:35], v[48:63]
  ds_read_b128 v[28:31], v2 offset:19456
  buffer_load_dwordx4 v1, s[4:7], s26 offen offset:2048 sc1 lds
  s_waitcnt lgkmcnt(6)
  v_mfma_f32_32x32x16_bf16 v[48:63], a[52:55], v[36:39], v[48:63]
  ds_read_b128 v[32:35], v2 offset:20480
  s_waitcnt lgkmcnt(6)
  v_mfma_f32_32x32x16_bf16 v[48:63], a[56:59], v[40:43], v[48:63]
  ds_read_b128 v[36:39], v2 offset:21504
  buffer_load_dwordx4 v1, s[4:7], s26 offen offset:3072 sc1 lds
  s_add_u32 s26, s26, 4096
  s_add_u32 s27, s27, 4096
  s_waitcnt lgkmcnt(6)
  v_mfma_f32_32x32x16_bf16 v[48:63], a[60:63], v[44:47], v[48:63]
  ds_read_b128 v[40:43], v2 offset:22528
  s_waitcnt lgkmcnt(6)
  v_mfma_f32_32x32x16_bf16 v[48:63], a[64:67], v[16:19], v[48:63]
  ds_read_b128 v[44:47], v2 offset:23552
  s_mov_b32 m0, s27
  s_nop 0
  buffer_load_dwordx4 v1, s[4:7], s26 offen offset:0 sc1 lds
  s_waitcnt lgkmcnt(6)
  v_mfma_f32_32x32x16_bf16 v[48:63], a[68:71], v[20:23], v[48:63]
  ds_read_b128 v[16:19], v2 offset:24576
  s_waitcnt lgkmcnt(6)
  v_mfma_f32_32x32x16_bf16 v[48:63], a[72:75], v[24:27], v[48:63]
  ds_read_b128 v[20:23], v2 offset:25600
  buffer_load_dwordx4 v1, s[4:7], s26 offen offset:1024 sc1 lds
  s_waitcnt lgkmcnt(6)
  v_mfma_f32_32x32x16_bf16 v[48:63], a[76:79], v[28:31], v[48:63]
  ds_read_b128 v[24:27], v2 offset:26624
  s_waitcnt lgkmcnt(6)
  v_mfma_f32_32x32x16_bf16 v[48:63], a[80:83], v[32:35], v[48:63]
  ds_read_b128 v[28:31], v2 offset:27648
  buffer_load_dwordx4 v1, s[4:7], s26 offen offset:2048 sc1 lds
  s_waitcnt lgkmcnt(6)
  v_mfma_f32_32x32x16_bf16 v[48:63], a[84:87], v[36:39], v[48:63]
  ds_read_b128 v[32:35], v2 offset:28672
  s_waitcnt lgkmcnt(6)
  v_mfma_f32_32x32x16_bf16 v[48:63], a[88:91], v[40:43], v[48:63]
  ds_read_b128 v[36:39], v2 offset:29696
  buffer_load_dwordx4 v1, s[4:7], s26 offen offset:3072 sc1 lds
  s_add_u32 s26, s26, 4096
  s_add_u32 s27, s27, 4096
  s_waitcnt lgkmcnt(6)
  v_mfma_f32_32x32x16_bf16 v[48:63], a[92:95], v[44:47], v[48:63]
  ds_read_b128 v[40:43], v2 offset:30720
  s_waitcnt lgkmcnt(6)
  v_mfma_f32_32x32x16_bf16 v[48:63], a[96:99], v[16:19], v[48:63]
  ds_read_b128 v[44:47], v2 offset:31744
  s_cmp_eq_u32 s22, 0
  s_cbranch_scc1 nsig_282
  s_waitcnt vmcnt(12)
  s_barrier
  s_cmp_lg_u32 s14, 0
  s_cbranch_scc1 sig_283
  s_mov_b64 exec, 1
  buffer_atomic_add v6, off, s[4:7], s22 sc1
  s_mov_b64 exec, -1
sig_283:
  s_mov_b32 s22, 0
nsig_282:
  s_mov_b32 m0, s27
  s_nop 0
  buffer_load_dwordx4 v1, s[4:7], s26 offen offset:0 sc1 lds
  s_waitcnt lgkmcnt(6)
  v_mfma_f32_32x32x16_bf16 v[48:63], a[100:103], v[20:23], v[48:63]
  ds_read_b128 v[16:19], v2 offset:32768
  s_waitcnt lgkmcnt(6)
  v_mfma_f32_32x32x16_bf16 v[48:63], a[104:107], v[24:27], v[48:63]
  ds_read_b128 v[20:23], v2 offset:33792
  buffer_load_dwordx4 v1, s[4:7], s26 offen offset:1024 sc1 lds
  s_waitcnt lgkmcnt(6)
  v_mfma_f32_32x32x16_bf16 v[48:63], a[108:111], v[28:31], v[48:63]
  ds_read_b128 v[24:27], v2 offset:34816
  s_waitcnt lgkmcnt(6)
  v_mfma_f32_32x32x16_bf16 v[48:63], a[112:115], v[32:35], v[48:63]
  ds_read_b128 v[28:31], v2 offset:35840
  buffer_load_dwordx4 v1, s[4:7], s26 offen offset:2048 sc1 lds
  s_waitcnt lgkmcnt(6)
  v_mfma_f32_32x32x16_bf16 v[48:63], a[116:119], v[36:39], v[48:63]
  ds_read_b128 v[32:35], v2 offset:36864
  s_waitcnt lgkmcnt(6)
  v_mfma_f32_32x32x16_bf16 v[48:63], a[120:123], v[40:43], v[48:63]
  ds_read_b128 v[36:39], v2 offset:37888
  buffer_load_dwordx4 v1, s[4:7], s26 offen offset:3072 sc1 lds
  s_waitcnt lgkmcnt(6)
  v_mfma_f32_32x32x16_bf16 v[48:63], a[124:127], v[44:47], v[48:63]
  ds_read_b128 v[40:43], v2 offset:38912
  s_waitcnt lgkmcnt(6)
  v_mfma_f32_32x32x16_bf16 v[48:63], a[128:131], v[16:19], v[48:63]
  ds_read_b128 v[44:47], v2 offset:39936
  s_waitcnt lgkmcnt(6)
  v_mfma_f32_32x32x16_bf16 v[48:63], a[132:135], v[20:23], v[48:63]
  ds_read_b128 v[16:19], v2 offset:40960
  s_waitcnt lgkmcnt(6)
  v_mfma_f32_32x32x16_bf16 v[48:63], a[136:139], v[24:27], v[48:63]
  ds_read_b128 v[20:23], v2 offset:41984
  s_waitcnt lgkmcnt(6)
  v_mfma_f32_32x32x16_bf16 v[48:63], a[140:143], v[28:31], v[48:63]
  ds_read_b128 v[24:27], v2 offset:43008
  s_waitcnt lgkmcnt(6)
  v_mfma_f32_32x32x16_bf16 v[48:63], a[144:147], v[32:35], v[48:63]
  ds_read_b128 v[28:31], v2 offset:44032
  s_waitcnt lgkmcnt(6)
  v_mfma_f32_32x32x16_bf16 v[48:63], a[148:151], v[36:39], v[48:63]
  ds_read_b128 v[32:35], v2 offset:45056
  s_waitcnt lgkmcnt(6)
  v_mfma_f32_32x32x16_bf16 v[48:63], a[152:155], v[40:43], v[48:63]
  ds_read_b128 v[36:39], v2 offset:46080
  s_waitcnt lgkmcnt(6)
  v_mfma_f32_32x32x16_bf16 v[48:63], a[156:159], v[44:47], v[48:63]
  ds_read_b128 v[40:43], v2 offset:47104
  s_waitcnt lgkmcnt(6)
  v_mfma_f32_32x32x16_bf16 v[48:63], a[160:163], v[16:19], v[48:63]
  ds_read_b128 v[44:47], v2 offset:48128
  s_waitcnt lgkmcnt(6)
  v_mfma_f32_32x32x16_bf16 v[48:63], a[164:167], v[20:23], v[48:63]
  ds_read_b128 v[16:19], v2 offset:49152
  s_waitcnt lgkmcnt(6)
  v_mfma_f32_32x32x16_bf16 v[48:63], a[168:171], v[24:27], v[48:63]
  ds_read_b128 v[20:23], v2 offset:50176
  s_waitcnt lgkmcnt(6)
  v_mfma_f32_32x32x16_bf16 v[48:63], a[172:175], v[28:31], v[48:63]
  ds_read_b128 v[24:27], v2 offset:51200
  s_waitcnt lgkmcnt(6)
  v_mfma_f32_32x32x16_bf16 v[48:63], a[176:179], v[32:35], v[48:63]
  ds_read_b128 v[28:31], v2 offset:52224
  s_cmp_lg_u32 s14, 0
  s_cbranch_scc1 w0_284
  s_waitcnt vmcnt(16)
  ds_write_b32 v7, v4
w0_284:
  s_waitcnt lgkmcnt(6)
  v_mfma_f32_32x32x16_bf16 v[48:63], a[180:183], v[36:39], v[48:63]
  ds_read_b128 v[32:35], v2 offset:53248
  s_waitcnt lgkmcnt(6)
  v_mfma_f32_32x32x16_bf16 v[48:63], a[184:187], v[40:43], v[48:63]
  ds_read_b128 v[36:39], v2 offset:54272
  s_waitcnt lgkmcnt(6)
  v_mfma_f32_32x32x16_bf16 v[48:63], a[188:191], v[44:47], v[48:63]
  ds_read_b128 v[40:43], v2 offset:55296
  s_waitcnt lgkmcnt(6)
  v_mfma_f32_32x32x16_bf16 v[48:63], a[192:195], v[16:19], v[48:63]
  ds_read_b128 v[44:47], v2 offset:56320
  s_waitcnt lgkmcnt(6)
  v_mfma_f32_32x32x16_bf16 v[48:63], a[196:199], v[20:23], v[48:63]
  ds_read_b128 v[16:19], v2 offset:57344
  s_waitcnt lgkmcnt(6)
  v_mfma_f32_32x32x16_bf16 v[48:63], a[200:203], v[24:27], v[48:63]
  ds_read_b128 v[20:23], v2 offset:58368
  s_waitcnt lgkmcnt(6)
  v_mfma_f32_32x32x16_bf16 v[48:63], a[204:207], v[28:31], v[48:63]
  ds_read_b128 v[24:27], v2 offset:59392
  s_waitcnt lgkmcnt(6)
  v_mfma_f32_32x32x16_bf16 v[48:63], a[208:211], v[32:35], v[48:63]
  ds_read_b128 v[28:31], v2 offset:60416
  s_waitcnt lgkmcnt(6)
  v_mfma_f32_32x32x16_bf16 v[48:63], a[212:215], v[36:39], v[48:63]
  ds_read_b128 v[32:35], v2 offset:61440
  s_waitcnt lgkmcnt(6)
  v_mfma_f32_32x32x16_bf16 v[48:63], a[216:219], v[40:43], v[48:63]
  ds_read_b128 v[36:39], v2 offset:62464
  s_waitcnt lgkmcnt(6)
  v_mfma_f32_32x32x16_bf16 v[48:63], a[220:223], v[44:47], v[48:63]
  ds_read_b128 v[40:43], v2 offset:63488
  s_waitcnt lgkmcnt(6)
  v_mfma_f32_32x32x16_bf16 v[48:63], a[224:227], v[16:19], v[48:63]
  ds_read_b128 v[44:47], v2 offset:64512
  s_waitcnt lgkmcnt(6)
  v_mfma_f32_32x32x16_bf16 v[48:63], a[228:231], v[20:23], v[48:63]
  s_waitcnt lgkmcnt(5)
  v_mfma_f32_32x32x16_bf16 v[48:63], a[232:235], v[24:27], v[48:63]
  s_waitcnt lgkmcnt(4)
  v_mfma_f32_32x32x16_bf16 v[48:63], a[236:239], v[28:31], v[48:63]
  s_waitcnt lgkmcnt(3)
  v_mfma_f32_32x32x16_bf16 v[48:63], a[240:243], v[32:35], v[48:63]
  s_waitcnt lgkmcnt(2)
  v_mfma_f32_32x32x16_bf16 v[48:63], a[244:247], v[36:39], v[48:63]
  s_waitcnt lgkmcnt(1)
  v_mfma_f32_32x32x16_bf16 v[48:63], a[248:251], v[40:43], v[48:63]
  s_waitcnt lgkmcnt(0)
  v_mfma_f32_32x32x16_bf16 v[48:63], a[252:255], v[44:47], v[48:63]
  s_waitcnt vmcnt(0)
  s_barrier
  v_xor_b32 v2, 0x10000, v2
  ds_read_b32 v5, v7
  ds_read_b128 v[16:19], v2 offset:0
  ds_read_b128 v[20:23], v2 offset:1024
  ds_read_b128 v[24:27], v2 offset:2048
  ds_read_b128 v[28:31], v2 offset:3072
  ds_read_b128 v[32:35], v2 offset:4096
  ds_read_b128 v[36:39], v2 offset:5120
  ds_read_b128 v[40:43], v2 offset:6144
  v_xor_b32 v7, 4, v7
  s_mul_i32 s23, s16, 229376
  s_add_u32 s23, s23, s19
  s_mov_b32 s24, 0xbfb8aa3b
  v_mul_f32 v80, s24, v48
  v_mul_f32 v81, s24, v49
  v_mul_f32 v82, s24, v50
  v_mul_f32 v83, s24, v51
  v_mul_f32 v84, s24, v52
  v_mul_f32 v85, s24, v53
  v_mul_f32 v86, s24, v54
  v_mul_f32 v87, s24, v55
  v_exp_f32 v80, v80
  v_exp_f32 v81, v81
  v_exp_f32 v82, v82
  v_exp_f32 v83, v83
  v_exp_f32 v84, v84
  v_exp_f32 v85, v85
  v_exp_f32 v86, v86
  v_exp_f32 v87, v87
  v_mul_f32 v56, v48, v56
  v_mul_f32 v57, v49, v57
  v_mul_f32 v58, v50, v58
  v_mul_f32 v59, v51, v59
  v_mul_f32 v60, v52, v60
  v_mul_f32 v61, v53, v61
  v_mul_f32 v62, v54, v62
  v_mul_f32 v63, v55, v63
  v_add_f32 v80, 1.0, v80
  v_add_f32 v81, 1.0, v81
  v_add_f32 v82, 1.0, v82
  v_add_f32 v83, 1.0, v83
  v_add_f32 v84, 1.0, v84
  v_add_f32 v85, 1.0, v85
  v_add_f32 v86, 1.0, v86
  v_add_f32 v87, 1.0, v87
  v_rcp_f32 v80, v80
  v_rcp_f32 v81, v81
  v_rcp_f32 v82, v82
  v_rcp_f32 v83, v83
  v_rcp_f32 v84, v84
  v_rcp_f32 v85, v85
  v_rcp_f32 v86, v86
  v_rcp_f32 v87, v87
  v_mul_f32 v56, v56, v80
  v_mul_f32 v57, v57, v81
  v_mul_f32 v58, v58, v82
  v_mul_f32 v59, v59, v83
  v_mul_f32 v60, v60, v84
  v_mul_f32 v61, v61, v85
  v_mul_f32 v62, v62, v86
  v_mul_f32 v63, v63, v87
  v_cvt_pk_bf16_f32 v80, v56, v57
  v_cvt_pk_bf16_f32 v81, v58, v59
  v_cvt_pk_bf16_f32 v82, v60, v61
  v_cvt_pk_bf16_f32 v83, v62, v63
  buffer_store_dwordx4 v[80:83], v3, s[4:7], s23 offen sc1
  s_mul_i32 s22, s16, 256
  s_add_u32 s22, s22, s21
  s_mov_b32 s16, s17
  s_add_u32 s17, s16, 1
  s_xor_b32 s28, s28, 0x10000
  s_branch g4dec_277
g4npre_278:
  s_waitcnt lgkmcnt(6)
  v_mfma_f32_32x32x16_bf16 v[48:63], a[0:3], v[16:19], 0
  ds_read_b128 v[44:47], v2 offset:7168
  s_waitcnt lgkmcnt(6)
  v_mfma_f32_32x32x16_bf16 v[48:63], a[4:7], v[20:23], v[48:63]
  ds_read_b128 v[16:19], v2 offset:8192
  s_waitcnt lgkmcnt(6)
  v_mfma_f32_32x32x16_bf16 v[48:63], a[8:11], v[24:27], v[48:63]
  ds_read_b128 v[20:23], v2 offset:9216
  s_waitcnt lgkmcnt(6)
  v_mfma_f32_32x32x16_bf16 v[48:63], a[12:15], v[28:31], v[48:63]
  ds_read_b128 v[24:27], v2 offset:10240
  s_waitcnt lgkmcnt(6)
  v_mfma_f32_32x32x16_bf16 v[48:63], a[16:19], v[32:35], v[48:63]
  ds_read_b128 v[28:31], v2 offset:11264
  s_waitcnt lgkmcnt(6)
  v_mfma_f32_32x32x16_bf16 v[48:63], a[20:23], v[36:39], v[48:63]
  ds_read_b128 v[32:35], v2 offset:12288
  s_waitcnt lgkmcnt(6)
  v_mfma_f32_32x32x16_bf16 v[48:63], a[24:27], v[40:43], v[48:63]
  ds_read_b128 v[36:39], v2 offset:13312
  s_waitcnt lgkmcnt(6)
  v_mfma_f32_32x32x16_bf16 v[48:63], a[28:31], v[44:47], v[48:63]
  ds_read_b128 v[40:43], v2 offset:14336
  s_waitcnt lgkmcnt(6)
  v_mfma_f32_32x32x16_bf16 v[48:63], a[32:35], v[16:19], v[48:63]
  ds_read_b128 v[44:47], v2 offset:15360
  s_waitcnt lgkmcnt(6)
  v_mfma_f32_32x32x16_bf16 v[48:63], a[36:39], v[20:23], v[48:63]
  ds_read_b128 v[16:19], v2 offset:16384
  s_waitcnt lgkmcnt(6)
  v_mfma_f32_32x32x16_bf16 v[48:63], a[40:43], v[24:27], v[48:63]
  ds_read_b128 v[20:23], v2 offset:17408
  s_waitcnt lgkmcnt(6)
  v_mfma_f32_32x32x16_bf16 v[48:63], a[44:47], v[28:31], v[48:63]
  ds_read_b128 v[24:27], v2 offset:18432
  s_waitcnt lgkmcnt(6)
  v_mfma_f32_32x32x16_bf16 v[48:63], a[48:51], v[32:35], v[48:63]
  ds_read_b128 v[28:31], v2 offset:19456
  s_waitcnt lgkmcnt(6)
  v_mfma_f32_32x32x16_bf16 v[48:63], a[52:55], v[36:39], v[48:63]
  ds_read_b128 v[32:35], v2 offset:20480
  s_waitcnt lgkmcnt(6)
  v_mfma_f32_32x32x16_bf16 v[48:63], a[56:59], v[40:43], v[48:63]
  ds_read_b128 v[36:39], v2 offset:21504
  s_waitcnt lgkmcnt(6)
  v_mfma_f32_32x32x16_bf16 v[48:63], a[60:63], v[44:47], v[48:63]
  ds_read_b128 v[40:43], v2 offset:22528
  s_waitcnt lgkmcnt(6)
  v_mfma_f32_32x32x16_bf16 v[48:63], a[64:67], v[16:19], v[48:63]
  ds_read_b128 v[44:47], v2 offset:23552
  s_waitcnt lgkmcnt(6)
  v_mfma_f32_32x32x16_bf16 v[48:63], a[68:71], v[20:23], v[48:63]
  ds_read_b128 v[16:19], v2 offset:24576
  s_waitcnt lgkmcnt(6)
  v_mfma_f32_32x32x16_bf16 v[48:63], a[72:75], v[24:27], v[48:63]
  ds_read_b128 v[20:23], v2 offset:25600
  s_waitcnt lgkmcnt(6)
  v_mfma_f32_32x32x16_bf16 v[48:63], a[76:79], v[28:31], v[48:63]
  ds_read_b128 v[24:27], v2 offset:26624
  s_waitcnt lgkmcnt(6)
  v_mfma_f32_32x32x16_bf16 v[48:63], a[80:83], v[32:35], v[48:63]
  ds_read_b128 v[28:31], v2 offset:27648
  s_waitcnt lgkmcnt(6)
  v_mfma_f32_32x32x16_bf16 v[48:63], a[84:87], v[36:39], v[48:63]
  ds_read_b128 v[32:35], v2 offset:28672
  s_waitcnt lgkmcnt(6)
  v_mfma_f32_32x32x16_bf16 v[48:63], a[88:91], v[40:43], v[48:63]
  ds_read_b128 v[36:39], v2 offset:29696
  s_waitcnt lgkmcnt(6)
  v_mfma_f32_32x32x16_bf16 v[48:63], a[92:95], v[44:47], v[48:63]
  ds_read_b128 v[40:43], v2 offset:30720
  s_waitcnt lgkmcnt(6)
  v_mfma_f32_32x32x16_bf16 v[48:63], a[96:99], v[16:19], v[48:63]
  ds_read_b128 v[44:47], v2 offset:31744
  s_cmp_eq_u32 s22, 0
  s_cbranch_scc1 nsig_285
  s_waitcnt vmcnt(0)
  s_barrier
  s_cmp_lg_u32 s14, 0
  s_cbranch_scc1 sig_286
  s_mov_b64 exec, 1
  buffer_atomic_add v6, off, s[4:7], s22 sc1
  s_mov_b64 exec, -1
sig_286:
  s_mov_b32 s22, 0
nsig_285:
  s_waitcnt lgkmcnt(6)
  v_mfma_f32_32x32x16_bf16 v[48:63], a[100:103], v[20:23], v[48:63]
  ds_read_b128 v[16:19], v2 offset:32768
  s_waitcnt lgkmcnt(6)
  v_mfma_f32_32x32x16_bf16 v[48:63], a[104:107], v[24:27], v[48:63]
  ds_read_b128 v[20:23], v2 offset:33792
  s_waitcnt lgkmcnt(6)
  v_mfma_f32_32x32x16_bf16 v[48:63], a[108:111], v[28:31], v[48:63]
  ds_read_b128 v[24:27], v2 offset:34816
  s_waitcnt lgkmcnt(6)
  v_mfma_f32_32x32x16_bf16 v[48:63], a[112:115], v[32:35], v[48:63]
  ds_read_b128 v[28:31], v2 offset:35840
  s_waitcnt lgkmcnt(6)
  v_mfma_f32_32x32x16_bf16 v[48:63], a[116:119], v[36:39], v[48:63]
  ds_read_b128 v[32:35], v2 offset:36864
  s_waitcnt lgkmcnt(6)
  v_mfma_f32_32x32x16_bf16 v[48:63], a[120:123], v[40:43], v[48:63]
  ds_read_b128 v[36:39], v2 offset:37888
  s_waitcnt lgkmcnt(6)
  v_mfma_f32_32x32x16_bf16 v[48:63], a[124:127], v[44:47], v[48:63]
  ds_read_b128 v[40:43], v2 offset:38912
  s_waitcnt lgkmcnt(6)
  v_mfma_f32_32x32x16_bf16 v[48:63], a[128:131], v[16:19], v[48:63]
  ds_read_b128 v[44:47], v2 offset:39936
  s_waitcnt lgkmcnt(6)
  v_mfma_f32_32x32x16_bf16 v[48:63], a[132:135], v[20:23], v[48:63]
  ds_read_b128 v[16:19], v2 offset:40960
  s_waitcnt lgkmcnt(6)
  v_mfma_f32_32x32x16_bf16 v[48:63], a[136:139], v[24:27], v[48:63]
  ds_read_b128 v[20:23], v2 offset:41984
  s_waitcnt lgkmcnt(6)
  v_mfma_f32_32x32x16_bf16 v[48:63], a[140:143], v[28:31], v[48:63]
  ds_read_b128 v[24:27], v2 offset:43008
  s_waitcnt lgkmcnt(6)
  v_mfma_f32_32x32x16_bf16 v[48:63], a[144:147], v[32:35], v[48:63]
  ds_read_b128 v[28:31], v2 offset:44032
  s_waitcnt lgkmcnt(6)
  v_mfma_f32_32x32x16_bf16 v[48:63], a[148:151], v[36:39], v[48:63]
  ds_read_b128 v[32:35], v2 offset:45056
  s_waitcnt lgkmcnt(6)
  v_mfma_f32_32x32x16_bf16 v[48:63], a[152:155], v[40:43], v[48:63]
  ds_read_b128 v[36:39], v2 offset:46080
  s_waitcnt lgkmcnt(6)
  v_mfma_f32_32x32x16_bf16 v[48:63], a[156:159], v[44:47], v[48:63]
  ds_read_b128 v[40:43], v2 offset:47104
  s_waitcnt lgkmcnt(6)
  v_mfma_f32_32x32x16_bf16 v[48:63], a[160:163], v[16:19], v[48:63]
  ds_read_b128 v[44:47], v2 offset:48128
  s_waitcnt lgkmcnt(6)
  v_mfma_f32_32x32x16_bf16 v[48:63], a[164:167], v[20:23], v[48:63]
  ds_read_b128 v[16:19], v2 offset:49152
  s_waitcnt lgkmcnt(6)
  v_mfma_f32_32x32x16_bf16 v[48:63], a[168:171], v[24:27], v[48:63]
  ds_read_b128 v[20:23], v2 offset:50176
  s_waitcnt lgkmcnt(6)
  v_mfma_f32_32x32x16_bf16 v[48:63], a[172:175], v[28:31], v[48:63]
  ds_read_b128 v[24:27], v2 offset:51200
  s_waitcnt lgkmcnt(6)
  v_mfma_f32_32x32x16_bf16 v[48:63], a[176:179], v[32:35], v[48:63]
  ds_read_b128 v[28:31], v2 offset:52224
  s_waitcnt lgkmcnt(6)
  v_mfma_f32_32x32x16_bf16 v[48:63], a[180:183], v[36:39], v[48:63]
  ds_read_b128 v[32:35], v2 offset:53248
  s_waitcnt lgkmcnt(6)
  v_mfma_f32_32x32x16_bf16 v[48:63], a[184:187], v[40:43], v[48:63]
  ds_read_b128 v[36:39], v2 offset:54272
  s_waitcnt lgkmcnt(6)
  v_mfma_f32_32x32x16_bf16 v[48:63], a[188:191], v[44:47], v[48:63]
  ds_read_b128 v[40:43], v2 offset:55296
  s_waitcnt lgkmcnt(6)
  v_mfma_f32_32x32x16_bf16 v[48:63], a[192:195], v[16:19], v[48:63]
  ds_read_b128 v[44:47], v2 offset:56320
  s_waitcnt lgkmcnt(6)
  v_mfma_f32_32x32x16_bf16 v[48:63], a[196:199], v[20:23], v[48:63]
  ds_read_b128 v[16:19], v2 offset:57344
  s_waitcnt lgkmcnt(6)
  v_mfma_f32_32x32x16_bf16 v[48:63], a[200:203], v[24:27], v[48:63]
  ds_read_b128 v[20:23], v2 offset:58368
  s_waitcnt lgkmcnt(6)
  v_mfma_f32_32x32x16_bf16 v[48:63], a[204:207], v[28:31], v[48:63]
  ds_read_b128 v[24:27], v2 offset:59392
  s_waitcnt lgkmcnt(6)
  v_mfma_f32_32x32x16_bf16 v[48:63], a[208:211], v[32:35], v[48:63]
  ds_read_b128 v[28:31], v2 offset:60416
  s_waitcnt lgkmcnt(6)
  v_mfma_f32_32x32x16_bf16 v[48:63], a[212:215], v[36:39], v[48:63]
  ds_read_b128 v[32:35], v2 offset:61440
  s_waitcnt lgkmcnt(6)
  v_mfma_f32_32x32x16_bf16 v[48:63], a[216:219], v[40:43], v[48:63]
  ds_read_b128 v[36:39], v2 offset:62464
  s_waitcnt lgkmcnt(6)
  v_mfma_f32_32x32x16_bf16 v[48:63], a[220:223], v[44:47], v[48:63]
  ds_read_b128 v[40:43], v2 offset:63488
  s_waitcnt lgkmcnt(6)
  v_mfma_f32_32x32x16_bf16 v[48:63], a[224:227], v[16:19], v[48:63]
  ds_read_b128 v[44:47], v2 offset:64512
  s_waitcnt lgkmcnt(6)
  v_mfma_f32_32x32x16_bf16 v[48:63], a[228:231], v[20:23], v[48:63]
  s_waitcnt lgkmcnt(5)
  v_mfma_f32_32x32x16_bf16 v[48:63], a[232:235], v[24:27], v[48:63]
  s_waitcnt lgkmcnt(4)
  v_mfma_f32_32x32x16_bf16 v[48:63], a[236:239], v[28:31], v[48:63]
  s_waitcnt lgkmcnt(3)
  v_mfma_f32_32x32x16_bf16 v[48:63], a[240:243], v[32:35], v[48:63]
  s_waitcnt lgkmcnt(2)
  v_mfma_f32_32x32x16_bf16 v[48:63], a[244:247], v[36:39], v[48:63]
  s_waitcnt lgkmcnt(1)
  v_mfma_f32_32x32x16_bf16 v[48:63], a[248:251], v[40:43], v[48:63]
  s_waitcnt lgkmcnt(0)
  v_mfma_f32_32x32x16_bf16 v[48:63], a[252:255], v[44:47], v[48:63]
g4epi_287:
  s_mul_i32 s23, s16, 229376
  s_add_u32 s23, s23, s19
  s_mov_b32 s24, 0xbfb8aa3b
  s_nop 8
  v_mul_f32 v80, s24, v48
  v_mul_f32 v81, s24, v49
  v_mul_f32 v82, s24, v50
  v_mul_f32 v83, s24, v51
  v_mul_f32 v84, s24, v52
  v_mul_f32 v85, s24, v53
  v_mul_f32 v86, s24, v54
  v_mul_f32 v87, s24, v55
  v_exp_f32 v80, v80
  v_exp_f32 v81, v81
  v_exp_f32 v82, v82
  v_exp_f32 v83, v83
  v_exp_f32 v84, v84
  v_exp_f32 v85, v85
  v_exp_f32 v86, v86
  v_exp_f32 v87, v87
  v_mul_f32 v56, v48, v56
  v_mul_f32 v57, v49, v57
  v_mul_f32 v58, v50, v58
  v_mul_f32 v59, v51, v59
  v_mul_f32 v60, v52, v60
  v_mul_f32 v61, v53, v61
  v_mul_f32 v62, v54, v62
  v_mul_f32 v63, v55, v63
  v_add_f32 v80, 1.0, v80
  v_add_f32 v81, 1.0, v81
  v_add_f32 v82, 1.0, v82
  v_add_f32 v83, 1.0, v83
  v_add_f32 v84, 1.0, v84
  v_add_f32 v85, 1.0, v85
  v_add_f32 v86, 1.0, v86
  v_add_f32 v87, 1.0, v87
  v_rcp_f32 v80, v80
  v_rcp_f32 v81, v81
  v_rcp_f32 v82, v82
  v_rcp_f32 v83, v83
  v_rcp_f32 v84, v84
  v_rcp_f32 v85, v85
  v_rcp_f32 v86, v86
  v_rcp_f32 v87, v87
  v_mul_f32 v56, v56, v80
  v_mul_f32 v57, v57, v81
  v_mul_f32 v58, v58, v82
  v_mul_f32 v59, v59, v83
  v_mul_f32 v60, v60, v84
  v_mul_f32 v61, v61, v85
  v_mul_f32 v62, v62, v86
  v_mul_f32 v63, v63, v87
  v_cvt_pk_bf16_f32 v80, v56, v57
  v_cvt_pk_bf16_f32 v81, v58, v59
  v_cvt_pk_bf16_f32 v82, v60, v61
  v_cvt_pk_bf16_f32 v83, v62, v63
  buffer_store_dwordx4 v[80:83], v3, s[4:7], s23 offen sc1
  s_mul_i32 s25, s16, 256
  s_add_u32 s25, s25, s21
  s_cmp_lg_u32 s14, 0
  s_cbranch_scc1 w0_288
  s_cmp_ge_u32 s17, 64
  s_cbranch_scc1 p3f_289
  s_mul_i32 s23, s17, 64
  s_add_u32 s23, s23, s20
  s_add_u32 s27, s17, 1
  s_min_u32 s26, s27, 63
  s_mul_i32 s26, s26, 64
  s_add_u32 s26, s26, s20
  buffer_load_dword v5, off, s[4:7], s23 sc1
  buffer_load_dword v4, off, s[4:7], s26 sc1
p3f_289:
w0_288:
  s_waitcnt vmcnt(0)
  s_barrier
  s_cmp_lg_u32 s14, 0
  s_cbranch_scc1 sig_290
  s_mov_b64 exec, 1
  buffer_atomic_add v6, off, s[4:7], s25 sc1
  s_mov_b64 exec, -1
sig_290:
  s_cmp_ge_u32 s17, 64
  s_cbranch_scc1 g4done_279
  s_cmp_lg_u32 s14, 0
  s_cbranch_scc1 w0_292
  s_branch p3c_296
p3_293:
  buffer_load_dword v5, off, s[4:7], s23 sc1
  buffer_load_dword v4, off, s[4:7], s26 sc1
  s_waitcnt vmcnt(0)
p3c_296:
  v_readfirstlane_b32 s24, v5
  s_cmp_ge_u32 s24, 8
  s_cbranch_scc1 p3ok_294
  s_cmp_eq_u32 s29, 0
  s_cbranch_scc1 p3ok_294
  s_sub_u32 s29, s29, 1
  s_branch p3_293
p3ok_294:
  s_cmp_lt_u32 s27, 64
  s_cbranch_scc1 p3z_295
  v_mov_b32 v4, 0
p3z_295:
  ds_write_b32 v7, v4
  s_waitcnt lgkmcnt(0)
w0_292:
  s_barrier
  ds_read_b32 v5, v7
  s_mul_i32 s23, s17, 65536
  s_add_u32 s23, s23, s18
  s_sub_u32 s23, s23, s38
  s_lshl_b32 s24, s14, 10
  s_add_u32 s23, s23, s24
  s_xor_b32 s25, s28, 0x10000
  s_add_u32 s24, s24, s25
  s_mov_b32 m0, s24
  s_nop 0
  buffer_load_dwordx4 v1, s[4:7], s23 offen sc1 lds
  s_add_u32 s23, s23, 4096
  s_add_u32 s24, s24, 4096
  s_mov_b32 m0, s24
  s_nop 0
  buffer_load_dwordx4 v1, s[4:7], s23 offen sc1 lds
  s_add_u32 s23, s23, 4096
  s_add_u32 s24, s24, 4096
  s_mov_b32 m0, s24
  s_nop 0
  buffer_load_dwordx4 v1, s[4:7], s23 offen sc1 lds
  s_add_u32 s23, s23, 4096
  s_add_u32 s24, s24, 4096
  s_mov_b32 m0, s24
  s_nop 0
  buffer_load_dwordx4 v1, s[4:7], s23 offen sc1 lds
  s_add_u32 s23, s23, 4096
  s_add_u32 s24, s24, 4096
  s_mov_b32 m0, s24
  s_nop 0
  buffer_load_dwordx4 v1, s[4:7], s23 offen sc1 lds
  s_add_u32 s23, s23, 4096
  s_add_u32 s24, s24, 4096
  s_mov_b32 m0, s24
  s_nop 0
  buffer_load_dwordx4 v1, s[4:7], s23 offen sc1 lds
  s_add_u32 s23, s23, 4096
  s_add_u32 s24, s24, 4096
  s_mov_b32 m0, s24
  s_nop 0
  buffer_load_dwordx4 v1, s[4:7], s23 offen sc1 lds
  s_add_u32 s23, s23, 4096
  s_add_u32 s24, s24, 4096
  s_mov_b32 m0, s24
  s_nop 0
  buffer_load_dwordx4 v1, s[4:7], s23 offen sc1 lds
  s_add_u32 s23, s23, 4096
  s_add_u32 s24, s24, 4096
  s_mov_b32 m0, s24
  s_nop 0
  buffer_load_dwordx4 v1, s[4:7], s23 offen sc1 lds
  s_add_u32 s23, s23, 4096
  s_add_u32 s24, s24, 4096
  s_mov_b32 m0, s24
  s_nop 0
  buffer_load_dwordx4 v1, s[4:7], s23 offen sc1 lds
  s_add_u32 s23, s23, 4096
  s_add_u32 s24, s24, 4096
  s_mov_b32 m0, s24
  s_nop 0
  buffer_load_dwordx4 v1, s[4:7], s23 offen sc1 lds
  s_add_u32 s23, s23, 4096
  s_add_u32 s24, s24, 4096
  s_mov_b32 m0, s24
  s_nop 0
  buffer_load_dwordx4 v1, s[4:7], s23 offen sc1 lds
  s_add_u32 s23, s23, 4096
  s_add_u32 s24, s24, 4096
  s_mov_b32 m0, s24
  s_nop 0
  buffer_load_dwordx4 v1, s[4:7], s23 offen sc1 lds
  s_add_u32 s23, s23, 4096
  s_add_u32 s24, s24, 4096
  s_mov_b32 m0, s24
  s_nop 0
  buffer_load_dwordx4 v1, s[4:7], s23 offen sc1 lds
  s_add_u32 s23, s23, 4096
  s_add_u32 s24, s24, 4096
  s_mov_b32 m0, s24
  s_nop 0
  buffer_load_dwordx4 v1, s[4:7], s23 offen sc1 lds
  s_add_u32 s23, s23, 4096
  s_add_u32 s24, s24, 4096
  s_mov_b32 m0, s24
  s_nop 0
  buffer_load_dwordx4 v1, s[4:7], s23 offen sc1 lds
  s_mov_b32 s16, s17
  s_add_u32 s17, s16, 1
  s_xor_b32 s28, s28, 0x10000
  s_waitcnt lgkmcnt(0)
  v_readfirstlane_b32 s36, v5
  s_cmp_ge_u32 s36, 8
  s_cbranch_scc0 g4chase_291
  s_waitcnt vmcnt(0)
  s_barrier
  v_xor_b32 v2, 0x10000, v2
  ds_read_b32 v5, v7
  ds_read_b128 v[16:19], v2 offset:0
  ds_read_b128 v[20:23], v2 offset:1024
  ds_read_b128 v[24:27], v2 offset:2048
  ds_read_b128 v[28:31], v2 offset:3072
  ds_read_b128 v[32:35], v2 offset:4096
  ds_read_b128 v[36:39], v2 offset:5120
  ds_read_b128 v[40:43], v2 offset:6144
  v_xor_b32 v7, 4, v7
  s_branch g4dec_277
g4chase_291:
  v_xor_b32 v2, 0x10000, v2
  s_waitcnt vmcnt(12)
  s_barrier
  ds_read_b128 v[16:19], v2 offset:0
  ds_read_b128 v[20:23], v2 offset:1024
  ds_read_b128 v[24:27], v2 offset:2048
  ds_read_b128 v[28:31], v2 offset:3072
  ds_read_b128 v[32:35], v2 offset:4096
  ds_read_b128 v[36:39], v2 offset:5120
  ds_read_b128 v[40:43], v2 offset:6144
  s_waitcnt lgkmcnt(6)
  v_mfma_f32_32x32x16_bf16 v[48:63], a[0:3], v[16:19], 0
  ds_read_b128 v[44:47], v2 offset:7168
  s_waitcnt lgkmcnt(6)
  v_mfma_f32_32x32x16_bf16 v[48:63], a[4:7], v[20:23], v[48:63]
  ds_read_b128 v[16:19], v2 offset:8192
  s_waitcnt lgkmcnt(6)
  v_mfma_f32_32x32x16_bf16 v[48:63], a[8:11], v[24:27], v[48:63]
  ds_read_b128 v[20:23], v2 offset:9216
  s_waitcnt lgkmcnt(6)
  v_mfma_f32_32x32x16_bf16 v[48:63], a[12:15], v[28:31], v[48:63]
  ds_read_b128 v[24:27], v2 offset:10240
  s_waitcnt lgkmcnt(6)
  v_mfma_f32_32x32x16_bf16 v[48:63], a[16:19], v[32:35], v[48:63]
  ds_read_b128 v[28:31], v2 offset:11264
  s_waitcnt lgkmcnt(6)
  v_mfma_f32_32x32x16_bf16 v[48:63], a[20:23], v[36:39], v[48:63]
  ds_read_b128 v[32:35], v2 offset:12288
  s_waitcnt lgkmcnt(6)
  v_mfma_f32_32x32x16_bf16 v[48:63], a[24:27], v[40:43], v[48:63]
  ds_read_b128 v[36:39], v2 offset:13312
  s_waitcnt lgkmcnt(6)
  v_mfma_f32_32x32x16_bf16 v[48:63], a[28:31], v[44:47], v[48:63]
  ds_read_b128 v[40:43], v2 offset:14336
  s_waitcnt lgkmcnt(6)
  v_mfma_f32_32x32x16_bf16 v[48:63], a[32:35], v[16:19], v[48:63]
  ds_read_b128 v[44:47], v2 offset:15360
  s_waitcnt lgkmcnt(6)
  v_mfma_f32_32x32x16_bf16 v[48:63], a[36:39], v[20:23], v[48:63]
  s_waitcnt vmcnt(8)
  s_barrier
  ds_read_b128 v[16:19], v2 offset:16384
  s_waitcnt lgkmcnt(6)
  v_mfma_f32_32x32x16_bf16 v[48:63], a[40:43], v[24:27], v[48:63]
  ds_read_b128 v[20:23], v2 offset:17408
  s_waitcnt lgkmcnt(6)
  v_mfma_f32_32x32x16_bf16 v[48:63], a[44:47], v[28:31], v[48:63]
  ds_read_b128 v[24:27], v2 offset:18432
  s_waitcnt lgkmcnt(6)
  v_mfma_f32_32x32x16_bf16 v[48:63], a[48:51], v[32:35], v[48:63]
  ds_read_b128 v[28:31], v2 offset:19456
  s_waitcnt lgkmcnt(6)
  v_mfma_f32_32x32x16_bf16 v[48:63], a[52:55], v[36:39], v[48:63]
  ds_read_b128 v[32:35], v2 offset:20480
  s_waitcnt lgkmcnt(6)
  v_mfma_f32_32x32x16_bf16 v[48:63], a[56:59], v[40:43], v[48:63]
  ds_read_b128 v[36:39], v2 offset:21504
  s_waitcnt lgkmcnt(6)
  v_mfma_f32_32x32x16_bf16 v[48:63], a[60:63], v[44:47], v[48:63]
  ds_read_b128 v[40:43], v2 offset:22528
  s_waitcnt lgkmcnt(6)
  v_mfma_f32_32x32x16_bf16 v[48:63], a[64:67], v[16:19], v[48:63]
  ds_read_b128 v[44:47], v2 offset:23552
  s_waitcnt lgkmcnt(6)
  v_mfma_f32_32x32x16_bf16 v[48:63], a[68:71], v[20:23], v[48:63]
  ds_read_b128 v[16:19], v2 offset:24576
  s_waitcnt lgkmcnt(6)
  v_mfma_f32_32x32x16_bf16 v[48:63], a[72:75], v[24:27], v[48:63]
  ds_read_b128 v[20:23], v2 offset:25600
  s_waitcnt lgkmcnt(6)
  v_mfma_f32_32x32x16_bf16 v[48:63], a[76:79], v[28:31], v[48:63]
  ds_read_b128 v[24:27], v2 offset:26624
  s_waitcnt lgkmcnt(6)
  v_mfma_f32_32x32x16_bf16 v[48:63], a[80:83], v[32:35], v[48:63]
  ds_read_b128 v[28:31], v2 offset:27648
  s_waitcnt lgkmcnt(6)
  v_mfma_f32_32x32x16_bf16 v[48:63], a[84:87], v[36:39], v[48:63]
  ds_read_b128 v[32:35], v2 offset:28672
  s_waitcnt lgkmcnt(6)
  v_mfma_f32_32x32x16_bf16 v[48:63], a[88:91], v[40:43], v[48:63]
  ds_read_b128 v[36:39], v2 offset:29696
  s_waitcnt lgkmcnt(6)
  v_mfma_f32_32x32x16_bf16 v[48:63], a[92:95], v[44:47], v[48:63]
  ds_read_b128 v[40:43], v2 offset:30720
  s_waitcnt lgkmcnt(6)
  v_mfma_f32_32x32x16_bf16 v[48:63], a[96:99], v[16:19], v[48:63]
  ds_read_b128 v[44:47], v2 offset:31744
  s_waitcnt lgkmcnt(6)
  v_mfma_f32_32x32x16_bf16 v[48:63], a[100:103], v[20:23], v[48:63]
  s_waitcnt vmcnt(4)
  s_barrier
  ds_read_b128 v[16:19], v2 offset:32768
  s_waitcnt lgkmcnt(6)
  v_mfma_f32_32x32x16_bf16 v[48:63], a[104:107], v[24:27], v[48:63]
  ds_read_b128 v[20:23], v2 offset:33792
  s_waitcnt lgkmcnt(6)
  v_mfma_f32_32x32x16_bf16 v[48:63], a[108:111], v[28:31], v[48:63]
  ds_read_b128 v[24:27], v2 offset:34816
  s_waitcnt lgkmcnt(6)
  v_mfma_f32_32x32x16_bf16 v[48:63], a[112:115], v[32:35], v[48:63]
  ds_read_b128 v[28:31], v2 offset:35840
  s_waitcnt lgkmcnt(6)
  v_mfma_f32_32x32x16_bf16 v[48:63], a[116:119], v[36:39], v[48:63]
  ds_read_b128 v[32:35], v2 offset:36864
  s_waitcnt lgkmcnt(6)
  v_mfma_f32_32x32x16_bf16 v[48:63], a[120:123], v[40:43], v[48:63]
  ds_read_b128 v[36:39], v2 offset:37888
  s_waitcnt lgkmcnt(6)
  v_mfma_f32_32x32x16_bf16 v[48:63], a[124:127], v[44:47], v[48:63]
  ds_read_b128 v[40:43], v2 offset:38912
  s_waitcnt lgkmcnt(6)
  v_mfma_f32_32x32x16_bf16 v[48:63], a[128:131], v[16:19], v[48:63]
  ds_read_b128 v[44:47], v2 offset:39936
  s_waitcnt lgkmcnt(6)
  v_mfma_f32_32x32x16_bf16 v[48:63], a[132:135], v[20:23], v[48:63]
  ds_read_b128 v[16:19], v2 offset:40960
  s_waitcnt lgkmcnt(6)
  v_mfma_f32_32x32x16_bf16 v[48:63], a[136:139], v[24:27], v[48:63]
  ds_read_b128 v[20:23], v2 offset:41984
  s_waitcnt lgkmcnt(6)
  v_mfma_f32_32x32x16_bf16 v[48:63], a[140:143], v[28:31], v[48:63]
  ds_read_b128 v[24:27], v2 offset:43008
  s_waitcnt lgkmcnt(6)
  v_mfma_f32_32x32x16_bf16 v[48:63], a[144:147], v[32:35], v[48:63]
  ds_read_b128 v[28:31], v2 offset:44032
  s_waitcnt lgkmcnt(6)
  v_mfma_f32_32x32x16_bf16 v[48:63], a[148:151], v[36:39], v[48:63]
  ds_read_b128 v[32:35], v2 offset:45056
  s_waitcnt lgkmcnt(6)
  v_mfma_f32_32x32x16_bf16 v[48:63], a[152:155], v[40:43], v[48:63]
  ds_read_b128 v[36:39], v2 offset:46080
  s_waitcnt lgkmcnt(6)
  v_mfma_f32_32x32x16_bf16 v[48:63], a[156:159], v[44:47], v[48:63]
  ds_read_b128 v[40:43], v2 offset:47104
  s_waitcnt lgkmcnt(6)
  v_mfma_f32_32x32x16_bf16 v[48:63], a[160:163], v[16:19], v[48:63]
  ds_read_b128 v[44:47], v2 offset:48128
  s_waitcnt lgkmcnt(6)
  v_mfma_f32_32x32x16_bf16 v[48:63], a[164:167], v[20:23], v[48:63]
  s_waitcnt vmcnt(0)
  s_barrier
  ds_read_b128 v[16:19], v2 offset:49152
  s_waitcnt lgkmcnt(6)
  v_mfma_f32_32x32x16_bf16 v[48:63], a[168:171], v[24:27], v[48:63]
  ds_read_b128 v[20:23], v2 offset:50176
  s_waitcnt lgkmcnt(6)
  v_mfma_f32_32x32x16_bf16 v[48:63], a[172:175], v[28:31], v[48:63]
  ds_read_b128 v[24:27], v2 offset:51200
  s_waitcnt lgkmcnt(6)
  v_mfma_f32_32x32x16_bf16 v[48:63], a[176:179], v[32:35], v[48:63]
  ds_read_b128 v[28:31], v2 offset:52224
  s_waitcnt lgkmcnt(6)
  v_mfma_f32_32x32x16_bf16 v[48:63], a[180:183], v[36:39], v[48:63]
  ds_read_b128 v[32:35], v2 offset:53248
  s_waitcnt lgkmcnt(6)
  v_mfma_f32_32x32x16_bf16 v[48:63], a[184:187], v[40:43], v[48:63]
  ds_read_b128 v[36:39], v2 offset:54272
  s_waitcnt lgkmcnt(6)
  v_mfma_f32_32x32x16_bf16 v[48:63], a[188:191], v[44:47], v[48:63]
  ds_read_b128 v[40:43], v2 offset:55296
  s_waitcnt lgkmcnt(6)
  v_mfma_f32_32x32x16_bf16 v[48:63], a[192:195], v[16:19], v[48:63]
  ds_read_b128 v[44:47], v2 offset:56320
  s_waitcnt lgkmcnt(6)
  v_mfma_f32_32x32x16_bf16 v[48:63], a[196:199], v[20:23], v[48:63]
  ds_read_b128 v[16:19], v2 offset:57344
  s_waitcnt lgkmcnt(6)
  v_mfma_f32_32x32x16_bf16 v[48:63], a[200:203], v[24:27], v[48:63]
  ds_read_b128 v[20:23], v2 offset:58368
  s_waitcnt lgkmcnt(6)
  v_mfma_f32_32x32x16_bf16 v[48:63], a[204:207], v[28:31], v[48:63]
  ds_read_b128 v[24:27], v2 offset:59392
  s_waitcnt lgkmcnt(6)
  v_mfma_f32_32x32x16_bf16 v[48:63], a[208:211], v[32:35], v[48:63]
  ds_read_b128 v[28:31], v2 offset:60416
  s_waitcnt lgkmcnt(6)
  v_mfma_f32_32x32x16_bf16 v[48:63], a[212:215], v[36:39], v[48:63]
  ds_read_b128 v[32:35], v2 offset:61440
  s_waitcnt lgkmcnt(6)
  v_mfma_f32_32x32x16_bf16 v[48:63], a[216:219], v[40:43], v[48:63]
  ds_read_b128 v[36:39], v2 offset:62464
  s_waitcnt lgkmcnt(6)
  v_mfma_f32_32x32x16_bf16 v[48:63], a[220:223], v[44:47], v[48:63]
  ds_read_b128 v[40:43], v2 offset:63488
  s_waitcnt lgkmcnt(6)
  v_mfma_f32_32x32x16_bf16 v[48:63], a[224:227], v[16:19], v[48:63]
  ds_read_b128 v[44:47], v2 offset:64512
  s_waitcnt lgkmcnt(6)
  v_mfma_f32_32x32x16_bf16 v[48:63], a[228:231], v[20:23], v[48:63]
  s_waitcnt lgkmcnt(5)
  v_mfma_f32_32x32x16_bf16 v[48:63], a[232:235], v[24:27], v[48:63]
  s_waitcnt lgkmcnt(4)
  v_mfma_f32_32x32x16_bf16 v[48:63], a[236:239], v[28:31], v[48:63]
  s_waitcnt lgkmcnt(3)
  v_mfma_f32_32x32x16_bf16 v[48:63], a[240:243], v[32:35], v[48:63]
  s_waitcnt lgkmcnt(2)
  v_mfma_f32_32x32x16_bf16 v[48:63], a[244:247], v[36:39], v[48:63]
  s_waitcnt lgkmcnt(1)
  v_mfma_f32_32x32x16_bf16 v[48:63], a[248:251], v[40:43], v[48:63]
  s_waitcnt lgkmcnt(0)
  v_mfma_f32_32x32x16_bf16 v[48:63], a[252:255], v[44:47], v[48:63]
  s_branch g4epi_287
g4done_279:
  s_waitcnt vmcnt(0)
  s_barrier
  s_branch k_dump_2
r2_221:
  s_lshr_b32 s16, s43, 3
  s_and_b32 s23, s43, 7
  s_lshl_b32 s23, s23, 2
  s_add_u32 s17, s23, s14
  s_mov_b32 s38, 0x3e0293ee
  v_and_b32 v10, 63, v0
  v_lshlrev_b32 v1, 4, v10
  v_lshrrev_b32 v11, 5, v10
  v_lshlrev_b32 v12, 9, v11
  v_and_b32 v13, 7, v10
  v_and_b32 v14, 8, v10
  v_lshl_or_b32 v13, v14, 1, v13
  v_and_b32 v14, 16, v10
  v_lshrrev_b32 v14, 1, v14
  v_or_b32 v13, v13, v14
  v_lshl_add_u32 v2, v13, 4, v12
  v_and_b32 v13, 19, v10
  v_and_b32 v14, 4, v10
  v_lshl_or_b32 v13, v14, 1, v13
  v_and_b32 v14, 8, v10
  v_lshrrev_b32 v14, 1, v14
  v_or_b32 v13, v13, v14
  v_lshl_add_u32 v3, v13, 4, v12
  v_lshlrev_b32 v13, 4, v13
  v_lshl_add_u32 v5, v11, 3, v13
  v_and_b32 v13, 7, v10
  v_lshlrev_b32 v13, 4, v13
  v_lshl_add_u32 v4, v11, 7, v13
  v_and_b32 v13, 1, v10
  v_lshlrev_b32 v8, 4, v13
  v_mov_b32 v9, 1
  v_and_b32 v13, 31, v10
  v_lshlrev_b32 v14, 2, v11
  v_sub_u32 v13, v13, v14
  v_cmp_le_i32 s[40:41], 0, v13
  v_cmp_le_i32 s[42:43], 1, v13
  v_cmp_le_i32 s[44:45], 2, v13
  v_cmp_le_i32 s[46:47], 3, v13
  v_cmp_le_i32 s[48:49], 16, v13
  v_cmp_le_i32 s[50:51], 17, v13
  v_cmp_le_i32 s[52:53], 18, v13
  v_cmp_le_i32 s[54:55], 19, v13
  v_cmp_le_i32 s[56:57], 8, v13
  v_cmp_le_i32 s[58:59], 9, v13
  v_cmp_le_i32 s[60:61], 10, v13
  v_cmp_le_i32 s[62:63], 11, v13
  v_cmp_le_i32 s[64:65], 24, v13
  v_cmp_le_i32 s[66:67], 25, v13
  v_cmp_le_i32 s[68:69], 26, v13
  v_cmp_le_i32 s[70:71], 27, v13
g2top_297:
  s_lshl_b32 s23, s16, 18
  s_lshl_b32 s24, s17, 13
  s_add_u32 s18, s23, s24
  s_lshl_b32 s23, s16, 9
  s_lshl_b32 s24, s17, 4
  s_add_u32 s19, s23, s24
  s_add_u32 s19, s19, 65536
  s_lshl_b32 s23, s16, 9
  s_lshl_b32 s24, s17, 4
  s_add_u32 s20, s23, s24
  s_add_u32 s20, s20, 131072
  s_lshl_b32 s23, s16, 16
  s_lshl_b32 s24, s17, 11
  s_add_u32 s23, s23, s24
  s_add_u32 s21, s23, 4194304
  s_add_u32 s22, s23, 8388608
  s_lshl_b32 s23, s16, 8
  s_lshr_b32 s24, s17, 3
  s_lshl_b32 s24, s24, 6
  s_add_u32 s37, s23, s24
  s_add_u32 s37, s37, 20480
g2q_299:
  buffer_load_dwordx3 v[12:14], off, s[4:7], s19 sc1
  s_waitcnt vmcnt(0)
  v_min3_u32 v12, v12, v13, v14
  v_cmp_eq_u32 vcc, 0, v12
  s_cbranch_vccz g2qok_300
  s_cmp_eq_u32 s29, 0
  s_cbranch_scc1 g2qok_300
  s_sub_u32 s29, s29, 1
  s_branch g2q_299
g2qok_300:
  s_add_u32 s23, s18, 33554432
  s_add_u32 s24, s18, 50331648
  s_add_u32 s25, s18, 67108864
  buffer_load_dwordx4 v[48:51], v2, s[4:7], s24 offen offset:0 sc1
  buffer_load_dwordx4 v[52:55], v2, s[4:7], s24 offen offset:1024 sc1
  buffer_load_dwordx4 v[56:59], v2, s[4:7], s24 offen offset:2048 sc1
  buffer_load_dwordx4 v[60:63], v2, s[4:7], s24 offen offset:3072 sc1
  s_add_u32 s24, s24, 4096
  buffer_load_dwordx4 v[64:67], v2, s[4:7], s24 offen offset:0 sc1
  buffer_load_dwordx4 v[68:71], v2, s[4:7], s24 offen offset:1024 sc1
  buffer_load_dwordx4 v[72:75], v2, s[4:7], s24 offen offset:2048 sc1
  buffer_load_dwordx4 v[76:79], v2, s[4:7], s24 offen offset:3072 sc1
  buffer_load_dwordx4 v[16:19], v1, s[4:7], s23 offen offset:0 sc1
  buffer_load_dwordx4 v[20:23], v1, s[4:7], s23 offen offset:1024 sc1
  buffer_load_dwordx4 v[24:27], v1, s[4:7], s23 offen offset:2048 sc1
  buffer_load_dwordx4 v[28:31], v1, s[4:7], s23 offen offset:3072 sc1
  s_add_u32 s23, s23, 4096
  buffer_load_dwordx4 v[32:35], v1, s[4:7], s23 offen offset:0 sc1
  buffer_load_dwordx4 v[36:39], v1, s[4:7], s23 offen offset:1024 sc1
  buffer_load_dwordx4 v[40:43], v1, s[4:7], s23 offen offset:2048 sc1
  buffer_load_dwordx4 v[44:47], v1, s[4:7], s23 offen offset:3072 sc1
  buffer_load_dwordx4 v[80:83], v3, s[4:7], s25 offen offset:0 sc1
  buffer_load_dwordx4 v[84:87], v3, s[4:7], s25 offen offset:1024 sc1
  buffer_load_dwordx4 v[88:91], v3, s[4:7], s25 offen offset:2048 sc1
  buffer_load_dwordx4 v[92:95], v3, s[4:7], s25 offen offset:3072 sc1
  s_add_u32 s25, s25, 4096
  buffer_load_dwordx4 v[96:99], v3, s[4:7], s25 offen offset:0 sc1
  buffer_load_dwordx4 v[100:103], v3, s[4:7], s25 offen offset:1024 sc1
  buffer_load_dwordx4 v[104:107], v3, s[4:7], s25 offen offset:2048 sc1
  buffer_load_dwordx4 v[108:111], v3, s[4:7], s25 offen offset:3072 sc1
  s_waitcnt vmcnt(15)
  v_mfma_f32_32x32x16_bf16 v[120:135], v[48:51], v[16:19], 0
  s_waitcnt vmcnt(14)
  v_mfma_f32_32x32x16_bf16 v[120:135], v[52:55], v[20:23], v[120:135]
  s_waitcnt vmcnt(13)
  v_mfma_f32_32x32x16_bf16 v[120:135], v[56:59], v[24:27], v[120:135]
  s_waitcnt vmcnt(12)
  v_mfma_f32_32x32x16_bf16 v[120:135], v[60:63], v[28:31], v[120:135]
  s_waitcnt vmcnt(11)
  v_mfma_f32_32x32x16_bf16 v[120:135], v[64:67], v[32:35], v[120:135]
  s_waitcnt vmcnt(10)
  v_mfma_f32_32x32x16_bf16 v[120:135], v[68:71], v[36:39], v[120:135]
  s_waitcnt vmcnt(9)
  v_mfma_f32_32x32x16_bf16 v[120:135], v[72:75], v[40:43], v[120:135]
  s_waitcnt vmcnt(8)
  v_mfma_f32_32x32x16_bf16 v[120:135], v[76:79], v[44:47], v[120:135]
  s_cmp_lt_u32 s16, 57
  s_cbranch_scc1 g2pl_301
  s_sub_u32 s23, s20, 512
g2c_303:
  buffer_load_dwordx2 v[12:13], off, s[4:7], s23 sc1
  s_waitcnt vmcnt(0)
  v_min_u32 v12, v12, v13
  v_cmp_eq_u32 vcc, 0, v12
  s_cbranch_vccz g2cok_304
  s_cmp_eq_u32 s29, 0
  s_cbranch_scc1 g2cok_304
  s_sub_u32 s29, s29, 1
  s_branch g2c_303
g2cok_304:
  buffer_load_dwordx4 v[48:51], v4, s[4:7], s21 offen offset:0 sc1
  buffer_load_dwordx4 v[52:55], v4, s[4:7], s21 offen offset:256 sc1
  buffer_load_dwordx4 v[56:59], v4, s[4:7], s21 offen offset:512 sc1
  buffer_load_dwordx4 v[60:63], v4, s[4:7], s21 offen offset:768 sc1
  buffer_load_dwordx4 v[64:67], v4, s[4:7], s21 offen offset:1024 sc1
  buffer_load_dwordx4 v[68:71], v4, s[4:7], s21 offen offset:1280 sc1
  buffer_load_dwordx4 v[72:75], v4, s[4:7], s21 offen offset:1536 sc1
  buffer_load_dwordx4 v[76:79], v4, s[4:7], s21 offen offset:1792 sc1
  buffer_load_dwordx2 v[112:113], v5, s[4:7], s22 offen offset:0 sc1
  buffer_load_dwordx2 v[114:115], v5, s[4:7], s22 offen offset:512 sc1
  buffer_load_dwordx2 v[116:117], v5, s[4:7], s22 offen offset:1024 sc1
  buffer_load_dwordx2 v[118:119], v5, s[4:7], s22 offen offset:1536 sc1
  buffer_load_dwordx2 v[226:227], off, s[4:7], s20 sc1
  v_mov_b32 v6, 0xff800000
  v_cndmask_b32 v120, v6, v120, s[40:41]
  v_cndmask_b32 v121, v6, v121, s[42:43]
  v_cndmask_b32 v122, v6, v122, s[44:45]
  v_cndmask_b32 v123, v6, v123, s[46:47]
  v_cndmask_b32 v124, v6, v124, s[48:49]
  v_cndmask_b32 v125, v6, v125, s[50:51]
  v_cndmask_b32 v126, v6, v126, s[52:53]
  v_cndmask_b32 v127, v6, v127, s[54:55]
  v_cndmask_b32 v128, v6, v128, s[56:57]
  v_cndmask_b32 v129, v6, v129, s[58:59]
  v_cndmask_b32 v130, v6, v130, s[60:61]
  v_cndmask_b32 v131, v6, v131, s[62:63]
  v_cndmask_b32 v132, v6, v132, s[64:65]
  v_cndmask_b32 v133, v6, v133, s[66:67]
  v_cndmask_b32 v134, v6, v134, s[68:69]
  v_cndmask_b32 v135, v6, v135, s[70:71]
  v_max3_f32 v6, v120, v121, v122
  v_max3_f32 v6, v6, v123, v124
  v_max3_f32 v6, v6, v125, v126
  v_max3_f32 v6, v6, v127, v128
  v_max3_f32 v6, v6, v129, v130
  v_max3_f32 v6, v6, v131, v132
  v_max3_f32 v6, v6, v133, v134
  v_max_f32 v6, v6, v135
  s_branch g2f_306
g2d_305:
  buffer_load_dwordx4 v[48:51], v4, s[4:7], s21 offen offset:0 sc1
  buffer_load_dwordx4 v[52:55], v4, s[4:7], s21 offen offset:256 sc1
  buffer_load_dwordx4 v[56:59], v4, s[4:7], s21 offen offset:512 sc1
  buffer_load_dwordx4 v[60:63], v4, s[4:7], s21 offen offset:768 sc1
  buffer_load_dwordx4 v[64:67], v4, s[4:7], s21 offen offset:1024 sc1
  buffer_load_dwordx4 v[68:71], v4, s[4:7], s21 offen offset:1280 sc1
  buffer_load_dwordx4 v[72:75], v4, s[4:7], s21 offen offset:1536 sc1
  buffer_load_dwordx4 v[76:79], v4, s[4:7], s21 offen offset:1792 sc1
  buffer_load_dwordx2 v[112:113], v5, s[4:7], s22 offen offset:0 sc1
  buffer_load_dwordx2 v[114:115], v5, s[4:7], s22 offen offset:512 sc1
  buffer_load_dwordx2 v[116:117], v5, s[4:7], s22 offen offset:1024 sc1
  buffer_load_dwordx2 v[118:119], v5, s[4:7], s22 offen offset:1536 sc1
  buffer_load_dwordx2 v[226:227], off, s[4:7], s20 sc1
g2f_306:
  s_waitcnt vmcnt(9)
  v_max3_u32 v14, v48, v49, v50
  v_max_u32 v14, v14, v51
  v_max3_u32 v14, v14, v52, v53
  v_max3_u32 v14, v14, v54, v55
  s_waitcnt vmcnt(9)
  v_max3_u32 v14, v14, v56, v57
  v_max3_u32 v14, v14, v58, v59
  v_max3_u32 v14, v14, v60, v61
  v_max3_u32 v14, v14, v62, v63
  s_waitcnt vmcnt(7)
  v_max3_u32 v14, v14, v64, v65
  v_max3_u32 v14, v14, v66, v67
  v_max3_u32 v14, v14, v68, v69
  v_max3_u32 v14, v14, v70, v71
  s_waitcnt vmcnt(5)
  v_max3_u32 v14, v14, v72, v73
  v_max3_u32 v14, v14, v74, v75
  v_max3_u32 v14, v14, v76, v77
  v_max3_u32 v14, v14, v78, v79
  s_waitcnt vmcnt(1)
  v_max3_u32 v14, v14, v112, v113
  v_max3_u32 v14, v14, v114, v115
  v_max3_u32 v14, v14, v116, v117
  v_max3_u32 v14, v14, v118, v119
  v_cmp_eq_u32 vcc, -1, v14
  s_cbranch_vccz g2dok_307
  s_waitcnt vmcnt(0)
  v_min_u32 v12, v226, v227
  s_nop 0
  v_readfirstlane_b32 s23, v12
  s_cmp_eq_u32 s23, 0
  s_cbranch_scc1 g2n_308
  buffer_load_dwordx4 v[48:51], v4, s[4:7], s21 offen offset:0 sc1
  buffer_load_dwordx4 v[52:55], v4, s[4:7], s21 offen offset:256 sc1
  buffer_load_dwordx4 v[56:59], v4, s[4:7], s21 offen offset:512 sc1
  buffer_load_dwordx4 v[60:63], v4, s[4:7], s21 offen offset:768 sc1
  buffer_load_dwordx4 v[64:67], v4, s[4:7], s21 offen offset:1024 sc1
  buffer_load_dwordx4 v[68:71], v4, s[4:7], s21 offen offset:1280 sc1
  buffer_load_dwordx4 v[72:75], v4, s[4:7], s21 offen offset:1536 sc1
  buffer_load_dwordx4 v[76:79], v4, s[4:7], s21 offen offset:1792 sc1
  buffer_load_dwordx2 v[112:113], v5, s[4:7], s22 offen offset:0 sc1
  buffer_load_dwordx2 v[114:115], v5, s[4:7], s22 offen offset:512 sc1
  buffer_load_dwordx2 v[116:117], v5, s[4:7], s22 offen offset:1024 sc1
  buffer_load_dwordx2 v[118:119], v5, s[4:7], s22 offen offset:1536 sc1
  s_waitcnt vmcnt(0)
  s_branch g2dok_307
g2n_308:
  s_cmp_eq_u32 s29, 0
  s_cbranch_scc1 g2dok_307
  s_sub_u32 s29, s29, 1
  s_branch g2d_305
g2dok_307:
  v_mfma_f32_32x32x16_bf16 v[136:151], v[48:51], v[16:19], 0
  v_mfma_f32_32x32x16_bf16 v[136:151], v[52:55], v[20:23], v[136:151]
  v_mfma_f32_32x32x16_bf16 v[136:151], v[56:59], v[24:27], v[136:151]
  v_mfma_f32_32x32x16_bf16 v[136:151], v[60:63], v[28:31], v[136:151]
  v_mfma_f32_32x32x16_bf16 v[136:151], v[64:67], v[32:35], v[136:151]
  v_mfma_f32_32x32x16_bf16 v[136:151], v[68:71], v[36:39], v[136:151]
  v_mfma_f32_32x32x16_bf16 v[136:151], v[72:75], v[40:43], v[136:151]
  v_mfma_f32_32x32x16_bf16 v[136:151], v[76:79], v[44:47], v[136:151]
  s_branch g2j_302
g2pl_301:
g2c_309:
  buffer_load_dwordx2 v[12:13], off, s[4:7], s20 sc1
  s_waitcnt vmcnt(0)
  v_min_u32 v12, v12, v13
  v_cmp_eq_u32 vcc, 0, v12
  s_cbranch_vccz g2cok_310
  s_cmp_eq_u32 s29, 0
  s_cbranch_scc1 g2cok_310
  s_sub_u32 s29, s29, 1
  s_branch g2c_309
g2cok_310:
  buffer_load_dwordx4 v[48:51], v4, s[4:7], s21 offen offset:0 sc1
  buffer_load_dwordx4 v[52:55], v4, s[4:7], s21 offen offset:256 sc1
  buffer_load_dwordx4 v[56:59], v4, s[4:7], s21 offen offset:512 sc1
  buffer_load_dwordx4 v[60:63], v4, s[4:7], s21 offen offset:768 sc1
  buffer_load_dwordx4 v[64:67], v4, s[4:7], s21 offen offset:1024 sc1
  buffer_load_dwordx4 v[68:71], v4, s[4:7], s21 offen offset:1280 sc1
  buffer_load_dwordx4 v[72:75], v4, s[4:7], s21 offen offset:1536 sc1
  buffer_load_dwordx4 v[76:79], v4, s[4:7], s21 offen offset:1792 sc1
  buffer_load_dwordx2 v[112:113], v5, s[4:7], s22 offen offset:0 sc1
  buffer_load_dwordx2 v[114:115], v5, s[4:7], s22 offen offset:512 sc1
  buffer_load_dwordx2 v[116:117], v5, s[4:7], s22 offen offset:1024 sc1
  buffer_load_dwordx2 v[118:119], v5, s[4:7], s22 offen offset:1536 sc1
  v_mov_b32 v6, 0xff800000
  v_cndmask_b32 v120, v6, v120, s[40:41]
  v_cndmask_b32 v121, v6, v121, s[42:43]
  v_cndmask_b32 v122, v6, v122, s[44:45]
  v_cndmask_b32 v123, v6, v123, s[46:47]
  v_cndmask_b32 v124, v6, v124, s[48:49]
  v_cndmask_b32 v125, v6, v125, s[50:51]
  v_cndmask_b32 v126, v6, v126, s[52:53]
  v_cndmask_b32 v127, v6, v127, s[54:55]
  v_cndmask_b32 v128, v6, v128, s[56:57]
  v_cndmask_b32 v129, v6, v129, s[58:59]
  v_cndmask_b32 v130, v6, v130, s[60:61]
  v_cndmask_b32 v131, v6, v131, s[62:63]
  v_cndmask_b32 v132, v6, v132, s[64:65]
  v_cndmask_b32 v133, v6, v133, s[66:67]
  v_cndmask_b32 v134, v6, v134, s[68:69]
  v_cndmask_b32 v135, v6, v135, s[70:71]
  v_max3_f32 v6, v120, v121, v122
  v_max3_f32 v6, v6, v123, v124
  v_max3_f32 v6, v6, v125, v126
  v_max3_f32 v6, v6, v127, v128
  v_max3_f32 v6, v6, v129, v130
  v_max3_f32 v6, v6, v131, v132
  v_max3_f32 v6, v6, v133, v134
  v_max_f32 v6, v6, v135
  s_waitcnt vmcnt(11)
  v_mfma_f32_32x32x16_bf16 v[136:151], v[48:51], v[16:19], 0
  s_waitcnt vmcnt(10)
  v_mfma_f32_32x32x16_bf16 v[136:151], v[52:55], v[20:23], v[136:151]
  s_waitcnt vmcnt(9)
  v_mfma_f32_32x32x16_bf16 v[136:151], v[56:59], v[24:27], v[136:151]
  s_waitcnt vmcnt(8)
  v_mfma_f32_32x32x16_bf16 v[136:151], v[60:63], v[28:31], v[136:151]
  s_waitcnt vmcnt(7)
  v_mfma_f32_32x32x16_bf16 v[136:151], v[64:67], v[32:35], v[136:151]
  s_waitcnt vmcnt(6)
  v_mfma_f32_32x32x16_bf16 v[136:151], v[68:71], v[36:39], v[136:151]
  s_waitcnt vmcnt(5)
  v_mfma_f32_32x32x16_bf16 v[136:151], v[72:75], v[40:43], v[136:151]
  s_waitcnt vmcnt(4)
  v_mfma_f32_32x32x16_bf16 v[136:151], v[76:79], v[44:47], v[136:151]
g2j_302:
  s_nop 11
  v_max3_f32 v6, v6, v136, v137
  v_max3_f32 v6, v6, v138, v139
  v_mov_b32 v7, v6
  s_nop 1
  v_permlane32_swap_b32 v6, v7
  v_max_f32 v6, v6, v7
  v_mul_f32 v6, s38, v6
  v_fma_f32 v120, v120, s38, -v6
  v_fma_f32 v121, v121, s38, -v6
  v_fma_f32 v122, v122, s38, -v6
  v_fma_f32 v123, v123, s38, -v6
  v_fma_f32 v124, v124, s38, -v6
  v_fma_f32 v125, v125, s38, -v6
  v_fma_f32 v126, v126, s38, -v6
  v_fma_f32 v127, v127, s38, -v6
  v_fma_f32 v128, v128, s38, -v6
  v_fma_f32 v129, v129, s38, -v6
  v_fma_f32 v130, v130, s38, -v6
  v_fma_f32 v131, v131, s38, -v6
  v_fma_f32 v132, v132, s38, -v6
  v_fma_f32 v133, v133, s38, -v6
  v_fma_f32 v134, v134, s38, -v6
  v_fma_f32 v135, v135, s38, -v6
  v_fma_f32 v136, v136, s38, -v6
  v_fma_f32 v137, v137, s38, -v6
  v_fma_f32 v138, v138, s38, -v6
  v_fma_f32 v139, v139, s38, -v6
  v_exp_f32 v120, v120
  v_exp_f32 v121, v121
  v_exp_f32 v122, v122
  v_exp_f32 v123, v123
  v_exp_f32 v124, v124
  v_exp_f32 v125, v125
  v_exp_f32 v126, v126
  v_exp_f32 v127, v127
  v_exp_f32 v128, v128
  v_exp_f32 v129, v129
  v_exp_f32 v130, v130
  v_exp_f32 v131, v131
  v_exp_f32 v132, v132
  v_exp_f32 v133, v133
  v_exp_f32 v134, v134
  v_exp_f32 v135, v135
  v_exp_f32 v136, v136
  v_exp_f32 v137, v137
  v_exp_f32 v138, v138
  v_exp_f32 v139, v139
  v_pk_add_f32 v[12:13], v[120:121], v[122:123]
  v_pk_add_f32 v[12:13], v[12:13], v[124:125]
  v_pk_add_f32 v[12:13], v[12:13], v[126:127]
  v_pk_add_f32 v[12:13], v[12:13], v[128:129]
  v_pk_add_f32 v[12:13], v[12:13], v[130:131]
  v_pk_add_f32 v[12:13], v[12:13], v[132:133]
  v_pk_add_f32 v[12:13], v[12:13], v[134:135]
  v_pk_add_f32 v[12:13], v[12:13], v[136:137]
  v_pk_add_f32 v[12:13], v[12:13], v[138:139]
  v_add_f32 v12, v12, v13
  v_mov_b32 v13, v12
  s_nop 1
  v_permlane32_swap_b32 v12, v13
  v_add_f32 v12, v12, v13
  v_rcp_f32 v12, v12
  s_nop 0
  v_pk_mul_f32 v[120:121], v[120:121], v[12:13] op_sel_hi:[1,0]
  v_pk_mul_f32 v[122:123], v[122:123], v[12:13] op_sel_hi:[1,0]
  v_pk_mul_f32 v[124:125], v[124:125], v[12:13] op_sel_hi:[1,0]
  v_pk_mul_f32 v[126:127], v[126:127], v[12:13] op_sel_hi:[1,0]
  v_pk_mul_f32 v[128:129], v[128:129], v[12:13] op_sel_hi:[1,0]
  v_pk_mul_f32 v[130:131], v[130:131], v[12:13] op_sel_hi:[1,0]
  v_pk_mul_f32 v[132:133], v[132:133], v[12:13] op_sel_hi:[1,0]
  v_pk_mul_f32 v[134:135], v[134:135], v[12:13] op_sel_hi:[1,0]
  v_pk_mul_f32 v[136:137], v[136:137], v[12:13] op_sel_hi:[1,0]
  v_pk_mul_f32 v[138:139], v[138:139], v[12:13] op_sel_hi:[1,0]
  v_cvt_pk_bf16_f32 v216, v120, v121
  v_cvt_pk_bf16_f32 v217, v122, v123
  v_cvt_pk_bf16_f32 v218, v124, v125
  v_cvt_pk_bf16_f32 v219, v126, v127
  v_cvt_pk_bf16_f32 v220, v128, v129
  v_cvt_pk_bf16_f32 v221, v130, v131
  v_cvt_pk_bf16_f32 v222, v132, v133
  v_cvt_pk_bf16_f32 v223, v134, v135
  v_cvt_pk_bf16_f32 v224, v136, v137
  v_cvt_pk_bf16_f32 v225, v138, v139
  s_waitcnt vmcnt(0)
  v_mfma_f32_32x32x16_bf16 v[152:167], v[80:83], v[216:219], 0
  v_mfma_f32_32x32x16_bf16 v[152:167], v[84:87], v[220:223], v[152:167]
  s_nop 9
  v_mfma_f32_32x32x8_bf16 v[152:167], v[112:113], v[224:225], v[152:167]
  v_mfma_f32_32x32x16_bf16 v[168:183], v[88:91], v[216:219], 0
  v_mfma_f32_32x32x16_bf16 v[168:183], v[92:95], v[220:223], v[168:183]
  s_nop 9
  v_mfma_f32_32x32x8_bf16 v[168:183], v[114:115], v[224:225], v[168:183]
  v_mfma_f32_32x32x16_bf16 v[184:199], v[96:99], v[216:219], 0
  v_mfma_f32_32x32x16_bf16 v[184:199], v[100:103], v[220:223], v[184:199]
  s_nop 9
  v_mfma_f32_32x32x8_bf16 v[184:199], v[116:117], v[224:225], v[184:199]
  v_mfma_f32_32x32x16_bf16 v[200:215], v[104:107], v[216:219], 0
  v_mfma_f32_32x32x16_bf16 v[200:215], v[108:111], v[220:223], v[200:215]
  s_nop 9
  v_mfma_f32_32x32x8_bf16 v[200:215], v[118:119], v[224:225], v[200:215]
  s_add_u32 s23, s18, 83886080
  v_cvt_pk_bf16_f32 v48, v152, v153
  v_cvt_pk_bf16_f32 v49, v154, v155
  v_cvt_pk_bf16_f32 v50, v156, v157
  v_cvt_pk_bf16_f32 v51, v158, v159
  v_cvt_pk_bf16_f32 v52, v160, v161
  v_cvt_pk_bf16_f32 v53, v162, v163
  v_cvt_pk_bf16_f32 v54, v164, v165
  v_cvt_pk_bf16_f32 v55, v166, v167
  buffer_store_dwordx4 v[48:51], v1, s[4:7], s23 offen offset:0 sc1
  buffer_store_dwordx4 v[52:55], v1, s[4:7], s23 offen offset:1024 sc1
  v_cvt_pk_bf16_f32 v56, v168, v169
  v_cvt_pk_bf16_f32 v57, v170, v171
  v_cvt_pk_bf16_f32 v58, v172, v173
  v_cvt_pk_bf16_f32 v59, v174, v175
  v_cvt_pk_bf16_f32 v60, v176, v177
  v_cvt_pk_bf16_f32 v61, v178, v179
  v_cvt_pk_bf16_f32 v62, v180, v181
  v_cvt_pk_bf16_f32 v63, v182, v183
  buffer_store_dwordx4 v[56:59], v1, s[4:7], s23 offen offset:2048 sc1
  buffer_store_dwordx4 v[60:63], v1, s[4:7], s23 offen offset:3072 sc1
  s_add_u32 s23, s23, 4096
  v_cvt_pk_bf16_f32 v64, v184, v185
  v_cvt_pk_bf16_f32 v65, v186, v187
  v_cvt_pk_bf16_f32 v66, v188, v189
  v_cvt_pk_bf16_f32 v67, v190, v191
  v_cvt_pk_bf16_f32 v68, v192, v193
  v_cvt_pk_bf16_f32 v69, v194, v195
  v_cvt_pk_bf16_f32 v70, v196, v197
  v_cvt_pk_bf16_f32 v71, v198, v199
  buffer_store_dwordx4 v[64:67], v1, s[4:7], s23 offen offset:0 sc1
  buffer_store_dwordx4 v[68:71], v1, s[4:7], s23 offen offset:1024 sc1
  v_cvt_pk_bf16_f32 v72, v200, v201
  v_cvt_pk_bf16_f32 v73, v202, v203
  v_cvt_pk_bf16_f32 v74, v204, v205
  v_cvt_pk_bf16_f32 v75, v206, v207
  v_cvt_pk_bf16_f32 v76, v208, v209
  v_cvt_pk_bf16_f32 v77, v210, v211
  v_cvt_pk_bf16_f32 v78, v212, v213
  v_cvt_pk_bf16_f32 v79, v214, v215
  buffer_store_dwordx4 v[72:75], v1, s[4:7], s23 offen offset:2048 sc1
  buffer_store_dwordx4 v[76:79], v1, s[4:7], s23 offen offset:3072 sc1
  s_waitcnt vmcnt(0)
  s_mov_b64 exec, 1
  buffer_atomic_add v9, off, s[4:7], s37 sc1
  s_mov_b64 exec, -1
  s_add_u32 s16, s16, 4
  s_cmp_lt_u32 s16, 64
  s_cbranch_scc1 g2top_297
  s_waitcnt vmcnt(0)
  s_branch k_dump_2
rc_222:
  s_cmp_ge_u32 s43, 16
  s_cbranch_scc1 rc5_311
rc3_271:
  s_load_dwordx2 s[8:9], s[0:1], 0
  s_waitcnt lgkmcnt(0)
  s_mov_b32 s10, 4194304
  s_mov_b32 s11, 0x00020000
  s_lshr_b32 s16, s43, 3
  s_and_b32 s17, s43, 7
  v_and_b32 v1, 63, v0
  v_and_b32 v2, 3, v1
  v_lshrrev_b32 v3, 2, v1
  v_lshlrev_b32 v4, 11, v2
  v_lshl_add_u32 v4, v3, 4, v4
  v_lshlrev_b32 v6, 9, v3
  v_lshl_add_u32 v6, v2, 4, v6
  v_add_u32 v7, 8192, v6
  s_lshl_b32 s23, s14, 2
  v_lshlrev_b32 v8, 4, v2
  v_add_u32 v9, s23, v8
  v_mov_b32 v5, 1
  s_mov_b32 s21, 0x00003f80
  s_mov_b32 s22, 0x3f800000
c3top_312:
  s_lshl_b32 s19, s16, 16
  s_lshl_b32 s23, s14, 14
  s_add_u32 s19, s19, s23
  s_lshl_b32 s23, s17, 6
  s_add_u32 s19, s19, s23
  s_lshl_b32 s20, s16, 16
  s_lshl_b32 s23, s17, 13
  s_add_u32 s20, s20, s23
  s_lshl_b32 s23, s14, 9
  s_add_u32 s20, s20, s23
  buffer_load_dwordx4 v[16:19], v4, s[8:11], s20 offen offset:0
  buffer_load_dwordx4 v[20:23], v4, s[8:11], s20 offen offset:256
  s_lshl_b32 s18, s16, 6
  s_add_u32 s18, s18, 8192
cw_313:
  buffer_load_dword v10, off, s[4:7], s18 sc1
  s_waitcnt vmcnt(0)
  v_readfirstlane_b32 s24, v10
  s_cmp_ge_u32 s24, 32
  s_cbranch_scc1 cwok_314
  s_cmp_eq_u32 s29, 0
  s_cbranch_scc1 cwok_314
  s_sub_u32 s29, s29, 1
  s_branch cw_313
cwok_314:
  s_add_u32 s23, s19, 100663296
  buffer_load_dwordx4 v[32:35], v6, s[4:7], s23 offen sc1
  buffer_load_dwordx4 v[36:39], v7, s[4:7], s23 offen sc1
  s_add_u32 s23, s19, 104857600
  buffer_load_dwordx4 v[40:43], v6, s[4:7], s23 offen sc1
  buffer_load_dwordx4 v[44:47], v7, s[4:7], s23 offen sc1
  s_add_u32 s23, s19, 109051904
  buffer_load_dwordx4 v[48:51], v6, s[4:7], s23 offen sc1
  buffer_load_dwordx4 v[52:55], v7, s[4:7], s23 offen sc1
  s_add_u32 s23, s19, 113246208
  buffer_load_dwordx4 v[56:59], v6, s[4:7], s23 offen sc1
  buffer_load_dwordx4 v[60:63], v7, s[4:7], s23 offen sc1
  v_and_b32 v97, 0xffff0000, v16
  v_lshlrev_b32 v96, 16, v16
  v_and_b32 v99, 0xffff0000, v17
  v_lshlrev_b32 v98, 16, v17
  v_and_b32 v101, 0xffff0000, v18
  v_lshlrev_b32 v100, 16, v18
  v_and_b32 v103, 0xffff0000, v19
  v_lshlrev_b32 v102, 16, v19
  v_and_b32 v105, 0xffff0000, v20
  v_lshlrev_b32 v104, 16, v20
  v_and_b32 v107, 0xffff0000, v21
  v_lshlrev_b32 v106, 16, v21
  v_and_b32 v109, 0xffff0000, v22
  v_lshlrev_b32 v108, 16, v22
  v_and_b32 v111, 0xffff0000, v23
  v_lshlrev_b32 v110, 16, v23
  s_waitcnt vmcnt(6)
  v_dot2c_f32_bf16 v96, s21, v32
  v_dot2c_f32_bf16 v97, s22, v32
  v_dot2c_f32_bf16 v98, s21, v33
  v_dot2c_f32_bf16 v99, s22, v33
  v_dot2c_f32_bf16 v100, s21, v34
  v_dot2c_f32_bf16 v101, s22, v34
  v_dot2c_f32_bf16 v102, s21, v35
  v_dot2c_f32_bf16 v103, s22, v35
  v_dot2c_f32_bf16 v104, s21, v36
  v_dot2c_f32_bf16 v105, s22, v36
  v_dot2c_f32_bf16 v106, s21, v37
  v_dot2c_f32_bf16 v107, s22, v37
  v_dot2c_f32_bf16 v108, s21, v38
  v_dot2c_f32_bf16 v109, s22, v38
  v_dot2c_f32_bf16 v110, s21, v39
  v_dot2c_f32_bf16 v111, s22, v39
  s_waitcnt vmcnt(4)
  v_dot2c_f32_bf16 v96, s21, v40
  v_dot2c_f32_bf16 v97, s22, v40
  v_dot2c_f32_bf16 v98, s21, v41
  v_dot2c_f32_bf16 v99, s22, v41
  v_dot2c_f32_bf16 v100, s21, v42
  v_dot2c_f32_bf16 v101, s22, v42
  v_dot2c_f32_bf16 v102, s21, v43
  v_dot2c_f32_bf16 v103, s22, v43
  v_dot2c_f32_bf16 v104, s21, v44
  v_dot2c_f32_bf16 v105, s22, v44
  v_dot2c_f32_bf16 v106, s21, v45
  v_dot2c_f32_bf16 v107, s22, v45
  v_dot2c_f32_bf16 v108, s21, v46
  v_dot2c_f32_bf16 v109, s22, v46
  v_dot2c_f32_bf16 v110, s21, v47
  v_dot2c_f32_bf16 v111, s22, v47
  s_waitcnt vmcnt(2)
  v_dot2c_f32_bf16 v96, s21, v48
  v_dot2c_f32_bf16 v97, s22, v48
  v_dot2c_f32_bf16 v98, s21, v49
  v_dot2c_f32_bf16 v99, s22, v49
  v_dot2c_f32_bf16 v100, s21, v50
  v_dot2c_f32_bf16 v101, s22, v50
  v_dot2c_f32_bf16 v102, s21, v51
  v_dot2c_f32_bf16 v103, s22, v51
  v_dot2c_f32_bf16 v104, s21, v52
  v_dot2c_f32_bf16 v105, s22, v52
  v_dot2c_f32_bf16 v106, s21, v53
  v_dot2c_f32_bf16 v107, s22, v53
  v_dot2c_f32_bf16 v108, s21, v54
  v_dot2c_f32_bf16 v109, s22, v54
  v_dot2c_f32_bf16 v110, s21, v55
  v_dot2c_f32_bf16 v111, s22, v55
  s_waitcnt vmcnt(0)
  v_dot2c_f32_bf16 v96, s21, v56
  v_dot2c_f32_bf16 v97, s22, v56
  v_dot2c_f32_bf16 v98, s21, v57
  v_dot2c_f32_bf16 v99, s22, v57
  v_dot2c_f32_bf16 v100, s21, v58
  v_dot2c_f32_bf16 v101, s22, v58
  v_dot2c_f32_bf16 v102, s21, v59
  v_dot2c_f32_bf16 v103, s22, v59
  v_dot2c_f32_bf16 v104, s21, v60
  v_dot2c_f32_bf16 v105, s22, v60
  v_dot2c_f32_bf16 v106, s21, v61
  v_dot2c_f32_bf16 v107, s22, v61
  v_dot2c_f32_bf16 v108, s21, v62
  v_dot2c_f32_bf16 v109, s22, v62
  v_dot2c_f32_bf16 v110, s21, v63
  v_dot2c_f32_bf16 v111, s22, v63
  v_cvt_pk_bf16_f32 v16, v96, v97
  v_cvt_pk_bf16_f32 v17, v98, v99
  v_cvt_pk_bf16_f32 v18, v100, v101
  v_cvt_pk_bf16_f32 v19, v102, v103
  v_cvt_pk_bf16_f32 v20, v104, v105
  v_cvt_pk_bf16_f32 v21, v106, v107
  v_cvt_pk_bf16_f32 v22, v108, v109
  v_cvt_pk_bf16_f32 v23, v110, v111
  s_add_u32 s23, s19, 25165824
  buffer_store_dwordx4 v[16:19], v6, s[4:7], s23 offen sc1
  buffer_store_dwordx4 v[20:23], v7, s[4:7], s23 offen sc1
  v_pk_add_f32 v[128:129], v[96:97], v[98:99]
  v_pk_add_f32 v[130:131], v[100:101], v[102:103]
  v_pk_add_f32 v[128:129], v[128:129], v[104:105]
  v_pk_add_f32 v[130:131], v[130:131], v[106:107]
  v_pk_add_f32 v[128:129], v[128:129], v[108:109]
  v_pk_add_f32 v[130:131], v[130:131], v[110:111]
  v_pk_add_f32 v[128:129], v[128:129], v[130:131]
  v_add_f32 v128, v128, v129
  s_nop 1
  v_add_f32_dpp v129, v128, v128 row_ror:4 row_mask:0xf bank_mask:0xf
  s_nop 1
  v_add_f32_dpp v128, v129, v129 row_ror:8 row_mask:0xf bank_mask:0xf
  v_mov_b32 v129, v128
  s_nop 1
  v_permlane16_swap_b32 v128, v129
  v_add_f32 v128, v128, v129
  v_mov_b32 v129, v128
  s_nop 1
  v_permlane32_swap_b32 v128, v129
  v_add_f32 v128, v128, v129
  s_mov_b64 exec, 15
  ds_write_b32 v9, v128 offset:0
  s_mov_b64 exec, -1
  s_waitcnt lgkmcnt(0)
  s_barrier
  ds_read_b128 v[132:135], v8 offset:0
  s_waitcnt lgkmcnt(0)
  v_pk_add_f32 v[132:133], v[132:133], v[134:135]
  v_add_f32 v128, v132, v133
  v_mul_f32 v128, 0x3a800000, v128
  v_pk_add_f32 v[96:97], v[96:97], v[128:129] op_sel_hi:[1,0] neg_lo:[0,1] neg_hi:[0,1]
  v_pk_add_f32 v[98:99], v[98:99], v[128:129] op_sel_hi:[1,0] neg_lo:[0,1] neg_hi:[0,1]
  v_pk_add_f32 v[100:101], v[100:101], v[128:129] op_sel_hi:[1,0] neg_lo:[0,1] neg_hi:[0,1]
  v_pk_add_f32 v[102:103], v[102:103], v[128:129] op_sel_hi:[1,0] neg_lo:[0,1] neg_hi:[0,1]
  v_pk_add_f32 v[104:105], v[104:105], v[128:129] op_sel_hi:[1,0] neg_lo:[0,1] neg_hi:[0,1]
  v_pk_add_f32 v[106:107], v[106:107], v[128:129] op_sel_hi:[1,0] neg_lo:[0,1] neg_hi:[0,1]
  v_pk_add_f32 v[108:109], v[108:109], v[128:129] op_sel_hi:[1,0] neg_lo:[0,1] neg_hi:[0,1]
  v_pk_add_f32 v[110:111], v[110:111], v[128:129] op_sel_hi:[1,0] neg_lo:[0,1] neg_hi:[0,1]
  v_pk_mul_f32 v[128:129], v[96:97], v[96:97]
  v_pk_mul_f32 v[130:131], v[98:99], v[98:99]
  v_pk_fma_f32 v[128:129], v[100:101], v[100:101], v[128:129]
  v_pk_fma_f32 v[130:131], v[102:103], v[102:103], v[130:131]
  v_pk_fma_f32 v[128:129], v[104:105], v[104:105], v[128:129]
  v_pk_fma_f32 v[130:131], v[106:107], v[106:107], v[130:131]
  v_pk_fma_f32 v[128:129], v[108:109], v[108:109], v[128:129]
  v_pk_fma_f32 v[130:131], v[110:111], v[110:111], v[130:131]
  v_pk_add_f32 v[128:129], v[128:129], v[130:131]
  v_add_f32 v128, v128, v129
  s_nop 1
  v_add_f32_dpp v129, v128, v128 row_ror:4 row_mask:0xf bank_mask:0xf
  s_nop 1
  v_add_f32_dpp v128, v129, v129 row_ror:8 row_mask:0xf bank_mask:0xf
  v_mov_b32 v129, v128
  s_nop 1
  v_permlane16_swap_b32 v128, v129
  v_add_f32 v128, v128, v129
  v_mov_b32 v129, v128
  s_nop 1
  v_permlane32_swap_b32 v128, v129
  v_add_f32 v128, v128, v129
  s_mov_b64 exec, 15
  ds_write_b32 v9, v128 offset:64
  s_mov_b64 exec, -1
  s_waitcnt lgkmcnt(0)
  s_barrier
  ds_read_b128 v[132:135], v8 offset:64
  s_waitcnt lgkmcnt(0)
  v_pk_add_f32 v[132:133], v[132:133], v[134:135]
  v_add_f32 v128, v132, v133
  v_mov_b32 v129, 0x3727c5ac
  v_fmac_f32 v129, 0x3a800000, v128
  v_rsq_f32 v128, v129
  s_nop 0
  v_pk_mul_f32 v[96:97], v[96:97], v[128:129] op_sel_hi:[1,0]
  v_pk_mul_f32 v[98:99], v[98:99], v[128:129] op_sel_hi:[1,0]
  v_pk_mul_f32 v[100:101], v[100:101], v[128:129] op_sel_hi:[1,0]
  v_pk_mul_f32 v[102:103], v[102:103], v[128:129] op_sel_hi:[1,0]
  v_pk_mul_f32 v[104:105], v[104:105], v[128:129] op_sel_hi:[1,0]
  v_pk_mul_f32 v[106:107], v[106:107], v[128:129] op_sel_hi:[1,0]
  v_pk_mul_f32 v[108:109], v[108:109], v[128:129] op_sel_hi:[1,0]
  v_pk_mul_f32 v[110:111], v[110:111], v[128:129] op_sel_hi:[1,0]
  v_cvt_pk_bf16_f32 v32, v96, v97
  v_cvt_pk_bf16_f32 v33, v98, v99
  v_cvt_pk_bf16_f32 v34, v100, v101
  v_cvt_pk_bf16_f32 v35, v102, v103
  v_cvt_pk_bf16_f32 v36, v104, v105
  v_cvt_pk_bf16_f32 v37, v106, v107
  v_cvt_pk_bf16_f32 v38, v108, v109
  v_cvt_pk_bf16_f32 v39, v110, v111
  s_add_u32 s23, s19, 29360128
  buffer_store_dwordx4 v[32:35], v6, s[4:7], s23 offen sc1
  buffer_store_dwordx4 v[36:39], v7, s[4:7], s23 offen sc1
  s_waitcnt vmcnt(0)
  s_barrier
  s_cmp_lg_u32 s14, 0
  s_cbranch_scc1 c3s_315
  s_lshl_b32 s23, s16, 6
  s_add_u32 s23, s23, 12288
  s_mov_b64 exec, 1
  buffer_atomic_add v5, off, s[4:7], s23 sc1
  s_mov_b64 exec, -1
c3s_315:
  s_add_u32 s16, s16, 3
  s_cmp_lt_u32 s16, 64
  s_cbranch_scc1 c3top_312
  s_waitcnt vmcnt(0)
  s_branch k_dump_2
rc5_311:
  s_sub_u32 s43, s43, 16
  s_load_dwordx2 s[8:9], s[0:1], 88
  s_waitcnt lgkmcnt(0)
  s_mov_b32 s10, 4194304
  s_mov_b32 s11, 0x00020000
  s_lshr_b32 s16, s43, 3
  s_and_b32 s17, s43, 7
  v_and_b32 v1, 63, v0
  v_and_b32 v2, 3, v1
  v_lshrrev_b32 v3, 2, v1
  v_lshlrev_b32 v4, 11, v2
  v_lshl_add_u32 v4, v3, 4, v4
  v_lshlrev_b32 v6, 9, v3
  v_lshl_add_u32 v6, v2, 4, v6
  v_add_u32 v7, 8192, v6
  s_lshl_b32 s23, s14, 2
  v_lshlrev_b32 v8, 4, v2
  v_add_u32 v9, s23, v8
  v_mov_b32 v5, 1
  s_mov_b32 s21, 0x00003f80
  s_mov_b32 s22, 0x3f800000
c5top_316:
  s_lshl_b32 s19, s16, 16
  s_lshl_b32 s23, s14, 14
  s_add_u32 s19, s19, s23
  s_lshl_b32 s23, s17, 6
  s_add_u32 s19, s19, s23
  s_lshl_b32 s20, s16, 16
  s_lshl_b32 s23, s17, 13
  s_add_u32 s20, s20, s23
  s_lshl_b32 s23, s14, 9
  s_add_u32 s20, s20, s23
  s_lshl_b32 s18, s16, 6
  s_add_u32 s18, s18, 12288
cw_317:
  buffer_load_dword v10, off, s[4:7], s18 sc1
  s_waitcnt vmcnt(0)
  v_readfirstlane_b32 s24, v10
  s_cmp_ge_u32 s24, 8
  s_cbranch_scc1 cwok_318
  s_cmp_eq_u32 s29, 0
  s_cbranch_scc1 cwok_318
  s_sub_u32 s29, s29, 1
  s_branch cw_317
cwok_318:
  s_add_u32 s23, s19, 25165824
  buffer_load_dwordx4 v[16:19], v6, s[4:7], s23 offen sc1
  buffer_load_dwordx4 v[20:23], v7, s[4:7], s23 offen sc1
  s_cmp_lt_u32 s16, 63
  s_cbranch_scc1 cwp_319
  s_lshl_b32 s18, s16, 6
  s_add_u32 s18, s18, 16384
cw_323:
  buffer_load_dword v10, off, s[4:7], s18 sc1
  s_waitcnt vmcnt(0)
  v_readfirstlane_b32 s24, v10
  s_cmp_ge_u32 s24, 1
  s_cbranch_scc1 cwok_324
  s_cmp_eq_u32 s29, 0
  s_cbranch_scc1 cwok_324
  s_sub_u32 s29, s29, 1
  s_branch cw_323
cwok_324:
cwl_321:
  s_add_u32 s23, s19, 134217728
  buffer_load_dwordx4 v[32:35], v6, s[4:7], s23 offen sc1
  buffer_load_dwordx4 v[36:39], v7, s[4:7], s23 offen sc1
  s_add_u32 s23, s19, 138412032
  buffer_load_dwordx4 v[40:43], v6, s[4:7], s23 offen sc1
  buffer_load_dwordx4 v[44:47], v7, s[4:7], s23 offen sc1
  s_add_u32 s23, s19, 142606336
  buffer_load_dwordx4 v[48:51], v6, s[4:7], s23 offen sc1
  buffer_load_dwordx4 v[52:55], v7, s[4:7], s23 offen sc1
  s_add_u32 s23, s19, 146800640
  buffer_load_dwordx4 v[56:59], v6, s[4:7], s23 offen sc1
  buffer_load_dwordx4 v[60:63], v7, s[4:7], s23 offen sc1
  buffer_load_dword v10, off, s[4:7], s18 sc1
  s_waitcnt vmcnt(7)
  v_max3_u32 v11, v32, v33, v34
  v_max_u32 v11, v11, v35
  v_max3_u32 v11, v11, v36, v37
  v_max3_u32 v11, v11, v38, v39
  s_waitcnt vmcnt(5)
  v_max3_u32 v11, v11, v40, v41
  v_max3_u32 v11, v11, v42, v43
  v_max3_u32 v11, v11, v44, v45
  v_max3_u32 v11, v11, v46, v47
  s_waitcnt vmcnt(3)
  v_max3_u32 v11, v11, v48, v49
  v_max3_u32 v11, v11, v50, v51
  v_max3_u32 v11, v11, v52, v53
  v_max3_u32 v11, v11, v54, v55
  s_waitcnt vmcnt(1)
  v_max3_u32 v11, v11, v56, v57
  v_max3_u32 v11, v11, v58, v59
  v_max3_u32 v11, v11, v60, v61
  v_max3_u32 v11, v11, v62, v63
  v_cmp_eq_u32 vcc, -1, v11
  s_cbranch_vccz cwj_320
  s_waitcnt vmcnt(0)
  v_readfirstlane_b32 s24, v10
  s_cmp_lt_u32 s24, 32
  s_cbranch_scc1 cwn_322
  s_add_u32 s23, s19, 134217728
  buffer_load_dwordx4 v[32:35], v6, s[4:7], s23 offen sc1
  buffer_load_dwordx4 v[36:39], v7, s[4:7], s23 offen sc1
  s_add_u32 s23, s19, 138412032
  buffer_load_dwordx4 v[40:43], v6, s[4:7], s23 offen sc1
  buffer_load_dwordx4 v[44:47], v7, s[4:7], s23 offen sc1
  s_add_u32 s23, s19, 142606336
  buffer_load_dwordx4 v[48:51], v6, s[4:7], s23 offen sc1
  buffer_load_dwordx4 v[52:55], v7, s[4:7], s23 offen sc1
  s_add_u32 s23, s19, 146800640
  buffer_load_dwordx4 v[56:59], v6, s[4:7], s23 offen sc1
  buffer_load_dwordx4 v[60:63], v7, s[4:7], s23 offen sc1
  s_branch cwj_320
cwn_322:
  s_cmp_eq_u32 s29, 0
  s_cbranch_scc1 cwj_320
  s_sub_u32 s29, s29, 1
  s_branch cwl_321
cwp_319:
  s_lshl_b32 s18, s16, 6
  s_add_u32 s18, s18, 16384
cw_325:
  buffer_load_dword v10, off, s[4:7], s18 sc1
  s_waitcnt vmcnt(0)
  v_readfirstlane_b32 s24, v10
  s_cmp_ge_u32 s24, 32
  s_cbranch_scc1 cwok_326
  s_cmp_eq_u32 s29, 0
  s_cbranch_scc1 cwok_326
  s_sub_u32 s29, s29, 1
  s_branch cw_325
cwok_326:
  s_add_u32 s23, s19, 134217728
  buffer_load_dwordx4 v[32:35], v6, s[4:7], s23 offen sc1
  buffer_load_dwordx4 v[36:39], v7, s[4:7], s23 offen sc1
  s_add_u32 s23, s19, 138412032
  buffer_load_dwordx4 v[40:43], v6, s[4:7], s23 offen sc1
  buffer_load_dwordx4 v[44:47], v7, s[4:7], s23 offen sc1
  s_add_u32 s23, s19, 142606336
  buffer_load_dwordx4 v[48:51], v6, s[4:7], s23 offen sc1
  buffer_load_dwordx4 v[52:55], v7, s[4:7], s23 offen sc1
  s_add_u32 s23, s19, 146800640
  buffer_load_dwordx4 v[56:59], v6, s[4:7], s23 offen sc1
  buffer_load_dwordx4 v[60:63], v7, s[4:7], s23 offen sc1
cwj_320:
  v_and_b32 v97, 0xffff0000, v16
  v_lshlrev_b32 v96, 16, v16
  v_and_b32 v99, 0xffff0000, v17
  v_lshlrev_b32 v98, 16, v17
  v_and_b32 v101, 0xffff0000, v18
  v_lshlrev_b32 v100, 16, v18
  v_and_b32 v103, 0xffff0000, v19
  v_lshlrev_b32 v102, 16, v19
  v_and_b32 v105, 0xffff0000, v20
  v_lshlrev_b32 v104, 16, v20
  v_and_b32 v107, 0xffff0000, v21
  v_lshlrev_b32 v106, 16, v21
  v_and_b32 v109, 0xffff0000, v22
  v_lshlrev_b32 v108, 16, v22
  v_and_b32 v111, 0xffff0000, v23
  v_lshlrev_b32 v110, 16, v23
  s_waitcnt vmcnt(6)
  v_dot2c_f32_bf16 v96, s21, v32
  v_dot2c_f32_bf16 v97, s22, v32
  v_dot2c_f32_bf16 v98, s21, v33
  v_dot2c_f32_bf16 v99, s22, v33
  v_dot2c_f32_bf16 v100, s21, v34
  v_dot2c_f32_bf16 v101, s22, v34
  v_dot2c_f32_bf16 v102, s21, v35
  v_dot2c_f32_bf16 v103, s22, v35
  v_dot2c_f32_bf16 v104, s21, v36
  v_dot2c_f32_bf16 v105, s22, v36
  v_dot2c_f32_bf16 v106, s21, v37
  v_dot2c_f32_bf16 v107, s22, v37
  v_dot2c_f32_bf16 v108, s21, v38
  v_dot2c_f32_bf16 v109, s22, v38
  v_dot2c_f32_bf16 v110, s21, v39
  v_dot2c_f32_bf16 v111, s22, v39
  s_waitcnt vmcnt(4)
  v_dot2c_f32_bf16 v96, s21, v40
  v_dot2c_f32_bf16 v97, s22, v40
  v_dot2c_f32_bf16 v98, s21, v41
  v_dot2c_f32_bf16 v99, s22, v41
  v_dot2c_f32_bf16 v100, s21, v42
  v_dot2c_f32_bf16 v101, s22, v42
  v_dot2c_f32_bf16 v102, s21, v43
  v_dot2c_f32_bf16 v103, s22, v43
  v_dot2c_f32_bf16 v104, s21, v44
  v_dot2c_f32_bf16 v105, s22, v44
  v_dot2c_f32_bf16 v106, s21, v45
  v_dot2c_f32_bf16 v107, s22, v45
  v_dot2c_f32_bf16 v108, s21, v46
  v_dot2c_f32_bf16 v109, s22, v46
  v_dot2c_f32_bf16 v110, s21, v47
  v_dot2c_f32_bf16 v111, s22, v47
  s_waitcnt vmcnt(2)
  v_dot2c_f32_bf16 v96, s21, v48
  v_dot2c_f32_bf16 v97, s22, v48
  v_dot2c_f32_bf16 v98, s21, v49
  v_dot2c_f32_bf16 v99, s22, v49
  v_dot2c_f32_bf16 v100, s21, v50
  v_dot2c_f32_bf16 v101, s22, v50
  v_dot2c_f32_bf16 v102, s21, v51
  v_dot2c_f32_bf16 v103, s22, v51
  v_dot2c_f32_bf16 v104, s21, v52
  v_dot2c_f32_bf16 v105, s22, v52
  v_dot2c_f32_bf16 v106, s21, v53
  v_dot2c_f32_bf16 v107, s22, v53
  v_dot2c_f32_bf16 v108, s21, v54
  v_dot2c_f32_bf16 v109, s22, v54
  v_dot2c_f32_bf16 v110, s21, v55
  v_dot2c_f32_bf16 v111, s22, v55
  s_waitcnt vmcnt(0)
  v_dot2c_f32_bf16 v96, s21, v56
  v_dot2c_f32_bf16 v97, s22, v56
  v_dot2c_f32_bf16 v98, s21, v57
  v_dot2c_f32_bf16 v99, s22, v57
  v_dot2c_f32_bf16 v100, s21, v58
  v_dot2c_f32_bf16 v101, s22, v58
  v_dot2c_f32_bf16 v102, s21, v59
  v_dot2c_f32_bf16 v103, s22, v59
  v_dot2c_f32_bf16 v104, s21, v60
  v_dot2c_f32_bf16 v105, s22, v60
  v_dot2c_f32_bf16 v106, s21, v61
  v_dot2c_f32_bf16 v107, s22, v61
  v_dot2c_f32_bf16 v108, s21, v62
  v_dot2c_f32_bf16 v109, s22, v62
  v_dot2c_f32_bf16 v110, s21, v63
  v_dot2c_f32_bf16 v111, s22, v63
  v_cvt_pk_bf16_f32 v16, v96, v97
  v_cvt_pk_bf16_f32 v17, v98, v99
  v_cvt_pk_bf16_f32 v18, v100, v101
  v_cvt_pk_bf16_f32 v19, v102, v103
  v_cvt_pk_bf16_f32 v20, v104, v105
  v_cvt_pk_bf16_f32 v21, v106, v107
  v_cvt_pk_bf16_f32 v22, v108, v109
  v_cvt_pk_bf16_f32 v23, v110, v111
  buffer_store_dwordx4 v[16:19], v4, s[8:11], s20 offen offset:0
  buffer_store_dwordx4 v[20:23], v4, s[8:11], s20 offen offset:256
  s_add_u32 s16, s16, 2
  s_cmp_lt_u32 s16, 64
  s_cbranch_scc1 c5top_316
  s_waitcnt vmcnt(0)
k_dump_2:
k_exit_1:
  s_endpgm
.section .rodata,"a"
.p2align 6
.amdhsa_kernel sequential_preLN__memory_aug_recurrent_mem_tr__glu_gated_swiglu__prompt_kernel
  .amdhsa_next_free_vgpr 512
  .amdhsa_next_free_sgpr 102
  .amdhsa_accum_offset 256
  .amdhsa_group_segment_fixed_size 0
  .amdhsa_kernarg_size 112
  .amdhsa_user_sgpr_count 2
  .amdhsa_user_sgpr_kernarg_segment_ptr 1
  .amdhsa_system_sgpr_workgroup_id_x 1
.end_amdhsa_kernel
```
